```python
import torch

def _softmax(x, axis=-1):
    return torch.softmax(x, dim=axis)
def _gelu(x):
    return torch.nn.functional.gelu(x, approximate="tanh")
def _silu(x):
    return torch.nn.functional.silu(x)
def _sigmoid(x):
    return torch.sigmoid(x)
def _layernorm(x, axis=-1, eps=1e-5):
    m = x.mean(dim=axis, keepdim=True)
    v = x.var(dim=axis, keepdim=True, unbiased=False)
    return (x - m) / torch.sqrt(v + eps)
def _scatter_add(tgt, idx, src, axis=0):
    return tgt.clone().index_add_(axis, idx, src)
def _segment_sum(src, seg, n):
    out = torch.zeros((n,) + src.shape[1:], dtype=src.dtype)
    return out.index_add_(0, seg, src)
def _pad(x, pw):
    flat = tuple(v for pair in reversed(pw) for v in pair)
    return torch.nn.functional.pad(x, flat)

kernel_name = 'standalone__mha_block_cached__near_ridge'

def setup_inputs():

    _w = (lambda a: (lambda t: t.to(torch.bfloat16) if t.is_floating_point() else t)(torch.as_tensor(a)))
    B, Sq, D = 16, 192, 576
    H, Sk, Dh = 32, 1024, 128
    return {
        "x": _w((lambda *s: torch.randn(*s, dtype=torch.bfloat16) * 0.8)(B, Sq, D)),
        "k_cache": _w((lambda *s: torch.randn(*s, dtype=torch.bfloat16) * 0.8)(B, H, Sk, Dh)),
        "v_cache": _w((lambda *s: torch.randn(*s, dtype=torch.bfloat16) * 0.05)(B, H, Sk, Dh)),
        "wq": _w((lambda *s: torch.randn(*s, dtype=torch.bfloat16) * 0.8)(D, H * Dh) * (D ** -0.5)),
        "wo": _w((lambda *s: torch.randn(*s, dtype=torch.bfloat16) * 0.05)(H * Dh, D) * ((H * Dh) ** -0.5)),
    }

def reference(x, k_cache, v_cache, wq, wo):
    B, Sq, D = x.shape
    H, Dh = 32, 128
    q = (lambda x, *d: x.permute(*d))((x @ wq).reshape(B, Sq, H, Dh), 0, 2, 1, 3)
    scores = torch.einsum("bhqd,bhkd->bhqk", q, k_cache) * (Dh ** -0.5)
    p = _softmax(scores, axis=-1)
    o = torch.einsum("bhqk,bhkd->bhqd", p, v_cache)
    return (lambda x, *d: x.permute(*d))(o, 0, 2, 1, 3).reshape(B, Sq, H * Dh) @ wo
```

```asm
; @launch grid=(256,1,1) block=(256,1,1) lds=163840
.amdgcn_target "amdgcn-amd-amdhsa--gfx950"
.text
.globl standalone__mha_block_cached__near_ridge_kernel
.p2align 8
.type standalone__mha_block_cached__near_ridge_kernel,@function
standalone__mha_block_cached__near_ridge_kernel:
    s_cmp_ge_u32 s2, 256
    s_cbranch_scc1 L_end
    s_load_dwordx16 s[4:19], s[0:1], 0
    s_getpc_b64 s[36:37]
L_pc:
    s_lshr_b32 s72, s2, 3
    s_and_b32 s72, s72, 15
    s_lshl_b32 s72, s72, 7
    v_lshrrev_b32 v8, 2, v0
    v_lshlrev_b32 v8, 11, v8
    v_add_u32 v8, s72, v8
    v_min_u32 v8, L_last-L_pc, v8
    v_mov_b32 v9, s37
    v_add_co_u32 v8, vcc, s36, v8
    s_nop 1
    v_addc_co_u32 v9, vcc, 0, v9, vcc
    global_load_dword v8, v[8:9], off
    v_lshrrev_b32 v7, 6, v0
    v_and_b32 v0, 63, v0
    v_readfirstlane_b32 s48, v7
    s_and_b32 s72, s2, 7
    s_lshr_b32 s73, s2, 3
    s_and_b32 s49, s72, 1
    s_lshl_b32 s49, s49, 3
    s_and_b32 s74, s73, 7
    s_add_u32 s49, s49, s74
    s_lshr_b32 s54, s72, 1
    s_lshr_b32 s55, s73, 3
    s_lshl_b32 s50, s54, 2
    s_add_u32 s50, s50, s55
    s_lshr_b32 s51, s48, 1
    s_and_b32 s52, s48, 1
    s_lshl_b32 s53, s50, 1
    s_add_u32 s53, s53, s51
    v_lshrrev_b32 v16, 4, v0
    v_bfe_u32 v17, v0, 2, 2
    v_and_b32 v18, 3, v0
    v_lshlrev_b32 v14, 4, v0
    v_xor_b32 v11, v18, v16
    v_and_b32 v19, 4, v0
    v_or_b32 v11, v11, v19
    v_lshlrev_b32 v11, 4, v11
    v_lshrrev_b32 v19, 3, v0
    v_mul_u32_u24 v19, 1152, v19
    v_add_u32 v11, v11, v19
    s_mul_i32 s72, s48, 55296
    s_mul_i32 s73, s49, 221184
    s_add_u32 s72, s72, s73
    v_add_u32 v11, s72, v11
    s_mul_i32 s60, s48, 6528
    s_add_u32 s60, s60, 81920
    v_lshlrev_b32 v1, 4, v18
    v_lshl_add_u32 v1, v16, 6, v1
    v_lshl_add_u32 v10, v17, 13, v1
    s_lshl_b32 s72, s52, 15
    s_lshl_b32 s73, s53, 8
    s_add_u32 s72, s72, s73
    v_add_u32 v10, s72, v10
    s_lshl_b32 s59, s48, 12
    s_add_u32 s59, s59, 32768
    s_lshl_b32 s72, s52, 12
    s_lshl_b32 s58, s51, 14
    s_add_u32 s58, s58, s72
    v_lshl_add_u32 v1, v17, 8, v1
    v_add_u32 v1, s72, v1
    v_xor_b32 v2, 32, v1
    s_waitcnt lgkmcnt(0)
    s_mov_b32 s20, s4
    s_mov_b32 s21, s5
    s_mov_b32 s22, 3538944
    s_mov_b32 s23, 0x20000
    s_mov_b32 s24, s10
    s_mov_b32 s25, s11
    s_mov_b32 s26, 4718592
    s_mov_b32 s27, 0x20000
    s_add_u32 m0, s60, 0
    s_mov_b32 s72, 0
    buffer_load_dwordx4 v11, s[20:23], s72 offen lds
    s_add_u32 m0, s60, 1088
    s_mov_b32 s72, 9216
    buffer_load_dwordx4 v11, s[20:23], s72 offen lds
    s_add_u32 m0, s60, 2176
    s_mov_b32 s72, 18432
    buffer_load_dwordx4 v11, s[20:23], s72 offen lds
    s_add_u32 m0, s60, 3264
    s_mov_b32 s72, 27648
    buffer_load_dwordx4 v11, s[20:23], s72 offen lds
    s_add_u32 m0, s60, 4352
    s_mov_b32 s72, 36864
    buffer_load_dwordx4 v11, s[20:23], s72 offen lds
    s_add_u32 m0, s60, 5440
    s_mov_b32 s72, 46080
    buffer_load_dwordx4 v11, s[20:23], s72 offen lds
    s_add_u32 m0, s59, 0
    s_mov_b32 s72, 0
    buffer_load_dwordx4 v10, s[24:27], s72 offen lds
    s_add_u32 m0, s59, 1024
    s_mov_b32 s72, 65536
    buffer_load_dwordx4 v10, s[24:27], s72 offen lds
    s_add_u32 m0, s59, 2048
    s_mov_b32 s72, 131072
    buffer_load_dwordx4 v10, s[24:27], s72 offen lds
    s_add_u32 m0, s59, 3072
    s_mov_b32 s72, 196608
    buffer_load_dwordx4 v10, s[24:27], s72 offen lds
    s_add_u32 m0, s59, 16384
    s_mov_b32 s72, 262144
    buffer_load_dwordx4 v10, s[24:27], s72 offen lds
    s_add_u32 m0, s59, 17408
    s_mov_b32 s72, 327680
    buffer_load_dwordx4 v10, s[24:27], s72 offen lds
    s_add_u32 m0, s59, 18432
    s_mov_b32 s72, 393216
    buffer_load_dwordx4 v10, s[24:27], s72 offen lds
    s_add_u32 m0, s59, 19456
    s_mov_b32 s72, 458752
    buffer_load_dwordx4 v10, s[24:27], s72 offen lds
    s_lshl_b32 s72, s49, 5
    s_add_u32 s72, s72, s53
    s_lshl_b32 s72, s72, 18
    s_add_u32 s28, s6, s72
    s_addc_u32 s29, s7, 0
    s_mov_b32 s30, 262144
    s_mov_b32 s31, 0x20000
    s_add_u32 s4, s8, s72
    s_addc_u32 s5, s9, 0
    s_mov_b32 s6, 262144
    s_mov_b32 s7, 0x20000
    s_mov_b32 s32, s18
    s_mov_b32 s33, s19
    s_mov_b32 s34, 51380224
    s_mov_b32 s35, 0x20000
    s_mov_b32 s36, s12
    s_mov_b32 s37, s13
    s_mov_b32 s38, 4718592
    s_mov_b32 s39, 0x20000
    s_mov_b32 s40, s14
    s_mov_b32 s41, s15
    s_mov_b32 s42, 3538944
    s_mov_b32 s43, 0x20000
    s_mov_b32 s44, s16
    s_mov_b32 s45, s17
    s_mov_b32 s46, 256
    s_mov_b32 s47, 0x20000
    s_lshl_b32 s56, s52, 1
    s_add_u32 s56, s56, s51
    s_lshl_b32 s57, s49, 4
    s_add_u32 s57, s57, s50
    v_or_b32 v53, s48, v0
    v_min_u32 v53, 1, v53
    v_lshlrev_b32 v53, 30, v53
    v_mov_b32 v56, 0
    v_mov_b32 v57, 0
    v_mov_b32 v58, 0
    v_mov_b32 v59, 0
    v_mov_b32 v55, 0
    s_lshl_b32 s72, s57, 7
    s_add_u32 s72, s72, 50331648
    buffer_store_dwordx4 v[56:59], v53, s[32:35], s72 offen sc1
    v_and_b32 v19, 1, v17
    v_lshlrev_b32 v19, 1, v19
    v_xor_b32 v19, v19, v16
    v_lshlrev_b32 v3, 4, v19
    v_lshl_add_u32 v3, v18, 6, v3
    v_lshl_add_u32 v3, v17, 10, v3
    s_lshl_b32 s72, s51, 14
    v_add_u32 v3, s72, v3
    v_lshlrev_b32 v13, 10, v16
    v_lshl_add_u32 v13, v17, 6, v13
    v_lshl_add_u32 v4, v18, 3, v13
    v_and_b32 v19, 1, v16
    v_lshl_add_u32 v4, v19, 5, v4
    s_add_u32 s72, s72, 8192
    v_add_u32 v4, s72, v4
    v_xor_b32 v5, 32, v4
    s_lshl_b32 s73, s51, 13
    s_add_u32 s73, s73, 32768
    v_lshl_add_u32 v13, v18, 4, v13
    v_add_u32 v13, s73, v13
    v_bfe_u32 v12, v0, 1, 2
    v_xor_b32 v12, v12, v16
    v_lshlrev_b32 v12, 4, v12
    v_and_b32 v19, 7, v0
    v_lshl_add_u32 v12, v19, 7, v12
    v_bfe_u32 v19, v0, 3, 1
    v_mul_u32_u24 v19, 1088, v19
    v_add_u32 v12, v12, v19
    s_mul_i32 s72, s56, 6528
    s_add_u32 s72, s72, 81920
    s_xor_b32 s73, s56, 1
    s_mul_i32 s73, s73, 6528
    s_add_u32 s73, s73, 81920
    v_add_u32 v52, s73, v12
    v_add_u32 v12, s72, v12
    v_mov_b32 v7, 0x3f803f80
    v_accvgpr_write_b32 a216, v7
    v_accvgpr_write_b32 a217, v7
    v_accvgpr_write_b32 a218, v7
    v_accvgpr_write_b32 a219, v7
    s_mov_b32 s62, 0x3e0293ee
    s_mov_b32 s63, 0x3e0293ee
    s_mov_b32 s61, 0x41200000
    v_add_u32 v248, 0x10000, v3
    v_add_u32 v251, 0x20000, v3
    v_add_u32 v249, 0x10000, v4
    v_add_u32 v252, 0x20000, v4
    v_add_u32 v250, 0x10000, v5
    v_add_u32 v253, 0x20000, v5
    v_add_u32 v254, s58, v14
    v_add_u32 v255, 0x10000, v254
    v_add_u32 v15, 0x20000, v254
    s_add_u32 s72, s55, 0
    s_and_b32 s72, s72, 3
    s_lshl_b32 s72, s72, 1
    s_lshl_b32 s73, s54, 3
    s_add_u32 s72, s72, s73
    s_add_u32 s72, s72, s51
    s_lshl_b32 s72, s72, 3
    s_add_u32 s72, s72, s52
    s_mul_i32 s66, s72, 18432
    s_add_u32 s72, s55, 1
    s_and_b32 s72, s72, 3
    s_lshl_b32 s72, s72, 1
    s_lshl_b32 s73, s54, 3
    s_add_u32 s72, s72, s73
    s_add_u32 s72, s72, s51
    s_lshl_b32 s72, s72, 3
    s_add_u32 s72, s72, s52
    s_mul_i32 s67, s72, 18432
    s_add_u32 s72, s55, 2
    s_and_b32 s72, s72, 3
    s_lshl_b32 s72, s72, 1
    s_lshl_b32 s73, s54, 3
    s_add_u32 s72, s72, s73
    s_add_u32 s72, s72, s51
    s_lshl_b32 s72, s72, 3
    s_add_u32 s72, s72, s52
    s_mul_i32 s68, s72, 18432
    s_add_u32 s72, s55, 3
    s_and_b32 s72, s72, 3
    s_lshl_b32 s72, s72, 1
    s_lshl_b32 s73, s54, 3
    s_add_u32 s72, s72, s73
    s_add_u32 s72, s72, s51
    s_lshl_b32 s72, s72, 3
    s_add_u32 s72, s72, s52
    s_mul_i32 s69, s72, 18432
    s_mul_i32 s64, s51, 12288
    s_lshl_b32 s72, s52, 11
    s_add_u32 s64, s64, s72
    s_and_b32 s72, s2, 1
    s_lshl_b32 s72, s72, 7
    s_lshr_b32 s73, s2, 3
    s_lshl_b32 s73, s73, 2
    s_add_u32 s73, s73, s48
    s_add_u32 s72, s72, s73
    s_mul_i32 s72, s72, 13824
    v_min_u32 v6, 11, v0
    v_mul_u32_u24 v6, 1152, v6
    v_add_u32 v6, s72, v6
    s_lshr_b32 s72, s73, 1
    s_lshl_b32 s72, s72, 13
    s_and_b32 s73, s73, 1
    s_lshl_b32 s73, s73, 10
    s_add_u32 s72, s72, s73
    s_lshl_b32 s73, s54, 11
    s_add_u32 s72, s72, s73
    v_and_b32 v9, 7, v0
    v_lshlrev_b32 v9, 7, v9
    v_add_u32 v9, s72, v9
    s_mov_b32 s72, 524288
    buffer_load_dword v8, v9, s[24:27], s72 offen
    buffer_load_dword v8, v6, s[20:23], 0 offen offset:128
    s_add_u32 m0, s59, 32768
    s_mov_b32 s72, 524288
    buffer_load_dwordx4 v10, s[24:27], s72 offen lds
    s_add_u32 m0, s59, 33792
    s_mov_b32 s72, 589824
    buffer_load_dwordx4 v10, s[24:27], s72 offen lds
    s_add_u32 m0, s59, 34816
    s_mov_b32 s72, 655360
    buffer_load_dwordx4 v10, s[24:27], s72 offen lds
    s_add_u32 m0, s59, 35840
    s_mov_b32 s72, 720896
    buffer_load_dwordx4 v10, s[24:27], s72 offen lds
    s_add_u32 m0, s60, 26112
    s_mov_b32 s72, 128
    buffer_load_dwordx4 v11, s[20:23], s72 offen lds
    s_add_u32 m0, s60, 27200
    s_mov_b32 s72, 9344
    buffer_load_dwordx4 v11, s[20:23], s72 offen lds
    s_add_u32 m0, s60, 28288
    s_mov_b32 s72, 18560
    buffer_load_dwordx4 v11, s[20:23], s72 offen lds
    s_add_u32 m0, s60, 29376
    s_mov_b32 s72, 27776
    buffer_load_dwordx4 v11, s[20:23], s72 offen lds
    s_add_u32 m0, s60, 30464
    s_mov_b32 s72, 36992
    buffer_load_dwordx4 v11, s[20:23], s72 offen lds
    s_add_u32 m0, s60, 31552
    s_mov_b32 s72, 46208
    buffer_load_dwordx4 v11, s[20:23], s72 offen lds
    v_add_u32 v16, 64512, v10
    v_add_u32 v17, 129024, v10
    v_add_u32 v18, 193536, v10
    v_add_u32 v19, 8128, v11
    v_add_u32 v54, 16256, v11
    s_waitcnt vmcnt(17)
    s_barrier
    ds_read_b128 a[32:35], v12 offset:0
    ds_read_b128 a[36:39], v12 offset:2176
    ds_read_b128 a[40:43], v12 offset:4352
    ds_read_b128 a[44:47], v52 offset:0
    ds_read_b128 a[48:51], v52 offset:2176
    ds_read_b128 a[52:55], v52 offset:4352
    ds_read_b64_tr_b16 a[0:1], v13 offset:0
    ds_read_b64_tr_b16 a[2:3], v13 offset:4096
    ds_read_b64_tr_b16 a[4:5], v13 offset:8
    ds_read_b64_tr_b16 a[6:7], v13 offset:4104
    ds_read_b64_tr_b16 a[8:9], v13 offset:256
    ds_read_b64_tr_b16 a[10:11], v13 offset:4352
    ds_read_b64_tr_b16 a[12:13], v13 offset:264
    ds_read_b64_tr_b16 a[14:15], v13 offset:4360
    ds_read_b64_tr_b16 a[16:17], v13 offset:512
    ds_read_b64_tr_b16 a[18:19], v13 offset:4608
    ds_read_b64_tr_b16 a[20:21], v13 offset:520
    ds_read_b64_tr_b16 a[22:23], v13 offset:4616
    ds_read_b64_tr_b16 a[24:25], v13 offset:768
    ds_read_b64_tr_b16 a[26:27], v13 offset:4864
    ds_read_b64_tr_b16 a[28:29], v13 offset:776
    ds_read_b64_tr_b16 a[30:31], v13 offset:4872
    s_waitcnt lgkmcnt(0)
    s_waitcnt vmcnt(13)
    s_barrier
    v_mfma_f32_16x16x32_bf16 v[56:59], a[0:3], a[32:35], 0
    buffer_load_dword v8, v6, s[20:23], 0 offen offset:256
    v_mfma_f32_16x16x32_bf16 v[88:91], a[0:3], a[36:39], 0
    s_mov_b32 s72, 1048576
    buffer_load_dword v8, v9, s[24:27], s72 offen
    v_mfma_f32_16x16x32_bf16 v[120:123], a[0:3], a[40:43], 0
    buffer_load_dword v8, v6, s[20:23], 0 offen offset:384
    v_mfma_f32_16x16x32_bf16 v[152:155], a[0:3], a[44:47], 0
    s_mov_b32 s72, 1572864
    buffer_load_dword v8, v9, s[24:27], s72 offen
    v_mfma_f32_16x16x32_bf16 v[184:187], a[0:3], a[48:51], 0
    s_mov_b32 s72, 2097152
    buffer_load_dword v8, v9, s[24:27], s72 offen
    v_mfma_f32_16x16x32_bf16 v[216:219], a[0:3], a[52:55], 0
    buffer_load_dword v8, v6, s[20:23], 0 offen offset:512
    v_mfma_f32_16x16x32_bf16 v[60:63], a[4:7], a[32:35], 0
    v_mfma_f32_16x16x32_bf16 v[92:95], a[4:7], a[36:39], 0
    v_mfma_f32_16x16x32_bf16 v[124:127], a[4:7], a[40:43], 0
    v_mfma_f32_16x16x32_bf16 v[156:159], a[4:7], a[44:47], 0
    ds_read_b128 a[88:91], v12 offset:64
    ds_read_b128 a[92:95], v12 offset:2240
    v_mfma_f32_16x16x32_bf16 v[188:191], a[4:7], a[48:51], 0
    v_mfma_f32_16x16x32_bf16 v[220:223], a[4:7], a[52:55], 0
    ds_read_b128 a[96:99], v12 offset:4416
    ds_read_b128 a[100:103], v52 offset:64
    v_mfma_f32_16x16x32_bf16 v[64:67], a[8:11], a[32:35], 0
    v_mfma_f32_16x16x32_bf16 v[96:99], a[8:11], a[36:39], 0
    ds_read_b128 a[104:107], v52 offset:2240
    ds_read_b128 a[108:111], v52 offset:4416
    v_mfma_f32_16x16x32_bf16 v[128:131], a[8:11], a[40:43], 0
    v_mfma_f32_16x16x32_bf16 v[160:163], a[8:11], a[44:47], 0
    ds_read_b64_tr_b16 a[56:57], v13 offset:16384
    ds_read_b64_tr_b16 a[58:59], v13 offset:20480
    v_mfma_f32_16x16x32_bf16 v[192:195], a[8:11], a[48:51], 0
    v_mfma_f32_16x16x32_bf16 v[224:227], a[8:11], a[52:55], 0
    ds_read_b64_tr_b16 a[60:61], v13 offset:16392
    ds_read_b64_tr_b16 a[62:63], v13 offset:20488
    v_mfma_f32_16x16x32_bf16 v[68:71], a[12:15], a[32:35], 0
    v_mfma_f32_16x16x32_bf16 v[100:103], a[12:15], a[36:39], 0
    ds_read_b64_tr_b16 a[64:65], v13 offset:16640
    ds_read_b64_tr_b16 a[66:67], v13 offset:20736
    v_mfma_f32_16x16x32_bf16 v[132:135], a[12:15], a[40:43], 0
    v_mfma_f32_16x16x32_bf16 v[164:167], a[12:15], a[44:47], 0
    ds_read_b64_tr_b16 a[68:69], v13 offset:16648
    ds_read_b64_tr_b16 a[70:71], v13 offset:20744
    v_mfma_f32_16x16x32_bf16 v[196:199], a[12:15], a[48:51], 0
    v_mfma_f32_16x16x32_bf16 v[228:231], a[12:15], a[52:55], 0
    ds_read_b64_tr_b16 a[72:73], v13 offset:16896
    ds_read_b64_tr_b16 a[74:75], v13 offset:20992
    v_mfma_f32_16x16x32_bf16 v[72:75], a[16:19], a[32:35], 0
    v_mfma_f32_16x16x32_bf16 v[104:107], a[16:19], a[36:39], 0
    ds_read_b64_tr_b16 a[76:77], v13 offset:16904
    ds_read_b64_tr_b16 a[78:79], v13 offset:21000
    v_mfma_f32_16x16x32_bf16 v[136:139], a[16:19], a[40:43], 0
    v_mfma_f32_16x16x32_bf16 v[168:171], a[16:19], a[44:47], 0
    ds_read_b64_tr_b16 a[80:81], v13 offset:17152
    ds_read_b64_tr_b16 a[82:83], v13 offset:21248
    v_mfma_f32_16x16x32_bf16 v[200:203], a[16:19], a[48:51], 0
    v_mfma_f32_16x16x32_bf16 v[232:235], a[16:19], a[52:55], 0
    ds_read_b64_tr_b16 a[84:85], v13 offset:17160
    ds_read_b64_tr_b16 a[86:87], v13 offset:21256
    v_mfma_f32_16x16x32_bf16 v[76:79], a[20:23], a[32:35], 0
    v_mfma_f32_16x16x32_bf16 v[108:111], a[20:23], a[36:39], 0
    v_mfma_f32_16x16x32_bf16 v[140:143], a[20:23], a[40:43], 0
    s_add_u32 m0, s59, 0
    s_mov_b32 s73, 786432
    v_mfma_f32_16x16x32_bf16 v[172:175], a[20:23], a[44:47], 0
    v_mfma_f32_16x16x32_bf16 v[204:207], a[20:23], a[48:51], 0
    buffer_load_dwordx4 v10, s[24:27], s73 offen offset:0 lds
    v_mfma_f32_16x16x32_bf16 v[236:239], a[20:23], a[52:55], 0
    v_mfma_f32_16x16x32_bf16 v[80:83], a[24:27], a[32:35], 0
    v_mfma_f32_16x16x32_bf16 v[112:115], a[24:27], a[36:39], 0
    buffer_load_dwordx4 v16, s[24:27], s73 offen offset:1024 lds
    v_mfma_f32_16x16x32_bf16 v[144:147], a[24:27], a[40:43], 0
    v_mfma_f32_16x16x32_bf16 v[176:179], a[24:27], a[44:47], 0
    v_mfma_f32_16x16x32_bf16 v[208:211], a[24:27], a[48:51], 0
    buffer_load_dwordx4 v17, s[24:27], s73 offen offset:2048 lds
    v_mfma_f32_16x16x32_bf16 v[240:243], a[24:27], a[52:55], 0
    v_mfma_f32_16x16x32_bf16 v[84:87], a[28:31], a[32:35], 0
    v_mfma_f32_16x16x32_bf16 v[116:119], a[28:31], a[36:39], 0
    buffer_load_dwordx4 v18, s[24:27], s73 offen offset:3072 lds
    v_mfma_f32_16x16x32_bf16 v[148:151], a[28:31], a[40:43], 0
    v_mfma_f32_16x16x32_bf16 v[180:183], a[28:31], a[44:47], 0
    v_mfma_f32_16x16x32_bf16 v[212:215], a[28:31], a[48:51], 0
    v_mfma_f32_16x16x32_bf16 v[244:247], a[28:31], a[52:55], 0
    s_waitcnt lgkmcnt(0)
    s_waitcnt vmcnt(10)
    s_barrier
    v_mfma_f32_16x16x32_bf16 v[56:59], a[56:59], a[88:91], v[56:59]
    ds_read_b128 a[32:35], v12 offset:26112
    ds_read_b128 a[36:39], v12 offset:28288
    v_mfma_f32_16x16x32_bf16 v[88:91], a[56:59], a[92:95], v[88:91]
    v_mfma_f32_16x16x32_bf16 v[120:123], a[56:59], a[96:99], v[120:123]
    v_mfma_f32_16x16x32_bf16 v[152:155], a[56:59], a[100:103], v[152:155]
    v_mfma_f32_16x16x32_bf16 v[184:187], a[56:59], a[104:107], v[184:187]
    ds_read_b128 a[40:43], v12 offset:30464
    ds_read_b128 a[44:47], v52 offset:26112
    v_mfma_f32_16x16x32_bf16 v[216:219], a[56:59], a[108:111], v[216:219]
    s_add_u32 m0, s59, 16384
    s_mov_b32 s73, 1048576
    v_mfma_f32_16x16x32_bf16 v[60:63], a[60:63], a[88:91], v[60:63]
    v_mfma_f32_16x16x32_bf16 v[92:95], a[60:63], a[92:95], v[92:95]
    buffer_load_dwordx4 v10, s[24:27], s73 offen offset:0 lds
    v_mfma_f32_16x16x32_bf16 v[124:127], a[60:63], a[96:99], v[124:127]
    ds_read_b128 a[48:51], v52 offset:28288
    ds_read_b128 a[52:55], v52 offset:30464
    v_mfma_f32_16x16x32_bf16 v[156:159], a[60:63], a[100:103], v[156:159]
    v_mfma_f32_16x16x32_bf16 v[188:191], a[60:63], a[104:107], v[188:191]
    buffer_load_dwordx4 v16, s[24:27], s73 offen offset:1024 lds
    v_mfma_f32_16x16x32_bf16 v[220:223], a[60:63], a[108:111], v[220:223]
    v_mfma_f32_16x16x32_bf16 v[64:67], a[64:67], a[88:91], v[64:67]
    ds_read_b64_tr_b16 a[0:1], v13 offset:32768
    ds_read_b64_tr_b16 a[2:3], v13 offset:36864
    v_mfma_f32_16x16x32_bf16 v[96:99], a[64:67], a[92:95], v[96:99]
    buffer_load_dwordx4 v17, s[24:27], s73 offen offset:2048 lds
    v_mfma_f32_16x16x32_bf16 v[128:131], a[64:67], a[96:99], v[128:131]
    v_mfma_f32_16x16x32_bf16 v[160:163], a[64:67], a[100:103], v[160:163]
    v_mfma_f32_16x16x32_bf16 v[192:195], a[64:67], a[104:107], v[192:195]
    ds_read_b64_tr_b16 a[4:5], v13 offset:32776
    ds_read_b64_tr_b16 a[6:7], v13 offset:36872
    v_mfma_f32_16x16x32_bf16 v[224:227], a[64:67], a[108:111], v[224:227]
    buffer_load_dwordx4 v18, s[24:27], s73 offen offset:3072 lds
    v_mfma_f32_16x16x32_bf16 v[68:71], a[68:71], a[88:91], v[68:71]
    v_mfma_f32_16x16x32_bf16 v[100:103], a[68:71], a[92:95], v[100:103]
    s_add_u32 m0, s60, 52224
    s_mov_b32 s73, 256
    v_mfma_f32_16x16x32_bf16 v[132:135], a[68:71], a[96:99], v[132:135]
    ds_read_b64_tr_b16 a[8:9], v13 offset:33024
    ds_read_b64_tr_b16 a[10:11], v13 offset:37120
    v_mfma_f32_16x16x32_bf16 v[164:167], a[68:71], a[100:103], v[164:167]
    v_mfma_f32_16x16x32_bf16 v[196:199], a[68:71], a[104:107], v[196:199]
    buffer_load_dwordx4 v11, s[20:23], s73 offen offset:0 lds
    v_mfma_f32_16x16x32_bf16 v[228:231], a[68:71], a[108:111], v[228:231]
    v_mfma_f32_16x16x32_bf16 v[72:75], a[72:75], a[88:91], v[72:75]
    ds_read_b64_tr_b16 a[12:13], v13 offset:33032
    ds_read_b64_tr_b16 a[14:15], v13 offset:37128
    v_mfma_f32_16x16x32_bf16 v[104:107], a[72:75], a[92:95], v[104:107]
    buffer_load_dwordx4 v19, s[20:23], s73 offen offset:1088 lds
    v_mfma_f32_16x16x32_bf16 v[136:139], a[72:75], a[96:99], v[136:139]
    v_mfma_f32_16x16x32_bf16 v[168:171], a[72:75], a[100:103], v[168:171]
    v_mfma_f32_16x16x32_bf16 v[200:203], a[72:75], a[104:107], v[200:203]
    ds_read_b64_tr_b16 a[16:17], v13 offset:33280
    ds_read_b64_tr_b16 a[18:19], v13 offset:37376
    v_mfma_f32_16x16x32_bf16 v[232:235], a[72:75], a[108:111], v[232:235]
    buffer_load_dwordx4 v54, s[20:23], s73 offen offset:2176 lds
    v_mfma_f32_16x16x32_bf16 v[76:79], a[76:79], a[88:91], v[76:79]
    v_mfma_f32_16x16x32_bf16 v[108:111], a[76:79], a[92:95], v[108:111]
    s_add_u32 m0, s60, 55488
    s_mov_b32 s73, 27904
    v_mfma_f32_16x16x32_bf16 v[140:143], a[76:79], a[96:99], v[140:143]
    ds_read_b64_tr_b16 a[20:21], v13 offset:33288
    ds_read_b64_tr_b16 a[22:23], v13 offset:37384
    v_mfma_f32_16x16x32_bf16 v[172:175], a[76:79], a[100:103], v[172:175]
    v_mfma_f32_16x16x32_bf16 v[204:207], a[76:79], a[104:107], v[204:207]
    buffer_load_dwordx4 v11, s[20:23], s73 offen offset:0 lds
    v_mfma_f32_16x16x32_bf16 v[236:239], a[76:79], a[108:111], v[236:239]
    v_mfma_f32_16x16x32_bf16 v[80:83], a[80:83], a[88:91], v[80:83]
    ds_read_b64_tr_b16 a[24:25], v13 offset:33536
    ds_read_b64_tr_b16 a[26:27], v13 offset:37632
    v_mfma_f32_16x16x32_bf16 v[112:115], a[80:83], a[92:95], v[112:115]
    buffer_load_dwordx4 v19, s[20:23], s73 offen offset:1088 lds
    v_mfma_f32_16x16x32_bf16 v[144:147], a[80:83], a[96:99], v[144:147]
    v_mfma_f32_16x16x32_bf16 v[176:179], a[80:83], a[100:103], v[176:179]
    v_mfma_f32_16x16x32_bf16 v[208:211], a[80:83], a[104:107], v[208:211]
    ds_read_b64_tr_b16 a[28:29], v13 offset:33544
    ds_read_b64_tr_b16 a[30:31], v13 offset:37640
    v_mfma_f32_16x16x32_bf16 v[240:243], a[80:83], a[108:111], v[240:243]
    buffer_load_dwordx4 v54, s[20:23], s73 offen offset:2176 lds
    v_mfma_f32_16x16x32_bf16 v[84:87], a[84:87], a[88:91], v[84:87]
    v_mfma_f32_16x16x32_bf16 v[116:119], a[84:87], a[92:95], v[116:119]
    v_mfma_f32_16x16x32_bf16 v[148:151], a[84:87], a[96:99], v[148:151]
    v_mfma_f32_16x16x32_bf16 v[180:183], a[84:87], a[100:103], v[180:183]
    v_mfma_f32_16x16x32_bf16 v[212:215], a[84:87], a[104:107], v[212:215]
    v_mfma_f32_16x16x32_bf16 v[244:247], a[84:87], a[108:111], v[244:247]
    s_waitcnt lgkmcnt(0)
    s_waitcnt vmcnt(10)
    s_barrier
    v_mfma_f32_16x16x32_bf16 v[56:59], a[0:3], a[32:35], v[56:59]
    s_mov_b32 s72, 2621440
    buffer_load_dword v8, v9, s[24:27], s72 offen
    v_mfma_f32_16x16x32_bf16 v[88:91], a[0:3], a[36:39], v[88:91]
    buffer_load_dword v8, v6, s[20:23], 0 offen offset:640
    v_mfma_f32_16x16x32_bf16 v[120:123], a[0:3], a[40:43], v[120:123]
    s_add_u32 m0, s58, 0
    s_mov_b32 s72, 0
    buffer_load_dwordx4 v1, s[28:31], s72 offen offset:0 nt lds
    v_mfma_f32_16x16x32_bf16 v[152:155], a[0:3], a[44:47], v[152:155]
    s_add_u32 m0, s58, 0
    s_mov_b32 s72, 0
    buffer_load_dwordx4 v2, s[28:31], s72 offen offset:1024 nt lds
    v_mfma_f32_16x16x32_bf16 v[184:187], a[0:3], a[48:51], v[184:187]
    s_add_u32 m0, s58, 0
    s_mov_b32 s72, 0
    buffer_load_dwordx4 v1, s[28:31], s72 offen offset:2048 nt lds
    v_mfma_f32_16x16x32_bf16 v[216:219], a[0:3], a[52:55], v[216:219]
    s_add_u32 m0, s58, 0
    s_mov_b32 s72, 0
    buffer_load_dwordx4 v2, s[28:31], s72 offen offset:3072 nt lds
    v_mfma_f32_16x16x32_bf16 v[60:63], a[4:7], a[32:35], v[60:63]
    v_mfma_f32_16x16x32_bf16 v[92:95], a[4:7], a[36:39], v[92:95]
    v_mfma_f32_16x16x32_bf16 v[124:127], a[4:7], a[40:43], v[124:127]
    v_mfma_f32_16x16x32_bf16 v[156:159], a[4:7], a[44:47], v[156:159]
    ds_read_b128 a[88:91], v12 offset:26176
    ds_read_b128 a[92:95], v12 offset:28352
    v_mfma_f32_16x16x32_bf16 v[188:191], a[4:7], a[48:51], v[188:191]
    v_mfma_f32_16x16x32_bf16 v[220:223], a[4:7], a[52:55], v[220:223]
    ds_read_b128 a[96:99], v12 offset:30528
    ds_read_b128 a[100:103], v52 offset:26176
    v_mfma_f32_16x16x32_bf16 v[64:67], a[8:11], a[32:35], v[64:67]
    v_mfma_f32_16x16x32_bf16 v[96:99], a[8:11], a[36:39], v[96:99]
    ds_read_b128 a[104:107], v52 offset:28352
    ds_read_b128 a[108:111], v52 offset:30528
    v_mfma_f32_16x16x32_bf16 v[128:131], a[8:11], a[40:43], v[128:131]
    v_mfma_f32_16x16x32_bf16 v[160:163], a[8:11], a[44:47], v[160:163]
    ds_read_b64_tr_b16 a[56:57], v13 offset:0
    ds_read_b64_tr_b16 a[58:59], v13 offset:4096
    v_mfma_f32_16x16x32_bf16 v[192:195], a[8:11], a[48:51], v[192:195]
    v_mfma_f32_16x16x32_bf16 v[224:227], a[8:11], a[52:55], v[224:227]
    ds_read_b64_tr_b16 a[60:61], v13 offset:8
    ds_read_b64_tr_b16 a[62:63], v13 offset:4104
    v_mfma_f32_16x16x32_bf16 v[68:71], a[12:15], a[32:35], v[68:71]
    v_mfma_f32_16x16x32_bf16 v[100:103], a[12:15], a[36:39], v[100:103]
    ds_read_b64_tr_b16 a[64:65], v13 offset:256
    ds_read_b64_tr_b16 a[66:67], v13 offset:4352
    v_mfma_f32_16x16x32_bf16 v[132:135], a[12:15], a[40:43], v[132:135]
    v_mfma_f32_16x16x32_bf16 v[164:167], a[12:15], a[44:47], v[164:167]
    ds_read_b64_tr_b16 a[68:69], v13 offset:264
    ds_read_b64_tr_b16 a[70:71], v13 offset:4360
    v_mfma_f32_16x16x32_bf16 v[196:199], a[12:15], a[48:51], v[196:199]
    v_mfma_f32_16x16x32_bf16 v[228:231], a[12:15], a[52:55], v[228:231]
    ds_read_b64_tr_b16 a[72:73], v13 offset:512
    ds_read_b64_tr_b16 a[74:75], v13 offset:4608
    v_mfma_f32_16x16x32_bf16 v[72:75], a[16:19], a[32:35], v[72:75]
    v_mfma_f32_16x16x32_bf16 v[104:107], a[16:19], a[36:39], v[104:107]
    ds_read_b64_tr_b16 a[76:77], v13 offset:520
    ds_read_b64_tr_b16 a[78:79], v13 offset:4616
    v_mfma_f32_16x16x32_bf16 v[136:139], a[16:19], a[40:43], v[136:139]
    v_mfma_f32_16x16x32_bf16 v[168:171], a[16:19], a[44:47], v[168:171]
    ds_read_b64_tr_b16 a[80:81], v13 offset:768
    ds_read_b64_tr_b16 a[82:83], v13 offset:4864
    v_mfma_f32_16x16x32_bf16 v[200:203], a[16:19], a[48:51], v[200:203]
    v_mfma_f32_16x16x32_bf16 v[232:235], a[16:19], a[52:55], v[232:235]
    ds_read_b64_tr_b16 a[84:85], v13 offset:776
    ds_read_b64_tr_b16 a[86:87], v13 offset:4872
    v_mfma_f32_16x16x32_bf16 v[76:79], a[20:23], a[32:35], v[76:79]
    v_mfma_f32_16x16x32_bf16 v[108:111], a[20:23], a[36:39], v[108:111]
    v_mfma_f32_16x16x32_bf16 v[140:143], a[20:23], a[40:43], v[140:143]
    s_add_u32 m0, s59, 32768
    s_mov_b32 s73, 1310720
    v_mfma_f32_16x16x32_bf16 v[172:175], a[20:23], a[44:47], v[172:175]
    v_mfma_f32_16x16x32_bf16 v[204:207], a[20:23], a[48:51], v[204:207]
    buffer_load_dwordx4 v10, s[24:27], s73 offen offset:0 lds
    v_mfma_f32_16x16x32_bf16 v[236:239], a[20:23], a[52:55], v[236:239]
    v_mfma_f32_16x16x32_bf16 v[80:83], a[24:27], a[32:35], v[80:83]
    v_mfma_f32_16x16x32_bf16 v[112:115], a[24:27], a[36:39], v[112:115]
    buffer_load_dwordx4 v16, s[24:27], s73 offen offset:1024 lds
    v_mfma_f32_16x16x32_bf16 v[144:147], a[24:27], a[40:43], v[144:147]
    v_mfma_f32_16x16x32_bf16 v[176:179], a[24:27], a[44:47], v[176:179]
    v_mfma_f32_16x16x32_bf16 v[208:211], a[24:27], a[48:51], v[208:211]
    buffer_load_dwordx4 v17, s[24:27], s73 offen offset:2048 lds
    v_mfma_f32_16x16x32_bf16 v[240:243], a[24:27], a[52:55], v[240:243]
    v_mfma_f32_16x16x32_bf16 v[84:87], a[28:31], a[32:35], v[84:87]
    v_mfma_f32_16x16x32_bf16 v[116:119], a[28:31], a[36:39], v[116:119]
    buffer_load_dwordx4 v18, s[24:27], s73 offen offset:3072 lds
    v_mfma_f32_16x16x32_bf16 v[148:151], a[28:31], a[40:43], v[148:151]
    v_mfma_f32_16x16x32_bf16 v[180:183], a[28:31], a[44:47], v[180:183]
    v_mfma_f32_16x16x32_bf16 v[212:215], a[28:31], a[48:51], v[212:215]
    v_mfma_f32_16x16x32_bf16 v[244:247], a[28:31], a[52:55], v[244:247]
    s_waitcnt lgkmcnt(0)
    s_waitcnt vmcnt(10)
    s_barrier
    v_mfma_f32_16x16x32_bf16 v[56:59], a[56:59], a[88:91], v[56:59]
    ds_read_b128 a[32:35], v12 offset:52224
    ds_read_b128 a[36:39], v12 offset:54400
    v_mfma_f32_16x16x32_bf16 v[88:91], a[56:59], a[92:95], v[88:91]
    v_mfma_f32_16x16x32_bf16 v[120:123], a[56:59], a[96:99], v[120:123]
    v_mfma_f32_16x16x32_bf16 v[152:155], a[56:59], a[100:103], v[152:155]
    v_mfma_f32_16x16x32_bf16 v[184:187], a[56:59], a[104:107], v[184:187]
    ds_read_b128 a[40:43], v12 offset:56576
    ds_read_b128 a[44:47], v52 offset:52224
    v_mfma_f32_16x16x32_bf16 v[216:219], a[56:59], a[108:111], v[216:219]
    s_add_u32 m0, s59, 0
    s_mov_b32 s73, 1572864
    v_mfma_f32_16x16x32_bf16 v[60:63], a[60:63], a[88:91], v[60:63]
    v_mfma_f32_16x16x32_bf16 v[92:95], a[60:63], a[92:95], v[92:95]
    buffer_load_dwordx4 v10, s[24:27], s73 offen offset:0 lds
    v_mfma_f32_16x16x32_bf16 v[124:127], a[60:63], a[96:99], v[124:127]
    ds_read_b128 a[48:51], v52 offset:54400
    ds_read_b128 a[52:55], v52 offset:56576
    v_mfma_f32_16x16x32_bf16 v[156:159], a[60:63], a[100:103], v[156:159]
    v_mfma_f32_16x16x32_bf16 v[188:191], a[60:63], a[104:107], v[188:191]
    buffer_load_dwordx4 v16, s[24:27], s73 offen offset:1024 lds
    v_mfma_f32_16x16x32_bf16 v[220:223], a[60:63], a[108:111], v[220:223]
    v_mfma_f32_16x16x32_bf16 v[64:67], a[64:67], a[88:91], v[64:67]
    ds_read_b64_tr_b16 a[0:1], v13 offset:16384
    ds_read_b64_tr_b16 a[2:3], v13 offset:20480
    v_mfma_f32_16x16x32_bf16 v[96:99], a[64:67], a[92:95], v[96:99]
    buffer_load_dwordx4 v17, s[24:27], s73 offen offset:2048 lds
    v_mfma_f32_16x16x32_bf16 v[128:131], a[64:67], a[96:99], v[128:131]
    v_mfma_f32_16x16x32_bf16 v[160:163], a[64:67], a[100:103], v[160:163]
    v_mfma_f32_16x16x32_bf16 v[192:195], a[64:67], a[104:107], v[192:195]
    ds_read_b64_tr_b16 a[4:5], v13 offset:16392
    ds_read_b64_tr_b16 a[6:7], v13 offset:20488
    v_mfma_f32_16x16x32_bf16 v[224:227], a[64:67], a[108:111], v[224:227]
    buffer_load_dwordx4 v18, s[24:27], s73 offen offset:3072 lds
    v_mfma_f32_16x16x32_bf16 v[68:71], a[68:71], a[88:91], v[68:71]
    v_mfma_f32_16x16x32_bf16 v[100:103], a[68:71], a[92:95], v[100:103]
    s_add_u32 m0, s60, 0
    s_mov_b32 s73, 384
    v_mfma_f32_16x16x32_bf16 v[132:135], a[68:71], a[96:99], v[132:135]
    ds_read_b64_tr_b16 a[8:9], v13 offset:16640
    ds_read_b64_tr_b16 a[10:11], v13 offset:20736
    v_mfma_f32_16x16x32_bf16 v[164:167], a[68:71], a[100:103], v[164:167]
    v_mfma_f32_16x16x32_bf16 v[196:199], a[68:71], a[104:107], v[196:199]
    buffer_load_dwordx4 v11, s[20:23], s73 offen offset:0 lds
    v_mfma_f32_16x16x32_bf16 v[228:231], a[68:71], a[108:111], v[228:231]
    v_mfma_f32_16x16x32_bf16 v[72:75], a[72:75], a[88:91], v[72:75]
    ds_read_b64_tr_b16 a[12:13], v13 offset:16648
    ds_read_b64_tr_b16 a[14:15], v13 offset:20744
    v_mfma_f32_16x16x32_bf16 v[104:107], a[72:75], a[92:95], v[104:107]
    buffer_load_dwordx4 v19, s[20:23], s73 offen offset:1088 lds
    v_mfma_f32_16x16x32_bf16 v[136:139], a[72:75], a[96:99], v[136:139]
    v_mfma_f32_16x16x32_bf16 v[168:171], a[72:75], a[100:103], v[168:171]
    v_mfma_f32_16x16x32_bf16 v[200:203], a[72:75], a[104:107], v[200:203]
    ds_read_b64_tr_b16 a[16:17], v13 offset:16896
    ds_read_b64_tr_b16 a[18:19], v13 offset:20992
    v_mfma_f32_16x16x32_bf16 v[232:235], a[72:75], a[108:111], v[232:235]
    buffer_load_dwordx4 v54, s[20:23], s73 offen offset:2176 lds
    v_mfma_f32_16x16x32_bf16 v[76:79], a[76:79], a[88:91], v[76:79]
    v_mfma_f32_16x16x32_bf16 v[108:111], a[76:79], a[92:95], v[108:111]
    s_add_u32 m0, s60, 3264
    s_mov_b32 s73, 28032
    v_mfma_f32_16x16x32_bf16 v[140:143], a[76:79], a[96:99], v[140:143]
    ds_read_b64_tr_b16 a[20:21], v13 offset:16904
    ds_read_b64_tr_b16 a[22:23], v13 offset:21000
    v_mfma_f32_16x16x32_bf16 v[172:175], a[76:79], a[100:103], v[172:175]
    v_mfma_f32_16x16x32_bf16 v[204:207], a[76:79], a[104:107], v[204:207]
    buffer_load_dwordx4 v11, s[20:23], s73 offen offset:0 lds
    v_mfma_f32_16x16x32_bf16 v[236:239], a[76:79], a[108:111], v[236:239]
    v_mfma_f32_16x16x32_bf16 v[80:83], a[80:83], a[88:91], v[80:83]
    ds_read_b64_tr_b16 a[24:25], v13 offset:17152
    ds_read_b64_tr_b16 a[26:27], v13 offset:21248
    v_mfma_f32_16x16x32_bf16 v[112:115], a[80:83], a[92:95], v[112:115]
    buffer_load_dwordx4 v19, s[20:23], s73 offen offset:1088 lds
    v_mfma_f32_16x16x32_bf16 v[144:147], a[80:83], a[96:99], v[144:147]
    v_mfma_f32_16x16x32_bf16 v[176:179], a[80:83], a[100:103], v[176:179]
    v_mfma_f32_16x16x32_bf16 v[208:211], a[80:83], a[104:107], v[208:211]
    ds_read_b64_tr_b16 a[28:29], v13 offset:17160
    ds_read_b64_tr_b16 a[30:31], v13 offset:21256
    v_mfma_f32_16x16x32_bf16 v[240:243], a[80:83], a[108:111], v[240:243]
    buffer_load_dwordx4 v54, s[20:23], s73 offen offset:2176 lds
    v_mfma_f32_16x16x32_bf16 v[84:87], a[84:87], a[88:91], v[84:87]
    v_mfma_f32_16x16x32_bf16 v[116:119], a[84:87], a[92:95], v[116:119]
    v_mfma_f32_16x16x32_bf16 v[148:151], a[84:87], a[96:99], v[148:151]
    v_mfma_f32_16x16x32_bf16 v[180:183], a[84:87], a[100:103], v[180:183]
    v_mfma_f32_16x16x32_bf16 v[212:215], a[84:87], a[104:107], v[212:215]
    v_mfma_f32_16x16x32_bf16 v[244:247], a[84:87], a[108:111], v[244:247]
    s_waitcnt lgkmcnt(0)
    s_waitcnt vmcnt(10)
    s_barrier
    v_mfma_f32_16x16x32_bf16 v[56:59], a[0:3], a[32:35], v[56:59]
    s_mov_b32 s72, 3145728
    buffer_load_dword v8, v9, s[24:27], s72 offen
    v_mfma_f32_16x16x32_bf16 v[88:91], a[0:3], a[36:39], v[88:91]
    buffer_load_dword v8, v6, s[20:23], 0 offen offset:768
    v_mfma_f32_16x16x32_bf16 v[120:123], a[0:3], a[40:43], v[120:123]
    s_add_u32 m0, s58, 8192
    s_mov_b32 s72, 0
    buffer_load_dwordx4 v1, s[4:7], s72 offen offset:0 nt lds
    v_mfma_f32_16x16x32_bf16 v[152:155], a[0:3], a[44:47], v[152:155]
    s_add_u32 m0, s58, 8192
    s_mov_b32 s72, 0
    buffer_load_dwordx4 v2, s[4:7], s72 offen offset:1024 nt lds
    v_mfma_f32_16x16x32_bf16 v[184:187], a[0:3], a[48:51], v[184:187]
    s_add_u32 m0, s58, 8192
    s_mov_b32 s72, 0
    buffer_load_dwordx4 v1, s[4:7], s72 offen offset:2048 nt lds
    v_mfma_f32_16x16x32_bf16 v[216:219], a[0:3], a[52:55], v[216:219]
    s_add_u32 m0, s58, 8192
    s_mov_b32 s72, 0
    buffer_load_dwordx4 v2, s[4:7], s72 offen offset:3072 nt lds
    v_mfma_f32_16x16x32_bf16 v[60:63], a[4:7], a[32:35], v[60:63]
    v_mfma_f32_16x16x32_bf16 v[92:95], a[4:7], a[36:39], v[92:95]
    v_mfma_f32_16x16x32_bf16 v[124:127], a[4:7], a[40:43], v[124:127]
    v_mfma_f32_16x16x32_bf16 v[156:159], a[4:7], a[44:47], v[156:159]
    ds_read_b128 a[88:91], v12 offset:52288
    ds_read_b128 a[92:95], v12 offset:54464
    v_mfma_f32_16x16x32_bf16 v[188:191], a[4:7], a[48:51], v[188:191]
    v_mfma_f32_16x16x32_bf16 v[220:223], a[4:7], a[52:55], v[220:223]
    ds_read_b128 a[96:99], v12 offset:56640
    ds_read_b128 a[100:103], v52 offset:52288
    v_mfma_f32_16x16x32_bf16 v[64:67], a[8:11], a[32:35], v[64:67]
    v_mfma_f32_16x16x32_bf16 v[96:99], a[8:11], a[36:39], v[96:99]
    ds_read_b128 a[104:107], v52 offset:54464
    ds_read_b128 a[108:111], v52 offset:56640
    v_mfma_f32_16x16x32_bf16 v[128:131], a[8:11], a[40:43], v[128:131]
    v_mfma_f32_16x16x32_bf16 v[160:163], a[8:11], a[44:47], v[160:163]
    ds_read_b64_tr_b16 a[56:57], v13 offset:32768
    ds_read_b64_tr_b16 a[58:59], v13 offset:36864
    v_mfma_f32_16x16x32_bf16 v[192:195], a[8:11], a[48:51], v[192:195]
    v_mfma_f32_16x16x32_bf16 v[224:227], a[8:11], a[52:55], v[224:227]
    ds_read_b64_tr_b16 a[60:61], v13 offset:32776
    ds_read_b64_tr_b16 a[62:63], v13 offset:36872
    v_mfma_f32_16x16x32_bf16 v[68:71], a[12:15], a[32:35], v[68:71]
    v_mfma_f32_16x16x32_bf16 v[100:103], a[12:15], a[36:39], v[100:103]
    ds_read_b64_tr_b16 a[64:65], v13 offset:33024
    ds_read_b64_tr_b16 a[66:67], v13 offset:37120
    v_mfma_f32_16x16x32_bf16 v[132:135], a[12:15], a[40:43], v[132:135]
    v_mfma_f32_16x16x32_bf16 v[164:167], a[12:15], a[44:47], v[164:167]
    ds_read_b64_tr_b16 a[68:69], v13 offset:33032
    ds_read_b64_tr_b16 a[70:71], v13 offset:37128
    v_mfma_f32_16x16x32_bf16 v[196:199], a[12:15], a[48:51], v[196:199]
    v_mfma_f32_16x16x32_bf16 v[228:231], a[12:15], a[52:55], v[228:231]
    ds_read_b64_tr_b16 a[72:73], v13 offset:33280
    ds_read_b64_tr_b16 a[74:75], v13 offset:37376
    v_mfma_f32_16x16x32_bf16 v[72:75], a[16:19], a[32:35], v[72:75]
    v_mfma_f32_16x16x32_bf16 v[104:107], a[16:19], a[36:39], v[104:107]
    ds_read_b64_tr_b16 a[76:77], v13 offset:33288
    ds_read_b64_tr_b16 a[78:79], v13 offset:37384
    v_mfma_f32_16x16x32_bf16 v[136:139], a[16:19], a[40:43], v[136:139]
    v_mfma_f32_16x16x32_bf16 v[168:171], a[16:19], a[44:47], v[168:171]
    ds_read_b64_tr_b16 a[80:81], v13 offset:33536
    ds_read_b64_tr_b16 a[82:83], v13 offset:37632
    v_mfma_f32_16x16x32_bf16 v[200:203], a[16:19], a[48:51], v[200:203]
    v_mfma_f32_16x16x32_bf16 v[232:235], a[16:19], a[52:55], v[232:235]
    ds_read_b64_tr_b16 a[84:85], v13 offset:33544
    ds_read_b64_tr_b16 a[86:87], v13 offset:37640
    v_mfma_f32_16x16x32_bf16 v[76:79], a[20:23], a[32:35], v[76:79]
    v_mfma_f32_16x16x32_bf16 v[108:111], a[20:23], a[36:39], v[108:111]
    v_mfma_f32_16x16x32_bf16 v[140:143], a[20:23], a[40:43], v[140:143]
    s_add_u32 m0, s59, 16384
    s_mov_b32 s73, 1835008
    v_mfma_f32_16x16x32_bf16 v[172:175], a[20:23], a[44:47], v[172:175]
    v_mfma_f32_16x16x32_bf16 v[204:207], a[20:23], a[48:51], v[204:207]
    buffer_load_dwordx4 v10, s[24:27], s73 offen offset:0 lds
    v_mfma_f32_16x16x32_bf16 v[236:239], a[20:23], a[52:55], v[236:239]
    v_mfma_f32_16x16x32_bf16 v[80:83], a[24:27], a[32:35], v[80:83]
    v_mfma_f32_16x16x32_bf16 v[112:115], a[24:27], a[36:39], v[112:115]
    buffer_load_dwordx4 v16, s[24:27], s73 offen offset:1024 lds
    v_mfma_f32_16x16x32_bf16 v[144:147], a[24:27], a[40:43], v[144:147]
    v_mfma_f32_16x16x32_bf16 v[176:179], a[24:27], a[44:47], v[176:179]
    v_mfma_f32_16x16x32_bf16 v[208:211], a[24:27], a[48:51], v[208:211]
    buffer_load_dwordx4 v17, s[24:27], s73 offen offset:2048 lds
    v_mfma_f32_16x16x32_bf16 v[240:243], a[24:27], a[52:55], v[240:243]
    v_mfma_f32_16x16x32_bf16 v[84:87], a[28:31], a[32:35], v[84:87]
    v_mfma_f32_16x16x32_bf16 v[116:119], a[28:31], a[36:39], v[116:119]
    buffer_load_dwordx4 v18, s[24:27], s73 offen offset:3072 lds
    v_mfma_f32_16x16x32_bf16 v[148:151], a[28:31], a[40:43], v[148:151]
    v_mfma_f32_16x16x32_bf16 v[180:183], a[28:31], a[44:47], v[180:183]
    v_mfma_f32_16x16x32_bf16 v[212:215], a[28:31], a[48:51], v[212:215]
    v_mfma_f32_16x16x32_bf16 v[244:247], a[28:31], a[52:55], v[244:247]
    s_waitcnt lgkmcnt(0)
    s_waitcnt vmcnt(10)
    s_barrier
    v_mfma_f32_16x16x32_bf16 v[56:59], a[56:59], a[88:91], v[56:59]
    ds_read_b128 a[32:35], v12 offset:0
    ds_read_b128 a[36:39], v12 offset:2176
    v_mfma_f32_16x16x32_bf16 v[88:91], a[56:59], a[92:95], v[88:91]
    v_mfma_f32_16x16x32_bf16 v[120:123], a[56:59], a[96:99], v[120:123]
    v_mfma_f32_16x16x32_bf16 v[152:155], a[56:59], a[100:103], v[152:155]
    v_mfma_f32_16x16x32_bf16 v[184:187], a[56:59], a[104:107], v[184:187]
    ds_read_b128 a[40:43], v12 offset:4352
    ds_read_b128 a[44:47], v52 offset:0
    v_mfma_f32_16x16x32_bf16 v[216:219], a[56:59], a[108:111], v[216:219]
    s_add_u32 m0, s59, 32768
    s_mov_b32 s73, 2097152
    v_mfma_f32_16x16x32_bf16 v[60:63], a[60:63], a[88:91], v[60:63]
    v_mfma_f32_16x16x32_bf16 v[92:95], a[60:63], a[92:95], v[92:95]
    buffer_load_dwordx4 v10, s[24:27], s73 offen offset:0 lds
    v_mfma_f32_16x16x32_bf16 v[124:127], a[60:63], a[96:99], v[124:127]
    ds_read_b128 a[48:51], v52 offset:2176
    ds_read_b128 a[52:55], v52 offset:4352
    v_mfma_f32_16x16x32_bf16 v[156:159], a[60:63], a[100:103], v[156:159]
    v_mfma_f32_16x16x32_bf16 v[188:191], a[60:63], a[104:107], v[188:191]
    buffer_load_dwordx4 v16, s[24:27], s73 offen offset:1024 lds
    v_mfma_f32_16x16x32_bf16 v[220:223], a[60:63], a[108:111], v[220:223]
    v_mfma_f32_16x16x32_bf16 v[64:67], a[64:67], a[88:91], v[64:67]
    ds_read_b64_tr_b16 a[0:1], v13 offset:0
    ds_read_b64_tr_b16 a[2:3], v13 offset:4096
    v_mfma_f32_16x16x32_bf16 v[96:99], a[64:67], a[92:95], v[96:99]
    buffer_load_dwordx4 v17, s[24:27], s73 offen offset:2048 lds
    v_mfma_f32_16x16x32_bf16 v[128:131], a[64:67], a[96:99], v[128:131]
    v_mfma_f32_16x16x32_bf16 v[160:163], a[64:67], a[100:103], v[160:163]
    v_mfma_f32_16x16x32_bf16 v[192:195], a[64:67], a[104:107], v[192:195]
    ds_read_b64_tr_b16 a[4:5], v13 offset:8
    ds_read_b64_tr_b16 a[6:7], v13 offset:4104
    v_mfma_f32_16x16x32_bf16 v[224:227], a[64:67], a[108:111], v[224:227]
    buffer_load_dwordx4 v18, s[24:27], s73 offen offset:3072 lds
    v_mfma_f32_16x16x32_bf16 v[68:71], a[68:71], a[88:91], v[68:71]
    v_mfma_f32_16x16x32_bf16 v[100:103], a[68:71], a[92:95], v[100:103]
    s_add_u32 m0, s60, 26112
    s_mov_b32 s73, 512
    v_mfma_f32_16x16x32_bf16 v[132:135], a[68:71], a[96:99], v[132:135]
    ds_read_b64_tr_b16 a[8:9], v13 offset:256
    ds_read_b64_tr_b16 a[10:11], v13 offset:4352
    v_mfma_f32_16x16x32_bf16 v[164:167], a[68:71], a[100:103], v[164:167]
    v_mfma_f32_16x16x32_bf16 v[196:199], a[68:71], a[104:107], v[196:199]
    buffer_load_dwordx4 v11, s[20:23], s73 offen offset:0 lds
    v_mfma_f32_16x16x32_bf16 v[228:231], a[68:71], a[108:111], v[228:231]
    v_mfma_f32_16x16x32_bf16 v[72:75], a[72:75], a[88:91], v[72:75]
    ds_read_b64_tr_b16 a[12:13], v13 offset:264
    ds_read_b64_tr_b16 a[14:15], v13 offset:4360
    v_mfma_f32_16x16x32_bf16 v[104:107], a[72:75], a[92:95], v[104:107]
    buffer_load_dwordx4 v19, s[20:23], s73 offen offset:1088 lds
    v_mfma_f32_16x16x32_bf16 v[136:139], a[72:75], a[96:99], v[136:139]
    v_mfma_f32_16x16x32_bf16 v[168:171], a[72:75], a[100:103], v[168:171]
    v_mfma_f32_16x16x32_bf16 v[200:203], a[72:75], a[104:107], v[200:203]
    ds_read_b64_tr_b16 a[16:17], v13 offset:512
    ds_read_b64_tr_b16 a[18:19], v13 offset:4608
    v_mfma_f32_16x16x32_bf16 v[232:235], a[72:75], a[108:111], v[232:235]
    buffer_load_dwordx4 v54, s[20:23], s73 offen offset:2176 lds
    v_mfma_f32_16x16x32_bf16 v[76:79], a[76:79], a[88:91], v[76:79]
    v_mfma_f32_16x16x32_bf16 v[108:111], a[76:79], a[92:95], v[108:111]
    s_add_u32 m0, s60, 29376
    s_mov_b32 s73, 28160
    v_mfma_f32_16x16x32_bf16 v[140:143], a[76:79], a[96:99], v[140:143]
    ds_read_b64_tr_b16 a[20:21], v13 offset:520
    ds_read_b64_tr_b16 a[22:23], v13 offset:4616
    v_mfma_f32_16x16x32_bf16 v[172:175], a[76:79], a[100:103], v[172:175]
    v_mfma_f32_16x16x32_bf16 v[204:207], a[76:79], a[104:107], v[204:207]
    buffer_load_dwordx4 v11, s[20:23], s73 offen offset:0 lds
    v_mfma_f32_16x16x32_bf16 v[236:239], a[76:79], a[108:111], v[236:239]
    v_mfma_f32_16x16x32_bf16 v[80:83], a[80:83], a[88:91], v[80:83]
    ds_read_b64_tr_b16 a[24:25], v13 offset:768
    ds_read_b64_tr_b16 a[26:27], v13 offset:4864
    v_mfma_f32_16x16x32_bf16 v[112:115], a[80:83], a[92:95], v[112:115]
    buffer_load_dwordx4 v19, s[20:23], s73 offen offset:1088 lds
    v_mfma_f32_16x16x32_bf16 v[144:147], a[80:83], a[96:99], v[144:147]
    v_mfma_f32_16x16x32_bf16 v[176:179], a[80:83], a[100:103], v[176:179]
    v_mfma_f32_16x16x32_bf16 v[208:211], a[80:83], a[104:107], v[208:211]
    ds_read_b64_tr_b16 a[28:29], v13 offset:776
    ds_read_b64_tr_b16 a[30:31], v13 offset:4872
    v_mfma_f32_16x16x32_bf16 v[240:243], a[80:83], a[108:111], v[240:243]
    buffer_load_dwordx4 v54, s[20:23], s73 offen offset:2176 lds
    v_mfma_f32_16x16x32_bf16 v[84:87], a[84:87], a[88:91], v[84:87]
    v_mfma_f32_16x16x32_bf16 v[116:119], a[84:87], a[92:95], v[116:119]
    v_mfma_f32_16x16x32_bf16 v[148:151], a[84:87], a[96:99], v[148:151]
    v_mfma_f32_16x16x32_bf16 v[180:183], a[84:87], a[100:103], v[180:183]
    v_mfma_f32_16x16x32_bf16 v[212:215], a[84:87], a[104:107], v[212:215]
    v_mfma_f32_16x16x32_bf16 v[244:247], a[84:87], a[108:111], v[244:247]
    s_waitcnt lgkmcnt(0)
    s_waitcnt vmcnt(10)
    s_barrier
    v_mfma_f32_16x16x32_bf16 v[56:59], a[0:3], a[32:35], v[56:59]
    s_mov_b32 s72, 3670016
    buffer_load_dword v8, v9, s[24:27], s72 offen
    v_mfma_f32_16x16x32_bf16 v[88:91], a[0:3], a[36:39], v[88:91]
    buffer_load_dword v8, v6, s[20:23], 0 offen offset:896
    v_mfma_f32_16x16x32_bf16 v[120:123], a[0:3], a[40:43], v[120:123]
    s_mov_b32 s72, 8192
    buffer_load_dwordx4 v[20:23], v1, s[28:31], s72 offen offset:0 nt
    v_mfma_f32_16x16x32_bf16 v[152:155], a[0:3], a[44:47], v[152:155]
    s_mov_b32 s72, 8192
    buffer_load_dwordx4 v[24:27], v2, s[28:31], s72 offen offset:1024 nt
    v_mfma_f32_16x16x32_bf16 v[184:187], a[0:3], a[48:51], v[184:187]
    s_mov_b32 s72, 8192
    buffer_load_dwordx4 v[28:31], v1, s[28:31], s72 offen offset:2048 nt
    v_mfma_f32_16x16x32_bf16 v[216:219], a[0:3], a[52:55], v[216:219]
    s_mov_b32 s72, 8192
    buffer_load_dwordx4 v[32:35], v2, s[28:31], s72 offen offset:3072 nt
    v_mfma_f32_16x16x32_bf16 v[60:63], a[4:7], a[32:35], v[60:63]
    v_mfma_f32_16x16x32_bf16 v[92:95], a[4:7], a[36:39], v[92:95]
    v_mfma_f32_16x16x32_bf16 v[124:127], a[4:7], a[40:43], v[124:127]
    v_mfma_f32_16x16x32_bf16 v[156:159], a[4:7], a[44:47], v[156:159]
    ds_read_b128 a[88:91], v12 offset:64
    ds_read_b128 a[92:95], v12 offset:2240
    v_mfma_f32_16x16x32_bf16 v[188:191], a[4:7], a[48:51], v[188:191]
    v_mfma_f32_16x16x32_bf16 v[220:223], a[4:7], a[52:55], v[220:223]
    ds_read_b128 a[96:99], v12 offset:4416
    ds_read_b128 a[100:103], v52 offset:64
    v_mfma_f32_16x16x32_bf16 v[64:67], a[8:11], a[32:35], v[64:67]
    v_mfma_f32_16x16x32_bf16 v[96:99], a[8:11], a[36:39], v[96:99]
    ds_read_b128 a[104:107], v52 offset:2240
    ds_read_b128 a[108:111], v52 offset:4416
    v_mfma_f32_16x16x32_bf16 v[128:131], a[8:11], a[40:43], v[128:131]
    v_mfma_f32_16x16x32_bf16 v[160:163], a[8:11], a[44:47], v[160:163]
    ds_read_b64_tr_b16 a[56:57], v13 offset:16384
    ds_read_b64_tr_b16 a[58:59], v13 offset:20480
    v_mfma_f32_16x16x32_bf16 v[192:195], a[8:11], a[48:51], v[192:195]
    v_mfma_f32_16x16x32_bf16 v[224:227], a[8:11], a[52:55], v[224:227]
    ds_read_b64_tr_b16 a[60:61], v13 offset:16392
    ds_read_b64_tr_b16 a[62:63], v13 offset:20488
    v_mfma_f32_16x16x32_bf16 v[68:71], a[12:15], a[32:35], v[68:71]
    v_mfma_f32_16x16x32_bf16 v[100:103], a[12:15], a[36:39], v[100:103]
    ds_read_b64_tr_b16 a[64:65], v13 offset:16640
    ds_read_b64_tr_b16 a[66:67], v13 offset:20736
    v_mfma_f32_16x16x32_bf16 v[132:135], a[12:15], a[40:43], v[132:135]
    v_mfma_f32_16x16x32_bf16 v[164:167], a[12:15], a[44:47], v[164:167]
    ds_read_b64_tr_b16 a[68:69], v13 offset:16648
    ds_read_b64_tr_b16 a[70:71], v13 offset:20744
    v_mfma_f32_16x16x32_bf16 v[196:199], a[12:15], a[48:51], v[196:199]
    v_mfma_f32_16x16x32_bf16 v[228:231], a[12:15], a[52:55], v[228:231]
    ds_read_b64_tr_b16 a[72:73], v13 offset:16896
    ds_read_b64_tr_b16 a[74:75], v13 offset:20992
    v_mfma_f32_16x16x32_bf16 v[72:75], a[16:19], a[32:35], v[72:75]
    v_mfma_f32_16x16x32_bf16 v[104:107], a[16:19], a[36:39], v[104:107]
    ds_read_b64_tr_b16 a[76:77], v13 offset:16904
    ds_read_b64_tr_b16 a[78:79], v13 offset:21000
    v_mfma_f32_16x16x32_bf16 v[136:139], a[16:19], a[40:43], v[136:139]
    v_mfma_f32_16x16x32_bf16 v[168:171], a[16:19], a[44:47], v[168:171]
    ds_read_b64_tr_b16 a[80:81], v13 offset:17152
    ds_read_b64_tr_b16 a[82:83], v13 offset:21248
    v_mfma_f32_16x16x32_bf16 v[200:203], a[16:19], a[48:51], v[200:203]
    v_mfma_f32_16x16x32_bf16 v[232:235], a[16:19], a[52:55], v[232:235]
    ds_read_b64_tr_b16 a[84:85], v13 offset:17160
    ds_read_b64_tr_b16 a[86:87], v13 offset:21256
    v_mfma_f32_16x16x32_bf16 v[76:79], a[20:23], a[32:35], v[76:79]
    v_mfma_f32_16x16x32_bf16 v[108:111], a[20:23], a[36:39], v[108:111]
    v_mfma_f32_16x16x32_bf16 v[140:143], a[20:23], a[40:43], v[140:143]
    s_add_u32 m0, s59, 0
    s_mov_b32 s73, 2359296
    v_mfma_f32_16x16x32_bf16 v[172:175], a[20:23], a[44:47], v[172:175]
    v_mfma_f32_16x16x32_bf16 v[204:207], a[20:23], a[48:51], v[204:207]
    buffer_load_dwordx4 v10, s[24:27], s73 offen offset:0 lds
    v_mfma_f32_16x16x32_bf16 v[236:239], a[20:23], a[52:55], v[236:239]
    v_mfma_f32_16x16x32_bf16 v[80:83], a[24:27], a[32:35], v[80:83]
    v_mfma_f32_16x16x32_bf16 v[112:115], a[24:27], a[36:39], v[112:115]
    buffer_load_dwordx4 v16, s[24:27], s73 offen offset:1024 lds
    v_mfma_f32_16x16x32_bf16 v[144:147], a[24:27], a[40:43], v[144:147]
    v_mfma_f32_16x16x32_bf16 v[176:179], a[24:27], a[44:47], v[176:179]
    v_mfma_f32_16x16x32_bf16 v[208:211], a[24:27], a[48:51], v[208:211]
    buffer_load_dwordx4 v17, s[24:27], s73 offen offset:2048 lds
    v_mfma_f32_16x16x32_bf16 v[240:243], a[24:27], a[52:55], v[240:243]
    v_mfma_f32_16x16x32_bf16 v[84:87], a[28:31], a[32:35], v[84:87]
    v_mfma_f32_16x16x32_bf16 v[116:119], a[28:31], a[36:39], v[116:119]
    buffer_load_dwordx4 v18, s[24:27], s73 offen offset:3072 lds
    v_mfma_f32_16x16x32_bf16 v[148:151], a[28:31], a[40:43], v[148:151]
    v_mfma_f32_16x16x32_bf16 v[180:183], a[28:31], a[44:47], v[180:183]
    v_mfma_f32_16x16x32_bf16 v[212:215], a[28:31], a[48:51], v[212:215]
    v_mfma_f32_16x16x32_bf16 v[244:247], a[28:31], a[52:55], v[244:247]
    s_waitcnt lgkmcnt(0)
    s_waitcnt vmcnt(10)
    s_barrier
    v_mfma_f32_16x16x32_bf16 v[56:59], a[56:59], a[88:91], v[56:59]
    ds_read_b128 a[32:35], v12 offset:26112
    ds_read_b128 a[36:39], v12 offset:28288
    v_mfma_f32_16x16x32_bf16 v[88:91], a[56:59], a[92:95], v[88:91]
    v_mfma_f32_16x16x32_bf16 v[120:123], a[56:59], a[96:99], v[120:123]
    v_mfma_f32_16x16x32_bf16 v[152:155], a[56:59], a[100:103], v[152:155]
    v_mfma_f32_16x16x32_bf16 v[184:187], a[56:59], a[104:107], v[184:187]
    ds_read_b128 a[40:43], v12 offset:30464
    ds_read_b128 a[44:47], v52 offset:26112
    v_mfma_f32_16x16x32_bf16 v[216:219], a[56:59], a[108:111], v[216:219]
    s_add_u32 m0, s59, 16384
    s_mov_b32 s73, 2621440
    v_mfma_f32_16x16x32_bf16 v[60:63], a[60:63], a[88:91], v[60:63]
    v_mfma_f32_16x16x32_bf16 v[92:95], a[60:63], a[92:95], v[92:95]
    buffer_load_dwordx4 v10, s[24:27], s73 offen offset:0 lds
    v_mfma_f32_16x16x32_bf16 v[124:127], a[60:63], a[96:99], v[124:127]
    ds_read_b128 a[48:51], v52 offset:28288
    ds_read_b128 a[52:55], v52 offset:30464
    v_mfma_f32_16x16x32_bf16 v[156:159], a[60:63], a[100:103], v[156:159]
    v_mfma_f32_16x16x32_bf16 v[188:191], a[60:63], a[104:107], v[188:191]
    buffer_load_dwordx4 v16, s[24:27], s73 offen offset:1024 lds
    v_mfma_f32_16x16x32_bf16 v[220:223], a[60:63], a[108:111], v[220:223]
    v_mfma_f32_16x16x32_bf16 v[64:67], a[64:67], a[88:91], v[64:67]
    ds_read_b64_tr_b16 a[0:1], v13 offset:32768
    ds_read_b64_tr_b16 a[2:3], v13 offset:36864
    v_mfma_f32_16x16x32_bf16 v[96:99], a[64:67], a[92:95], v[96:99]
    buffer_load_dwordx4 v17, s[24:27], s73 offen offset:2048 lds
    v_mfma_f32_16x16x32_bf16 v[128:131], a[64:67], a[96:99], v[128:131]
    v_mfma_f32_16x16x32_bf16 v[160:163], a[64:67], a[100:103], v[160:163]
    v_mfma_f32_16x16x32_bf16 v[192:195], a[64:67], a[104:107], v[192:195]
    ds_read_b64_tr_b16 a[4:5], v13 offset:32776
    ds_read_b64_tr_b16 a[6:7], v13 offset:36872
    v_mfma_f32_16x16x32_bf16 v[224:227], a[64:67], a[108:111], v[224:227]
    buffer_load_dwordx4 v18, s[24:27], s73 offen offset:3072 lds
    v_mfma_f32_16x16x32_bf16 v[68:71], a[68:71], a[88:91], v[68:71]
    v_mfma_f32_16x16x32_bf16 v[100:103], a[68:71], a[92:95], v[100:103]
    s_add_u32 m0, s60, 52224
    s_mov_b32 s73, 640
    v_mfma_f32_16x16x32_bf16 v[132:135], a[68:71], a[96:99], v[132:135]
    ds_read_b64_tr_b16 a[8:9], v13 offset:33024
    ds_read_b64_tr_b16 a[10:11], v13 offset:37120
    v_mfma_f32_16x16x32_bf16 v[164:167], a[68:71], a[100:103], v[164:167]
    v_mfma_f32_16x16x32_bf16 v[196:199], a[68:71], a[104:107], v[196:199]
    buffer_load_dwordx4 v11, s[20:23], s73 offen offset:0 lds
    v_mfma_f32_16x16x32_bf16 v[228:231], a[68:71], a[108:111], v[228:231]
    v_mfma_f32_16x16x32_bf16 v[72:75], a[72:75], a[88:91], v[72:75]
    ds_read_b64_tr_b16 a[12:13], v13 offset:33032
    ds_read_b64_tr_b16 a[14:15], v13 offset:37128
    v_mfma_f32_16x16x32_bf16 v[104:107], a[72:75], a[92:95], v[104:107]
    buffer_load_dwordx4 v19, s[20:23], s73 offen offset:1088 lds
    v_mfma_f32_16x16x32_bf16 v[136:139], a[72:75], a[96:99], v[136:139]
    v_mfma_f32_16x16x32_bf16 v[168:171], a[72:75], a[100:103], v[168:171]
    v_mfma_f32_16x16x32_bf16 v[200:203], a[72:75], a[104:107], v[200:203]
    ds_read_b64_tr_b16 a[16:17], v13 offset:33280
    ds_read_b64_tr_b16 a[18:19], v13 offset:37376
    v_mfma_f32_16x16x32_bf16 v[232:235], a[72:75], a[108:111], v[232:235]
    buffer_load_dwordx4 v54, s[20:23], s73 offen offset:2176 lds
    v_mfma_f32_16x16x32_bf16 v[76:79], a[76:79], a[88:91], v[76:79]
    v_mfma_f32_16x16x32_bf16 v[108:111], a[76:79], a[92:95], v[108:111]
    s_add_u32 m0, s60, 55488
    s_mov_b32 s73, 28288
    v_mfma_f32_16x16x32_bf16 v[140:143], a[76:79], a[96:99], v[140:143]
    ds_read_b64_tr_b16 a[20:21], v13 offset:33288
    ds_read_b64_tr_b16 a[22:23], v13 offset:37384
    v_mfma_f32_16x16x32_bf16 v[172:175], a[76:79], a[100:103], v[172:175]
    v_mfma_f32_16x16x32_bf16 v[204:207], a[76:79], a[104:107], v[204:207]
    buffer_load_dwordx4 v11, s[20:23], s73 offen offset:0 lds
    v_mfma_f32_16x16x32_bf16 v[236:239], a[76:79], a[108:111], v[236:239]
    v_mfma_f32_16x16x32_bf16 v[80:83], a[80:83], a[88:91], v[80:83]
    ds_read_b64_tr_b16 a[24:25], v13 offset:33536
    ds_read_b64_tr_b16 a[26:27], v13 offset:37632
    v_mfma_f32_16x16x32_bf16 v[112:115], a[80:83], a[92:95], v[112:115]
    buffer_load_dwordx4 v19, s[20:23], s73 offen offset:1088 lds
    v_mfma_f32_16x16x32_bf16 v[144:147], a[80:83], a[96:99], v[144:147]
    v_mfma_f32_16x16x32_bf16 v[176:179], a[80:83], a[100:103], v[176:179]
    v_mfma_f32_16x16x32_bf16 v[208:211], a[80:83], a[104:107], v[208:211]
    ds_read_b64_tr_b16 a[28:29], v13 offset:33544
    ds_read_b64_tr_b16 a[30:31], v13 offset:37640
    v_mfma_f32_16x16x32_bf16 v[240:243], a[80:83], a[108:111], v[240:243]
    buffer_load_dwordx4 v54, s[20:23], s73 offen offset:2176 lds
    v_mfma_f32_16x16x32_bf16 v[84:87], a[84:87], a[88:91], v[84:87]
    v_mfma_f32_16x16x32_bf16 v[116:119], a[84:87], a[92:95], v[116:119]
    v_mfma_f32_16x16x32_bf16 v[148:151], a[84:87], a[96:99], v[148:151]
    v_mfma_f32_16x16x32_bf16 v[180:183], a[84:87], a[100:103], v[180:183]
    v_mfma_f32_16x16x32_bf16 v[212:215], a[84:87], a[104:107], v[212:215]
    v_mfma_f32_16x16x32_bf16 v[244:247], a[84:87], a[108:111], v[244:247]
    s_waitcnt lgkmcnt(0)
    s_waitcnt vmcnt(10)
    s_barrier
    v_mfma_f32_16x16x32_bf16 v[56:59], a[0:3], a[32:35], v[56:59]
    s_mov_b32 s72, 4194304
    buffer_load_dword v8, v9, s[24:27], s72 offen
    v_mfma_f32_16x16x32_bf16 v[88:91], a[0:3], a[36:39], v[88:91]
    buffer_load_dword v8, v6, s[20:23], 0 offen offset:1024
    v_mfma_f32_16x16x32_bf16 v[120:123], a[0:3], a[40:43], v[120:123]
    s_mov_b32 s72, 8192
    buffer_load_dwordx4 v[36:39], v1, s[4:7], s72 offen offset:0 nt
    v_mfma_f32_16x16x32_bf16 v[152:155], a[0:3], a[44:47], v[152:155]
    s_mov_b32 s72, 8192
    buffer_load_dwordx4 v[40:43], v2, s[4:7], s72 offen offset:1024 nt
    v_mfma_f32_16x16x32_bf16 v[184:187], a[0:3], a[48:51], v[184:187]
    s_mov_b32 s72, 8192
    buffer_load_dwordx4 v[44:47], v1, s[4:7], s72 offen offset:2048 nt
    v_mfma_f32_16x16x32_bf16 v[216:219], a[0:3], a[52:55], v[216:219]
    s_mov_b32 s72, 8192
    buffer_load_dwordx4 v[48:51], v2, s[4:7], s72 offen offset:3072 nt
    v_mfma_f32_16x16x32_bf16 v[60:63], a[4:7], a[32:35], v[60:63]
    v_mfma_f32_16x16x32_bf16 v[92:95], a[4:7], a[36:39], v[92:95]
    v_mfma_f32_16x16x32_bf16 v[124:127], a[4:7], a[40:43], v[124:127]
    v_mfma_f32_16x16x32_bf16 v[156:159], a[4:7], a[44:47], v[156:159]
    ds_read_b128 a[88:91], v12 offset:26176
    ds_read_b128 a[92:95], v12 offset:28352
    v_mfma_f32_16x16x32_bf16 v[188:191], a[4:7], a[48:51], v[188:191]
    v_mfma_f32_16x16x32_bf16 v[220:223], a[4:7], a[52:55], v[220:223]
    ds_read_b128 a[96:99], v12 offset:30528
    ds_read_b128 a[100:103], v52 offset:26176
    v_mfma_f32_16x16x32_bf16 v[64:67], a[8:11], a[32:35], v[64:67]
    v_mfma_f32_16x16x32_bf16 v[96:99], a[8:11], a[36:39], v[96:99]
    ds_read_b128 a[104:107], v52 offset:28352
    ds_read_b128 a[108:111], v52 offset:30528
    v_mfma_f32_16x16x32_bf16 v[128:131], a[8:11], a[40:43], v[128:131]
    v_mfma_f32_16x16x32_bf16 v[160:163], a[8:11], a[44:47], v[160:163]
    ds_read_b64_tr_b16 a[56:57], v13 offset:0
    ds_read_b64_tr_b16 a[58:59], v13 offset:4096
    v_mfma_f32_16x16x32_bf16 v[192:195], a[8:11], a[48:51], v[192:195]
    v_mfma_f32_16x16x32_bf16 v[224:227], a[8:11], a[52:55], v[224:227]
    ds_read_b64_tr_b16 a[60:61], v13 offset:8
    ds_read_b64_tr_b16 a[62:63], v13 offset:4104
    v_mfma_f32_16x16x32_bf16 v[68:71], a[12:15], a[32:35], v[68:71]
    v_mfma_f32_16x16x32_bf16 v[100:103], a[12:15], a[36:39], v[100:103]
    ds_read_b64_tr_b16 a[64:65], v13 offset:256
    ds_read_b64_tr_b16 a[66:67], v13 offset:4352
    v_mfma_f32_16x16x32_bf16 v[132:135], a[12:15], a[40:43], v[132:135]
    v_mfma_f32_16x16x32_bf16 v[164:167], a[12:15], a[44:47], v[164:167]
    ds_read_b64_tr_b16 a[68:69], v13 offset:264
    ds_read_b64_tr_b16 a[70:71], v13 offset:4360
    v_mfma_f32_16x16x32_bf16 v[196:199], a[12:15], a[48:51], v[196:199]
    v_mfma_f32_16x16x32_bf16 v[228:231], a[12:15], a[52:55], v[228:231]
    ds_read_b64_tr_b16 a[72:73], v13 offset:512
    ds_read_b64_tr_b16 a[74:75], v13 offset:4608
    v_mfma_f32_16x16x32_bf16 v[72:75], a[16:19], a[32:35], v[72:75]
    v_mfma_f32_16x16x32_bf16 v[104:107], a[16:19], a[36:39], v[104:107]
    ds_read_b64_tr_b16 a[76:77], v13 offset:520
    ds_read_b64_tr_b16 a[78:79], v13 offset:4616
    v_mfma_f32_16x16x32_bf16 v[136:139], a[16:19], a[40:43], v[136:139]
    v_mfma_f32_16x16x32_bf16 v[168:171], a[16:19], a[44:47], v[168:171]
    ds_read_b64_tr_b16 a[80:81], v13 offset:768
    ds_read_b64_tr_b16 a[82:83], v13 offset:4864
    v_mfma_f32_16x16x32_bf16 v[200:203], a[16:19], a[48:51], v[200:203]
    v_mfma_f32_16x16x32_bf16 v[232:235], a[16:19], a[52:55], v[232:235]
    ds_read_b64_tr_b16 a[84:85], v13 offset:776
    ds_read_b64_tr_b16 a[86:87], v13 offset:4872
    v_mfma_f32_16x16x32_bf16 v[76:79], a[20:23], a[32:35], v[76:79]
    v_mfma_f32_16x16x32_bf16 v[108:111], a[20:23], a[36:39], v[108:111]
    v_mfma_f32_16x16x32_bf16 v[140:143], a[20:23], a[40:43], v[140:143]
    s_add_u32 m0, s59, 32768
    s_mov_b32 s73, 2883584
    v_mfma_f32_16x16x32_bf16 v[172:175], a[20:23], a[44:47], v[172:175]
    v_mfma_f32_16x16x32_bf16 v[204:207], a[20:23], a[48:51], v[204:207]
    buffer_load_dwordx4 v10, s[24:27], s73 offen offset:0 lds
    v_mfma_f32_16x16x32_bf16 v[236:239], a[20:23], a[52:55], v[236:239]
    v_mfma_f32_16x16x32_bf16 v[80:83], a[24:27], a[32:35], v[80:83]
    v_mfma_f32_16x16x32_bf16 v[112:115], a[24:27], a[36:39], v[112:115]
    buffer_load_dwordx4 v16, s[24:27], s73 offen offset:1024 lds
    v_mfma_f32_16x16x32_bf16 v[144:147], a[24:27], a[40:43], v[144:147]
    v_mfma_f32_16x16x32_bf16 v[176:179], a[24:27], a[44:47], v[176:179]
    v_mfma_f32_16x16x32_bf16 v[208:211], a[24:27], a[48:51], v[208:211]
    buffer_load_dwordx4 v17, s[24:27], s73 offen offset:2048 lds
    v_mfma_f32_16x16x32_bf16 v[240:243], a[24:27], a[52:55], v[240:243]
    v_mfma_f32_16x16x32_bf16 v[84:87], a[28:31], a[32:35], v[84:87]
    v_mfma_f32_16x16x32_bf16 v[116:119], a[28:31], a[36:39], v[116:119]
    buffer_load_dwordx4 v18, s[24:27], s73 offen offset:3072 lds
    v_mfma_f32_16x16x32_bf16 v[148:151], a[28:31], a[40:43], v[148:151]
    v_mfma_f32_16x16x32_bf16 v[180:183], a[28:31], a[44:47], v[180:183]
    v_mfma_f32_16x16x32_bf16 v[212:215], a[28:31], a[48:51], v[212:215]
    v_mfma_f32_16x16x32_bf16 v[244:247], a[28:31], a[52:55], v[244:247]
    s_waitcnt lgkmcnt(0)
    s_waitcnt vmcnt(10)
    s_barrier
    v_mfma_f32_16x16x32_bf16 v[56:59], a[56:59], a[88:91], v[56:59]
    ds_read_b128 a[32:35], v12 offset:52224
    ds_read_b128 a[36:39], v12 offset:54400
    v_mfma_f32_16x16x32_bf16 v[88:91], a[56:59], a[92:95], v[88:91]
    v_mfma_f32_16x16x32_bf16 v[120:123], a[56:59], a[96:99], v[120:123]
    v_mfma_f32_16x16x32_bf16 v[152:155], a[56:59], a[100:103], v[152:155]
    v_mfma_f32_16x16x32_bf16 v[184:187], a[56:59], a[104:107], v[184:187]
    ds_read_b128 a[40:43], v12 offset:56576
    ds_read_b128 a[44:47], v52 offset:52224
    v_mfma_f32_16x16x32_bf16 v[216:219], a[56:59], a[108:111], v[216:219]
    s_add_u32 m0, s59, 0
    s_mov_b32 s73, 3145728
    v_mfma_f32_16x16x32_bf16 v[60:63], a[60:63], a[88:91], v[60:63]
    v_mfma_f32_16x16x32_bf16 v[92:95], a[60:63], a[92:95], v[92:95]
    buffer_load_dwordx4 v10, s[24:27], s73 offen offset:0 lds
    v_mfma_f32_16x16x32_bf16 v[124:127], a[60:63], a[96:99], v[124:127]
    ds_read_b128 a[48:51], v52 offset:54400
    ds_read_b128 a[52:55], v52 offset:56576
    v_mfma_f32_16x16x32_bf16 v[156:159], a[60:63], a[100:103], v[156:159]
    v_mfma_f32_16x16x32_bf16 v[188:191], a[60:63], a[104:107], v[188:191]
    buffer_load_dwordx4 v16, s[24:27], s73 offen offset:1024 lds
    v_mfma_f32_16x16x32_bf16 v[220:223], a[60:63], a[108:111], v[220:223]
    v_mfma_f32_16x16x32_bf16 v[64:67], a[64:67], a[88:91], v[64:67]
    ds_read_b64_tr_b16 a[0:1], v13 offset:16384
    ds_read_b64_tr_b16 a[2:3], v13 offset:20480
    v_mfma_f32_16x16x32_bf16 v[96:99], a[64:67], a[92:95], v[96:99]
    buffer_load_dwordx4 v17, s[24:27], s73 offen offset:2048 lds
    v_mfma_f32_16x16x32_bf16 v[128:131], a[64:67], a[96:99], v[128:131]
    v_mfma_f32_16x16x32_bf16 v[160:163], a[64:67], a[100:103], v[160:163]
    v_mfma_f32_16x16x32_bf16 v[192:195], a[64:67], a[104:107], v[192:195]
    ds_read_b64_tr_b16 a[4:5], v13 offset:16392
    ds_read_b64_tr_b16 a[6:7], v13 offset:20488
    v_mfma_f32_16x16x32_bf16 v[224:227], a[64:67], a[108:111], v[224:227]
    buffer_load_dwordx4 v18, s[24:27], s73 offen offset:3072 lds
    v_mfma_f32_16x16x32_bf16 v[68:71], a[68:71], a[88:91], v[68:71]
    v_mfma_f32_16x16x32_bf16 v[100:103], a[68:71], a[92:95], v[100:103]
    s_add_u32 m0, s60, 0
    s_mov_b32 s73, 768
    v_mfma_f32_16x16x32_bf16 v[132:135], a[68:71], a[96:99], v[132:135]
    ds_read_b64_tr_b16 a[8:9], v13 offset:16640
    ds_read_b64_tr_b16 a[10:11], v13 offset:20736
    v_mfma_f32_16x16x32_bf16 v[164:167], a[68:71], a[100:103], v[164:167]
    v_mfma_f32_16x16x32_bf16 v[196:199], a[68:71], a[104:107], v[196:199]
    buffer_load_dwordx4 v11, s[20:23], s73 offen offset:0 lds
    v_mfma_f32_16x16x32_bf16 v[228:231], a[68:71], a[108:111], v[228:231]
    v_mfma_f32_16x16x32_bf16 v[72:75], a[72:75], a[88:91], v[72:75]
    ds_read_b64_tr_b16 a[12:13], v13 offset:16648
    ds_read_b64_tr_b16 a[14:15], v13 offset:20744
    v_mfma_f32_16x16x32_bf16 v[104:107], a[72:75], a[92:95], v[104:107]
    buffer_load_dwordx4 v19, s[20:23], s73 offen offset:1088 lds
    v_mfma_f32_16x16x32_bf16 v[136:139], a[72:75], a[96:99], v[136:139]
    v_mfma_f32_16x16x32_bf16 v[168:171], a[72:75], a[100:103], v[168:171]
    v_mfma_f32_16x16x32_bf16 v[200:203], a[72:75], a[104:107], v[200:203]
    ds_read_b64_tr_b16 a[16:17], v13 offset:16896
    ds_read_b64_tr_b16 a[18:19], v13 offset:20992
    v_mfma_f32_16x16x32_bf16 v[232:235], a[72:75], a[108:111], v[232:235]
    buffer_load_dwordx4 v54, s[20:23], s73 offen offset:2176 lds
    v_mfma_f32_16x16x32_bf16 v[76:79], a[76:79], a[88:91], v[76:79]
    v_mfma_f32_16x16x32_bf16 v[108:111], a[76:79], a[92:95], v[108:111]
    s_add_u32 m0, s60, 3264
    s_mov_b32 s73, 28416
    v_mfma_f32_16x16x32_bf16 v[140:143], a[76:79], a[96:99], v[140:143]
    ds_read_b64_tr_b16 a[20:21], v13 offset:16904
    ds_read_b64_tr_b16 a[22:23], v13 offset:21000
    v_mfma_f32_16x16x32_bf16 v[172:175], a[76:79], a[100:103], v[172:175]
    v_mfma_f32_16x16x32_bf16 v[204:207], a[76:79], a[104:107], v[204:207]
    buffer_load_dwordx4 v11, s[20:23], s73 offen offset:0 lds
    v_mfma_f32_16x16x32_bf16 v[236:239], a[76:79], a[108:111], v[236:239]
    v_mfma_f32_16x16x32_bf16 v[80:83], a[80:83], a[88:91], v[80:83]
    ds_read_b64_tr_b16 a[24:25], v13 offset:17152
    ds_read_b64_tr_b16 a[26:27], v13 offset:21248
    v_mfma_f32_16x16x32_bf16 v[112:115], a[80:83], a[92:95], v[112:115]
    buffer_load_dwordx4 v19, s[20:23], s73 offen offset:1088 lds
    v_mfma_f32_16x16x32_bf16 v[144:147], a[80:83], a[96:99], v[144:147]
    v_mfma_f32_16x16x32_bf16 v[176:179], a[80:83], a[100:103], v[176:179]
    v_mfma_f32_16x16x32_bf16 v[208:211], a[80:83], a[104:107], v[208:211]
    ds_read_b64_tr_b16 a[28:29], v13 offset:17160
    ds_read_b64_tr_b16 a[30:31], v13 offset:21256
    v_mfma_f32_16x16x32_bf16 v[240:243], a[80:83], a[108:111], v[240:243]
    buffer_load_dwordx4 v54, s[20:23], s73 offen offset:2176 lds
    v_mfma_f32_16x16x32_bf16 v[84:87], a[84:87], a[88:91], v[84:87]
    v_mfma_f32_16x16x32_bf16 v[116:119], a[84:87], a[92:95], v[116:119]
    v_mfma_f32_16x16x32_bf16 v[148:151], a[84:87], a[96:99], v[148:151]
    v_mfma_f32_16x16x32_bf16 v[180:183], a[84:87], a[100:103], v[180:183]
    v_mfma_f32_16x16x32_bf16 v[212:215], a[84:87], a[104:107], v[212:215]
    v_mfma_f32_16x16x32_bf16 v[244:247], a[84:87], a[108:111], v[244:247]
    s_waitcnt lgkmcnt(0)
    s_waitcnt vmcnt(10)
    s_barrier
    v_mfma_f32_16x16x32_bf16 v[56:59], a[0:3], a[32:35], v[56:59]
    s_mov_b32 s72, 16384
    buffer_load_dwordx4 a[112:115], v1, s[28:31], s72 offen offset:0 nt
    v_mfma_f32_16x16x32_bf16 v[88:91], a[0:3], a[36:39], v[88:91]
    s_mov_b32 s72, 16384
    buffer_load_dwordx4 a[116:119], v2, s[28:31], s72 offen offset:1024 nt
    v_mfma_f32_16x16x32_bf16 v[120:123], a[0:3], a[40:43], v[120:123]
    s_mov_b32 s72, 16384
    buffer_load_dwordx4 a[120:123], v1, s[28:31], s72 offen offset:2048 nt
    v_mfma_f32_16x16x32_bf16 v[152:155], a[0:3], a[44:47], v[152:155]
    s_mov_b32 s72, 16384
    buffer_load_dwordx4 a[124:127], v2, s[28:31], s72 offen offset:3072 nt
    v_mfma_f32_16x16x32_bf16 v[184:187], a[0:3], a[48:51], v[184:187]
    s_mov_b32 s72, 16384
    buffer_load_dwordx4 a[128:131], v1, s[4:7], s72 offen offset:0 nt
    v_mfma_f32_16x16x32_bf16 v[216:219], a[0:3], a[52:55], v[216:219]
    v_mfma_f32_16x16x32_bf16 v[60:63], a[4:7], a[32:35], v[60:63]
    v_mfma_f32_16x16x32_bf16 v[92:95], a[4:7], a[36:39], v[92:95]
    v_mfma_f32_16x16x32_bf16 v[124:127], a[4:7], a[40:43], v[124:127]
    v_mfma_f32_16x16x32_bf16 v[156:159], a[4:7], a[44:47], v[156:159]
    ds_read_b128 a[88:91], v12 offset:52288
    ds_read_b128 a[92:95], v12 offset:54464
    v_mfma_f32_16x16x32_bf16 v[188:191], a[4:7], a[48:51], v[188:191]
    v_mfma_f32_16x16x32_bf16 v[220:223], a[4:7], a[52:55], v[220:223]
    ds_read_b128 a[96:99], v12 offset:56640
    ds_read_b128 a[100:103], v52 offset:52288
    v_mfma_f32_16x16x32_bf16 v[64:67], a[8:11], a[32:35], v[64:67]
    v_mfma_f32_16x16x32_bf16 v[96:99], a[8:11], a[36:39], v[96:99]
    ds_read_b128 a[104:107], v52 offset:54464
    ds_read_b128 a[108:111], v52 offset:56640
    v_mfma_f32_16x16x32_bf16 v[128:131], a[8:11], a[40:43], v[128:131]
    v_mfma_f32_16x16x32_bf16 v[160:163], a[8:11], a[44:47], v[160:163]
    ds_read_b64_tr_b16 a[56:57], v13 offset:32768
    ds_read_b64_tr_b16 a[58:59], v13 offset:36864
    v_mfma_f32_16x16x32_bf16 v[192:195], a[8:11], a[48:51], v[192:195]
    v_mfma_f32_16x16x32_bf16 v[224:227], a[8:11], a[52:55], v[224:227]
    ds_read_b64_tr_b16 a[60:61], v13 offset:32776
    ds_read_b64_tr_b16 a[62:63], v13 offset:36872
    v_mfma_f32_16x16x32_bf16 v[68:71], a[12:15], a[32:35], v[68:71]
    v_mfma_f32_16x16x32_bf16 v[100:103], a[12:15], a[36:39], v[100:103]
    ds_read_b64_tr_b16 a[64:65], v13 offset:33024
    ds_read_b64_tr_b16 a[66:67], v13 offset:37120
    v_mfma_f32_16x16x32_bf16 v[132:135], a[12:15], a[40:43], v[132:135]
    v_mfma_f32_16x16x32_bf16 v[164:167], a[12:15], a[44:47], v[164:167]
    ds_read_b64_tr_b16 a[68:69], v13 offset:33032
    ds_read_b64_tr_b16 a[70:71], v13 offset:37128
    v_mfma_f32_16x16x32_bf16 v[196:199], a[12:15], a[48:51], v[196:199]
    v_mfma_f32_16x16x32_bf16 v[228:231], a[12:15], a[52:55], v[228:231]
    ds_read_b64_tr_b16 a[72:73], v13 offset:33280
    ds_read_b64_tr_b16 a[74:75], v13 offset:37376
    v_mfma_f32_16x16x32_bf16 v[72:75], a[16:19], a[32:35], v[72:75]
    v_mfma_f32_16x16x32_bf16 v[104:107], a[16:19], a[36:39], v[104:107]
    ds_read_b64_tr_b16 a[76:77], v13 offset:33288
    ds_read_b64_tr_b16 a[78:79], v13 offset:37384
    v_mfma_f32_16x16x32_bf16 v[136:139], a[16:19], a[40:43], v[136:139]
    v_mfma_f32_16x16x32_bf16 v[168:171], a[16:19], a[44:47], v[168:171]
    ds_read_b64_tr_b16 a[80:81], v13 offset:33536
    ds_read_b64_tr_b16 a[82:83], v13 offset:37632
    v_mfma_f32_16x16x32_bf16 v[200:203], a[16:19], a[48:51], v[200:203]
    v_mfma_f32_16x16x32_bf16 v[232:235], a[16:19], a[52:55], v[232:235]
    ds_read_b64_tr_b16 a[84:85], v13 offset:33544
    ds_read_b64_tr_b16 a[86:87], v13 offset:37640
    v_mfma_f32_16x16x32_bf16 v[76:79], a[20:23], a[32:35], v[76:79]
    v_mfma_f32_16x16x32_bf16 v[108:111], a[20:23], a[36:39], v[108:111]
    v_mfma_f32_16x16x32_bf16 v[140:143], a[20:23], a[40:43], v[140:143]
    s_add_u32 m0, s59, 16384
    s_mov_b32 s73, 3407872
    v_mfma_f32_16x16x32_bf16 v[172:175], a[20:23], a[44:47], v[172:175]
    v_mfma_f32_16x16x32_bf16 v[204:207], a[20:23], a[48:51], v[204:207]
    buffer_load_dwordx4 v10, s[24:27], s73 offen offset:0 lds
    v_mfma_f32_16x16x32_bf16 v[236:239], a[20:23], a[52:55], v[236:239]
    v_mfma_f32_16x16x32_bf16 v[80:83], a[24:27], a[32:35], v[80:83]
    v_mfma_f32_16x16x32_bf16 v[112:115], a[24:27], a[36:39], v[112:115]
    buffer_load_dwordx4 v16, s[24:27], s73 offen offset:1024 lds
    v_mfma_f32_16x16x32_bf16 v[144:147], a[24:27], a[40:43], v[144:147]
    v_mfma_f32_16x16x32_bf16 v[176:179], a[24:27], a[44:47], v[176:179]
    v_mfma_f32_16x16x32_bf16 v[208:211], a[24:27], a[48:51], v[208:211]
    buffer_load_dwordx4 v17, s[24:27], s73 offen offset:2048 lds
    v_mfma_f32_16x16x32_bf16 v[240:243], a[24:27], a[52:55], v[240:243]
    v_mfma_f32_16x16x32_bf16 v[84:87], a[28:31], a[32:35], v[84:87]
    v_mfma_f32_16x16x32_bf16 v[116:119], a[28:31], a[36:39], v[116:119]
    buffer_load_dwordx4 v18, s[24:27], s73 offen offset:3072 lds
    v_mfma_f32_16x16x32_bf16 v[148:151], a[28:31], a[40:43], v[148:151]
    v_mfma_f32_16x16x32_bf16 v[180:183], a[28:31], a[44:47], v[180:183]
    v_mfma_f32_16x16x32_bf16 v[212:215], a[28:31], a[48:51], v[212:215]
    v_mfma_f32_16x16x32_bf16 v[244:247], a[28:31], a[52:55], v[244:247]
    s_waitcnt lgkmcnt(0)
    s_waitcnt vmcnt(9)
    s_barrier
    v_mfma_f32_16x16x32_bf16 v[56:59], a[56:59], a[88:91], v[56:59]
    ds_read_b128 a[32:35], v12 offset:0
    ds_read_b128 a[36:39], v12 offset:2176
    v_mfma_f32_16x16x32_bf16 v[88:91], a[56:59], a[92:95], v[88:91]
    v_mfma_f32_16x16x32_bf16 v[120:123], a[56:59], a[96:99], v[120:123]
    v_mfma_f32_16x16x32_bf16 v[152:155], a[56:59], a[100:103], v[152:155]
    v_mfma_f32_16x16x32_bf16 v[184:187], a[56:59], a[104:107], v[184:187]
    ds_read_b128 a[40:43], v12 offset:4352
    ds_read_b128 a[44:47], v52 offset:0
    v_mfma_f32_16x16x32_bf16 v[216:219], a[56:59], a[108:111], v[216:219]
    s_add_u32 m0, s59, 32768
    s_mov_b32 s73, 3670016
    v_mfma_f32_16x16x32_bf16 v[60:63], a[60:63], a[88:91], v[60:63]
    v_mfma_f32_16x16x32_bf16 v[92:95], a[60:63], a[92:95], v[92:95]
    buffer_load_dwordx4 v10, s[24:27], s73 offen offset:0 lds
    v_mfma_f32_16x16x32_bf16 v[124:127], a[60:63], a[96:99], v[124:127]
    ds_read_b128 a[48:51], v52 offset:2176
    ds_read_b128 a[52:55], v52 offset:4352
    v_mfma_f32_16x16x32_bf16 v[156:159], a[60:63], a[100:103], v[156:159]
    v_mfma_f32_16x16x32_bf16 v[188:191], a[60:63], a[104:107], v[188:191]
    buffer_load_dwordx4 v16, s[24:27], s73 offen offset:1024 lds
    v_mfma_f32_16x16x32_bf16 v[220:223], a[60:63], a[108:111], v[220:223]
    v_mfma_f32_16x16x32_bf16 v[64:67], a[64:67], a[88:91], v[64:67]
    ds_read_b64_tr_b16 a[0:1], v13 offset:0
    ds_read_b64_tr_b16 a[2:3], v13 offset:4096
    v_mfma_f32_16x16x32_bf16 v[96:99], a[64:67], a[92:95], v[96:99]
    buffer_load_dwordx4 v17, s[24:27], s73 offen offset:2048 lds
    v_mfma_f32_16x16x32_bf16 v[128:131], a[64:67], a[96:99], v[128:131]
    v_mfma_f32_16x16x32_bf16 v[160:163], a[64:67], a[100:103], v[160:163]
    v_mfma_f32_16x16x32_bf16 v[192:195], a[64:67], a[104:107], v[192:195]
    ds_read_b64_tr_b16 a[4:5], v13 offset:8
    ds_read_b64_tr_b16 a[6:7], v13 offset:4104
    v_mfma_f32_16x16x32_bf16 v[224:227], a[64:67], a[108:111], v[224:227]
    buffer_load_dwordx4 v18, s[24:27], s73 offen offset:3072 lds
    v_mfma_f32_16x16x32_bf16 v[68:71], a[68:71], a[88:91], v[68:71]
    v_mfma_f32_16x16x32_bf16 v[100:103], a[68:71], a[92:95], v[100:103]
    s_add_u32 m0, s60, 26112
    s_mov_b32 s73, 896
    v_mfma_f32_16x16x32_bf16 v[132:135], a[68:71], a[96:99], v[132:135]
    ds_read_b64_tr_b16 a[8:9], v13 offset:256
    ds_read_b64_tr_b16 a[10:11], v13 offset:4352
    v_mfma_f32_16x16x32_bf16 v[164:167], a[68:71], a[100:103], v[164:167]
    v_mfma_f32_16x16x32_bf16 v[196:199], a[68:71], a[104:107], v[196:199]
    buffer_load_dwordx4 v11, s[20:23], s73 offen offset:0 lds
    v_mfma_f32_16x16x32_bf16 v[228:231], a[68:71], a[108:111], v[228:231]
    v_mfma_f32_16x16x32_bf16 v[72:75], a[72:75], a[88:91], v[72:75]
    ds_read_b64_tr_b16 a[12:13], v13 offset:264
    ds_read_b64_tr_b16 a[14:15], v13 offset:4360
    v_mfma_f32_16x16x32_bf16 v[104:107], a[72:75], a[92:95], v[104:107]
    buffer_load_dwordx4 v19, s[20:23], s73 offen offset:1088 lds
    v_mfma_f32_16x16x32_bf16 v[136:139], a[72:75], a[96:99], v[136:139]
    v_mfma_f32_16x16x32_bf16 v[168:171], a[72:75], a[100:103], v[168:171]
    v_mfma_f32_16x16x32_bf16 v[200:203], a[72:75], a[104:107], v[200:203]
    ds_read_b64_tr_b16 a[16:17], v13 offset:512
    ds_read_b64_tr_b16 a[18:19], v13 offset:4608
    v_mfma_f32_16x16x32_bf16 v[232:235], a[72:75], a[108:111], v[232:235]
    buffer_load_dwordx4 v54, s[20:23], s73 offen offset:2176 lds
    v_mfma_f32_16x16x32_bf16 v[76:79], a[76:79], a[88:91], v[76:79]
    v_mfma_f32_16x16x32_bf16 v[108:111], a[76:79], a[92:95], v[108:111]
    s_add_u32 m0, s60, 29376
    s_mov_b32 s73, 28544
    v_mfma_f32_16x16x32_bf16 v[140:143], a[76:79], a[96:99], v[140:143]
    ds_read_b64_tr_b16 a[20:21], v13 offset:520
    ds_read_b64_tr_b16 a[22:23], v13 offset:4616
    v_mfma_f32_16x16x32_bf16 v[172:175], a[76:79], a[100:103], v[172:175]
    v_mfma_f32_16x16x32_bf16 v[204:207], a[76:79], a[104:107], v[204:207]
    buffer_load_dwordx4 v11, s[20:23], s73 offen offset:0 lds
    v_mfma_f32_16x16x32_bf16 v[236:239], a[76:79], a[108:111], v[236:239]
    v_mfma_f32_16x16x32_bf16 v[80:83], a[80:83], a[88:91], v[80:83]
    ds_read_b64_tr_b16 a[24:25], v13 offset:768
    ds_read_b64_tr_b16 a[26:27], v13 offset:4864
    v_mfma_f32_16x16x32_bf16 v[112:115], a[80:83], a[92:95], v[112:115]
    buffer_load_dwordx4 v19, s[20:23], s73 offen offset:1088 lds
    v_mfma_f32_16x16x32_bf16 v[144:147], a[80:83], a[96:99], v[144:147]
    v_mfma_f32_16x16x32_bf16 v[176:179], a[80:83], a[100:103], v[176:179]
    v_mfma_f32_16x16x32_bf16 v[208:211], a[80:83], a[104:107], v[208:211]
    ds_read_b64_tr_b16 a[28:29], v13 offset:776
    ds_read_b64_tr_b16 a[30:31], v13 offset:4872
    v_mfma_f32_16x16x32_bf16 v[240:243], a[80:83], a[108:111], v[240:243]
    buffer_load_dwordx4 v54, s[20:23], s73 offen offset:2176 lds
    v_mfma_f32_16x16x32_bf16 v[84:87], a[84:87], a[88:91], v[84:87]
    v_mfma_f32_16x16x32_bf16 v[116:119], a[84:87], a[92:95], v[116:119]
    v_mfma_f32_16x16x32_bf16 v[148:151], a[84:87], a[96:99], v[148:151]
    v_mfma_f32_16x16x32_bf16 v[180:183], a[84:87], a[100:103], v[180:183]
    v_mfma_f32_16x16x32_bf16 v[212:215], a[84:87], a[104:107], v[212:215]
    v_mfma_f32_16x16x32_bf16 v[244:247], a[84:87], a[108:111], v[244:247]
    s_waitcnt lgkmcnt(0)
    s_waitcnt vmcnt(10)
    s_barrier
    v_mfma_f32_16x16x32_bf16 v[56:59], a[0:3], a[32:35], v[56:59]
    s_mov_b32 s72, 16384
    buffer_load_dwordx4 a[132:135], v2, s[4:7], s72 offen offset:1024 nt
    v_mfma_f32_16x16x32_bf16 v[88:91], a[0:3], a[36:39], v[88:91]
    s_mov_b32 s72, 16384
    buffer_load_dwordx4 a[136:139], v1, s[4:7], s72 offen offset:2048 nt
    v_mfma_f32_16x16x32_bf16 v[120:123], a[0:3], a[40:43], v[120:123]
    s_mov_b32 s72, 16384
    buffer_load_dwordx4 a[140:143], v2, s[4:7], s72 offen offset:3072 nt
    v_mfma_f32_16x16x32_bf16 v[152:155], a[0:3], a[44:47], v[152:155]
    s_mov_b32 s72, 24576
    buffer_load_dwordx4 a[144:147], v1, s[28:31], s72 offen offset:0 nt
    v_mfma_f32_16x16x32_bf16 v[184:187], a[0:3], a[48:51], v[184:187]
    s_mov_b32 s72, 24576
    buffer_load_dwordx4 a[148:151], v2, s[28:31], s72 offen offset:1024 nt
    v_mfma_f32_16x16x32_bf16 v[216:219], a[0:3], a[52:55], v[216:219]
    v_mfma_f32_16x16x32_bf16 v[60:63], a[4:7], a[32:35], v[60:63]
    v_mfma_f32_16x16x32_bf16 v[92:95], a[4:7], a[36:39], v[92:95]
    v_mfma_f32_16x16x32_bf16 v[124:127], a[4:7], a[40:43], v[124:127]
    v_mfma_f32_16x16x32_bf16 v[156:159], a[4:7], a[44:47], v[156:159]
    ds_read_b128 a[88:91], v12 offset:64
    ds_read_b128 a[92:95], v12 offset:2240
    v_mfma_f32_16x16x32_bf16 v[188:191], a[4:7], a[48:51], v[188:191]
    v_mfma_f32_16x16x32_bf16 v[220:223], a[4:7], a[52:55], v[220:223]
    ds_read_b128 a[96:99], v12 offset:4416
    ds_read_b128 a[100:103], v52 offset:64
    v_mfma_f32_16x16x32_bf16 v[64:67], a[8:11], a[32:35], v[64:67]
    v_mfma_f32_16x16x32_bf16 v[96:99], a[8:11], a[36:39], v[96:99]
    ds_read_b128 a[104:107], v52 offset:2240
    ds_read_b128 a[108:111], v52 offset:4416
    v_mfma_f32_16x16x32_bf16 v[128:131], a[8:11], a[40:43], v[128:131]
    v_mfma_f32_16x16x32_bf16 v[160:163], a[8:11], a[44:47], v[160:163]
    ds_read_b64_tr_b16 a[56:57], v13 offset:16384
    ds_read_b64_tr_b16 a[58:59], v13 offset:20480
    v_mfma_f32_16x16x32_bf16 v[192:195], a[8:11], a[48:51], v[192:195]
    v_mfma_f32_16x16x32_bf16 v[224:227], a[8:11], a[52:55], v[224:227]
    ds_read_b64_tr_b16 a[60:61], v13 offset:16392
    ds_read_b64_tr_b16 a[62:63], v13 offset:20488
    v_mfma_f32_16x16x32_bf16 v[68:71], a[12:15], a[32:35], v[68:71]
    v_mfma_f32_16x16x32_bf16 v[100:103], a[12:15], a[36:39], v[100:103]
    ds_read_b64_tr_b16 a[64:65], v13 offset:16640
    ds_read_b64_tr_b16 a[66:67], v13 offset:20736
    v_mfma_f32_16x16x32_bf16 v[132:135], a[12:15], a[40:43], v[132:135]
    v_mfma_f32_16x16x32_bf16 v[164:167], a[12:15], a[44:47], v[164:167]
    ds_read_b64_tr_b16 a[68:69], v13 offset:16648
    ds_read_b64_tr_b16 a[70:71], v13 offset:20744
    v_mfma_f32_16x16x32_bf16 v[196:199], a[12:15], a[48:51], v[196:199]
    v_mfma_f32_16x16x32_bf16 v[228:231], a[12:15], a[52:55], v[228:231]
    ds_read_b64_tr_b16 a[72:73], v13 offset:16896
    ds_read_b64_tr_b16 a[74:75], v13 offset:20992
    v_mfma_f32_16x16x32_bf16 v[72:75], a[16:19], a[32:35], v[72:75]
    v_mfma_f32_16x16x32_bf16 v[104:107], a[16:19], a[36:39], v[104:107]
    ds_read_b64_tr_b16 a[76:77], v13 offset:16904
    ds_read_b64_tr_b16 a[78:79], v13 offset:21000
    v_mfma_f32_16x16x32_bf16 v[136:139], a[16:19], a[40:43], v[136:139]
    v_mfma_f32_16x16x32_bf16 v[168:171], a[16:19], a[44:47], v[168:171]
    ds_read_b64_tr_b16 a[80:81], v13 offset:17152
    ds_read_b64_tr_b16 a[82:83], v13 offset:21248
    v_mfma_f32_16x16x32_bf16 v[200:203], a[16:19], a[48:51], v[200:203]
    v_mfma_f32_16x16x32_bf16 v[232:235], a[16:19], a[52:55], v[232:235]
    ds_read_b64_tr_b16 a[84:85], v13 offset:17160
    ds_read_b64_tr_b16 a[86:87], v13 offset:21256
    v_mfma_f32_16x16x32_bf16 v[76:79], a[20:23], a[32:35], v[76:79]
    v_mfma_f32_16x16x32_bf16 v[108:111], a[20:23], a[36:39], v[108:111]
    v_mfma_f32_16x16x32_bf16 v[140:143], a[20:23], a[40:43], v[140:143]
    s_add_u32 m0, s59, 0
    s_mov_b32 s73, 3932160
    v_mfma_f32_16x16x32_bf16 v[172:175], a[20:23], a[44:47], v[172:175]
    v_mfma_f32_16x16x32_bf16 v[204:207], a[20:23], a[48:51], v[204:207]
    buffer_load_dwordx4 v10, s[24:27], s73 offen offset:0 lds
    v_mfma_f32_16x16x32_bf16 v[236:239], a[20:23], a[52:55], v[236:239]
    v_mfma_f32_16x16x32_bf16 v[80:83], a[24:27], a[32:35], v[80:83]
    v_mfma_f32_16x16x32_bf16 v[112:115], a[24:27], a[36:39], v[112:115]
    buffer_load_dwordx4 v16, s[24:27], s73 offen offset:1024 lds
    v_mfma_f32_16x16x32_bf16 v[144:147], a[24:27], a[40:43], v[144:147]
    v_mfma_f32_16x16x32_bf16 v[176:179], a[24:27], a[44:47], v[176:179]
    v_mfma_f32_16x16x32_bf16 v[208:211], a[24:27], a[48:51], v[208:211]
    buffer_load_dwordx4 v17, s[24:27], s73 offen offset:2048 lds
    v_mfma_f32_16x16x32_bf16 v[240:243], a[24:27], a[52:55], v[240:243]
    v_mfma_f32_16x16x32_bf16 v[84:87], a[28:31], a[32:35], v[84:87]
    v_mfma_f32_16x16x32_bf16 v[116:119], a[28:31], a[36:39], v[116:119]
    buffer_load_dwordx4 v18, s[24:27], s73 offen offset:3072 lds
    v_mfma_f32_16x16x32_bf16 v[148:151], a[28:31], a[40:43], v[148:151]
    v_mfma_f32_16x16x32_bf16 v[180:183], a[28:31], a[44:47], v[180:183]
    v_mfma_f32_16x16x32_bf16 v[212:215], a[28:31], a[48:51], v[212:215]
    v_mfma_f32_16x16x32_bf16 v[244:247], a[28:31], a[52:55], v[244:247]
    s_waitcnt lgkmcnt(0)
    s_waitcnt vmcnt(9)
    s_barrier
    v_mfma_f32_16x16x32_bf16 v[56:59], a[56:59], a[88:91], v[56:59]
    ds_read_b128 a[32:35], v12 offset:26112
    ds_read_b128 a[36:39], v12 offset:28288
    v_mfma_f32_16x16x32_bf16 v[88:91], a[56:59], a[92:95], v[88:91]
    v_mfma_f32_16x16x32_bf16 v[120:123], a[56:59], a[96:99], v[120:123]
    v_mfma_f32_16x16x32_bf16 v[152:155], a[56:59], a[100:103], v[152:155]
    v_mfma_f32_16x16x32_bf16 v[184:187], a[56:59], a[104:107], v[184:187]
    ds_read_b128 a[40:43], v12 offset:30464
    ds_read_b128 a[44:47], v52 offset:26112
    v_mfma_f32_16x16x32_bf16 v[216:219], a[56:59], a[108:111], v[216:219]
    s_add_u32 m0, s59, 16384
    s_mov_b32 s73, 4194304
    v_mfma_f32_16x16x32_bf16 v[60:63], a[60:63], a[88:91], v[60:63]
    v_mfma_f32_16x16x32_bf16 v[92:95], a[60:63], a[92:95], v[92:95]
    buffer_load_dwordx4 v10, s[24:27], s73 offen offset:0 lds
    v_mfma_f32_16x16x32_bf16 v[124:127], a[60:63], a[96:99], v[124:127]
    ds_read_b128 a[48:51], v52 offset:28288
    ds_read_b128 a[52:55], v52 offset:30464
    v_mfma_f32_16x16x32_bf16 v[156:159], a[60:63], a[100:103], v[156:159]
    v_mfma_f32_16x16x32_bf16 v[188:191], a[60:63], a[104:107], v[188:191]
    buffer_load_dwordx4 v16, s[24:27], s73 offen offset:1024 lds
    v_mfma_f32_16x16x32_bf16 v[220:223], a[60:63], a[108:111], v[220:223]
    v_mfma_f32_16x16x32_bf16 v[64:67], a[64:67], a[88:91], v[64:67]
    ds_read_b64_tr_b16 a[0:1], v13 offset:32768
    ds_read_b64_tr_b16 a[2:3], v13 offset:36864
    v_mfma_f32_16x16x32_bf16 v[96:99], a[64:67], a[92:95], v[96:99]
    buffer_load_dwordx4 v17, s[24:27], s73 offen offset:2048 lds
    v_mfma_f32_16x16x32_bf16 v[128:131], a[64:67], a[96:99], v[128:131]
    v_mfma_f32_16x16x32_bf16 v[160:163], a[64:67], a[100:103], v[160:163]
    v_mfma_f32_16x16x32_bf16 v[192:195], a[64:67], a[104:107], v[192:195]
    ds_read_b64_tr_b16 a[4:5], v13 offset:32776
    ds_read_b64_tr_b16 a[6:7], v13 offset:36872
    v_mfma_f32_16x16x32_bf16 v[224:227], a[64:67], a[108:111], v[224:227]
    buffer_load_dwordx4 v18, s[24:27], s73 offen offset:3072 lds
    v_mfma_f32_16x16x32_bf16 v[68:71], a[68:71], a[88:91], v[68:71]
    v_mfma_f32_16x16x32_bf16 v[100:103], a[68:71], a[92:95], v[100:103]
    s_add_u32 m0, s60, 52224
    s_mov_b32 s73, 1024
    v_mfma_f32_16x16x32_bf16 v[132:135], a[68:71], a[96:99], v[132:135]
    ds_read_b64_tr_b16 a[8:9], v13 offset:33024
    ds_read_b64_tr_b16 a[10:11], v13 offset:37120
    v_mfma_f32_16x16x32_bf16 v[164:167], a[68:71], a[100:103], v[164:167]
    v_mfma_f32_16x16x32_bf16 v[196:199], a[68:71], a[104:107], v[196:199]
    buffer_load_dwordx4 v11, s[20:23], s73 offen offset:0 lds
    v_mfma_f32_16x16x32_bf16 v[228:231], a[68:71], a[108:111], v[228:231]
    v_mfma_f32_16x16x32_bf16 v[72:75], a[72:75], a[88:91], v[72:75]
    ds_read_b64_tr_b16 a[12:13], v13 offset:33032
    ds_read_b64_tr_b16 a[14:15], v13 offset:37128
    v_mfma_f32_16x16x32_bf16 v[104:107], a[72:75], a[92:95], v[104:107]
    buffer_load_dwordx4 v19, s[20:23], s73 offen offset:1088 lds
    v_mfma_f32_16x16x32_bf16 v[136:139], a[72:75], a[96:99], v[136:139]
    v_mfma_f32_16x16x32_bf16 v[168:171], a[72:75], a[100:103], v[168:171]
    v_mfma_f32_16x16x32_bf16 v[200:203], a[72:75], a[104:107], v[200:203]
    ds_read_b64_tr_b16 a[16:17], v13 offset:33280
    ds_read_b64_tr_b16 a[18:19], v13 offset:37376
    v_mfma_f32_16x16x32_bf16 v[232:235], a[72:75], a[108:111], v[232:235]
    buffer_load_dwordx4 v54, s[20:23], s73 offen offset:2176 lds
    v_mfma_f32_16x16x32_bf16 v[76:79], a[76:79], a[88:91], v[76:79]
    v_mfma_f32_16x16x32_bf16 v[108:111], a[76:79], a[92:95], v[108:111]
    s_add_u32 m0, s60, 55488
    s_mov_b32 s73, 28672
    v_mfma_f32_16x16x32_bf16 v[140:143], a[76:79], a[96:99], v[140:143]
    ds_read_b64_tr_b16 a[20:21], v13 offset:33288
    ds_read_b64_tr_b16 a[22:23], v13 offset:37384
    v_mfma_f32_16x16x32_bf16 v[172:175], a[76:79], a[100:103], v[172:175]
    v_mfma_f32_16x16x32_bf16 v[204:207], a[76:79], a[104:107], v[204:207]
    buffer_load_dwordx4 v11, s[20:23], s73 offen offset:0 lds
    v_mfma_f32_16x16x32_bf16 v[236:239], a[76:79], a[108:111], v[236:239]
    v_mfma_f32_16x16x32_bf16 v[80:83], a[80:83], a[88:91], v[80:83]
    ds_read_b64_tr_b16 a[24:25], v13 offset:33536
    ds_read_b64_tr_b16 a[26:27], v13 offset:37632
    v_mfma_f32_16x16x32_bf16 v[112:115], a[80:83], a[92:95], v[112:115]
    buffer_load_dwordx4 v19, s[20:23], s73 offen offset:1088 lds
    v_mfma_f32_16x16x32_bf16 v[144:147], a[80:83], a[96:99], v[144:147]
    v_mfma_f32_16x16x32_bf16 v[176:179], a[80:83], a[100:103], v[176:179]
    v_mfma_f32_16x16x32_bf16 v[208:211], a[80:83], a[104:107], v[208:211]
    ds_read_b64_tr_b16 a[28:29], v13 offset:33544
    ds_read_b64_tr_b16 a[30:31], v13 offset:37640
    v_mfma_f32_16x16x32_bf16 v[240:243], a[80:83], a[108:111], v[240:243]
    buffer_load_dwordx4 v54, s[20:23], s73 offen offset:2176 lds
    v_mfma_f32_16x16x32_bf16 v[84:87], a[84:87], a[88:91], v[84:87]
    v_mfma_f32_16x16x32_bf16 v[116:119], a[84:87], a[92:95], v[116:119]
    v_mfma_f32_16x16x32_bf16 v[148:151], a[84:87], a[96:99], v[148:151]
    v_mfma_f32_16x16x32_bf16 v[180:183], a[84:87], a[100:103], v[180:183]
    v_mfma_f32_16x16x32_bf16 v[212:215], a[84:87], a[104:107], v[212:215]
    v_mfma_f32_16x16x32_bf16 v[244:247], a[84:87], a[108:111], v[244:247]
    s_waitcnt lgkmcnt(0)
    s_waitcnt vmcnt(10)
    s_barrier
    v_mfma_f32_16x16x32_bf16 v[56:59], a[0:3], a[32:35], v[56:59]
    s_mov_b32 s72, 24576
    buffer_load_dwordx4 a[152:155], v1, s[28:31], s72 offen offset:2048 nt
    v_mfma_f32_16x16x32_bf16 v[88:91], a[0:3], a[36:39], v[88:91]
    s_mov_b32 s72, 24576
    buffer_load_dwordx4 a[156:159], v2, s[28:31], s72 offen offset:3072 nt
    v_mfma_f32_16x16x32_bf16 v[120:123], a[0:3], a[40:43], v[120:123]
    s_mov_b32 s72, 24576
    buffer_load_dwordx4 a[160:163], v1, s[4:7], s72 offen offset:0 nt
    v_mfma_f32_16x16x32_bf16 v[152:155], a[0:3], a[44:47], v[152:155]
    s_mov_b32 s72, 24576
    buffer_load_dwordx4 a[164:167], v2, s[4:7], s72 offen offset:1024 nt
    v_mfma_f32_16x16x32_bf16 v[184:187], a[0:3], a[48:51], v[184:187]
    s_mov_b32 s72, 24576
    buffer_load_dwordx4 a[168:171], v1, s[4:7], s72 offen offset:2048 nt
    v_mfma_f32_16x16x32_bf16 v[216:219], a[0:3], a[52:55], v[216:219]
    v_mfma_f32_16x16x32_bf16 v[60:63], a[4:7], a[32:35], v[60:63]
    v_mfma_f32_16x16x32_bf16 v[92:95], a[4:7], a[36:39], v[92:95]
    v_mfma_f32_16x16x32_bf16 v[124:127], a[4:7], a[40:43], v[124:127]
    v_mfma_f32_16x16x32_bf16 v[156:159], a[4:7], a[44:47], v[156:159]
    ds_read_b128 a[88:91], v12 offset:26176
    ds_read_b128 a[92:95], v12 offset:28352
    v_mfma_f32_16x16x32_bf16 v[188:191], a[4:7], a[48:51], v[188:191]
    v_mfma_f32_16x16x32_bf16 v[220:223], a[4:7], a[52:55], v[220:223]
    ds_read_b128 a[96:99], v12 offset:30528
    ds_read_b128 a[100:103], v52 offset:26176
    v_mfma_f32_16x16x32_bf16 v[64:67], a[8:11], a[32:35], v[64:67]
    v_mfma_f32_16x16x32_bf16 v[96:99], a[8:11], a[36:39], v[96:99]
    ds_read_b128 a[104:107], v52 offset:28352
    ds_read_b128 a[108:111], v52 offset:30528
    v_mfma_f32_16x16x32_bf16 v[128:131], a[8:11], a[40:43], v[128:131]
    v_mfma_f32_16x16x32_bf16 v[160:163], a[8:11], a[44:47], v[160:163]
    ds_read_b64_tr_b16 a[56:57], v13 offset:0
    ds_read_b64_tr_b16 a[58:59], v13 offset:4096
    v_mfma_f32_16x16x32_bf16 v[192:195], a[8:11], a[48:51], v[192:195]
    v_mfma_f32_16x16x32_bf16 v[224:227], a[8:11], a[52:55], v[224:227]
    ds_read_b64_tr_b16 a[60:61], v13 offset:8
    ds_read_b64_tr_b16 a[62:63], v13 offset:4104
    v_mfma_f32_16x16x32_bf16 v[68:71], a[12:15], a[32:35], v[68:71]
    v_mfma_f32_16x16x32_bf16 v[100:103], a[12:15], a[36:39], v[100:103]
    ds_read_b64_tr_b16 a[64:65], v13 offset:256
    ds_read_b64_tr_b16 a[66:67], v13 offset:4352
    v_mfma_f32_16x16x32_bf16 v[132:135], a[12:15], a[40:43], v[132:135]
    v_mfma_f32_16x16x32_bf16 v[164:167], a[12:15], a[44:47], v[164:167]
    ds_read_b64_tr_b16 a[68:69], v13 offset:264
    ds_read_b64_tr_b16 a[70:71], v13 offset:4360
    v_mfma_f32_16x16x32_bf16 v[196:199], a[12:15], a[48:51], v[196:199]
    v_mfma_f32_16x16x32_bf16 v[228:231], a[12:15], a[52:55], v[228:231]
    ds_read_b64_tr_b16 a[72:73], v13 offset:512
    ds_read_b64_tr_b16 a[74:75], v13 offset:4608
    v_mfma_f32_16x16x32_bf16 v[72:75], a[16:19], a[32:35], v[72:75]
    v_mfma_f32_16x16x32_bf16 v[104:107], a[16:19], a[36:39], v[104:107]
    ds_read_b64_tr_b16 a[76:77], v13 offset:520
    ds_read_b64_tr_b16 a[78:79], v13 offset:4616
    v_mfma_f32_16x16x32_bf16 v[136:139], a[16:19], a[40:43], v[136:139]
    v_mfma_f32_16x16x32_bf16 v[168:171], a[16:19], a[44:47], v[168:171]
    ds_read_b64_tr_b16 a[80:81], v13 offset:768
    ds_read_b64_tr_b16 a[82:83], v13 offset:4864
    v_mfma_f32_16x16x32_bf16 v[200:203], a[16:19], a[48:51], v[200:203]
    v_mfma_f32_16x16x32_bf16 v[232:235], a[16:19], a[52:55], v[232:235]
    ds_read_b64_tr_b16 a[84:85], v13 offset:776
    ds_read_b64_tr_b16 a[86:87], v13 offset:4872
    v_mfma_f32_16x16x32_bf16 v[76:79], a[20:23], a[32:35], v[76:79]
    v_mfma_f32_16x16x32_bf16 v[108:111], a[20:23], a[36:39], v[108:111]
    v_mfma_f32_16x16x32_bf16 v[140:143], a[20:23], a[40:43], v[140:143]
    s_add_u32 m0, s59, 32768
    s_mov_b32 s73, 4456448
    v_mfma_f32_16x16x32_bf16 v[172:175], a[20:23], a[44:47], v[172:175]
    v_mfma_f32_16x16x32_bf16 v[204:207], a[20:23], a[48:51], v[204:207]
    buffer_load_dwordx4 v10, s[24:27], s73 offen offset:0 lds
    v_mfma_f32_16x16x32_bf16 v[236:239], a[20:23], a[52:55], v[236:239]
    v_mfma_f32_16x16x32_bf16 v[80:83], a[24:27], a[32:35], v[80:83]
    v_mfma_f32_16x16x32_bf16 v[112:115], a[24:27], a[36:39], v[112:115]
    buffer_load_dwordx4 v16, s[24:27], s73 offen offset:1024 lds
    v_mfma_f32_16x16x32_bf16 v[144:147], a[24:27], a[40:43], v[144:147]
    v_mfma_f32_16x16x32_bf16 v[176:179], a[24:27], a[44:47], v[176:179]
    v_mfma_f32_16x16x32_bf16 v[208:211], a[24:27], a[48:51], v[208:211]
    buffer_load_dwordx4 v17, s[24:27], s73 offen offset:2048 lds
    v_mfma_f32_16x16x32_bf16 v[240:243], a[24:27], a[52:55], v[240:243]
    v_mfma_f32_16x16x32_bf16 v[84:87], a[28:31], a[32:35], v[84:87]
    v_mfma_f32_16x16x32_bf16 v[116:119], a[28:31], a[36:39], v[116:119]
    buffer_load_dwordx4 v18, s[24:27], s73 offen offset:3072 lds
    v_mfma_f32_16x16x32_bf16 v[148:151], a[28:31], a[40:43], v[148:151]
    v_mfma_f32_16x16x32_bf16 v[180:183], a[28:31], a[44:47], v[180:183]
    v_mfma_f32_16x16x32_bf16 v[212:215], a[28:31], a[48:51], v[212:215]
    v_mfma_f32_16x16x32_bf16 v[244:247], a[28:31], a[52:55], v[244:247]
    s_waitcnt lgkmcnt(0)
    s_waitcnt vmcnt(9)
    s_barrier
    v_mfma_f32_16x16x32_bf16 v[56:59], a[56:59], a[88:91], v[56:59]
    ds_read_b128 a[32:35], v12 offset:52224
    ds_read_b128 a[36:39], v12 offset:54400
    v_mfma_f32_16x16x32_bf16 v[88:91], a[56:59], a[92:95], v[88:91]
    s_mov_b32 s72, 24576
    buffer_load_dwordx4 a[172:175], v2, s[4:7], s72 offen offset:3072 nt
    v_mfma_f32_16x16x32_bf16 v[120:123], a[56:59], a[96:99], v[120:123]
    v_mfma_f32_16x16x32_bf16 v[152:155], a[56:59], a[100:103], v[152:155]
    v_mfma_f32_16x16x32_bf16 v[184:187], a[56:59], a[104:107], v[184:187]
    ds_read_b128 a[40:43], v12 offset:56576
    ds_read_b128 a[44:47], v52 offset:52224
    v_mfma_f32_16x16x32_bf16 v[216:219], a[56:59], a[108:111], v[216:219]
    v_mfma_f32_16x16x32_bf16 v[60:63], a[60:63], a[88:91], v[60:63]
    v_mfma_f32_16x16x32_bf16 v[92:95], a[60:63], a[92:95], v[92:95]
    v_mfma_f32_16x16x32_bf16 v[124:127], a[60:63], a[96:99], v[124:127]
    ds_read_b128 a[48:51], v52 offset:54400
    ds_read_b128 a[52:55], v52 offset:56576
    v_mfma_f32_16x16x32_bf16 v[156:159], a[60:63], a[100:103], v[156:159]
    s_mov_b32 s72, 32768
    buffer_load_dwordx4 a[176:179], v1, s[28:31], s72 offen offset:0 nt
    v_mfma_f32_16x16x32_bf16 v[188:191], a[60:63], a[104:107], v[188:191]
    v_mfma_f32_16x16x32_bf16 v[220:223], a[60:63], a[108:111], v[220:223]
    v_mfma_f32_16x16x32_bf16 v[64:67], a[64:67], a[88:91], v[64:67]
    ds_read_b64_tr_b16 a[0:1], v13 offset:16384
    ds_read_b64_tr_b16 a[2:3], v13 offset:20480
    v_mfma_f32_16x16x32_bf16 v[96:99], a[64:67], a[92:95], v[96:99]
    v_mfma_f32_16x16x32_bf16 v[128:131], a[64:67], a[96:99], v[128:131]
    v_mfma_f32_16x16x32_bf16 v[160:163], a[64:67], a[100:103], v[160:163]
    v_mfma_f32_16x16x32_bf16 v[192:195], a[64:67], a[104:107], v[192:195]
    ds_read_b64_tr_b16 a[4:5], v13 offset:16392
    ds_read_b64_tr_b16 a[6:7], v13 offset:20488
    v_mfma_f32_16x16x32_bf16 v[224:227], a[64:67], a[108:111], v[224:227]
    s_mov_b32 s72, 32768
    buffer_load_dwordx4 a[180:183], v2, s[28:31], s72 offen offset:1024 nt
    v_mfma_f32_16x16x32_bf16 v[68:71], a[68:71], a[88:91], v[68:71]
    v_mfma_f32_16x16x32_bf16 v[100:103], a[68:71], a[92:95], v[100:103]
    v_mfma_f32_16x16x32_bf16 v[132:135], a[68:71], a[96:99], v[132:135]
    ds_read_b64_tr_b16 a[8:9], v13 offset:16640
    ds_read_b64_tr_b16 a[10:11], v13 offset:20736
    v_mfma_f32_16x16x32_bf16 v[164:167], a[68:71], a[100:103], v[164:167]
    v_mfma_f32_16x16x32_bf16 v[196:199], a[68:71], a[104:107], v[196:199]
    v_mfma_f32_16x16x32_bf16 v[228:231], a[68:71], a[108:111], v[228:231]
    v_mfma_f32_16x16x32_bf16 v[72:75], a[72:75], a[88:91], v[72:75]
    ds_read_b64_tr_b16 a[12:13], v13 offset:16648
    ds_read_b64_tr_b16 a[14:15], v13 offset:20744
    v_mfma_f32_16x16x32_bf16 v[104:107], a[72:75], a[92:95], v[104:107]
    v_mfma_f32_16x16x32_bf16 v[136:139], a[72:75], a[96:99], v[136:139]
    s_mov_b32 s72, 32768
    buffer_load_dwordx4 a[184:187], v1, s[28:31], s72 offen offset:2048 nt
    v_mfma_f32_16x16x32_bf16 v[168:171], a[72:75], a[100:103], v[168:171]
    v_mfma_f32_16x16x32_bf16 v[200:203], a[72:75], a[104:107], v[200:203]
    ds_read_b64_tr_b16 a[16:17], v13 offset:16896
    ds_read_b64_tr_b16 a[18:19], v13 offset:20992
    v_mfma_f32_16x16x32_bf16 v[232:235], a[72:75], a[108:111], v[232:235]
    v_mfma_f32_16x16x32_bf16 v[76:79], a[76:79], a[88:91], v[76:79]
    v_mfma_f32_16x16x32_bf16 v[108:111], a[76:79], a[92:95], v[108:111]
    v_mfma_f32_16x16x32_bf16 v[140:143], a[76:79], a[96:99], v[140:143]
    ds_read_b64_tr_b16 a[20:21], v13 offset:16904
    ds_read_b64_tr_b16 a[22:23], v13 offset:21000
    v_mfma_f32_16x16x32_bf16 v[172:175], a[76:79], a[100:103], v[172:175]
    v_mfma_f32_16x16x32_bf16 v[204:207], a[76:79], a[104:107], v[204:207]
    v_mfma_f32_16x16x32_bf16 v[236:239], a[76:79], a[108:111], v[236:239]
    s_mov_b32 s72, 32768
    buffer_load_dwordx4 a[188:191], v2, s[28:31], s72 offen offset:3072 nt
    v_mfma_f32_16x16x32_bf16 v[80:83], a[80:83], a[88:91], v[80:83]
    ds_read_b64_tr_b16 a[24:25], v13 offset:17152
    ds_read_b64_tr_b16 a[26:27], v13 offset:21248
    v_mfma_f32_16x16x32_bf16 v[112:115], a[80:83], a[92:95], v[112:115]
    v_mfma_f32_16x16x32_bf16 v[144:147], a[80:83], a[96:99], v[144:147]
    v_mfma_f32_16x16x32_bf16 v[176:179], a[80:83], a[100:103], v[176:179]
    v_mfma_f32_16x16x32_bf16 v[208:211], a[80:83], a[104:107], v[208:211]
    ds_read_b64_tr_b16 a[28:29], v13 offset:17160
    ds_read_b64_tr_b16 a[30:31], v13 offset:21256
    v_mfma_f32_16x16x32_bf16 v[240:243], a[80:83], a[108:111], v[240:243]
    v_mfma_f32_16x16x32_bf16 v[84:87], a[84:87], a[88:91], v[84:87]
    v_mfma_f32_16x16x32_bf16 v[116:119], a[84:87], a[92:95], v[116:119]
    v_mfma_f32_16x16x32_bf16 v[148:151], a[84:87], a[96:99], v[148:151]
    v_mfma_f32_16x16x32_bf16 v[180:183], a[84:87], a[100:103], v[180:183]
    v_mfma_f32_16x16x32_bf16 v[212:215], a[84:87], a[104:107], v[212:215]
    v_mfma_f32_16x16x32_bf16 v[244:247], a[84:87], a[108:111], v[244:247]
    s_waitcnt lgkmcnt(0)
    s_waitcnt vmcnt(5)
    s_barrier
    v_mfma_f32_16x16x32_bf16 v[56:59], a[0:3], a[32:35], v[56:59]
    s_mov_b32 s72, 32768
    buffer_load_dwordx4 a[192:195], v1, s[4:7], s72 offen offset:0 nt
    v_mfma_f32_16x16x32_bf16 v[88:91], a[0:3], a[36:39], v[88:91]
    v_mfma_f32_16x16x32_bf16 v[120:123], a[0:3], a[40:43], v[120:123]
    v_mfma_f32_16x16x32_bf16 v[152:155], a[0:3], a[44:47], v[152:155]
    v_mfma_f32_16x16x32_bf16 v[184:187], a[0:3], a[48:51], v[184:187]
    v_mfma_f32_16x16x32_bf16 v[216:219], a[0:3], a[52:55], v[216:219]
    v_mfma_f32_16x16x32_bf16 v[60:63], a[4:7], a[32:35], v[60:63]
    v_mfma_f32_16x16x32_bf16 v[92:95], a[4:7], a[36:39], v[92:95]
    v_mfma_f32_16x16x32_bf16 v[124:127], a[4:7], a[40:43], v[124:127]
    v_mfma_f32_16x16x32_bf16 v[156:159], a[4:7], a[44:47], v[156:159]
    ds_read_b128 a[88:91], v12 offset:52288
    ds_read_b128 a[92:95], v12 offset:54464
    v_mfma_f32_16x16x32_bf16 v[188:191], a[4:7], a[48:51], v[188:191]
    v_mfma_f32_16x16x32_bf16 v[220:223], a[4:7], a[52:55], v[220:223]
    ds_read_b128 a[96:99], v12 offset:56640
    ds_read_b128 a[100:103], v52 offset:52288
    v_mfma_f32_16x16x32_bf16 v[64:67], a[8:11], a[32:35], v[64:67]
    s_mov_b32 s72, 32768
    buffer_load_dwordx4 a[196:199], v2, s[4:7], s72 offen offset:1024 nt
    v_mfma_f32_16x16x32_bf16 v[96:99], a[8:11], a[36:39], v[96:99]
    ds_read_b128 a[104:107], v52 offset:54464
    ds_read_b128 a[108:111], v52 offset:56640
    v_mfma_f32_16x16x32_bf16 v[128:131], a[8:11], a[40:43], v[128:131]
    v_mfma_f32_16x16x32_bf16 v[160:163], a[8:11], a[44:47], v[160:163]
    ds_read_b64_tr_b16 a[56:57], v13 offset:32768
    ds_read_b64_tr_b16 a[58:59], v13 offset:36864
    v_mfma_f32_16x16x32_bf16 v[192:195], a[8:11], a[48:51], v[192:195]
    v_mfma_f32_16x16x32_bf16 v[224:227], a[8:11], a[52:55], v[224:227]
    ds_read_b64_tr_b16 a[60:61], v13 offset:32776
    ds_read_b64_tr_b16 a[62:63], v13 offset:36872
    v_mfma_f32_16x16x32_bf16 v[68:71], a[12:15], a[32:35], v[68:71]
    v_mfma_f32_16x16x32_bf16 v[100:103], a[12:15], a[36:39], v[100:103]
    ds_read_b64_tr_b16 a[64:65], v13 offset:33024
    ds_read_b64_tr_b16 a[66:67], v13 offset:37120
    v_mfma_f32_16x16x32_bf16 v[132:135], a[12:15], a[40:43], v[132:135]
    v_mfma_f32_16x16x32_bf16 v[164:167], a[12:15], a[44:47], v[164:167]
    ds_read_b64_tr_b16 a[68:69], v13 offset:33032
    ds_read_b64_tr_b16 a[70:71], v13 offset:37128
    v_mfma_f32_16x16x32_bf16 v[196:199], a[12:15], a[48:51], v[196:199]
    s_mov_b32 s72, 32768
    buffer_load_dwordx4 a[200:203], v1, s[4:7], s72 offen offset:2048 nt
    v_mfma_f32_16x16x32_bf16 v[228:231], a[12:15], a[52:55], v[228:231]
    ds_read_b64_tr_b16 a[72:73], v13 offset:33280
    ds_read_b64_tr_b16 a[74:75], v13 offset:37376
    v_mfma_f32_16x16x32_bf16 v[72:75], a[16:19], a[32:35], v[72:75]
    v_mfma_f32_16x16x32_bf16 v[104:107], a[16:19], a[36:39], v[104:107]
    ds_read_b64_tr_b16 a[76:77], v13 offset:33288
    ds_read_b64_tr_b16 a[78:79], v13 offset:37384
    v_mfma_f32_16x16x32_bf16 v[136:139], a[16:19], a[40:43], v[136:139]
    v_mfma_f32_16x16x32_bf16 v[168:171], a[16:19], a[44:47], v[168:171]
    ds_read_b64_tr_b16 a[80:81], v13 offset:33536
    ds_read_b64_tr_b16 a[82:83], v13 offset:37632
    v_mfma_f32_16x16x32_bf16 v[200:203], a[16:19], a[48:51], v[200:203]
    v_mfma_f32_16x16x32_bf16 v[232:235], a[16:19], a[52:55], v[232:235]
    ds_read_b64_tr_b16 a[84:85], v13 offset:33544
    ds_read_b64_tr_b16 a[86:87], v13 offset:37640
    v_mfma_f32_16x16x32_bf16 v[76:79], a[20:23], a[32:35], v[76:79]
    v_mfma_f32_16x16x32_bf16 v[108:111], a[20:23], a[36:39], v[108:111]
    v_mfma_f32_16x16x32_bf16 v[140:143], a[20:23], a[40:43], v[140:143]
    v_mfma_f32_16x16x32_bf16 v[172:175], a[20:23], a[44:47], v[172:175]
    s_mov_b32 s72, 32768
    buffer_load_dwordx4 a[204:207], v2, s[4:7], s72 offen offset:3072 nt
    v_mfma_f32_16x16x32_bf16 v[204:207], a[20:23], a[48:51], v[204:207]
    v_mfma_f32_16x16x32_bf16 v[236:239], a[20:23], a[52:55], v[236:239]
    v_mfma_f32_16x16x32_bf16 v[80:83], a[24:27], a[32:35], v[80:83]
    v_mfma_f32_16x16x32_bf16 v[112:115], a[24:27], a[36:39], v[112:115]
    v_mfma_f32_16x16x32_bf16 v[144:147], a[24:27], a[40:43], v[144:147]
    v_mfma_f32_16x16x32_bf16 v[176:179], a[24:27], a[44:47], v[176:179]
    v_mfma_f32_16x16x32_bf16 v[208:211], a[24:27], a[48:51], v[208:211]
    v_mfma_f32_16x16x32_bf16 v[240:243], a[24:27], a[52:55], v[240:243]
    v_mfma_f32_16x16x32_bf16 v[84:87], a[28:31], a[32:35], v[84:87]
    v_mfma_f32_16x16x32_bf16 v[116:119], a[28:31], a[36:39], v[116:119]
    v_mfma_f32_16x16x32_bf16 v[148:151], a[28:31], a[40:43], v[148:151]
    v_mfma_f32_16x16x32_bf16 v[180:183], a[28:31], a[44:47], v[180:183]
    v_mfma_f32_16x16x32_bf16 v[212:215], a[28:31], a[48:51], v[212:215]
    v_mfma_f32_16x16x32_bf16 v[244:247], a[28:31], a[52:55], v[244:247]
    s_waitcnt lgkmcnt(0)
    s_barrier
    v_mfma_f32_16x16x32_bf16 v[244:247], a[84:87], a[108:111], v[244:247]
    ds_write_b128 v254, v[20:23] offset:32768
    ds_write_b128 v254, v[24:27] offset:33792
    v_mfma_f32_16x16x32_bf16 v[240:243], a[80:83], a[108:111], v[240:243]
    ds_write_b128 v254, v[28:31] offset:34816
    ds_write_b128 v254, v[32:35] offset:35840
    v_mfma_f32_16x16x32_bf16 v[236:239], a[76:79], a[108:111], v[236:239]
    ds_write_b128 v254, v[36:39] offset:40960
    ds_write_b128 v254, v[40:43] offset:41984
    v_mfma_f32_16x16x32_bf16 v[232:235], a[72:75], a[108:111], v[232:235]
    ds_write_b128 v254, v[44:47] offset:43008
    ds_write_b128 v254, v[48:51] offset:44032
    v_mfma_f32_16x16x32_bf16 v[228:231], a[68:71], a[108:111], v[228:231]
    ds_write_b128 v255, a[112:115] offset:0
    ds_write_b128 v255, a[116:119] offset:1024
    v_mfma_f32_16x16x32_bf16 v[224:227], a[64:67], a[108:111], v[224:227]
    ds_write_b128 v255, a[120:123] offset:2048
    ds_write_b128 v255, a[124:127] offset:3072
    v_mfma_f32_16x16x32_bf16 v[220:223], a[60:63], a[108:111], v[220:223]
    ds_write_b128 v255, a[128:131] offset:8192
    ds_write_b128 v255, a[132:135] offset:9216
    v_mfma_f32_16x16x32_bf16 v[216:219], a[56:59], a[108:111], v[216:219]
    ds_write_b128 v255, a[136:139] offset:10240
    ds_write_b128 v255, a[140:143] offset:11264
    v_mfma_f32_16x16x32_bf16 v[212:215], a[84:87], a[104:107], v[212:215]
    ds_write_b128 v255, a[144:147] offset:32768
    ds_write_b128 v255, a[148:151] offset:33792
    v_mfma_f32_16x16x32_bf16 v[208:211], a[80:83], a[104:107], v[208:211]
    ds_write_b128 v255, a[152:155] offset:34816
    ds_write_b128 v255, a[156:159] offset:35840
    v_mfma_f32_16x16x32_bf16 v[204:207], a[76:79], a[104:107], v[204:207]
    v_mfma_f32_16x16x32_bf16 v[200:203], a[72:75], a[104:107], v[200:203]
    v_pk_mul_f32 v[244:245], v[244:245], s[62:63]
    v_pk_mul_f32 v[246:247], v[246:247], s[62:63]
    v_mfma_f32_16x16x32_bf16 v[196:199], a[68:71], a[104:107], v[196:199]
    s_mov_b32 s72, 40960
    buffer_load_dwordx4 a[220:223], v1, s[28:31], s72 offen offset:0 nt
    v_mfma_f32_16x16x32_bf16 v[192:195], a[64:67], a[104:107], v[192:195]
    v_cvt_pk_bf16_f32 v247, v246, v247
    v_cvt_pk_bf16_f32 v246, v244, v245
    v_mfma_f32_16x16x32_bf16 v[188:191], a[60:63], a[104:107], v[188:191]
    v_pk_mul_f32 v[240:241], v[240:241], s[62:63]
    v_pk_mul_f32 v[242:243], v[242:243], s[62:63]
    v_mfma_f32_16x16x32_bf16 v[184:187], a[56:59], a[104:107], v[184:187]
    ds_write_b128 v255, a[160:163] offset:40960
    v_mfma_f32_16x16x32_bf16 v[180:183], a[84:87], a[100:103], v[180:183]
    v_cvt_pk_bf16_f32 v245, v242, v243
    v_cvt_pk_bf16_f32 v244, v240, v241
    v_mfma_f32_16x16x32_bf16 v[176:179], a[80:83], a[100:103], v[176:179]
    s_mov_b32 s72, 40960
    buffer_load_dwordx4 a[224:227], v2, s[28:31], s72 offen offset:1024 nt
    v_mfma_f32_16x16x32_bf16 v[172:175], a[76:79], a[100:103], v[172:175]
    v_pk_mul_f32 v[236:237], v[236:237], s[62:63]
    v_pk_mul_f32 v[238:239], v[238:239], s[62:63]
    v_mfma_f32_16x16x32_bf16 v[168:171], a[72:75], a[100:103], v[168:171]
    v_cvt_pk_bf16_f32 v243, v238, v239
    v_cvt_pk_bf16_f32 v242, v236, v237
    v_mfma_f32_16x16x32_bf16 v[164:167], a[68:71], a[100:103], v[164:167]
    ds_write_b128 v255, a[164:167] offset:41984
    v_mfma_f32_16x16x32_bf16 v[160:163], a[64:67], a[100:103], v[160:163]
    v_pk_mul_f32 v[232:233], v[232:233], s[62:63]
    v_pk_mul_f32 v[234:235], v[234:235], s[62:63]
    v_mfma_f32_16x16x32_bf16 v[156:159], a[60:63], a[100:103], v[156:159]
    s_mov_b32 s72, 40960
    buffer_load_dwordx4 a[228:231], v1, s[28:31], s72 offen offset:2048 nt
    v_mfma_f32_16x16x32_bf16 v[152:155], a[56:59], a[100:103], v[152:155]
    v_cvt_pk_bf16_f32 v241, v234, v235
    v_cvt_pk_bf16_f32 v240, v232, v233
    v_mfma_f32_16x16x32_bf16 v[148:151], a[84:87], a[96:99], v[148:151]
    v_pk_mul_f32 v[228:229], v[228:229], s[62:63]
    v_pk_mul_f32 v[230:231], v[230:231], s[62:63]
    v_mfma_f32_16x16x32_bf16 v[144:147], a[80:83], a[96:99], v[144:147]
    ds_write_b128 v255, a[168:171] offset:43008
    v_mfma_f32_16x16x32_bf16 v[140:143], a[76:79], a[96:99], v[140:143]
    v_cvt_pk_bf16_f32 v239, v230, v231
    v_cvt_pk_bf16_f32 v238, v228, v229
    v_mfma_f32_16x16x32_bf16 v[136:139], a[72:75], a[96:99], v[136:139]
    s_mov_b32 s72, 40960
    buffer_load_dwordx4 a[232:235], v2, s[28:31], s72 offen offset:3072 nt
    v_mfma_f32_16x16x32_bf16 v[132:135], a[68:71], a[96:99], v[132:135]
    v_pk_mul_f32 v[224:225], v[224:225], s[62:63]
    v_pk_mul_f32 v[226:227], v[226:227], s[62:63]
    v_mfma_f32_16x16x32_bf16 v[128:131], a[64:67], a[96:99], v[128:131]
    v_cvt_pk_bf16_f32 v237, v226, v227
    v_cvt_pk_bf16_f32 v236, v224, v225
    v_mfma_f32_16x16x32_bf16 v[124:127], a[60:63], a[96:99], v[124:127]
    s_waitcnt vmcnt(12)
    ds_write_b128 v255, a[172:175] offset:44032
    v_mfma_f32_16x16x32_bf16 v[120:123], a[56:59], a[96:99], v[120:123]
    v_pk_mul_f32 v[220:221], v[220:221], s[62:63]
    v_pk_mul_f32 v[222:223], v[222:223], s[62:63]
    v_mfma_f32_16x16x32_bf16 v[116:119], a[84:87], a[92:95], v[116:119]
    s_mov_b32 s72, 40960
    buffer_load_dwordx4 a[236:239], v1, s[4:7], s72 offen offset:0 nt
    v_mfma_f32_16x16x32_bf16 v[112:115], a[80:83], a[92:95], v[112:115]
    v_cvt_pk_bf16_f32 v235, v222, v223
    v_cvt_pk_bf16_f32 v234, v220, v221
    v_mfma_f32_16x16x32_bf16 v[108:111], a[76:79], a[92:95], v[108:111]
    v_pk_mul_f32 v[216:217], v[216:217], s[62:63]
    v_pk_mul_f32 v[218:219], v[218:219], s[62:63]
    v_mfma_f32_16x16x32_bf16 v[104:107], a[72:75], a[92:95], v[104:107]
    s_waitcnt vmcnt(12)
    ds_write_b128 v15, a[176:179] offset:0
    v_mfma_f32_16x16x32_bf16 v[100:103], a[68:71], a[92:95], v[100:103]
    v_cvt_pk_bf16_f32 v233, v218, v219
    v_cvt_pk_bf16_f32 v232, v216, v217
    v_mfma_f32_16x16x32_bf16 v[96:99], a[64:67], a[92:95], v[96:99]
    s_mov_b32 s72, 40960
    buffer_load_dwordx4 a[240:243], v2, s[4:7], s72 offen offset:1024 nt
    v_mfma_f32_16x16x32_bf16 v[92:95], a[60:63], a[92:95], v[92:95]
    v_pk_mul_f32 v[212:213], v[212:213], s[62:63]
    v_pk_mul_f32 v[214:215], v[214:215], s[62:63]
    v_mfma_f32_16x16x32_bf16 v[88:91], a[56:59], a[92:95], v[88:91]
    v_cvt_pk_bf16_f32 v231, v214, v215
    v_cvt_pk_bf16_f32 v230, v212, v213
    v_mfma_f32_16x16x32_bf16 v[84:87], a[84:87], a[88:91], v[84:87]
    s_waitcnt vmcnt(12)
    ds_write_b128 v15, a[180:183] offset:1024
    v_mfma_f32_16x16x32_bf16 v[80:83], a[80:83], a[88:91], v[80:83]
    v_pk_mul_f32 v[208:209], v[208:209], s[62:63]
    v_pk_mul_f32 v[210:211], v[210:211], s[62:63]
    v_mfma_f32_16x16x32_bf16 v[76:79], a[76:79], a[88:91], v[76:79]
    s_mov_b32 s72, 40960
    buffer_load_dwordx4 a[244:247], v1, s[4:7], s72 offen offset:2048 nt
    v_mfma_f32_16x16x32_bf16 v[72:75], a[72:75], a[88:91], v[72:75]
    v_cvt_pk_bf16_f32 v229, v210, v211
    v_cvt_pk_bf16_f32 v228, v208, v209
    v_mfma_f32_16x16x32_bf16 v[68:71], a[68:71], a[88:91], v[68:71]
    v_pk_mul_f32 v[204:205], v[204:205], s[62:63]
    v_pk_mul_f32 v[206:207], v[206:207], s[62:63]
    v_mfma_f32_16x16x32_bf16 v[64:67], a[64:67], a[88:91], v[64:67]
    s_waitcnt vmcnt(12)
    ds_write_b128 v15, a[184:187] offset:2048
    v_mfma_f32_16x16x32_bf16 v[60:63], a[60:63], a[88:91], v[60:63]
    v_cvt_pk_bf16_f32 v227, v206, v207
    v_cvt_pk_bf16_f32 v226, v204, v205
    v_mfma_f32_16x16x32_bf16 v[56:59], a[56:59], a[88:91], v[56:59]
    s_mov_b32 s72, 40960
    buffer_load_dwordx4 a[248:251], v2, s[4:7], s72 offen offset:3072 nt
    v_pk_mul_f32 v[200:201], v[200:201], s[62:63]
    v_pk_mul_f32 v[202:203], v[202:203], s[62:63]
    v_cvt_pk_bf16_f32 v225, v202, v203
    v_cvt_pk_bf16_f32 v224, v200, v201
    s_waitcnt vmcnt(12)
    ds_write_b128 v15, a[188:191] offset:3072
    v_pk_mul_f32 v[196:197], v[196:197], s[62:63]
    v_pk_mul_f32 v[198:199], v[198:199], s[62:63]
    v_cvt_pk_bf16_f32 v223, v198, v199
    v_cvt_pk_bf16_f32 v222, v196, v197
    v_pk_mul_f32 v[192:193], v[192:193], s[62:63]
    v_pk_mul_f32 v[194:195], v[194:195], s[62:63]
    s_waitcnt vmcnt(11)
    ds_write_b128 v15, a[192:195] offset:8192
    v_cvt_pk_bf16_f32 v221, v194, v195
    v_cvt_pk_bf16_f32 v220, v192, v193
    v_pk_mul_f32 v[188:189], v[188:189], s[62:63]
    v_pk_mul_f32 v[190:191], v[190:191], s[62:63]
    v_cvt_pk_bf16_f32 v219, v190, v191
    v_cvt_pk_bf16_f32 v218, v188, v189
    s_waitcnt vmcnt(10)
    ds_write_b128 v15, a[196:199] offset:9216
    v_pk_mul_f32 v[184:185], v[184:185], s[62:63]
    v_pk_mul_f32 v[186:187], v[186:187], s[62:63]
    v_cvt_pk_bf16_f32 v217, v186, v187
    v_cvt_pk_bf16_f32 v216, v184, v185
    v_pk_mul_f32 v[180:181], v[180:181], s[62:63]
    v_pk_mul_f32 v[182:183], v[182:183], s[62:63]
    s_waitcnt vmcnt(9)
    ds_write_b128 v15, a[200:203] offset:10240
    v_cvt_pk_bf16_f32 v215, v182, v183
    v_cvt_pk_bf16_f32 v214, v180, v181
    v_pk_mul_f32 v[176:177], v[176:177], s[62:63]
    v_pk_mul_f32 v[178:179], v[178:179], s[62:63]
    v_cvt_pk_bf16_f32 v213, v178, v179
    v_cvt_pk_bf16_f32 v212, v176, v177
    s_waitcnt vmcnt(8)
    ds_write_b128 v15, a[204:207] offset:11264
    v_pk_mul_f32 v[172:173], v[172:173], s[62:63]
    v_pk_mul_f32 v[174:175], v[174:175], s[62:63]
    v_cvt_pk_bf16_f32 v211, v174, v175
    v_cvt_pk_bf16_f32 v210, v172, v173
    v_pk_mul_f32 v[168:169], v[168:169], s[62:63]
    v_pk_mul_f32 v[170:171], v[170:171], s[62:63]
    v_cvt_pk_bf16_f32 v209, v170, v171
    v_cvt_pk_bf16_f32 v208, v168, v169
    v_pk_mul_f32 v[164:165], v[164:165], s[62:63]
    v_pk_mul_f32 v[166:167], v[166:167], s[62:63]
    v_cvt_pk_bf16_f32 v207, v166, v167
    v_cvt_pk_bf16_f32 v206, v164, v165
    v_pk_mul_f32 v[160:161], v[160:161], s[62:63]
    v_pk_mul_f32 v[162:163], v[162:163], s[62:63]
    v_cvt_pk_bf16_f32 v205, v162, v163
    v_cvt_pk_bf16_f32 v204, v160, v161
    v_pk_mul_f32 v[156:157], v[156:157], s[62:63]
    v_pk_mul_f32 v[158:159], v[158:159], s[62:63]
    v_cvt_pk_bf16_f32 v203, v158, v159
    v_cvt_pk_bf16_f32 v202, v156, v157
    v_pk_mul_f32 v[152:153], v[152:153], s[62:63]
    v_pk_mul_f32 v[154:155], v[154:155], s[62:63]
    v_cvt_pk_bf16_f32 v201, v154, v155
    v_cvt_pk_bf16_f32 v200, v152, v153
    v_pk_mul_f32 v[148:149], v[148:149], s[62:63]
    v_pk_mul_f32 v[150:151], v[150:151], s[62:63]
    v_cvt_pk_bf16_f32 v199, v150, v151
    v_cvt_pk_bf16_f32 v198, v148, v149
    v_pk_mul_f32 v[144:145], v[144:145], s[62:63]
    v_pk_mul_f32 v[146:147], v[146:147], s[62:63]
    v_cvt_pk_bf16_f32 v197, v146, v147
    v_cvt_pk_bf16_f32 v196, v144, v145
    v_pk_mul_f32 v[140:141], v[140:141], s[62:63]
    v_pk_mul_f32 v[142:143], v[142:143], s[62:63]
    v_cvt_pk_bf16_f32 v195, v142, v143
    v_cvt_pk_bf16_f32 v194, v140, v141
    v_pk_mul_f32 v[136:137], v[136:137], s[62:63]
    v_pk_mul_f32 v[138:139], v[138:139], s[62:63]
    v_cvt_pk_bf16_f32 v193, v138, v139
    v_cvt_pk_bf16_f32 v192, v136, v137
    v_pk_mul_f32 v[132:133], v[132:133], s[62:63]
    v_pk_mul_f32 v[134:135], v[134:135], s[62:63]
    v_cvt_pk_bf16_f32 v191, v134, v135
    v_cvt_pk_bf16_f32 v190, v132, v133
    v_pk_mul_f32 v[128:129], v[128:129], s[62:63]
    v_pk_mul_f32 v[130:131], v[130:131], s[62:63]
    v_cvt_pk_bf16_f32 v189, v130, v131
    v_cvt_pk_bf16_f32 v188, v128, v129
    v_pk_mul_f32 v[124:125], v[124:125], s[62:63]
    v_pk_mul_f32 v[126:127], v[126:127], s[62:63]
    v_cvt_pk_bf16_f32 v187, v126, v127
    v_cvt_pk_bf16_f32 v186, v124, v125
    v_pk_mul_f32 v[120:121], v[120:121], s[62:63]
    v_pk_mul_f32 v[122:123], v[122:123], s[62:63]
    v_cvt_pk_bf16_f32 v185, v122, v123
    v_cvt_pk_bf16_f32 v184, v120, v121
    v_pk_mul_f32 v[116:117], v[116:117], s[62:63]
    v_pk_mul_f32 v[118:119], v[118:119], s[62:63]
    v_cvt_pk_bf16_f32 v183, v118, v119
    v_cvt_pk_bf16_f32 v182, v116, v117
    v_pk_mul_f32 v[112:113], v[112:113], s[62:63]
    v_pk_mul_f32 v[114:115], v[114:115], s[62:63]
    v_cvt_pk_bf16_f32 v181, v114, v115
    v_cvt_pk_bf16_f32 v180, v112, v113
    v_pk_mul_f32 v[108:109], v[108:109], s[62:63]
    v_pk_mul_f32 v[110:111], v[110:111], s[62:63]
    v_cvt_pk_bf16_f32 v179, v110, v111
    v_cvt_pk_bf16_f32 v178, v108, v109
    v_pk_mul_f32 v[104:105], v[104:105], s[62:63]
    v_pk_mul_f32 v[106:107], v[106:107], s[62:63]
    v_cvt_pk_bf16_f32 v177, v106, v107
    v_cvt_pk_bf16_f32 v176, v104, v105
    v_pk_mul_f32 v[100:101], v[100:101], s[62:63]
    v_pk_mul_f32 v[102:103], v[102:103], s[62:63]
    v_cvt_pk_bf16_f32 v175, v102, v103
    v_cvt_pk_bf16_f32 v174, v100, v101
    v_pk_mul_f32 v[96:97], v[96:97], s[62:63]
    v_pk_mul_f32 v[98:99], v[98:99], s[62:63]
    v_cvt_pk_bf16_f32 v173, v98, v99
    v_cvt_pk_bf16_f32 v172, v96, v97
    v_pk_mul_f32 v[92:93], v[92:93], s[62:63]
    v_pk_mul_f32 v[94:95], v[94:95], s[62:63]
    v_cvt_pk_bf16_f32 v171, v94, v95
    v_cvt_pk_bf16_f32 v170, v92, v93
    v_pk_mul_f32 v[88:89], v[88:89], s[62:63]
    v_pk_mul_f32 v[90:91], v[90:91], s[62:63]
    v_cvt_pk_bf16_f32 v169, v90, v91
    v_cvt_pk_bf16_f32 v168, v88, v89
    v_pk_mul_f32 v[84:85], v[84:85], s[62:63]
    v_pk_mul_f32 v[86:87], v[86:87], s[62:63]
    v_cvt_pk_bf16_f32 v167, v86, v87
    v_cvt_pk_bf16_f32 v166, v84, v85
    v_pk_mul_f32 v[80:81], v[80:81], s[62:63]
    v_pk_mul_f32 v[82:83], v[82:83], s[62:63]
    v_cvt_pk_bf16_f32 v165, v82, v83
    v_cvt_pk_bf16_f32 v164, v80, v81
    v_pk_mul_f32 v[76:77], v[76:77], s[62:63]
    v_pk_mul_f32 v[78:79], v[78:79], s[62:63]
    v_cvt_pk_bf16_f32 v163, v78, v79
    v_cvt_pk_bf16_f32 v162, v76, v77
    v_pk_mul_f32 v[72:73], v[72:73], s[62:63]
    v_pk_mul_f32 v[74:75], v[74:75], s[62:63]
    v_cvt_pk_bf16_f32 v161, v74, v75
    v_cvt_pk_bf16_f32 v160, v72, v73
    v_pk_mul_f32 v[68:69], v[68:69], s[62:63]
    v_pk_mul_f32 v[70:71], v[70:71], s[62:63]
    v_cvt_pk_bf16_f32 v159, v70, v71
    v_cvt_pk_bf16_f32 v158, v68, v69
    v_pk_mul_f32 v[64:65], v[64:65], s[62:63]
    v_pk_mul_f32 v[66:67], v[66:67], s[62:63]
    v_cvt_pk_bf16_f32 v157, v66, v67
    v_cvt_pk_bf16_f32 v156, v64, v65
    v_pk_mul_f32 v[60:61], v[60:61], s[62:63]
    v_pk_mul_f32 v[62:63], v[62:63], s[62:63]
    v_cvt_pk_bf16_f32 v155, v62, v63
    v_cvt_pk_bf16_f32 v154, v60, v61
    v_pk_mul_f32 v[56:57], v[56:57], s[62:63]
    v_pk_mul_f32 v[58:59], v[58:59], s[62:63]
    v_cvt_pk_bf16_f32 v153, v58, v59
    v_cvt_pk_bf16_f32 v152, v56, v57
    v_bfe_u32 v12, v0, 1, 2
    v_lshrrev_b32 v7, 4, v0
    v_xor_b32 v12, v12, v7
    v_lshlrev_b32 v12, 5, v12
    v_and_b32 v7, 1, v0
    v_lshl_add_u32 v12, v7, 4, v12
    v_lshrrev_b32 v7, 3, v0
    v_mul_u32_u24 v7, 1152, v7
    v_add_u32 v12, v12, v7
    s_lshl_b32 s72, s55, 8
    v_add_u32 v12, s72, v12
    s_waitcnt lgkmcnt(0)
    s_lshr_b32 s72, s2, 3
    s_lshl_b32 s73, s54, 5
    s_add_u32 s72, s72, s73
    s_lshl_b32 s72, s72, 2
    s_add_u32 s72, s72, s48
    s_mul_i32 s72, s72, 9216
    v_and_b32 v255, 15, v0
    v_lshlrev_b32 v255, 7, v255
    v_add_u32 v255, s72, v255
    v_or_b32 v13, s48, v0
    v_min_u32 v13, 1, v13
    v_lshlrev_b32 v13, 30, v13
    v_mov_b32 v7, 1
    buffer_store_byte v7, v13, s[44:47], s57 offen sc1
    s_getpc_b64 s[20:21]
L_pc2:
    s_lshr_b32 s72, s2, 3
    s_and_b32 s72, s72, 15
    s_lshl_b32 s72, s72, 7
    s_lshl_b32 s73, s48, 15
    s_add_u32 s72, s72, s73
    v_lshrrev_b32 v10, 2, v0
    v_lshlrev_b32 v10, 11, v10
    v_add_u32 v10, s72, v10
    v_min_u32 v10, L_last-L_pc2, v10
    v_mov_b32 v11, s21
    v_add_co_u32 v10, vcc, s20, v10
    s_nop 1
    v_addc_co_u32 v11, vcc, 0, v11, vcc
    s_lshl_b32 s72, s49, 5
    s_add_u32 s72, s72, s53
    s_xor_b32 s74, s72, 1
    s_lshl_b32 s72, s72, 2
    s_lshl_b32 s74, s74, 2
    s_xor_b32 s73, s56, 1
    s_add_u32 s73, s73, s72
    s_add_u32 s72, s72, s56
    s_add_u32 s74, s74, s56
    s_mul_i32 s62, s72, 12288
    s_mul_i32 s63, s73, 12288
    s_mul_i32 s53, s74, 12288
    s_mul_i32 s60, s51, 12288
    s_sub_u32 s59, 12288, s60
    s_xor_b32 s50, s48, 2
    s_add_u32 s72, s55, 1
    s_and_b32 s72, s72, 3
    s_sub_u32 s72, s72, s55
    s_mul_i32 s72, s72, 98304
    s_add_u32 s11, s72, s62
    s_add_u32 s14, s72, s53
    s_add_u32 s72, s55, 2
    s_and_b32 s72, s72, 3
    s_sub_u32 s72, s72, s55
    s_mul_i32 s72, s72, 98304
    s_add_u32 s12, s72, s62
    s_add_u32 s15, s72, s53
    s_add_u32 s72, s55, 3
    s_and_b32 s72, s72, 3
    s_sub_u32 s72, s72, s55
    s_mul_i32 s72, s72, 98304
    s_add_u32 s13, s72, s62
    s_add_u32 s16, s72, s53
    s_barrier
    ds_read_b128 v[88:91], v3 offset:0
    ds_read_b128 v[92:95], v3 offset:256
    ds_read_b128 v[96:99], v3 offset:512
    ds_read_b128 v[100:103], v3 offset:768
    ds_read_b128 v[104:107], v3 offset:4096
    ds_read_b128 v[108:111], v3 offset:4352
    ds_read_b128 v[112:115], v3 offset:4608
    ds_read_b128 v[116:119], v3 offset:4864
    s_waitcnt lgkmcnt(7)
    v_mfma_f32_16x16x32_bf16 v[40:43], v[88:91], v[152:155], 0
    s_waitcnt lgkmcnt(6)
    v_mfma_f32_16x16x32_bf16 v[40:43], v[92:95], v[156:159], v[40:43]
    s_waitcnt lgkmcnt(5)
    v_mfma_f32_16x16x32_bf16 v[40:43], v[96:99], v[160:163], v[40:43]
    s_waitcnt lgkmcnt(4)
    v_mfma_f32_16x16x32_bf16 v[40:43], v[100:103], v[164:167], v[40:43]
    s_waitcnt lgkmcnt(3)
    v_mfma_f32_16x16x32_bf16 v[44:47], v[104:107], v[152:155], 0
    s_waitcnt lgkmcnt(2)
    v_mfma_f32_16x16x32_bf16 v[44:47], v[108:111], v[156:159], v[44:47]
    s_waitcnt lgkmcnt(1)
    v_mfma_f32_16x16x32_bf16 v[44:47], v[112:115], v[160:163], v[44:47]
    s_waitcnt lgkmcnt(0)
    v_mfma_f32_16x16x32_bf16 v[44:47], v[116:119], v[164:167], v[44:47]
    v_mfma_f32_16x16x32_bf16 v[48:51], v[88:91], v[168:171], 0
    ds_read_b64_tr_b16 v[120:121], v4 offset:0
    ds_read_b64_tr_b16 v[122:123], v4 offset:4096
    v_mfma_f32_16x16x32_bf16 v[48:51], v[92:95], v[172:175], v[48:51]
    ds_read_b64_tr_b16 v[124:125], v5 offset:0
    ds_read_b64_tr_b16 v[126:127], v5 offset:4096
    v_mfma_f32_16x16x32_bf16 v[48:51], v[96:99], v[176:179], v[48:51]
    ds_read_b64_tr_b16 v[128:129], v4 offset:256
    ds_read_b64_tr_b16 v[130:131], v4 offset:4352
    v_mfma_f32_16x16x32_bf16 v[48:51], v[100:103], v[180:183], v[48:51]
    ds_read_b64_tr_b16 v[132:133], v5 offset:256
    ds_read_b64_tr_b16 v[134:135], v5 offset:4352
    v_mfma_f32_16x16x32_bf16 v[52:55], v[104:107], v[168:171], 0
    ds_read_b64_tr_b16 v[136:137], v4 offset:512
    ds_read_b64_tr_b16 v[138:139], v4 offset:4608
    v_mfma_f32_16x16x32_bf16 v[52:55], v[108:111], v[172:175], v[52:55]
    ds_read_b64_tr_b16 v[140:141], v5 offset:512
    ds_read_b64_tr_b16 v[142:143], v5 offset:4608
    v_mfma_f32_16x16x32_bf16 v[52:55], v[112:115], v[176:179], v[52:55]
    ds_read_b64_tr_b16 v[144:145], v4 offset:768
    ds_read_b64_tr_b16 v[146:147], v4 offset:4864
    v_mfma_f32_16x16x32_bf16 v[52:55], v[116:119], v[180:183], v[52:55]
    ds_read_b64_tr_b16 v[148:149], v5 offset:768
    ds_read_b64_tr_b16 v[150:151], v5 offset:4864
    v_mfma_f32_16x16x32_bf16 v[56:59], v[88:91], v[184:187], 0
    v_mfma_f32_16x16x32_bf16 v[56:59], v[92:95], v[188:191], v[56:59]
    v_mfma_f32_16x16x32_bf16 v[56:59], v[96:99], v[192:195], v[56:59]
    v_max3_f32 v6, v40, v41, v42
    v_max3_f32 v6, v6, v43, v44
    v_mfma_f32_16x16x32_bf16 v[56:59], v[100:103], v[196:199], v[56:59]
    v_max3_f32 v6, v6, v45, v46
    v_max_f32 v6, v6, v47
    v_mfma_f32_16x16x32_bf16 v[60:63], v[104:107], v[184:187], 0
    v_mov_b32 v7, v6
    v_mfma_f32_16x16x32_bf16 v[60:63], v[108:111], v[188:191], v[60:63]
    s_nop 0
    v_permlane32_swap_b32 v7, v6
    v_max_f32 v6, v6, v7
    v_mfma_f32_16x16x32_bf16 v[60:63], v[112:115], v[192:195], v[60:63]
    v_mov_b32 v7, v6
    v_mfma_f32_16x16x32_bf16 v[60:63], v[116:119], v[196:199], v[60:63]
    s_nop 0
    v_permlane16_swap_b32 v7, v6
    v_max_f32 v6, v6, v7
    v_mfma_f32_16x16x32_bf16 v[64:67], v[88:91], v[200:203], 0
    v_sub_f32 v40, v40, v6
    v_sub_f32 v41, v41, v6
    v_mfma_f32_16x16x32_bf16 v[64:67], v[92:95], v[204:207], v[64:67]
    v_sub_f32 v42, v42, v6
    v_sub_f32 v43, v43, v6
    v_mfma_f32_16x16x32_bf16 v[64:67], v[96:99], v[208:211], v[64:67]
    v_sub_f32 v44, v44, v6
    v_sub_f32 v45, v45, v6
    v_mfma_f32_16x16x32_bf16 v[64:67], v[100:103], v[212:215], v[64:67]
    v_sub_f32 v46, v46, v6
    v_sub_f32 v47, v47, v6
    v_mfma_f32_16x16x32_bf16 v[68:71], v[104:107], v[200:203], 0
    v_sub_f32 v16, 0, v6
    v_sub_f32 v17, 0, v6
    v_mfma_f32_16x16x32_bf16 v[68:71], v[108:111], v[204:207], v[68:71]
    v_sub_f32 v18, 0, v6
    v_sub_f32 v19, 0, v6
    v_mfma_f32_16x16x32_bf16 v[68:71], v[112:115], v[208:211], v[68:71]
    v_max3_f32 v6, v48, v49, v50
    v_max3_f32 v6, v6, v51, v52
    v_mfma_f32_16x16x32_bf16 v[68:71], v[116:119], v[212:215], v[68:71]
    v_max3_f32 v6, v6, v53, v54
    v_max_f32 v6, v6, v55
    v_mov_b32 v7, v6
    s_nop 1
    v_permlane32_swap_b32 v7, v6
    v_max_f32 v6, v6, v7
    v_mov_b32 v7, v6
    s_nop 1
    v_permlane16_swap_b32 v7, v6
    v_max_f32 v6, v6, v7
    v_sub_f32 v48, v48, v6
    v_sub_f32 v49, v49, v6
    v_sub_f32 v50, v50, v6
    v_sub_f32 v51, v51, v6
    v_sub_f32 v52, v52, v6
    v_sub_f32 v53, v53, v6
    v_sub_f32 v54, v54, v6
    v_sub_f32 v55, v55, v6
    v_sub_f32 v20, 0, v6
    v_sub_f32 v21, 0, v6
    v_sub_f32 v22, 0, v6
    v_sub_f32 v23, 0, v6
    v_exp_f32 v40, v40
    v_exp_f32 v41, v41
    v_exp_f32 v42, v42
    v_exp_f32 v43, v43
    v_cvt_pk_bf16_f32 v40, v40, v41
    v_cvt_pk_bf16_f32 v41, v42, v43
    v_exp_f32 v44, v44
    v_exp_f32 v45, v45
    v_exp_f32 v46, v46
    v_exp_f32 v47, v47
    v_cvt_pk_bf16_f32 v42, v44, v45
    v_cvt_pk_bf16_f32 v43, v46, v47
    s_waitcnt lgkmcnt(0)
    s_nop 0
    v_mfma_f32_16x16x32_bf16 a[0:3], v[120:123], v[40:43], 0
    v_exp_f32 v48, v48
    v_mfma_f32_16x16x32_bf16 a[4:7], v[124:127], v[40:43], 0
    v_exp_f32 v49, v49
    v_mfma_f32_16x16x32_bf16 a[8:11], v[128:131], v[40:43], 0
    v_exp_f32 v50, v50
    v_mfma_f32_16x16x32_bf16 a[12:15], v[132:135], v[40:43], 0
    v_exp_f32 v51, v51
    v_mfma_f32_16x16x32_bf16 a[16:19], v[136:139], v[40:43], 0
    v_cvt_pk_bf16_f32 v48, v48, v49
    v_cvt_pk_bf16_f32 v49, v50, v51
    v_mfma_f32_16x16x32_bf16 a[20:23], v[140:143], v[40:43], 0
    v_exp_f32 v52, v52
    v_mfma_f32_16x16x32_bf16 a[24:27], v[144:147], v[40:43], 0
    v_exp_f32 v53, v53
    v_mfma_f32_16x16x32_bf16 a[28:31], v[148:151], v[40:43], 0
    v_exp_f32 v54, v54
    v_mfma_f32_16x16x32_bf16 a[192:195], a[216:219], v[40:43], 0
    v_exp_f32 v55, v55
    v_mfma_f32_16x16x32_bf16 v[72:75], v[88:91], v[216:219], 0
    v_cvt_pk_bf16_f32 v50, v52, v53
    v_cvt_pk_bf16_f32 v51, v54, v55
    v_mfma_f32_16x16x32_bf16 v[72:75], v[92:95], v[220:223], v[72:75]
    v_max3_f32 v6, v56, v57, v58
    v_max3_f32 v6, v6, v59, v60
    v_mfma_f32_16x16x32_bf16 v[72:75], v[96:99], v[224:227], v[72:75]
    v_max3_f32 v6, v6, v61, v62
    v_max_f32 v6, v6, v63
    v_mfma_f32_16x16x32_bf16 v[72:75], v[100:103], v[228:231], v[72:75]
    v_mov_b32 v7, v6
    v_mfma_f32_16x16x32_bf16 v[76:79], v[104:107], v[216:219], 0
    s_nop 0
    v_permlane32_swap_b32 v7, v6
    v_max_f32 v6, v6, v7
    v_mfma_f32_16x16x32_bf16 v[76:79], v[108:111], v[220:223], v[76:79]
    v_mov_b32 v7, v6
    v_mfma_f32_16x16x32_bf16 v[76:79], v[112:115], v[224:227], v[76:79]
    s_nop 0
    v_permlane16_swap_b32 v7, v6
    v_max_f32 v6, v6, v7
    v_mfma_f32_16x16x32_bf16 v[76:79], v[116:119], v[228:231], v[76:79]
    v_sub_f32 v56, v56, v6
    v_sub_f32 v57, v57, v6
    v_mfma_f32_16x16x32_bf16 a[32:35], v[120:123], v[48:51], 0
    v_sub_f32 v58, v58, v6
    v_sub_f32 v59, v59, v6
    v_mfma_f32_16x16x32_bf16 a[36:39], v[124:127], v[48:51], 0
    v_sub_f32 v60, v60, v6
    v_sub_f32 v61, v61, v6
    v_mfma_f32_16x16x32_bf16 a[40:43], v[128:131], v[48:51], 0
    v_sub_f32 v62, v62, v6
    v_sub_f32 v63, v63, v6
    v_mfma_f32_16x16x32_bf16 a[44:47], v[132:135], v[48:51], 0
    v_sub_f32 v24, 0, v6
    v_sub_f32 v25, 0, v6
    v_mfma_f32_16x16x32_bf16 a[48:51], v[136:139], v[48:51], 0
    v_sub_f32 v26, 0, v6
    v_sub_f32 v27, 0, v6
    v_mfma_f32_16x16x32_bf16 a[52:55], v[140:143], v[48:51], 0
    v_max3_f32 v6, v64, v65, v66
    v_max3_f32 v6, v6, v67, v68
    v_mfma_f32_16x16x32_bf16 a[56:59], v[144:147], v[48:51], 0
    v_max3_f32 v6, v6, v69, v70
    v_max_f32 v6, v6, v71
    v_mfma_f32_16x16x32_bf16 a[60:63], v[148:151], v[48:51], 0
    v_mov_b32 v7, v6
    v_mfma_f32_16x16x32_bf16 a[196:199], a[216:219], v[48:51], 0
    s_nop 0
    v_permlane32_swap_b32 v7, v6
    v_max_f32 v6, v6, v7
    v_mov_b32 v7, v6
    s_nop 1
    v_permlane16_swap_b32 v7, v6
    v_max_f32 v6, v6, v7
    v_sub_f32 v64, v64, v6
    v_sub_f32 v65, v65, v6
    v_sub_f32 v66, v66, v6
    v_sub_f32 v67, v67, v6
    v_sub_f32 v68, v68, v6
    v_sub_f32 v69, v69, v6
    v_sub_f32 v70, v70, v6
    v_sub_f32 v71, v71, v6
    v_sub_f32 v28, 0, v6
    v_sub_f32 v29, 0, v6
    v_sub_f32 v30, 0, v6
    v_sub_f32 v31, 0, v6
    v_exp_f32 v56, v56
    v_exp_f32 v57, v57
    v_exp_f32 v58, v58
    v_exp_f32 v59, v59
    v_cvt_pk_bf16_f32 v56, v56, v57
    v_cvt_pk_bf16_f32 v57, v58, v59
    v_exp_f32 v60, v60
    v_exp_f32 v61, v61
    v_exp_f32 v62, v62
    v_exp_f32 v63, v63
    v_cvt_pk_bf16_f32 v58, v60, v61
    v_cvt_pk_bf16_f32 v59, v62, v63
    s_barrier
    v_mfma_f32_16x16x32_bf16 v[80:83], v[88:91], v[232:235], 0
    v_exp_f32 v64, v64
    v_mfma_f32_16x16x32_bf16 v[80:83], v[92:95], v[236:239], v[80:83]
    ds_read_b128 v[88:91], v3 offset:32768
    ds_read_b128 v[92:95], v3 offset:33024
    v_mfma_f32_16x16x32_bf16 v[80:83], v[96:99], v[240:243], v[80:83]
    v_exp_f32 v65, v65
    v_mfma_f32_16x16x32_bf16 v[80:83], v[100:103], v[244:247], v[80:83]
    ds_read_b128 v[96:99], v3 offset:33280
    ds_read_b128 v[100:103], v3 offset:33536
    v_mfma_f32_16x16x32_bf16 v[84:87], v[104:107], v[232:235], 0
    v_exp_f32 v66, v66
    v_mfma_f32_16x16x32_bf16 v[84:87], v[108:111], v[236:239], v[84:87]
    ds_read_b128 v[104:107], v3 offset:36864
    ds_read_b128 v[108:111], v3 offset:37120
    v_mfma_f32_16x16x32_bf16 v[84:87], v[112:115], v[240:243], v[84:87]
    v_exp_f32 v67, v67
    v_mfma_f32_16x16x32_bf16 v[84:87], v[116:119], v[244:247], v[84:87]
    ds_read_b128 v[112:115], v3 offset:37376
    ds_read_b128 v[116:119], v3 offset:37632
    v_mfma_f32_16x16x32_bf16 a[64:67], v[120:123], v[56:59], 0
    v_cvt_pk_bf16_f32 v64, v64, v65
    v_cvt_pk_bf16_f32 v65, v66, v67
    v_mfma_f32_16x16x32_bf16 a[68:71], v[124:127], v[56:59], 0
    v_exp_f32 v68, v68
    v_mfma_f32_16x16x32_bf16 a[72:75], v[128:131], v[56:59], 0
    v_exp_f32 v69, v69
    v_mfma_f32_16x16x32_bf16 a[76:79], v[132:135], v[56:59], 0
    v_exp_f32 v70, v70
    v_mfma_f32_16x16x32_bf16 a[80:83], v[136:139], v[56:59], 0
    v_exp_f32 v71, v71
    v_mfma_f32_16x16x32_bf16 a[84:87], v[140:143], v[56:59], 0
    v_cvt_pk_bf16_f32 v66, v68, v69
    v_cvt_pk_bf16_f32 v67, v70, v71
    v_mfma_f32_16x16x32_bf16 a[88:91], v[144:147], v[56:59], 0
    v_max3_f32 v6, v72, v73, v74
    v_max3_f32 v6, v6, v75, v76
    v_mfma_f32_16x16x32_bf16 a[92:95], v[148:151], v[56:59], 0
    v_max3_f32 v6, v6, v77, v78
    v_max_f32 v6, v6, v79
    v_mfma_f32_16x16x32_bf16 a[200:203], a[216:219], v[56:59], 0
    v_mov_b32 v7, v6
    s_waitcnt lgkmcnt(0)
    v_mfma_f32_16x16x32_bf16 v[40:43], v[88:91], v[152:155], v[16:19]
    v_permlane32_swap_b32 v7, v6
    v_max_f32 v6, v6, v7
    v_mfma_f32_16x16x32_bf16 v[40:43], v[92:95], v[156:159], v[40:43]
    v_mov_b32 v7, v6
    v_mfma_f32_16x16x32_bf16 v[40:43], v[96:99], v[160:163], v[40:43]
    s_nop 0
    v_permlane16_swap_b32 v7, v6
    v_max_f32 v6, v6, v7
    v_mfma_f32_16x16x32_bf16 v[40:43], v[100:103], v[164:167], v[40:43]
    s_waitcnt vmcnt(8)
    ds_write_b128 v254, a[220:223] offset:0
    s_waitcnt vmcnt(7)
    ds_write_b128 v254, a[224:227] offset:1024
    v_mfma_f32_16x16x32_bf16 v[44:47], v[104:107], v[152:155], v[16:19]
    v_sub_f32 v72, v72, v6
    v_sub_f32 v73, v73, v6
    v_mfma_f32_16x16x32_bf16 v[44:47], v[108:111], v[156:159], v[44:47]
    v_sub_f32 v74, v74, v6
    v_sub_f32 v75, v75, v6
    v_mfma_f32_16x16x32_bf16 v[44:47], v[112:115], v[160:163], v[44:47]
    v_sub_f32 v76, v76, v6
    v_sub_f32 v77, v77, v6
    v_mfma_f32_16x16x32_bf16 v[44:47], v[116:119], v[164:167], v[44:47]
    s_waitcnt vmcnt(6)
    ds_write_b128 v254, a[228:231] offset:2048
    s_waitcnt vmcnt(5)
    ds_write_b128 v254, a[232:235] offset:3072
    v_mfma_f32_16x16x32_bf16 a[96:99], v[120:123], v[64:67], 0
    v_sub_f32 v78, v78, v6
    v_sub_f32 v79, v79, v6
    v_mfma_f32_16x16x32_bf16 a[100:103], v[124:127], v[64:67], 0
    v_sub_f32 v32, 0, v6
    v_sub_f32 v33, 0, v6
    v_mfma_f32_16x16x32_bf16 a[104:107], v[128:131], v[64:67], 0
    v_sub_f32 v34, 0, v6
    v_sub_f32 v35, 0, v6
    v_mfma_f32_16x16x32_bf16 a[108:111], v[132:135], v[64:67], 0
    s_waitcnt vmcnt(4)
    ds_write_b128 v254, a[236:239] offset:8192
    s_waitcnt vmcnt(3)
    ds_write_b128 v254, a[240:243] offset:9216
    v_mfma_f32_16x16x32_bf16 a[112:115], v[136:139], v[64:67], 0
    v_max3_f32 v6, v80, v81, v82
    v_max3_f32 v6, v6, v83, v84
    v_mfma_f32_16x16x32_bf16 a[116:119], v[140:143], v[64:67], 0
    v_max3_f32 v6, v6, v85, v86
    v_max_f32 v6, v6, v87
    v_mfma_f32_16x16x32_bf16 a[120:123], v[144:147], v[64:67], 0
    v_mov_b32 v7, v6
    v_mfma_f32_16x16x32_bf16 a[124:127], v[148:151], v[64:67], 0
    s_waitcnt vmcnt(2)
    ds_write_b128 v254, a[244:247] offset:10240
    s_waitcnt vmcnt(1)
    ds_write_b128 v254, a[248:251] offset:11264
    v_mfma_f32_16x16x32_bf16 a[204:207], a[216:219], v[64:67], 0
    v_permlane32_swap_b32 v7, v6
    v_max_f32 v6, v6, v7
    v_mfma_f32_16x16x32_bf16 v[48:51], v[88:91], v[168:171], v[20:23]
    v_mov_b32 v7, v6
    v_mfma_f32_16x16x32_bf16 v[48:51], v[92:95], v[172:175], v[48:51]
    s_nop 0
    v_permlane16_swap_b32 v7, v6
    v_max_f32 v6, v6, v7
    v_mfma_f32_16x16x32_bf16 v[48:51], v[96:99], v[176:179], v[48:51]
    v_sub_f32 v80, v80, v6
    v_sub_f32 v81, v81, v6
    v_mfma_f32_16x16x32_bf16 v[48:51], v[100:103], v[180:183], v[48:51]
    v_sub_f32 v82, v82, v6
    v_sub_f32 v83, v83, v6
    v_mfma_f32_16x16x32_bf16 v[52:55], v[104:107], v[168:171], v[20:23]
    v_sub_f32 v84, v84, v6
    v_sub_f32 v85, v85, v6
    v_mfma_f32_16x16x32_bf16 v[52:55], v[108:111], v[172:175], v[52:55]
    v_sub_f32 v86, v86, v6
    v_sub_f32 v87, v87, v6
    v_mfma_f32_16x16x32_bf16 v[52:55], v[112:115], v[176:179], v[52:55]
    v_sub_f32 v36, 0, v6
    v_sub_f32 v37, 0, v6
    v_mfma_f32_16x16x32_bf16 v[52:55], v[116:119], v[180:183], v[52:55]
    v_sub_f32 v38, 0, v6
    v_sub_f32 v39, 0, v6
    v_exp_f32 v72, v72
    v_exp_f32 v73, v73
    v_exp_f32 v74, v74
    v_exp_f32 v75, v75
    v_cvt_pk_bf16_f32 v72, v72, v73
    v_cvt_pk_bf16_f32 v73, v74, v75
    v_exp_f32 v76, v76
    v_exp_f32 v77, v77
    v_exp_f32 v78, v78
    v_exp_f32 v79, v79
    v_cvt_pk_bf16_f32 v74, v76, v77
    v_cvt_pk_bf16_f32 v75, v78, v79
    s_nop 1
    v_mfma_f32_16x16x32_bf16 a[128:131], v[120:123], v[72:75], 0
    v_exp_f32 v80, v80
    v_mfma_f32_16x16x32_bf16 a[132:135], v[124:127], v[72:75], 0
    v_exp_f32 v81, v81
    v_mfma_f32_16x16x32_bf16 a[136:139], v[128:131], v[72:75], 0
    v_exp_f32 v82, v82
    v_mfma_f32_16x16x32_bf16 a[140:143], v[132:135], v[72:75], 0
    v_exp_f32 v83, v83
    v_mfma_f32_16x16x32_bf16 a[144:147], v[136:139], v[72:75], 0
    v_cvt_pk_bf16_f32 v80, v80, v81
    v_cvt_pk_bf16_f32 v81, v82, v83
    v_mfma_f32_16x16x32_bf16 a[148:151], v[140:143], v[72:75], 0
    v_exp_f32 v84, v84
    v_mfma_f32_16x16x32_bf16 a[152:155], v[144:147], v[72:75], 0
    v_exp_f32 v85, v85
    v_mfma_f32_16x16x32_bf16 a[156:159], v[148:151], v[72:75], 0
    v_exp_f32 v86, v86
    v_mfma_f32_16x16x32_bf16 a[208:211], a[216:219], v[72:75], 0
    v_max3_f32 v6, v40, v41, v42
    v_max3_f32 v9, v48, v49, v50
    v_mfma_f32_16x16x32_bf16 v[56:59], v[88:91], v[184:187], v[24:27]
    v_max3_f32 v6, v6, v43, v44
    v_max3_f32 v9, v9, v51, v52
    v_mfma_f32_16x16x32_bf16 v[56:59], v[92:95], v[188:191], v[56:59]
    v_max3_f32 v6, v6, v45, v46
    v_max3_f32 v9, v9, v53, v54
    v_mfma_f32_16x16x32_bf16 v[56:59], v[96:99], v[192:195], v[56:59]
    v_max3_f32 v6, v6, v47, v55
    v_max_f32 v6, v6, v9
    v_mfma_f32_16x16x32_bf16 v[56:59], v[100:103], v[196:199], v[56:59]
    v_cmp_lt_f32 vcc, s61, v6
    v_mfma_f32_16x16x32_bf16 v[60:63], v[104:107], v[184:187], v[24:27]
    v_exp_f32 v87, v87
    v_mfma_f32_16x16x32_bf16 v[60:63], v[108:111], v[188:191], v[60:63]
    v_cvt_pk_bf16_f32 v82, v84, v85
    v_cvt_pk_bf16_f32 v83, v86, v87
    v_mfma_f32_16x16x32_bf16 v[60:63], v[112:115], v[192:195], v[60:63]
    s_cbranch_vccnz L_stub0_1
L_back0_1:
    v_mfma_f32_16x16x32_bf16 v[60:63], v[116:119], v[196:199], v[60:63]
    v_exp_f32 v40, v40
    v_mfma_f32_16x16x32_bf16 a[160:163], v[120:123], v[80:83], 0
    ds_read_b64_tr_b16 v[120:121], v4 offset:32768
    ds_read_b64_tr_b16 v[122:123], v4 offset:36864
    v_mfma_f32_16x16x32_bf16 a[164:167], v[124:127], v[80:83], 0
    ds_read_b64_tr_b16 v[124:125], v5 offset:32768
    ds_read_b64_tr_b16 v[126:127], v5 offset:36864
    v_mfma_f32_16x16x32_bf16 a[168:171], v[128:131], v[80:83], 0
    ds_read_b64_tr_b16 v[128:129], v4 offset:33024
    ds_read_b64_tr_b16 v[130:131], v4 offset:37120
    v_mfma_f32_16x16x32_bf16 a[172:175], v[132:135], v[80:83], 0
    ds_read_b64_tr_b16 v[132:133], v5 offset:33024
    ds_read_b64_tr_b16 v[134:135], v5 offset:37120
    v_mfma_f32_16x16x32_bf16 a[176:179], v[136:139], v[80:83], 0
    ds_read_b64_tr_b16 v[136:137], v4 offset:33280
    ds_read_b64_tr_b16 v[138:139], v4 offset:37376
    v_mfma_f32_16x16x32_bf16 a[180:183], v[140:143], v[80:83], 0
    ds_read_b64_tr_b16 v[140:141], v5 offset:33280
    ds_read_b64_tr_b16 v[142:143], v5 offset:37376
    v_mfma_f32_16x16x32_bf16 a[184:187], v[144:147], v[80:83], 0
    ds_read_b64_tr_b16 v[144:145], v4 offset:33536
    ds_read_b64_tr_b16 v[146:147], v4 offset:37632
    v_mfma_f32_16x16x32_bf16 a[188:191], v[148:151], v[80:83], 0
    ds_read_b64_tr_b16 v[148:149], v5 offset:33536
    ds_read_b64_tr_b16 v[150:151], v5 offset:37632
    v_mfma_f32_16x16x32_bf16 a[212:215], a[216:219], v[80:83], 0
    v_exp_f32 v41, v41
    v_mfma_f32_16x16x32_bf16 v[64:67], v[88:91], v[200:203], v[28:31]
    v_exp_f32 v42, v42
    v_mfma_f32_16x16x32_bf16 v[64:67], v[92:95], v[204:207], v[64:67]
    v_exp_f32 v43, v43
    v_mfma_f32_16x16x32_bf16 v[64:67], v[96:99], v[208:211], v[64:67]
    v_cvt_pk_bf16_f32 v40, v40, v41
    v_cvt_pk_bf16_f32 v41, v42, v43
    v_mfma_f32_16x16x32_bf16 v[64:67], v[100:103], v[212:215], v[64:67]
    v_exp_f32 v44, v44
    v_mfma_f32_16x16x32_bf16 v[68:71], v[104:107], v[200:203], v[28:31]
    v_exp_f32 v45, v45
    v_mfma_f32_16x16x32_bf16 v[68:71], v[108:111], v[204:207], v[68:71]
    v_exp_f32 v46, v46
    v_mfma_f32_16x16x32_bf16 v[68:71], v[112:115], v[208:211], v[68:71]
    v_exp_f32 v47, v47
    v_mfma_f32_16x16x32_bf16 v[68:71], v[116:119], v[212:215], v[68:71]
    v_cvt_pk_bf16_f32 v42, v44, v45
    v_cvt_pk_bf16_f32 v43, v46, v47
    s_waitcnt lgkmcnt(0)
    s_nop 0
    v_mfma_f32_16x16x32_bf16 a[0:3], v[120:123], v[40:43], a[0:3]
    v_exp_f32 v48, v48
    v_mfma_f32_16x16x32_bf16 a[4:7], v[124:127], v[40:43], a[4:7]
    v_exp_f32 v49, v49
    v_mfma_f32_16x16x32_bf16 a[8:11], v[128:131], v[40:43], a[8:11]
    v_exp_f32 v50, v50
    v_mfma_f32_16x16x32_bf16 a[12:15], v[132:135], v[40:43], a[12:15]
    v_exp_f32 v51, v51
    v_mfma_f32_16x16x32_bf16 a[16:19], v[136:139], v[40:43], a[16:19]
    v_cvt_pk_bf16_f32 v48, v48, v49
    v_cvt_pk_bf16_f32 v49, v50, v51
    v_mfma_f32_16x16x32_bf16 a[20:23], v[140:143], v[40:43], a[20:23]
    v_exp_f32 v52, v52
    v_mfma_f32_16x16x32_bf16 a[24:27], v[144:147], v[40:43], a[24:27]
    v_exp_f32 v53, v53
    v_mfma_f32_16x16x32_bf16 a[28:31], v[148:151], v[40:43], a[28:31]
    v_exp_f32 v54, v54
    v_mfma_f32_16x16x32_bf16 a[192:195], a[216:219], v[40:43], a[192:195]
    v_max3_f32 v6, v56, v57, v58
    v_max3_f32 v9, v64, v65, v66
    v_mfma_f32_16x16x32_bf16 v[72:75], v[88:91], v[216:219], v[32:35]
    v_max3_f32 v6, v6, v59, v60
    v_max3_f32 v9, v9, v67, v68
    v_mfma_f32_16x16x32_bf16 v[72:75], v[92:95], v[220:223], v[72:75]
    v_max3_f32 v6, v6, v61, v62
    v_max3_f32 v9, v9, v69, v70
    v_mfma_f32_16x16x32_bf16 v[72:75], v[96:99], v[224:227], v[72:75]
    v_max3_f32 v6, v6, v63, v71
    v_max_f32 v6, v6, v9
    v_mfma_f32_16x16x32_bf16 v[72:75], v[100:103], v[228:231], v[72:75]
    v_cmp_lt_f32 vcc, s61, v6
    v_mfma_f32_16x16x32_bf16 v[76:79], v[104:107], v[216:219], v[32:35]
    v_exp_f32 v55, v55
    v_mfma_f32_16x16x32_bf16 v[76:79], v[108:111], v[220:223], v[76:79]
    v_cvt_pk_bf16_f32 v50, v52, v53
    v_cvt_pk_bf16_f32 v51, v54, v55
    v_mfma_f32_16x16x32_bf16 v[76:79], v[112:115], v[224:227], v[76:79]
    s_cbranch_vccnz L_stub2_1
L_back2_1:
    v_mfma_f32_16x16x32_bf16 v[76:79], v[116:119], v[228:231], v[76:79]
    v_exp_f32 v56, v56
    v_mfma_f32_16x16x32_bf16 a[32:35], v[120:123], v[48:51], a[32:35]
    v_exp_f32 v57, v57
    v_mfma_f32_16x16x32_bf16 a[36:39], v[124:127], v[48:51], a[36:39]
    v_exp_f32 v58, v58
    v_mfma_f32_16x16x32_bf16 a[40:43], v[128:131], v[48:51], a[40:43]
    v_exp_f32 v59, v59
    v_mfma_f32_16x16x32_bf16 a[44:47], v[132:135], v[48:51], a[44:47]
    v_cvt_pk_bf16_f32 v56, v56, v57
    v_cvt_pk_bf16_f32 v57, v58, v59
    v_mfma_f32_16x16x32_bf16 a[48:51], v[136:139], v[48:51], a[48:51]
    v_exp_f32 v60, v60
    v_mfma_f32_16x16x32_bf16 a[52:55], v[140:143], v[48:51], a[52:55]
    v_exp_f32 v61, v61
    v_mfma_f32_16x16x32_bf16 a[56:59], v[144:147], v[48:51], a[56:59]
    v_exp_f32 v62, v62
    v_mfma_f32_16x16x32_bf16 a[60:63], v[148:151], v[48:51], a[60:63]
    v_exp_f32 v63, v63
    v_mfma_f32_16x16x32_bf16 a[196:199], a[216:219], v[48:51], a[196:199]
    v_cvt_pk_bf16_f32 v58, v60, v61
    v_cvt_pk_bf16_f32 v59, v62, v63
    s_barrier
    v_mfma_f32_16x16x32_bf16 v[80:83], v[88:91], v[232:235], v[36:39]
    v_exp_f32 v64, v64
    v_mfma_f32_16x16x32_bf16 v[80:83], v[92:95], v[236:239], v[80:83]
    ds_read_b128 v[88:91], v248 offset:0
    ds_read_b128 v[92:95], v248 offset:256
    v_mfma_f32_16x16x32_bf16 v[80:83], v[96:99], v[240:243], v[80:83]
    v_exp_f32 v65, v65
    v_mfma_f32_16x16x32_bf16 v[80:83], v[100:103], v[244:247], v[80:83]
    ds_read_b128 v[96:99], v248 offset:512
    ds_read_b128 v[100:103], v248 offset:768
    v_mfma_f32_16x16x32_bf16 v[84:87], v[104:107], v[232:235], v[36:39]
    v_exp_f32 v66, v66
    v_mfma_f32_16x16x32_bf16 v[84:87], v[108:111], v[236:239], v[84:87]
    ds_read_b128 v[104:107], v248 offset:4096
    ds_read_b128 v[108:111], v248 offset:4352
    v_mfma_f32_16x16x32_bf16 v[84:87], v[112:115], v[240:243], v[84:87]
    s_add_u32 m0, s58, 32768
    s_mov_b32 s65, 49152
    v_mfma_f32_16x16x32_bf16 v[84:87], v[116:119], v[244:247], v[84:87]
    ds_read_b128 v[112:115], v248 offset:4608
    ds_read_b128 v[116:119], v248 offset:4864
    v_mfma_f32_16x16x32_bf16 a[64:67], v[120:123], v[56:59], a[64:67]
    s_waitcnt vmcnt(3)
    buffer_load_dwordx4 v1, s[28:31], s65 offen offset:0 nt lds
    v_mfma_f32_16x16x32_bf16 a[68:71], v[124:127], v[56:59], a[68:71]
    v_exp_f32 v67, v67
    v_mfma_f32_16x16x32_bf16 a[72:75], v[128:131], v[56:59], a[72:75]
    v_cvt_pk_bf16_f32 v64, v64, v65
    v_cvt_pk_bf16_f32 v65, v66, v67
    v_mfma_f32_16x16x32_bf16 a[76:79], v[132:135], v[56:59], a[76:79]
    v_exp_f32 v68, v68
    v_mfma_f32_16x16x32_bf16 a[80:83], v[136:139], v[56:59], a[80:83]
    v_exp_f32 v69, v69
    v_mfma_f32_16x16x32_bf16 a[84:87], v[140:143], v[56:59], a[84:87]
    v_exp_f32 v70, v70
    v_mfma_f32_16x16x32_bf16 a[88:91], v[144:147], v[56:59], a[88:91]
    v_max3_f32 v6, v72, v73, v74
    v_max3_f32 v9, v80, v81, v82
    v_mfma_f32_16x16x32_bf16 a[92:95], v[148:151], v[56:59], a[92:95]
    v_max3_f32 v6, v6, v75, v76
    v_max3_f32 v9, v9, v83, v84
    v_mfma_f32_16x16x32_bf16 a[200:203], a[216:219], v[56:59], a[200:203]
    s_waitcnt lgkmcnt(0)
    v_mfma_f32_16x16x32_bf16 v[40:43], v[88:91], v[152:155], v[16:19]
    v_max3_f32 v6, v6, v77, v78
    v_max3_f32 v9, v9, v85, v86
    v_mfma_f32_16x16x32_bf16 v[40:43], v[92:95], v[156:159], v[40:43]
    s_waitcnt vmcnt(3)
    buffer_load_dwordx4 v2, s[28:31], s65 offen offset:1024 nt lds
    v_mfma_f32_16x16x32_bf16 v[40:43], v[96:99], v[160:163], v[40:43]
    v_max3_f32 v6, v6, v79, v87
    v_max_f32 v6, v6, v9
    v_mfma_f32_16x16x32_bf16 v[40:43], v[100:103], v[164:167], v[40:43]
    v_cmp_lt_f32 vcc, s61, v6
    v_mfma_f32_16x16x32_bf16 v[44:47], v[104:107], v[152:155], v[16:19]
    v_exp_f32 v71, v71
    v_mfma_f32_16x16x32_bf16 v[44:47], v[108:111], v[156:159], v[44:47]
    v_cvt_pk_bf16_f32 v66, v68, v69
    v_cvt_pk_bf16_f32 v67, v70, v71
    v_mfma_f32_16x16x32_bf16 v[44:47], v[112:115], v[160:163], v[44:47]
    s_cbranch_vccnz L_stub4_2
L_back4_2:
    v_mfma_f32_16x16x32_bf16 v[44:47], v[116:119], v[164:167], v[44:47]
    v_exp_f32 v72, v72
    v_mfma_f32_16x16x32_bf16 a[96:99], v[120:123], v[64:67], a[96:99]
    v_exp_f32 v73, v73
    v_mfma_f32_16x16x32_bf16 a[100:103], v[124:127], v[64:67], a[100:103]
    v_exp_f32 v74, v74
    v_mfma_f32_16x16x32_bf16 a[104:107], v[128:131], v[64:67], a[104:107]
    v_exp_f32 v75, v75
    v_mfma_f32_16x16x32_bf16 a[108:111], v[132:135], v[64:67], a[108:111]
    v_cvt_pk_bf16_f32 v72, v72, v73
    v_cvt_pk_bf16_f32 v73, v74, v75
    v_mfma_f32_16x16x32_bf16 a[112:115], v[136:139], v[64:67], a[112:115]
    v_exp_f32 v76, v76
    v_mfma_f32_16x16x32_bf16 a[116:119], v[140:143], v[64:67], a[116:119]
    v_exp_f32 v77, v77
    v_mfma_f32_16x16x32_bf16 a[120:123], v[144:147], v[64:67], a[120:123]
    s_waitcnt vmcnt(3)
    buffer_load_dwordx4 v1, s[28:31], s65 offen offset:2048 nt lds
    v_mfma_f32_16x16x32_bf16 a[124:127], v[148:151], v[64:67], a[124:127]
    v_exp_f32 v78, v78
    v_mfma_f32_16x16x32_bf16 a[204:207], a[216:219], v[64:67], a[204:207]
    v_exp_f32 v79, v79
    v_mfma_f32_16x16x32_bf16 v[48:51], v[88:91], v[168:171], v[20:23]
    v_cvt_pk_bf16_f32 v74, v76, v77
    v_cvt_pk_bf16_f32 v75, v78, v79
    v_mfma_f32_16x16x32_bf16 v[48:51], v[92:95], v[172:175], v[48:51]
    v_exp_f32 v80, v80
    v_mfma_f32_16x16x32_bf16 v[48:51], v[96:99], v[176:179], v[48:51]
    v_exp_f32 v81, v81
    v_mfma_f32_16x16x32_bf16 v[48:51], v[100:103], v[180:183], v[48:51]
    v_exp_f32 v82, v82
    v_mfma_f32_16x16x32_bf16 v[52:55], v[104:107], v[168:171], v[20:23]
    v_exp_f32 v83, v83
    v_mfma_f32_16x16x32_bf16 v[52:55], v[108:111], v[172:175], v[52:55]
    v_cvt_pk_bf16_f32 v80, v80, v81
    v_cvt_pk_bf16_f32 v81, v82, v83
    v_mfma_f32_16x16x32_bf16 v[52:55], v[112:115], v[176:179], v[52:55]
    v_exp_f32 v84, v84
    v_mfma_f32_16x16x32_bf16 v[52:55], v[116:119], v[180:183], v[52:55]
    v_exp_f32 v85, v85
    v_mfma_f32_16x16x32_bf16 a[128:131], v[120:123], v[72:75], a[128:131]
    v_exp_f32 v86, v86
    v_mfma_f32_16x16x32_bf16 a[132:135], v[124:127], v[72:75], a[132:135]
    v_mfma_f32_16x16x32_bf16 a[136:139], v[128:131], v[72:75], a[136:139]
    v_max3_f32 v6, v40, v41, v42
    v_max3_f32 v9, v48, v49, v50
    v_mfma_f32_16x16x32_bf16 a[140:143], v[132:135], v[72:75], a[140:143]
    s_waitcnt vmcnt(3)
    buffer_load_dwordx4 v2, s[28:31], s65 offen offset:3072 nt lds
    v_mfma_f32_16x16x32_bf16 a[144:147], v[136:139], v[72:75], a[144:147]
    v_max3_f32 v6, v6, v43, v44
    v_max3_f32 v9, v9, v51, v52
    v_mfma_f32_16x16x32_bf16 a[148:151], v[140:143], v[72:75], a[148:151]
    v_max3_f32 v6, v6, v45, v46
    v_max3_f32 v9, v9, v53, v54
    v_mfma_f32_16x16x32_bf16 a[152:155], v[144:147], v[72:75], a[152:155]
    v_max3_f32 v6, v6, v47, v55
    v_max_f32 v6, v6, v9
    v_mfma_f32_16x16x32_bf16 a[156:159], v[148:151], v[72:75], a[156:159]
    v_cmp_lt_f32 vcc, s61, v6
    v_mfma_f32_16x16x32_bf16 a[208:211], a[216:219], v[72:75], a[208:211]
    v_exp_f32 v87, v87
    v_mfma_f32_16x16x32_bf16 v[56:59], v[88:91], v[184:187], v[24:27]
    v_cvt_pk_bf16_f32 v82, v84, v85
    v_cvt_pk_bf16_f32 v83, v86, v87
    v_mfma_f32_16x16x32_bf16 v[56:59], v[92:95], v[188:191], v[56:59]
    s_cbranch_vccnz L_stub0_2
L_back0_2:
    v_mfma_f32_16x16x32_bf16 v[56:59], v[96:99], v[192:195], v[56:59]
    v_exp_f32 v40, v40
    v_mfma_f32_16x16x32_bf16 v[56:59], v[100:103], v[196:199], v[56:59]
    v_exp_f32 v41, v41
    v_mfma_f32_16x16x32_bf16 v[60:63], v[104:107], v[184:187], v[24:27]
    v_exp_f32 v42, v42
    v_mfma_f32_16x16x32_bf16 v[60:63], v[108:111], v[188:191], v[60:63]
    v_exp_f32 v43, v43
    v_mfma_f32_16x16x32_bf16 v[60:63], v[112:115], v[192:195], v[60:63]
    v_cvt_pk_bf16_f32 v40, v40, v41
    v_cvt_pk_bf16_f32 v41, v42, v43
    v_mfma_f32_16x16x32_bf16 v[60:63], v[116:119], v[196:199], v[60:63]
    s_add_u32 m0, s58, 40960
    v_mfma_f32_16x16x32_bf16 a[160:163], v[120:123], v[80:83], a[160:163]
    ds_read_b64_tr_b16 v[120:121], v249 offset:0
    ds_read_b64_tr_b16 v[122:123], v249 offset:4096
    v_mfma_f32_16x16x32_bf16 a[164:167], v[124:127], v[80:83], a[164:167]
    ds_read_b64_tr_b16 v[124:125], v250 offset:0
    ds_read_b64_tr_b16 v[126:127], v250 offset:4096
    v_mfma_f32_16x16x32_bf16 a[168:171], v[128:131], v[80:83], a[168:171]
    ds_read_b64_tr_b16 v[128:129], v249 offset:256
    ds_read_b64_tr_b16 v[130:131], v249 offset:4352
    v_mfma_f32_16x16x32_bf16 a[172:175], v[132:135], v[80:83], a[172:175]
    ds_read_b64_tr_b16 v[132:133], v250 offset:256
    ds_read_b64_tr_b16 v[134:135], v250 offset:4352
    v_mfma_f32_16x16x32_bf16 a[176:179], v[136:139], v[80:83], a[176:179]
    ds_read_b64_tr_b16 v[136:137], v249 offset:512
    ds_read_b64_tr_b16 v[138:139], v249 offset:4608
    v_mfma_f32_16x16x32_bf16 a[180:183], v[140:143], v[80:83], a[180:183]
    ds_read_b64_tr_b16 v[140:141], v250 offset:512
    ds_read_b64_tr_b16 v[142:143], v250 offset:4608
    v_mfma_f32_16x16x32_bf16 a[184:187], v[144:147], v[80:83], a[184:187]
    ds_read_b64_tr_b16 v[144:145], v249 offset:768
    ds_read_b64_tr_b16 v[146:147], v249 offset:4864
    v_mfma_f32_16x16x32_bf16 a[188:191], v[148:151], v[80:83], a[188:191]
    ds_read_b64_tr_b16 v[148:149], v250 offset:768
    ds_read_b64_tr_b16 v[150:151], v250 offset:4864
    v_mfma_f32_16x16x32_bf16 a[212:215], a[216:219], v[80:83], a[212:215]
    s_waitcnt vmcnt(3)
    buffer_load_dwordx4 v1, s[4:7], s65 offen offset:0 nt lds
    v_mfma_f32_16x16x32_bf16 v[64:67], v[88:91], v[200:203], v[28:31]
    v_exp_f32 v44, v44
    v_mfma_f32_16x16x32_bf16 v[64:67], v[92:95], v[204:207], v[64:67]
    v_exp_f32 v45, v45
    v_mfma_f32_16x16x32_bf16 v[64:67], v[96:99], v[208:211], v[64:67]
    v_exp_f32 v46, v46
    v_mfma_f32_16x16x32_bf16 v[64:67], v[100:103], v[212:215], v[64:67]
    s_waitcnt vmcnt(3)
    buffer_load_dwordx4 v2, s[4:7], s65 offen offset:1024 nt lds
    v_mfma_f32_16x16x32_bf16 v[68:71], v[104:107], v[200:203], v[28:31]
    v_exp_f32 v47, v47
    v_mfma_f32_16x16x32_bf16 v[68:71], v[108:111], v[204:207], v[68:71]
    v_cvt_pk_bf16_f32 v42, v44, v45
    v_cvt_pk_bf16_f32 v43, v46, v47
    v_mfma_f32_16x16x32_bf16 v[68:71], v[112:115], v[208:211], v[68:71]
    v_exp_f32 v48, v48
    v_mfma_f32_16x16x32_bf16 v[68:71], v[116:119], v[212:215], v[68:71]
    s_waitcnt lgkmcnt(0)
    v_mfma_f32_16x16x32_bf16 a[0:3], v[120:123], v[40:43], a[0:3]
    v_exp_f32 v49, v49
    v_mfma_f32_16x16x32_bf16 a[4:7], v[124:127], v[40:43], a[4:7]
    v_exp_f32 v50, v50
    v_mfma_f32_16x16x32_bf16 a[8:11], v[128:131], v[40:43], a[8:11]
    v_exp_f32 v51, v51
    v_mfma_f32_16x16x32_bf16 a[12:15], v[132:135], v[40:43], a[12:15]
    v_cvt_pk_bf16_f32 v48, v48, v49
    v_cvt_pk_bf16_f32 v49, v50, v51
    v_mfma_f32_16x16x32_bf16 a[16:19], v[136:139], v[40:43], a[16:19]
    v_exp_f32 v52, v52
    v_mfma_f32_16x16x32_bf16 a[20:23], v[140:143], v[40:43], a[20:23]
    v_exp_f32 v53, v53
    v_mfma_f32_16x16x32_bf16 a[24:27], v[144:147], v[40:43], a[24:27]
    v_exp_f32 v54, v54
    v_mfma_f32_16x16x32_bf16 a[28:31], v[148:151], v[40:43], a[28:31]
    v_max3_f32 v6, v56, v57, v58
    v_max3_f32 v9, v64, v65, v66
    v_mfma_f32_16x16x32_bf16 a[192:195], a[216:219], v[40:43], a[192:195]
    v_max3_f32 v6, v6, v59, v60
    v_max3_f32 v9, v9, v67, v68
    v_mfma_f32_16x16x32_bf16 v[72:75], v[88:91], v[216:219], v[32:35]
    s_waitcnt vmcnt(3)
    buffer_load_dwordx4 v1, s[4:7], s65 offen offset:2048 nt lds
    v_mfma_f32_16x16x32_bf16 v[72:75], v[92:95], v[220:223], v[72:75]
    v_max3_f32 v6, v6, v61, v62
    v_max3_f32 v9, v9, v69, v70
    v_mfma_f32_16x16x32_bf16 v[72:75], v[96:99], v[224:227], v[72:75]
    v_max3_f32 v6, v6, v63, v71
    v_max_f32 v6, v6, v9
    v_mfma_f32_16x16x32_bf16 v[72:75], v[100:103], v[228:231], v[72:75]
    v_cmp_lt_f32 vcc, s61, v6
    v_mfma_f32_16x16x32_bf16 v[76:79], v[104:107], v[216:219], v[32:35]
    v_exp_f32 v55, v55
    v_mfma_f32_16x16x32_bf16 v[76:79], v[108:111], v[220:223], v[76:79]
    v_cvt_pk_bf16_f32 v50, v52, v53
    v_cvt_pk_bf16_f32 v51, v54, v55
    v_mfma_f32_16x16x32_bf16 v[76:79], v[112:115], v[224:227], v[76:79]
    s_cbranch_vccnz L_stub2_2
L_back2_2:
    v_mfma_f32_16x16x32_bf16 v[76:79], v[116:119], v[228:231], v[76:79]
    v_exp_f32 v56, v56
    v_mfma_f32_16x16x32_bf16 a[32:35], v[120:123], v[48:51], a[32:35]
    v_exp_f32 v57, v57
    v_mfma_f32_16x16x32_bf16 a[36:39], v[124:127], v[48:51], a[36:39]
    v_exp_f32 v58, v58
    v_mfma_f32_16x16x32_bf16 a[40:43], v[128:131], v[48:51], a[40:43]
    v_exp_f32 v59, v59
    v_mfma_f32_16x16x32_bf16 a[44:47], v[132:135], v[48:51], a[44:47]
    v_cvt_pk_bf16_f32 v56, v56, v57
    v_cvt_pk_bf16_f32 v57, v58, v59
    v_mfma_f32_16x16x32_bf16 a[48:51], v[136:139], v[48:51], a[48:51]
    v_exp_f32 v60, v60
    v_mfma_f32_16x16x32_bf16 a[52:55], v[140:143], v[48:51], a[52:55]
    s_waitcnt vmcnt(3)
    buffer_load_dwordx4 v2, s[4:7], s65 offen offset:3072 nt lds
    v_mfma_f32_16x16x32_bf16 a[56:59], v[144:147], v[48:51], a[56:59]
    v_exp_f32 v61, v61
    v_mfma_f32_16x16x32_bf16 a[60:63], v[148:151], v[48:51], a[60:63]
    v_exp_f32 v62, v62
    v_mfma_f32_16x16x32_bf16 a[196:199], a[216:219], v[48:51], a[196:199]
    v_exp_f32 v63, v63
    v_cvt_pk_bf16_f32 v58, v60, v61
    v_cvt_pk_bf16_f32 v59, v62, v63
    s_barrier
    v_mfma_f32_16x16x32_bf16 v[80:83], v[88:91], v[232:235], v[36:39]
    v_exp_f32 v64, v64
    v_mfma_f32_16x16x32_bf16 v[80:83], v[92:95], v[236:239], v[80:83]
    ds_read_b128 v[88:91], v248 offset:32768
    ds_read_b128 v[92:95], v248 offset:33024
    v_mfma_f32_16x16x32_bf16 v[80:83], v[96:99], v[240:243], v[80:83]
    v_exp_f32 v65, v65
    v_mfma_f32_16x16x32_bf16 v[80:83], v[100:103], v[244:247], v[80:83]
    ds_read_b128 v[96:99], v248 offset:33280
    ds_read_b128 v[100:103], v248 offset:33536
    v_mfma_f32_16x16x32_bf16 v[84:87], v[104:107], v[232:235], v[36:39]
    v_exp_f32 v66, v66
    v_mfma_f32_16x16x32_bf16 v[84:87], v[108:111], v[236:239], v[84:87]
    ds_read_b128 v[104:107], v248 offset:36864
    ds_read_b128 v[108:111], v248 offset:37120
    v_mfma_f32_16x16x32_bf16 v[84:87], v[112:115], v[240:243], v[84:87]
    v_exp_f32 v67, v67
    v_mfma_f32_16x16x32_bf16 v[84:87], v[116:119], v[244:247], v[84:87]
    ds_read_b128 v[112:115], v248 offset:37376
    ds_read_b128 v[116:119], v248 offset:37632
    v_mfma_f32_16x16x32_bf16 a[64:67], v[120:123], v[56:59], a[64:67]
    v_cvt_pk_bf16_f32 v64, v64, v65
    v_cvt_pk_bf16_f32 v65, v66, v67
    v_mfma_f32_16x16x32_bf16 a[68:71], v[124:127], v[56:59], a[68:71]
    v_exp_f32 v68, v68
    v_mfma_f32_16x16x32_bf16 a[72:75], v[128:131], v[56:59], a[72:75]
    s_add_u32 m0, s58, 65536
    s_mov_b32 s65, 57344
    v_mfma_f32_16x16x32_bf16 a[76:79], v[132:135], v[56:59], a[76:79]
    s_waitcnt vmcnt(3)
    buffer_load_dwordx4 v1, s[28:31], s65 offen offset:0 nt lds
    v_mfma_f32_16x16x32_bf16 a[80:83], v[136:139], v[56:59], a[80:83]
    v_exp_f32 v69, v69
    v_mfma_f32_16x16x32_bf16 a[84:87], v[140:143], v[56:59], a[84:87]
    v_exp_f32 v70, v70
    v_mfma_f32_16x16x32_bf16 a[88:91], v[144:147], v[56:59], a[88:91]
    v_max3_f32 v6, v72, v73, v74
    v_max3_f32 v9, v80, v81, v82
    v_mfma_f32_16x16x32_bf16 a[92:95], v[148:151], v[56:59], a[92:95]
    v_max3_f32 v6, v6, v75, v76
    v_max3_f32 v9, v9, v83, v84
    v_mfma_f32_16x16x32_bf16 a[200:203], a[216:219], v[56:59], a[200:203]
    s_waitcnt lgkmcnt(0)
    v_mfma_f32_16x16x32_bf16 v[40:43], v[88:91], v[152:155], v[16:19]
    v_max3_f32 v6, v6, v77, v78
    v_max3_f32 v9, v9, v85, v86
    v_mfma_f32_16x16x32_bf16 v[40:43], v[92:95], v[156:159], v[40:43]
    v_max3_f32 v6, v6, v79, v87
    v_max_f32 v6, v6, v9
    v_mfma_f32_16x16x32_bf16 v[40:43], v[96:99], v[160:163], v[40:43]
    v_cmp_lt_f32 vcc, s61, v6
    v_mfma_f32_16x16x32_bf16 v[40:43], v[100:103], v[164:167], v[40:43]
    v_exp_f32 v71, v71
    v_mfma_f32_16x16x32_bf16 v[44:47], v[104:107], v[152:155], v[16:19]
    v_cvt_pk_bf16_f32 v66, v68, v69
    v_cvt_pk_bf16_f32 v67, v70, v71
    v_mfma_f32_16x16x32_bf16 v[44:47], v[108:111], v[156:159], v[44:47]
    s_cbranch_vccnz L_stub4_3
L_back4_3:
    v_mfma_f32_16x16x32_bf16 v[44:47], v[112:115], v[160:163], v[44:47]
    s_waitcnt vmcnt(3)
    buffer_load_dwordx4 v2, s[28:31], s65 offen offset:1024 nt lds
    v_mfma_f32_16x16x32_bf16 v[44:47], v[116:119], v[164:167], v[44:47]
    v_exp_f32 v72, v72
    v_mfma_f32_16x16x32_bf16 a[96:99], v[120:123], v[64:67], a[96:99]
    v_exp_f32 v73, v73
    v_mfma_f32_16x16x32_bf16 a[100:103], v[124:127], v[64:67], a[100:103]
    v_exp_f32 v74, v74
    v_mfma_f32_16x16x32_bf16 a[104:107], v[128:131], v[64:67], a[104:107]
    v_exp_f32 v75, v75
    v_mfma_f32_16x16x32_bf16 a[108:111], v[132:135], v[64:67], a[108:111]
    v_cvt_pk_bf16_f32 v72, v72, v73
    v_cvt_pk_bf16_f32 v73, v74, v75
    v_mfma_f32_16x16x32_bf16 a[112:115], v[136:139], v[64:67], a[112:115]
    v_exp_f32 v76, v76
    v_mfma_f32_16x16x32_bf16 a[116:119], v[140:143], v[64:67], a[116:119]
    v_exp_f32 v77, v77
    v_mfma_f32_16x16x32_bf16 a[120:123], v[144:147], v[64:67], a[120:123]
    v_exp_f32 v78, v78
    v_mfma_f32_16x16x32_bf16 a[124:127], v[148:151], v[64:67], a[124:127]
    v_exp_f32 v79, v79
    v_mfma_f32_16x16x32_bf16 a[204:207], a[216:219], v[64:67], a[204:207]
    v_cvt_pk_bf16_f32 v74, v76, v77
    v_cvt_pk_bf16_f32 v75, v78, v79
    v_mfma_f32_16x16x32_bf16 v[48:51], v[88:91], v[168:171], v[20:23]
    v_exp_f32 v80, v80
    v_mfma_f32_16x16x32_bf16 v[48:51], v[92:95], v[172:175], v[48:51]
    v_exp_f32 v81, v81
    v_mfma_f32_16x16x32_bf16 v[48:51], v[96:99], v[176:179], v[48:51]
    s_waitcnt vmcnt(3)
    buffer_load_dwordx4 v1, s[28:31], s65 offen offset:2048 nt lds
    v_mfma_f32_16x16x32_bf16 v[48:51], v[100:103], v[180:183], v[48:51]
    v_exp_f32 v82, v82
    v_mfma_f32_16x16x32_bf16 v[52:55], v[104:107], v[168:171], v[20:23]
    v_exp_f32 v83, v83
    v_mfma_f32_16x16x32_bf16 v[52:55], v[108:111], v[172:175], v[52:55]
    v_cvt_pk_bf16_f32 v80, v80, v81
    v_cvt_pk_bf16_f32 v81, v82, v83
    v_mfma_f32_16x16x32_bf16 v[52:55], v[112:115], v[176:179], v[52:55]
    v_exp_f32 v84, v84
    v_mfma_f32_16x16x32_bf16 v[52:55], v[116:119], v[180:183], v[52:55]
    v_exp_f32 v85, v85
    v_mfma_f32_16x16x32_bf16 a[128:131], v[120:123], v[72:75], a[128:131]
    v_exp_f32 v86, v86
    v_mfma_f32_16x16x32_bf16 a[132:135], v[124:127], v[72:75], a[132:135]
    v_mfma_f32_16x16x32_bf16 a[136:139], v[128:131], v[72:75], a[136:139]
    v_max3_f32 v6, v40, v41, v42
    v_max3_f32 v9, v48, v49, v50
    v_mfma_f32_16x16x32_bf16 a[140:143], v[132:135], v[72:75], a[140:143]
    v_max3_f32 v6, v6, v43, v44
    v_max3_f32 v9, v9, v51, v52
    v_mfma_f32_16x16x32_bf16 a[144:147], v[136:139], v[72:75], a[144:147]
    v_max3_f32 v6, v6, v45, v46
    v_max3_f32 v9, v9, v53, v54
    v_mfma_f32_16x16x32_bf16 a[148:151], v[140:143], v[72:75], a[148:151]
    v_max3_f32 v6, v6, v47, v55
    v_max_f32 v6, v6, v9
    v_mfma_f32_16x16x32_bf16 a[152:155], v[144:147], v[72:75], a[152:155]
    v_cmp_lt_f32 vcc, s61, v6
    v_mfma_f32_16x16x32_bf16 a[156:159], v[148:151], v[72:75], a[156:159]
    v_exp_f32 v87, v87
    v_mfma_f32_16x16x32_bf16 a[208:211], a[216:219], v[72:75], a[208:211]
    s_waitcnt vmcnt(3)
    buffer_load_dwordx4 v2, s[28:31], s65 offen offset:3072 nt lds
    v_mfma_f32_16x16x32_bf16 v[56:59], v[88:91], v[184:187], v[24:27]
    v_cvt_pk_bf16_f32 v82, v84, v85
    v_cvt_pk_bf16_f32 v83, v86, v87
    v_mfma_f32_16x16x32_bf16 v[56:59], v[92:95], v[188:191], v[56:59]
    s_cbranch_vccnz L_stub0_3
L_back0_3:
    v_mfma_f32_16x16x32_bf16 v[56:59], v[96:99], v[192:195], v[56:59]
    v_exp_f32 v40, v40
    v_mfma_f32_16x16x32_bf16 v[56:59], v[100:103], v[196:199], v[56:59]
    v_exp_f32 v41, v41
    v_mfma_f32_16x16x32_bf16 v[60:63], v[104:107], v[184:187], v[24:27]
    v_exp_f32 v42, v42
    v_mfma_f32_16x16x32_bf16 v[60:63], v[108:111], v[188:191], v[60:63]
    v_exp_f32 v43, v43
    v_mfma_f32_16x16x32_bf16 v[60:63], v[112:115], v[192:195], v[60:63]
    v_cvt_pk_bf16_f32 v40, v40, v41
    v_cvt_pk_bf16_f32 v41, v42, v43
    v_mfma_f32_16x16x32_bf16 v[60:63], v[116:119], v[196:199], v[60:63]
    v_exp_f32 v44, v44
    v_mfma_f32_16x16x32_bf16 a[160:163], v[120:123], v[80:83], a[160:163]
    ds_read_b64_tr_b16 v[120:121], v249 offset:32768
    ds_read_b64_tr_b16 v[122:123], v249 offset:36864
    v_mfma_f32_16x16x32_bf16 a[164:167], v[124:127], v[80:83], a[164:167]
    ds_read_b64_tr_b16 v[124:125], v250 offset:32768
    ds_read_b64_tr_b16 v[126:127], v250 offset:36864
    v_mfma_f32_16x16x32_bf16 a[168:171], v[128:131], v[80:83], a[168:171]
    ds_read_b64_tr_b16 v[128:129], v249 offset:33024
    ds_read_b64_tr_b16 v[130:131], v249 offset:37120
    v_mfma_f32_16x16x32_bf16 a[172:175], v[132:135], v[80:83], a[172:175]
    ds_read_b64_tr_b16 v[132:133], v250 offset:33024
    ds_read_b64_tr_b16 v[134:135], v250 offset:37120
    v_mfma_f32_16x16x32_bf16 a[176:179], v[136:139], v[80:83], a[176:179]
    ds_read_b64_tr_b16 v[136:137], v249 offset:33280
    ds_read_b64_tr_b16 v[138:139], v249 offset:37376
    v_mfma_f32_16x16x32_bf16 a[180:183], v[140:143], v[80:83], a[180:183]
    ds_read_b64_tr_b16 v[140:141], v250 offset:33280
    ds_read_b64_tr_b16 v[142:143], v250 offset:37376
    v_mfma_f32_16x16x32_bf16 a[184:187], v[144:147], v[80:83], a[184:187]
    ds_read_b64_tr_b16 v[144:145], v249 offset:33536
    ds_read_b64_tr_b16 v[146:147], v249 offset:37632
    v_mfma_f32_16x16x32_bf16 a[188:191], v[148:151], v[80:83], a[188:191]
    ds_read_b64_tr_b16 v[148:149], v250 offset:33536
    ds_read_b64_tr_b16 v[150:151], v250 offset:37632
    v_mfma_f32_16x16x32_bf16 a[212:215], a[216:219], v[80:83], a[212:215]
    s_add_u32 m0, s58, 73728
    v_mfma_f32_16x16x32_bf16 v[64:67], v[88:91], v[200:203], v[28:31]
    s_waitcnt vmcnt(3)
    buffer_load_dwordx4 v1, s[4:7], s65 offen offset:0 nt lds
    v_mfma_f32_16x16x32_bf16 v[64:67], v[92:95], v[204:207], v[64:67]
    v_exp_f32 v45, v45
    v_mfma_f32_16x16x32_bf16 v[64:67], v[96:99], v[208:211], v[64:67]
    v_exp_f32 v46, v46
    v_mfma_f32_16x16x32_bf16 v[64:67], v[100:103], v[212:215], v[64:67]
    v_exp_f32 v47, v47
    v_mfma_f32_16x16x32_bf16 v[68:71], v[104:107], v[200:203], v[28:31]
    v_cvt_pk_bf16_f32 v42, v44, v45
    v_cvt_pk_bf16_f32 v43, v46, v47
    v_mfma_f32_16x16x32_bf16 v[68:71], v[108:111], v[204:207], v[68:71]
    v_exp_f32 v48, v48
    v_mfma_f32_16x16x32_bf16 v[68:71], v[112:115], v[208:211], v[68:71]
    v_exp_f32 v49, v49
    v_mfma_f32_16x16x32_bf16 v[68:71], v[116:119], v[212:215], v[68:71]
    s_waitcnt lgkmcnt(0)
    v_mfma_f32_16x16x32_bf16 a[0:3], v[120:123], v[40:43], a[0:3]
    s_waitcnt vmcnt(3)
    buffer_load_dwordx4 v2, s[4:7], s65 offen offset:1024 nt lds
    v_mfma_f32_16x16x32_bf16 a[4:7], v[124:127], v[40:43], a[4:7]
    v_exp_f32 v50, v50
    v_mfma_f32_16x16x32_bf16 a[8:11], v[128:131], v[40:43], a[8:11]
    v_exp_f32 v51, v51
    v_mfma_f32_16x16x32_bf16 a[12:15], v[132:135], v[40:43], a[12:15]
    v_cvt_pk_bf16_f32 v48, v48, v49
    v_cvt_pk_bf16_f32 v49, v50, v51
    v_mfma_f32_16x16x32_bf16 a[16:19], v[136:139], v[40:43], a[16:19]
    v_exp_f32 v52, v52
    v_mfma_f32_16x16x32_bf16 a[20:23], v[140:143], v[40:43], a[20:23]
    v_exp_f32 v53, v53
    v_mfma_f32_16x16x32_bf16 a[24:27], v[144:147], v[40:43], a[24:27]
    v_exp_f32 v54, v54
    v_mfma_f32_16x16x32_bf16 a[28:31], v[148:151], v[40:43], a[28:31]
    v_max3_f32 v6, v56, v57, v58
    v_max3_f32 v9, v64, v65, v66
    v_mfma_f32_16x16x32_bf16 a[192:195], a[216:219], v[40:43], a[192:195]
    v_max3_f32 v6, v6, v59, v60
    v_max3_f32 v9, v9, v67, v68
    v_mfma_f32_16x16x32_bf16 v[72:75], v[88:91], v[216:219], v[32:35]
    v_max3_f32 v6, v6, v61, v62
    v_max3_f32 v9, v9, v69, v70
    v_mfma_f32_16x16x32_bf16 v[72:75], v[92:95], v[220:223], v[72:75]
    v_max3_f32 v6, v6, v63, v71
    v_max_f32 v6, v6, v9
    v_mfma_f32_16x16x32_bf16 v[72:75], v[96:99], v[224:227], v[72:75]
    v_cmp_lt_f32 vcc, s61, v6
    v_mfma_f32_16x16x32_bf16 v[72:75], v[100:103], v[228:231], v[72:75]
    v_exp_f32 v55, v55
    v_mfma_f32_16x16x32_bf16 v[76:79], v[104:107], v[216:219], v[32:35]
    v_cvt_pk_bf16_f32 v50, v52, v53
    v_cvt_pk_bf16_f32 v51, v54, v55
    v_mfma_f32_16x16x32_bf16 v[76:79], v[108:111], v[220:223], v[76:79]
    s_waitcnt vmcnt(3)
    buffer_load_dwordx4 v1, s[4:7], s65 offen offset:2048 nt lds
    v_mfma_f32_16x16x32_bf16 v[76:79], v[112:115], v[224:227], v[76:79]
    s_cbranch_vccnz L_stub2_3
L_back2_3:
    v_mfma_f32_16x16x32_bf16 v[76:79], v[116:119], v[228:231], v[76:79]
    v_exp_f32 v56, v56
    v_mfma_f32_16x16x32_bf16 a[32:35], v[120:123], v[48:51], a[32:35]
    v_exp_f32 v57, v57
    v_mfma_f32_16x16x32_bf16 a[36:39], v[124:127], v[48:51], a[36:39]
    v_exp_f32 v58, v58
    v_mfma_f32_16x16x32_bf16 a[40:43], v[128:131], v[48:51], a[40:43]
    v_exp_f32 v59, v59
    v_mfma_f32_16x16x32_bf16 a[44:47], v[132:135], v[48:51], a[44:47]
    v_cvt_pk_bf16_f32 v56, v56, v57
    v_cvt_pk_bf16_f32 v57, v58, v59
    v_mfma_f32_16x16x32_bf16 a[48:51], v[136:139], v[48:51], a[48:51]
    v_exp_f32 v60, v60
    v_mfma_f32_16x16x32_bf16 a[52:55], v[140:143], v[48:51], a[52:55]
    v_exp_f32 v61, v61
    v_mfma_f32_16x16x32_bf16 a[56:59], v[144:147], v[48:51], a[56:59]
    v_exp_f32 v62, v62
    v_mfma_f32_16x16x32_bf16 a[60:63], v[148:151], v[48:51], a[60:63]
    v_exp_f32 v63, v63
    v_mfma_f32_16x16x32_bf16 a[196:199], a[216:219], v[48:51], a[196:199]
    v_cvt_pk_bf16_f32 v58, v60, v61
    v_cvt_pk_bf16_f32 v59, v62, v63
    s_barrier
    v_mfma_f32_16x16x32_bf16 v[80:83], v[88:91], v[232:235], v[36:39]
    v_exp_f32 v64, v64
    v_mfma_f32_16x16x32_bf16 v[80:83], v[92:95], v[236:239], v[80:83]
    ds_read_b128 v[88:91], v251 offset:0
    ds_read_b128 v[92:95], v251 offset:256
    v_mfma_f32_16x16x32_bf16 v[80:83], v[96:99], v[240:243], v[80:83]
    s_waitcnt vmcnt(3)
    buffer_load_dwordx4 v2, s[4:7], s65 offen offset:3072 nt lds
    v_mfma_f32_16x16x32_bf16 v[80:83], v[100:103], v[244:247], v[80:83]
    ds_read_b128 v[96:99], v251 offset:512
    ds_read_b128 v[100:103], v251 offset:768
    v_mfma_f32_16x16x32_bf16 v[84:87], v[104:107], v[232:235], v[36:39]
    v_exp_f32 v65, v65
    v_mfma_f32_16x16x32_bf16 v[84:87], v[108:111], v[236:239], v[84:87]
    ds_read_b128 v[104:107], v251 offset:4096
    ds_read_b128 v[108:111], v251 offset:4352
    v_mfma_f32_16x16x32_bf16 v[84:87], v[112:115], v[240:243], v[84:87]
    v_exp_f32 v66, v66
    v_mfma_f32_16x16x32_bf16 v[84:87], v[116:119], v[244:247], v[84:87]
    ds_read_b128 v[112:115], v251 offset:4608
    ds_read_b128 v[116:119], v251 offset:4864
    v_mfma_f32_16x16x32_bf16 a[64:67], v[120:123], v[56:59], a[64:67]
    v_exp_f32 v67, v67
    v_mfma_f32_16x16x32_bf16 a[68:71], v[124:127], v[56:59], a[68:71]
    v_cvt_pk_bf16_f32 v64, v64, v65
    v_cvt_pk_bf16_f32 v65, v66, v67
    v_mfma_f32_16x16x32_bf16 a[72:75], v[128:131], v[56:59], a[72:75]
    v_exp_f32 v68, v68
    v_mfma_f32_16x16x32_bf16 a[76:79], v[132:135], v[56:59], a[76:79]
    v_exp_f32 v69, v69
    v_mfma_f32_16x16x32_bf16 a[80:83], v[136:139], v[56:59], a[80:83]
    v_exp_f32 v70, v70
    v_mfma_f32_16x16x32_bf16 a[84:87], v[140:143], v[56:59], a[84:87]
    v_max3_f32 v6, v72, v73, v74
    v_max3_f32 v9, v80, v81, v82
    v_mfma_f32_16x16x32_bf16 a[88:91], v[144:147], v[56:59], a[88:91]
    s_add_u32 m0, s58, 98304
    s_mov_b32 s65, 65536
    v_mfma_f32_16x16x32_bf16 a[92:95], v[148:151], v[56:59], a[92:95]
    s_waitcnt vmcnt(3)
    buffer_load_dwordx4 v1, s[28:31], s65 offen offset:0 nt lds
    v_mfma_f32_16x16x32_bf16 a[200:203], a[216:219], v[56:59], a[200:203]
    s_waitcnt lgkmcnt(0)
    v_mfma_f32_16x16x32_bf16 v[40:43], v[88:91], v[152:155], v[16:19]
    v_max3_f32 v6, v6, v75, v76
    v_max3_f32 v9, v9, v83, v84
    v_mfma_f32_16x16x32_bf16 v[40:43], v[92:95], v[156:159], v[40:43]
    v_max3_f32 v6, v6, v77, v78
    v_max3_f32 v9, v9, v85, v86
    v_mfma_f32_16x16x32_bf16 v[40:43], v[96:99], v[160:163], v[40:43]
    v_max3_f32 v6, v6, v79, v87
    v_max_f32 v6, v6, v9
    v_mfma_f32_16x16x32_bf16 v[40:43], v[100:103], v[164:167], v[40:43]
    v_cmp_lt_f32 vcc, s61, v6
    v_mfma_f32_16x16x32_bf16 v[44:47], v[104:107], v[152:155], v[16:19]
    v_exp_f32 v71, v71
    v_mfma_f32_16x16x32_bf16 v[44:47], v[108:111], v[156:159], v[44:47]
    v_cvt_pk_bf16_f32 v66, v68, v69
    v_cvt_pk_bf16_f32 v67, v70, v71
    v_mfma_f32_16x16x32_bf16 v[44:47], v[112:115], v[160:163], v[44:47]
    s_cbranch_vccnz L_stub4_4
L_back4_4:
    v_mfma_f32_16x16x32_bf16 v[44:47], v[116:119], v[164:167], v[44:47]
    v_exp_f32 v72, v72
    v_mfma_f32_16x16x32_bf16 a[96:99], v[120:123], v[64:67], a[96:99]
    v_exp_f32 v73, v73
    v_mfma_f32_16x16x32_bf16 a[100:103], v[124:127], v[64:67], a[100:103]
    v_exp_f32 v74, v74
    v_mfma_f32_16x16x32_bf16 a[104:107], v[128:131], v[64:67], a[104:107]
    v_exp_f32 v75, v75
    v_mfma_f32_16x16x32_bf16 a[108:111], v[132:135], v[64:67], a[108:111]
    s_waitcnt vmcnt(3)
    buffer_load_dwordx4 v2, s[28:31], s65 offen offset:1024 nt lds
    v_mfma_f32_16x16x32_bf16 a[112:115], v[136:139], v[64:67], a[112:115]
    v_cvt_pk_bf16_f32 v72, v72, v73
    v_cvt_pk_bf16_f32 v73, v74, v75
    v_mfma_f32_16x16x32_bf16 a[116:119], v[140:143], v[64:67], a[116:119]
    v_exp_f32 v76, v76
    v_mfma_f32_16x16x32_bf16 a[120:123], v[144:147], v[64:67], a[120:123]
    v_exp_f32 v77, v77
    v_mfma_f32_16x16x32_bf16 a[124:127], v[148:151], v[64:67], a[124:127]
    v_exp_f32 v78, v78
    v_mfma_f32_16x16x32_bf16 a[204:207], a[216:219], v[64:67], a[204:207]
    v_exp_f32 v79, v79
    v_mfma_f32_16x16x32_bf16 v[48:51], v[88:91], v[168:171], v[20:23]
    v_cvt_pk_bf16_f32 v74, v76, v77
    v_cvt_pk_bf16_f32 v75, v78, v79
    v_mfma_f32_16x16x32_bf16 v[48:51], v[92:95], v[172:175], v[48:51]
    v_exp_f32 v80, v80
    v_mfma_f32_16x16x32_bf16 v[48:51], v[96:99], v[176:179], v[48:51]
    v_exp_f32 v81, v81
    v_mfma_f32_16x16x32_bf16 v[48:51], v[100:103], v[180:183], v[48:51]
    v_exp_f32 v82, v82
    v_mfma_f32_16x16x32_bf16 v[52:55], v[104:107], v[168:171], v[20:23]
    v_exp_f32 v83, v83
    v_mfma_f32_16x16x32_bf16 v[52:55], v[108:111], v[172:175], v[52:55]
    v_cvt_pk_bf16_f32 v80, v80, v81
    v_cvt_pk_bf16_f32 v81, v82, v83
    v_mfma_f32_16x16x32_bf16 v[52:55], v[112:115], v[176:179], v[52:55]
    v_exp_f32 v84, v84
    v_mfma_f32_16x16x32_bf16 v[52:55], v[116:119], v[180:183], v[52:55]
    s_waitcnt vmcnt(3)
    buffer_load_dwordx4 v1, s[28:31], s65 offen offset:2048 nt lds
    v_mfma_f32_16x16x32_bf16 a[128:131], v[120:123], v[72:75], a[128:131]
    v_exp_f32 v85, v85
    v_mfma_f32_16x16x32_bf16 a[132:135], v[124:127], v[72:75], a[132:135]
    v_exp_f32 v86, v86
    v_mfma_f32_16x16x32_bf16 a[136:139], v[128:131], v[72:75], a[136:139]
    v_max3_f32 v6, v40, v41, v42
    v_max3_f32 v9, v48, v49, v50
    v_mfma_f32_16x16x32_bf16 a[140:143], v[132:135], v[72:75], a[140:143]
    v_max3_f32 v6, v6, v43, v44
    v_max3_f32 v9, v9, v51, v52
    v_mfma_f32_16x16x32_bf16 a[144:147], v[136:139], v[72:75], a[144:147]
    v_max3_f32 v6, v6, v45, v46
    v_max3_f32 v9, v9, v53, v54
    v_mfma_f32_16x16x32_bf16 a[148:151], v[140:143], v[72:75], a[148:151]
    v_max3_f32 v6, v6, v47, v55
    v_max_f32 v6, v6, v9
    v_mfma_f32_16x16x32_bf16 a[152:155], v[144:147], v[72:75], a[152:155]
    v_cmp_lt_f32 vcc, s61, v6
    v_mfma_f32_16x16x32_bf16 a[156:159], v[148:151], v[72:75], a[156:159]
    v_exp_f32 v87, v87
    v_mfma_f32_16x16x32_bf16 a[208:211], a[216:219], v[72:75], a[208:211]
    v_cvt_pk_bf16_f32 v82, v84, v85
    v_cvt_pk_bf16_f32 v83, v86, v87
    v_mfma_f32_16x16x32_bf16 v[56:59], v[88:91], v[184:187], v[24:27]
    s_cbranch_vccnz L_stub0_4
L_back0_4:
    v_mfma_f32_16x16x32_bf16 v[56:59], v[92:95], v[188:191], v[56:59]
    v_exp_f32 v40, v40
    v_mfma_f32_16x16x32_bf16 v[56:59], v[96:99], v[192:195], v[56:59]
    v_exp_f32 v41, v41
    v_mfma_f32_16x16x32_bf16 v[56:59], v[100:103], v[196:199], v[56:59]
    s_waitcnt vmcnt(3)
    buffer_load_dwordx4 v2, s[28:31], s65 offen offset:3072 nt lds
    v_mfma_f32_16x16x32_bf16 v[60:63], v[104:107], v[184:187], v[24:27]
    v_exp_f32 v42, v42
    v_mfma_f32_16x16x32_bf16 v[60:63], v[108:111], v[188:191], v[60:63]
    v_exp_f32 v43, v43
    v_mfma_f32_16x16x32_bf16 v[60:63], v[112:115], v[192:195], v[60:63]
    v_cvt_pk_bf16_f32 v40, v40, v41
    v_cvt_pk_bf16_f32 v41, v42, v43
    v_mfma_f32_16x16x32_bf16 v[60:63], v[116:119], v[196:199], v[60:63]
    v_exp_f32 v44, v44
    v_mfma_f32_16x16x32_bf16 a[160:163], v[120:123], v[80:83], a[160:163]
    ds_read_b64_tr_b16 v[120:121], v252 offset:0
    ds_read_b64_tr_b16 v[122:123], v252 offset:4096
    v_mfma_f32_16x16x32_bf16 a[164:167], v[124:127], v[80:83], a[164:167]
    ds_read_b64_tr_b16 v[124:125], v253 offset:0
    ds_read_b64_tr_b16 v[126:127], v253 offset:4096
    v_mfma_f32_16x16x32_bf16 a[168:171], v[128:131], v[80:83], a[168:171]
    ds_read_b64_tr_b16 v[128:129], v252 offset:256
    ds_read_b64_tr_b16 v[130:131], v252 offset:4352
    v_mfma_f32_16x16x32_bf16 a[172:175], v[132:135], v[80:83], a[172:175]
    ds_read_b64_tr_b16 v[132:133], v253 offset:256
    ds_read_b64_tr_b16 v[134:135], v253 offset:4352
    v_mfma_f32_16x16x32_bf16 a[176:179], v[136:139], v[80:83], a[176:179]
    ds_read_b64_tr_b16 v[136:137], v252 offset:512
    ds_read_b64_tr_b16 v[138:139], v252 offset:4608
    v_mfma_f32_16x16x32_bf16 a[180:183], v[140:143], v[80:83], a[180:183]
    ds_read_b64_tr_b16 v[140:141], v253 offset:512
    ds_read_b64_tr_b16 v[142:143], v253 offset:4608
    v_mfma_f32_16x16x32_bf16 a[184:187], v[144:147], v[80:83], a[184:187]
    ds_read_b64_tr_b16 v[144:145], v252 offset:768
    ds_read_b64_tr_b16 v[146:147], v252 offset:4864
    v_mfma_f32_16x16x32_bf16 a[188:191], v[148:151], v[80:83], a[188:191]
    ds_read_b64_tr_b16 v[148:149], v253 offset:768
    ds_read_b64_tr_b16 v[150:151], v253 offset:4864
    v_mfma_f32_16x16x32_bf16 a[212:215], a[216:219], v[80:83], a[212:215]
    v_exp_f32 v45, v45
    v_mfma_f32_16x16x32_bf16 v[64:67], v[88:91], v[200:203], v[28:31]
    s_add_u32 m0, s58, 106496
    v_mfma_f32_16x16x32_bf16 v[64:67], v[92:95], v[204:207], v[64:67]
    s_waitcnt vmcnt(3)
    buffer_load_dwordx4 v1, s[4:7], s65 offen offset:0 nt lds
    v_mfma_f32_16x16x32_bf16 v[64:67], v[96:99], v[208:211], v[64:67]
    v_exp_f32 v46, v46
    v_mfma_f32_16x16x32_bf16 v[64:67], v[100:103], v[212:215], v[64:67]
    v_exp_f32 v47, v47
    v_mfma_f32_16x16x32_bf16 v[68:71], v[104:107], v[200:203], v[28:31]
    v_cvt_pk_bf16_f32 v42, v44, v45
    v_cvt_pk_bf16_f32 v43, v46, v47
    v_mfma_f32_16x16x32_bf16 v[68:71], v[108:111], v[204:207], v[68:71]
    v_exp_f32 v48, v48
    v_mfma_f32_16x16x32_bf16 v[68:71], v[112:115], v[208:211], v[68:71]
    v_exp_f32 v49, v49
    v_mfma_f32_16x16x32_bf16 v[68:71], v[116:119], v[212:215], v[68:71]
    s_waitcnt lgkmcnt(0)
    v_mfma_f32_16x16x32_bf16 a[0:3], v[120:123], v[40:43], a[0:3]
    v_exp_f32 v50, v50
    v_mfma_f32_16x16x32_bf16 a[4:7], v[124:127], v[40:43], a[4:7]
    v_exp_f32 v51, v51
    v_mfma_f32_16x16x32_bf16 a[8:11], v[128:131], v[40:43], a[8:11]
    v_cvt_pk_bf16_f32 v48, v48, v49
    v_cvt_pk_bf16_f32 v49, v50, v51
    v_mfma_f32_16x16x32_bf16 a[12:15], v[132:135], v[40:43], a[12:15]
    v_exp_f32 v52, v52
    v_mfma_f32_16x16x32_bf16 a[16:19], v[136:139], v[40:43], a[16:19]
    v_exp_f32 v53, v53
    v_mfma_f32_16x16x32_bf16 a[20:23], v[140:143], v[40:43], a[20:23]
    s_waitcnt vmcnt(3)
    buffer_load_dwordx4 v2, s[4:7], s65 offen offset:1024 nt lds
    v_mfma_f32_16x16x32_bf16 a[24:27], v[144:147], v[40:43], a[24:27]
    v_exp_f32 v54, v54
    v_mfma_f32_16x16x32_bf16 a[28:31], v[148:151], v[40:43], a[28:31]
    v_max3_f32 v6, v56, v57, v58
    v_max3_f32 v9, v64, v65, v66
    v_mfma_f32_16x16x32_bf16 a[192:195], a[216:219], v[40:43], a[192:195]
    v_max3_f32 v6, v6, v59, v60
    v_max3_f32 v9, v9, v67, v68
    v_mfma_f32_16x16x32_bf16 v[72:75], v[88:91], v[216:219], v[32:35]
    v_max3_f32 v6, v6, v61, v62
    v_max3_f32 v9, v9, v69, v70
    v_mfma_f32_16x16x32_bf16 v[72:75], v[92:95], v[220:223], v[72:75]
    v_max3_f32 v6, v6, v63, v71
    v_max_f32 v6, v6, v9
    v_mfma_f32_16x16x32_bf16 v[72:75], v[96:99], v[224:227], v[72:75]
    v_cmp_lt_f32 vcc, s61, v6
    v_mfma_f32_16x16x32_bf16 v[72:75], v[100:103], v[228:231], v[72:75]
    v_exp_f32 v55, v55
    v_mfma_f32_16x16x32_bf16 v[76:79], v[104:107], v[216:219], v[32:35]
    v_cvt_pk_bf16_f32 v50, v52, v53
    v_cvt_pk_bf16_f32 v51, v54, v55
    v_mfma_f32_16x16x32_bf16 v[76:79], v[108:111], v[220:223], v[76:79]
    s_cbranch_vccnz L_stub2_4
L_back2_4:
    v_mfma_f32_16x16x32_bf16 v[76:79], v[112:115], v[224:227], v[76:79]
    v_exp_f32 v56, v56
    v_mfma_f32_16x16x32_bf16 v[76:79], v[116:119], v[228:231], v[76:79]
    v_exp_f32 v57, v57
    v_mfma_f32_16x16x32_bf16 a[32:35], v[120:123], v[48:51], a[32:35]
    v_exp_f32 v58, v58
    v_mfma_f32_16x16x32_bf16 a[36:39], v[124:127], v[48:51], a[36:39]
    v_exp_f32 v59, v59
    v_mfma_f32_16x16x32_bf16 a[40:43], v[128:131], v[48:51], a[40:43]
    s_waitcnt vmcnt(3)
    buffer_load_dwordx4 v1, s[4:7], s65 offen offset:2048 nt lds
    v_mfma_f32_16x16x32_bf16 a[44:47], v[132:135], v[48:51], a[44:47]
    v_cvt_pk_bf16_f32 v56, v56, v57
    v_cvt_pk_bf16_f32 v57, v58, v59
    v_mfma_f32_16x16x32_bf16 a[48:51], v[136:139], v[48:51], a[48:51]
    v_exp_f32 v60, v60
    v_mfma_f32_16x16x32_bf16 a[52:55], v[140:143], v[48:51], a[52:55]
    v_exp_f32 v61, v61
    v_mfma_f32_16x16x32_bf16 a[56:59], v[144:147], v[48:51], a[56:59]
    v_exp_f32 v62, v62
    v_mfma_f32_16x16x32_bf16 a[60:63], v[148:151], v[48:51], a[60:63]
    v_exp_f32 v63, v63
    v_mfma_f32_16x16x32_bf16 a[196:199], a[216:219], v[48:51], a[196:199]
    v_cvt_pk_bf16_f32 v58, v60, v61
    v_cvt_pk_bf16_f32 v59, v62, v63
    s_barrier
    v_mfma_f32_16x16x32_bf16 v[80:83], v[88:91], v[232:235], v[36:39]
    v_exp_f32 v64, v64
    v_mfma_f32_16x16x32_bf16 v[80:83], v[92:95], v[236:239], v[80:83]
    ds_read_b128 v[88:91], v3 offset:0
    ds_read_b128 v[92:95], v3 offset:256
    v_mfma_f32_16x16x32_bf16 v[80:83], v[96:99], v[240:243], v[80:83]
    v_exp_f32 v65, v65
    v_mfma_f32_16x16x32_bf16 v[80:83], v[100:103], v[244:247], v[80:83]
    ds_read_b128 v[96:99], v3 offset:512
    ds_read_b128 v[100:103], v3 offset:768
    v_mfma_f32_16x16x32_bf16 v[84:87], v[104:107], v[232:235], v[36:39]
    v_exp_f32 v66, v66
    v_mfma_f32_16x16x32_bf16 v[84:87], v[108:111], v[236:239], v[84:87]
    ds_read_b128 v[104:107], v3 offset:4096
    ds_read_b128 v[108:111], v3 offset:4352
    v_mfma_f32_16x16x32_bf16 v[84:87], v[112:115], v[240:243], v[84:87]
    s_waitcnt vmcnt(3)
    buffer_load_dwordx4 v2, s[4:7], s65 offen offset:3072 nt lds
    v_mfma_f32_16x16x32_bf16 v[84:87], v[116:119], v[244:247], v[84:87]
    ds_read_b128 v[112:115], v3 offset:4608
    ds_read_b128 v[116:119], v3 offset:4864
    v_mfma_f32_16x16x32_bf16 a[64:67], v[120:123], v[56:59], a[64:67]
    v_exp_f32 v67, v67
    v_mfma_f32_16x16x32_bf16 a[68:71], v[124:127], v[56:59], a[68:71]
    v_cvt_pk_bf16_f32 v64, v64, v65
    v_cvt_pk_bf16_f32 v65, v66, v67
    v_mfma_f32_16x16x32_bf16 a[72:75], v[128:131], v[56:59], a[72:75]
    v_exp_f32 v68, v68
    v_mfma_f32_16x16x32_bf16 a[76:79], v[132:135], v[56:59], a[76:79]
    v_exp_f32 v69, v69
    v_mfma_f32_16x16x32_bf16 a[80:83], v[136:139], v[56:59], a[80:83]
    v_exp_f32 v70, v70
    v_mfma_f32_16x16x32_bf16 a[84:87], v[140:143], v[56:59], a[84:87]
    v_max3_f32 v6, v72, v73, v74
    v_max3_f32 v9, v80, v81, v82
    v_mfma_f32_16x16x32_bf16 a[88:91], v[144:147], v[56:59], a[88:91]
    v_max3_f32 v6, v6, v75, v76
    v_max3_f32 v9, v9, v83, v84
    v_mfma_f32_16x16x32_bf16 a[92:95], v[148:151], v[56:59], a[92:95]
    v_max3_f32 v6, v6, v77, v78
    v_max3_f32 v9, v9, v85, v86
    v_mfma_f32_16x16x32_bf16 a[200:203], a[216:219], v[56:59], a[200:203]
    s_waitcnt lgkmcnt(0)
    v_mfma_f32_16x16x32_bf16 v[40:43], v[88:91], v[152:155], v[16:19]
    v_max3_f32 v6, v6, v79, v87
    v_max_f32 v6, v6, v9
    v_mfma_f32_16x16x32_bf16 v[40:43], v[92:95], v[156:159], v[40:43]
    v_cmp_lt_f32 vcc, s61, v6
    v_mfma_f32_16x16x32_bf16 v[40:43], v[96:99], v[160:163], v[40:43]
    s_add_u32 m0, s58, 131072
    s_mov_b32 s65, 73728
    v_mfma_f32_16x16x32_bf16 v[40:43], v[100:103], v[164:167], v[40:43]
    s_waitcnt vmcnt(3)
    buffer_load_dwordx4 v1, s[28:31], s65 offen offset:0 nt lds
    v_mfma_f32_16x16x32_bf16 v[44:47], v[104:107], v[152:155], v[16:19]
    v_exp_f32 v71, v71
    v_mfma_f32_16x16x32_bf16 v[44:47], v[108:111], v[156:159], v[44:47]
    v_cvt_pk_bf16_f32 v66, v68, v69
    v_cvt_pk_bf16_f32 v67, v70, v71
    v_mfma_f32_16x16x32_bf16 v[44:47], v[112:115], v[160:163], v[44:47]
    s_cbranch_vccnz L_stub4_5
L_back4_5:
    v_mfma_f32_16x16x32_bf16 v[44:47], v[116:119], v[164:167], v[44:47]
    v_exp_f32 v72, v72
    v_mfma_f32_16x16x32_bf16 a[96:99], v[120:123], v[64:67], a[96:99]
    v_exp_f32 v73, v73
    v_mfma_f32_16x16x32_bf16 a[100:103], v[124:127], v[64:67], a[100:103]
    v_exp_f32 v74, v74
    v_mfma_f32_16x16x32_bf16 a[104:107], v[128:131], v[64:67], a[104:107]
    v_exp_f32 v75, v75
    v_mfma_f32_16x16x32_bf16 a[108:111], v[132:135], v[64:67], a[108:111]
    v_cvt_pk_bf16_f32 v72, v72, v73
    v_cvt_pk_bf16_f32 v73, v74, v75
    v_mfma_f32_16x16x32_bf16 a[112:115], v[136:139], v[64:67], a[112:115]
    v_exp_f32 v76, v76
    v_mfma_f32_16x16x32_bf16 a[116:119], v[140:143], v[64:67], a[116:119]
    v_exp_f32 v77, v77
    v_mfma_f32_16x16x32_bf16 a[120:123], v[144:147], v[64:67], a[120:123]
    v_exp_f32 v78, v78
    v_mfma_f32_16x16x32_bf16 a[124:127], v[148:151], v[64:67], a[124:127]
    v_exp_f32 v79, v79
    v_mfma_f32_16x16x32_bf16 a[204:207], a[216:219], v[64:67], a[204:207]
    s_waitcnt vmcnt(3)
    buffer_load_dwordx4 v2, s[28:31], s65 offen offset:1024 nt lds
    v_mfma_f32_16x16x32_bf16 v[48:51], v[88:91], v[168:171], v[20:23]
    v_cvt_pk_bf16_f32 v74, v76, v77
    v_cvt_pk_bf16_f32 v75, v78, v79
    v_mfma_f32_16x16x32_bf16 v[48:51], v[92:95], v[172:175], v[48:51]
    v_exp_f32 v80, v80
    v_mfma_f32_16x16x32_bf16 v[48:51], v[96:99], v[176:179], v[48:51]
    v_exp_f32 v81, v81
    v_mfma_f32_16x16x32_bf16 v[48:51], v[100:103], v[180:183], v[48:51]
    v_exp_f32 v82, v82
    v_mfma_f32_16x16x32_bf16 v[52:55], v[104:107], v[168:171], v[20:23]
    v_exp_f32 v83, v83
    v_mfma_f32_16x16x32_bf16 v[52:55], v[108:111], v[172:175], v[52:55]
    v_cvt_pk_bf16_f32 v80, v80, v81
    v_cvt_pk_bf16_f32 v81, v82, v83
    v_mfma_f32_16x16x32_bf16 v[52:55], v[112:115], v[176:179], v[52:55]
    v_exp_f32 v84, v84
    v_mfma_f32_16x16x32_bf16 v[52:55], v[116:119], v[180:183], v[52:55]
    v_exp_f32 v85, v85
    v_mfma_f32_16x16x32_bf16 a[128:131], v[120:123], v[72:75], a[128:131]
    v_exp_f32 v86, v86
    v_mfma_f32_16x16x32_bf16 a[132:135], v[124:127], v[72:75], a[132:135]
    v_mfma_f32_16x16x32_bf16 a[136:139], v[128:131], v[72:75], a[136:139]
    v_max3_f32 v6, v40, v41, v42
    v_max3_f32 v9, v48, v49, v50
    v_mfma_f32_16x16x32_bf16 a[140:143], v[132:135], v[72:75], a[140:143]
    v_max3_f32 v6, v6, v43, v44
    v_max3_f32 v9, v9, v51, v52
    v_mfma_f32_16x16x32_bf16 a[144:147], v[136:139], v[72:75], a[144:147]
    s_waitcnt vmcnt(3)
    buffer_load_dwordx4 v1, s[28:31], s65 offen offset:2048 nt lds
    v_mfma_f32_16x16x32_bf16 a[148:151], v[140:143], v[72:75], a[148:151]
    v_max3_f32 v6, v6, v45, v46
    v_max3_f32 v9, v9, v53, v54
    v_mfma_f32_16x16x32_bf16 a[152:155], v[144:147], v[72:75], a[152:155]
    v_max3_f32 v6, v6, v47, v55
    v_max_f32 v6, v6, v9
    v_mfma_f32_16x16x32_bf16 a[156:159], v[148:151], v[72:75], a[156:159]
    v_cmp_lt_f32 vcc, s61, v6
    v_mfma_f32_16x16x32_bf16 a[208:211], a[216:219], v[72:75], a[208:211]
    v_exp_f32 v87, v87
    v_mfma_f32_16x16x32_bf16 v[56:59], v[88:91], v[184:187], v[24:27]
    v_cvt_pk_bf16_f32 v82, v84, v85
    v_cvt_pk_bf16_f32 v83, v86, v87
    v_mfma_f32_16x16x32_bf16 v[56:59], v[92:95], v[188:191], v[56:59]
    s_cbranch_vccnz L_stub0_5
L_back0_5:
    v_mfma_f32_16x16x32_bf16 v[56:59], v[96:99], v[192:195], v[56:59]
    v_exp_f32 v40, v40
    v_mfma_f32_16x16x32_bf16 v[56:59], v[100:103], v[196:199], v[56:59]
    v_exp_f32 v41, v41
    v_mfma_f32_16x16x32_bf16 v[60:63], v[104:107], v[184:187], v[24:27]
    v_exp_f32 v42, v42
    v_mfma_f32_16x16x32_bf16 v[60:63], v[108:111], v[188:191], v[60:63]
    v_exp_f32 v43, v43
    v_mfma_f32_16x16x32_bf16 v[60:63], v[112:115], v[192:195], v[60:63]
    v_cvt_pk_bf16_f32 v40, v40, v41
    v_cvt_pk_bf16_f32 v41, v42, v43
    v_mfma_f32_16x16x32_bf16 v[60:63], v[116:119], v[196:199], v[60:63]
    v_exp_f32 v44, v44
    v_mfma_f32_16x16x32_bf16 a[160:163], v[120:123], v[80:83], a[160:163]
    ds_read_b64_tr_b16 v[120:121], v4 offset:0
    ds_read_b64_tr_b16 v[122:123], v4 offset:4096
    v_mfma_f32_16x16x32_bf16 a[164:167], v[124:127], v[80:83], a[164:167]
    ds_read_b64_tr_b16 v[124:125], v5 offset:0
    ds_read_b64_tr_b16 v[126:127], v5 offset:4096
    v_mfma_f32_16x16x32_bf16 a[168:171], v[128:131], v[80:83], a[168:171]
    ds_read_b64_tr_b16 v[128:129], v4 offset:256
    ds_read_b64_tr_b16 v[130:131], v4 offset:4352
    v_mfma_f32_16x16x32_bf16 a[172:175], v[132:135], v[80:83], a[172:175]
    ds_read_b64_tr_b16 v[132:133], v5 offset:256
    ds_read_b64_tr_b16 v[134:135], v5 offset:4352
    v_mfma_f32_16x16x32_bf16 a[176:179], v[136:139], v[80:83], a[176:179]
    ds_read_b64_tr_b16 v[136:137], v4 offset:512
    ds_read_b64_tr_b16 v[138:139], v4 offset:4608
    v_mfma_f32_16x16x32_bf16 a[180:183], v[140:143], v[80:83], a[180:183]
    ds_read_b64_tr_b16 v[140:141], v5 offset:512
    ds_read_b64_tr_b16 v[142:143], v5 offset:4608
    v_mfma_f32_16x16x32_bf16 a[184:187], v[144:147], v[80:83], a[184:187]
    ds_read_b64_tr_b16 v[144:145], v4 offset:768
    ds_read_b64_tr_b16 v[146:147], v4 offset:4864
    v_mfma_f32_16x16x32_bf16 a[188:191], v[148:151], v[80:83], a[188:191]
    ds_read_b64_tr_b16 v[148:149], v5 offset:768
    ds_read_b64_tr_b16 v[150:151], v5 offset:4864
    v_mfma_f32_16x16x32_bf16 a[212:215], a[216:219], v[80:83], a[212:215]
    s_waitcnt vmcnt(3)
    buffer_load_dwordx4 v2, s[28:31], s65 offen offset:3072 nt lds
    v_mfma_f32_16x16x32_bf16 v[64:67], v[88:91], v[200:203], v[28:31]
    v_exp_f32 v45, v45
    v_mfma_f32_16x16x32_bf16 v[64:67], v[92:95], v[204:207], v[64:67]
    v_exp_f32 v46, v46
    v_mfma_f32_16x16x32_bf16 v[64:67], v[96:99], v[208:211], v[64:67]
    v_exp_f32 v47, v47
    v_mfma_f32_16x16x32_bf16 v[64:67], v[100:103], v[212:215], v[64:67]
    v_cvt_pk_bf16_f32 v42, v44, v45
    v_cvt_pk_bf16_f32 v43, v46, v47
    v_mfma_f32_16x16x32_bf16 v[68:71], v[104:107], v[200:203], v[28:31]
    v_exp_f32 v48, v48
    v_mfma_f32_16x16x32_bf16 v[68:71], v[108:111], v[204:207], v[68:71]
    s_add_u32 m0, s58, 139264
    v_mfma_f32_16x16x32_bf16 v[68:71], v[112:115], v[208:211], v[68:71]
    s_waitcnt vmcnt(3)
    buffer_load_dwordx4 v1, s[4:7], s65 offen offset:0 nt lds
    v_mfma_f32_16x16x32_bf16 v[68:71], v[116:119], v[212:215], v[68:71]
    s_waitcnt lgkmcnt(0)
    v_mfma_f32_16x16x32_bf16 a[0:3], v[120:123], v[40:43], a[0:3]
    v_exp_f32 v49, v49
    v_mfma_f32_16x16x32_bf16 a[4:7], v[124:127], v[40:43], a[4:7]
    v_exp_f32 v50, v50
    v_mfma_f32_16x16x32_bf16 a[8:11], v[128:131], v[40:43], a[8:11]
    v_exp_f32 v51, v51
    v_mfma_f32_16x16x32_bf16 a[12:15], v[132:135], v[40:43], a[12:15]
    v_cvt_pk_bf16_f32 v48, v48, v49
    v_cvt_pk_bf16_f32 v49, v50, v51
    v_mfma_f32_16x16x32_bf16 a[16:19], v[136:139], v[40:43], a[16:19]
    v_exp_f32 v52, v52
    v_mfma_f32_16x16x32_bf16 a[20:23], v[140:143], v[40:43], a[20:23]
    v_exp_f32 v53, v53
    v_mfma_f32_16x16x32_bf16 a[24:27], v[144:147], v[40:43], a[24:27]
    v_exp_f32 v54, v54
    v_mfma_f32_16x16x32_bf16 a[28:31], v[148:151], v[40:43], a[28:31]
    v_max3_f32 v6, v56, v57, v58
    v_max3_f32 v9, v64, v65, v66
    v_mfma_f32_16x16x32_bf16 a[192:195], a[216:219], v[40:43], a[192:195]
    v_max3_f32 v6, v6, v59, v60
    v_max3_f32 v9, v9, v67, v68
    v_mfma_f32_16x16x32_bf16 v[72:75], v[88:91], v[216:219], v[32:35]
    v_max3_f32 v6, v6, v61, v62
    v_max3_f32 v9, v9, v69, v70
    v_mfma_f32_16x16x32_bf16 v[72:75], v[92:95], v[220:223], v[72:75]
    s_waitcnt vmcnt(3)
    buffer_load_dwordx4 v2, s[4:7], s65 offen offset:1024 nt lds
    v_mfma_f32_16x16x32_bf16 v[72:75], v[96:99], v[224:227], v[72:75]
    v_max3_f32 v6, v6, v63, v71
    v_max_f32 v6, v6, v9
    v_mfma_f32_16x16x32_bf16 v[72:75], v[100:103], v[228:231], v[72:75]
    v_cmp_lt_f32 vcc, s61, v6
    v_mfma_f32_16x16x32_bf16 v[76:79], v[104:107], v[216:219], v[32:35]
    v_exp_f32 v55, v55
    v_mfma_f32_16x16x32_bf16 v[76:79], v[108:111], v[220:223], v[76:79]
    v_cvt_pk_bf16_f32 v50, v52, v53
    v_cvt_pk_bf16_f32 v51, v54, v55
    v_mfma_f32_16x16x32_bf16 v[76:79], v[112:115], v[224:227], v[76:79]
    s_cbranch_vccnz L_stub2_5
L_back2_5:
    v_mfma_f32_16x16x32_bf16 v[76:79], v[116:119], v[228:231], v[76:79]
    v_exp_f32 v56, v56
    v_mfma_f32_16x16x32_bf16 a[32:35], v[120:123], v[48:51], a[32:35]
    v_exp_f32 v57, v57
    v_mfma_f32_16x16x32_bf16 a[36:39], v[124:127], v[48:51], a[36:39]
    v_exp_f32 v58, v58
    v_mfma_f32_16x16x32_bf16 a[40:43], v[128:131], v[48:51], a[40:43]
    v_exp_f32 v59, v59
    v_mfma_f32_16x16x32_bf16 a[44:47], v[132:135], v[48:51], a[44:47]
    v_cvt_pk_bf16_f32 v56, v56, v57
    v_cvt_pk_bf16_f32 v57, v58, v59
    v_mfma_f32_16x16x32_bf16 a[48:51], v[136:139], v[48:51], a[48:51]
    v_exp_f32 v60, v60
    v_mfma_f32_16x16x32_bf16 a[52:55], v[140:143], v[48:51], a[52:55]
    v_exp_f32 v61, v61
    v_mfma_f32_16x16x32_bf16 a[56:59], v[144:147], v[48:51], a[56:59]
    s_waitcnt vmcnt(3)
    buffer_load_dwordx4 v1, s[4:7], s65 offen offset:2048 nt lds
    v_mfma_f32_16x16x32_bf16 a[60:63], v[148:151], v[48:51], a[60:63]
    v_exp_f32 v62, v62
    v_mfma_f32_16x16x32_bf16 a[196:199], a[216:219], v[48:51], a[196:199]
    v_exp_f32 v63, v63
    v_cvt_pk_bf16_f32 v58, v60, v61
    v_cvt_pk_bf16_f32 v59, v62, v63
    s_barrier
    v_mfma_f32_16x16x32_bf16 v[80:83], v[88:91], v[232:235], v[36:39]
    v_exp_f32 v64, v64
    v_mfma_f32_16x16x32_bf16 v[80:83], v[92:95], v[236:239], v[80:83]
    ds_read_b128 v[88:91], v3 offset:32768
    ds_read_b128 v[92:95], v3 offset:33024
    v_mfma_f32_16x16x32_bf16 v[80:83], v[96:99], v[240:243], v[80:83]
    v_exp_f32 v65, v65
    v_mfma_f32_16x16x32_bf16 v[80:83], v[100:103], v[244:247], v[80:83]
    ds_read_b128 v[96:99], v3 offset:33280
    ds_read_b128 v[100:103], v3 offset:33536
    v_mfma_f32_16x16x32_bf16 v[84:87], v[104:107], v[232:235], v[36:39]
    v_exp_f32 v66, v66
    v_mfma_f32_16x16x32_bf16 v[84:87], v[108:111], v[236:239], v[84:87]
    ds_read_b128 v[104:107], v3 offset:36864
    ds_read_b128 v[108:111], v3 offset:37120
    v_mfma_f32_16x16x32_bf16 v[84:87], v[112:115], v[240:243], v[84:87]
    v_exp_f32 v67, v67
    v_mfma_f32_16x16x32_bf16 v[84:87], v[116:119], v[244:247], v[84:87]
    ds_read_b128 v[112:115], v3 offset:37376
    ds_read_b128 v[116:119], v3 offset:37632
    v_mfma_f32_16x16x32_bf16 a[64:67], v[120:123], v[56:59], a[64:67]
    v_cvt_pk_bf16_f32 v64, v64, v65
    v_cvt_pk_bf16_f32 v65, v66, v67
    v_mfma_f32_16x16x32_bf16 a[68:71], v[124:127], v[56:59], a[68:71]
    v_exp_f32 v68, v68
    v_mfma_f32_16x16x32_bf16 a[72:75], v[128:131], v[56:59], a[72:75]
    v_exp_f32 v69, v69
    v_mfma_f32_16x16x32_bf16 a[76:79], v[132:135], v[56:59], a[76:79]
    s_waitcnt vmcnt(3)
    buffer_load_dwordx4 v2, s[4:7], s65 offen offset:3072 nt lds
    v_mfma_f32_16x16x32_bf16 a[80:83], v[136:139], v[56:59], a[80:83]
    v_exp_f32 v70, v70
    v_mfma_f32_16x16x32_bf16 a[84:87], v[140:143], v[56:59], a[84:87]
    v_max3_f32 v6, v72, v73, v74
    v_max3_f32 v9, v80, v81, v82
    v_mfma_f32_16x16x32_bf16 a[88:91], v[144:147], v[56:59], a[88:91]
    v_max3_f32 v6, v6, v75, v76
    v_max3_f32 v9, v9, v83, v84
    v_mfma_f32_16x16x32_bf16 a[92:95], v[148:151], v[56:59], a[92:95]
    v_max3_f32 v6, v6, v77, v78
    v_max3_f32 v9, v9, v85, v86
    v_mfma_f32_16x16x32_bf16 a[200:203], a[216:219], v[56:59], a[200:203]
    s_waitcnt lgkmcnt(0)
    v_mfma_f32_16x16x32_bf16 v[40:43], v[88:91], v[152:155], v[16:19]
    v_max3_f32 v6, v6, v79, v87
    v_max_f32 v6, v6, v9
    v_mfma_f32_16x16x32_bf16 v[40:43], v[92:95], v[156:159], v[40:43]
    v_cmp_lt_f32 vcc, s61, v6
    v_mfma_f32_16x16x32_bf16 v[40:43], v[96:99], v[160:163], v[40:43]
    v_exp_f32 v71, v71
    v_mfma_f32_16x16x32_bf16 v[40:43], v[100:103], v[164:167], v[40:43]
    v_cvt_pk_bf16_f32 v66, v68, v69
    v_cvt_pk_bf16_f32 v67, v70, v71
    v_mfma_f32_16x16x32_bf16 v[44:47], v[104:107], v[152:155], v[16:19]
    s_cbranch_vccnz L_stub4_6
L_back4_6:
    v_mfma_f32_16x16x32_bf16 v[44:47], v[108:111], v[156:159], v[44:47]
    v_exp_f32 v72, v72
    v_mfma_f32_16x16x32_bf16 v[44:47], v[112:115], v[160:163], v[44:47]
    v_exp_f32 v73, v73
    v_mfma_f32_16x16x32_bf16 v[44:47], v[116:119], v[164:167], v[44:47]
    s_add_u32 m0, s58, 0
    s_mov_b32 s65, 81920
    v_mfma_f32_16x16x32_bf16 a[96:99], v[120:123], v[64:67], a[96:99]
    s_waitcnt vmcnt(3)
    buffer_load_dwordx4 v1, s[28:31], s65 offen offset:0 nt lds
    v_mfma_f32_16x16x32_bf16 a[100:103], v[124:127], v[64:67], a[100:103]
    v_exp_f32 v74, v74
    v_mfma_f32_16x16x32_bf16 a[104:107], v[128:131], v[64:67], a[104:107]
    v_exp_f32 v75, v75
    v_mfma_f32_16x16x32_bf16 a[108:111], v[132:135], v[64:67], a[108:111]
    v_cvt_pk_bf16_f32 v72, v72, v73
    v_cvt_pk_bf16_f32 v73, v74, v75
    v_mfma_f32_16x16x32_bf16 a[112:115], v[136:139], v[64:67], a[112:115]
    v_exp_f32 v76, v76
    v_mfma_f32_16x16x32_bf16 a[116:119], v[140:143], v[64:67], a[116:119]
    v_exp_f32 v77, v77
    v_mfma_f32_16x16x32_bf16 a[120:123], v[144:147], v[64:67], a[120:123]
    v_exp_f32 v78, v78
    v_mfma_f32_16x16x32_bf16 a[124:127], v[148:151], v[64:67], a[124:127]
    v_exp_f32 v79, v79
    v_mfma_f32_16x16x32_bf16 a[204:207], a[216:219], v[64:67], a[204:207]
    v_cvt_pk_bf16_f32 v74, v76, v77
    v_cvt_pk_bf16_f32 v75, v78, v79
    v_mfma_f32_16x16x32_bf16 v[48:51], v[88:91], v[168:171], v[20:23]
    v_exp_f32 v80, v80
    v_mfma_f32_16x16x32_bf16 v[48:51], v[92:95], v[172:175], v[48:51]
    v_exp_f32 v81, v81
    v_mfma_f32_16x16x32_bf16 v[48:51], v[96:99], v[176:179], v[48:51]
    v_exp_f32 v82, v82
    v_mfma_f32_16x16x32_bf16 v[48:51], v[100:103], v[180:183], v[48:51]
    v_exp_f32 v83, v83
    v_mfma_f32_16x16x32_bf16 v[52:55], v[104:107], v[168:171], v[20:23]
    s_waitcnt vmcnt(3)
    buffer_load_dwordx4 v2, s[28:31], s65 offen offset:1024 nt lds
    v_mfma_f32_16x16x32_bf16 v[52:55], v[108:111], v[172:175], v[52:55]
    v_cvt_pk_bf16_f32 v80, v80, v81
    v_cvt_pk_bf16_f32 v81, v82, v83
    v_mfma_f32_16x16x32_bf16 v[52:55], v[112:115], v[176:179], v[52:55]
    v_exp_f32 v84, v84
    v_mfma_f32_16x16x32_bf16 v[52:55], v[116:119], v[180:183], v[52:55]
    v_exp_f32 v85, v85
    v_mfma_f32_16x16x32_bf16 a[128:131], v[120:123], v[72:75], a[128:131]
    v_exp_f32 v86, v86
    v_mfma_f32_16x16x32_bf16 a[132:135], v[124:127], v[72:75], a[132:135]
    v_mfma_f32_16x16x32_bf16 a[136:139], v[128:131], v[72:75], a[136:139]
    v_max3_f32 v6, v40, v41, v42
    v_max3_f32 v9, v48, v49, v50
    v_mfma_f32_16x16x32_bf16 a[140:143], v[132:135], v[72:75], a[140:143]
    v_max3_f32 v6, v6, v43, v44
    v_max3_f32 v9, v9, v51, v52
    v_mfma_f32_16x16x32_bf16 a[144:147], v[136:139], v[72:75], a[144:147]
    v_max3_f32 v6, v6, v45, v46
    v_max3_f32 v9, v9, v53, v54
    v_mfma_f32_16x16x32_bf16 a[148:151], v[140:143], v[72:75], a[148:151]
    v_max3_f32 v6, v6, v47, v55
    v_max_f32 v6, v6, v9
    v_mfma_f32_16x16x32_bf16 a[152:155], v[144:147], v[72:75], a[152:155]
    v_cmp_lt_f32 vcc, s61, v6
    v_mfma_f32_16x16x32_bf16 a[156:159], v[148:151], v[72:75], a[156:159]
    v_exp_f32 v87, v87
    v_mfma_f32_16x16x32_bf16 a[208:211], a[216:219], v[72:75], a[208:211]
    v_cvt_pk_bf16_f32 v82, v84, v85
    v_cvt_pk_bf16_f32 v83, v86, v87
    v_mfma_f32_16x16x32_bf16 v[56:59], v[88:91], v[184:187], v[24:27]
    s_waitcnt vmcnt(3)
    buffer_load_dwordx4 v1, s[28:31], s65 offen offset:2048 nt lds
    v_mfma_f32_16x16x32_bf16 v[56:59], v[92:95], v[188:191], v[56:59]
    s_cbranch_vccnz L_stub0_6
L_back0_6:
    v_mfma_f32_16x16x32_bf16 v[56:59], v[96:99], v[192:195], v[56:59]
    v_exp_f32 v40, v40
    v_mfma_f32_16x16x32_bf16 v[56:59], v[100:103], v[196:199], v[56:59]
    v_exp_f32 v41, v41
    v_mfma_f32_16x16x32_bf16 v[60:63], v[104:107], v[184:187], v[24:27]
    v_exp_f32 v42, v42
    v_mfma_f32_16x16x32_bf16 v[60:63], v[108:111], v[188:191], v[60:63]
    v_exp_f32 v43, v43
    v_mfma_f32_16x16x32_bf16 v[60:63], v[112:115], v[192:195], v[60:63]
    v_cvt_pk_bf16_f32 v40, v40, v41
    v_cvt_pk_bf16_f32 v41, v42, v43
    v_mfma_f32_16x16x32_bf16 v[60:63], v[116:119], v[196:199], v[60:63]
    v_exp_f32 v44, v44
    v_mfma_f32_16x16x32_bf16 a[160:163], v[120:123], v[80:83], a[160:163]
    ds_read_b64_tr_b16 v[120:121], v4 offset:32768
    ds_read_b64_tr_b16 v[122:123], v4 offset:36864
    v_mfma_f32_16x16x32_bf16 a[164:167], v[124:127], v[80:83], a[164:167]
    ds_read_b64_tr_b16 v[124:125], v5 offset:32768
    ds_read_b64_tr_b16 v[126:127], v5 offset:36864
    v_mfma_f32_16x16x32_bf16 a[168:171], v[128:131], v[80:83], a[168:171]
    ds_read_b64_tr_b16 v[128:129], v4 offset:33024
    ds_read_b64_tr_b16 v[130:131], v4 offset:37120
    v_mfma_f32_16x16x32_bf16 a[172:175], v[132:135], v[80:83], a[172:175]
    ds_read_b64_tr_b16 v[132:133], v5 offset:33024
    ds_read_b64_tr_b16 v[134:135], v5 offset:37120
    v_mfma_f32_16x16x32_bf16 a[176:179], v[136:139], v[80:83], a[176:179]
    ds_read_b64_tr_b16 v[136:137], v4 offset:33280
    ds_read_b64_tr_b16 v[138:139], v4 offset:37376
    v_mfma_f32_16x16x32_bf16 a[180:183], v[140:143], v[80:83], a[180:183]
    ds_read_b64_tr_b16 v[140:141], v5 offset:33280
    ds_read_b64_tr_b16 v[142:143], v5 offset:37376
    v_mfma_f32_16x16x32_bf16 a[184:187], v[144:147], v[80:83], a[184:187]
    ds_read_b64_tr_b16 v[144:145], v4 offset:33536
    ds_read_b64_tr_b16 v[146:147], v4 offset:37632
    v_mfma_f32_16x16x32_bf16 a[188:191], v[148:151], v[80:83], a[188:191]
    ds_read_b64_tr_b16 v[148:149], v5 offset:33536
    ds_read_b64_tr_b16 v[150:151], v5 offset:37632
    v_mfma_f32_16x16x32_bf16 a[212:215], a[216:219], v[80:83], a[212:215]
    s_waitcnt vmcnt(3)
    buffer_load_dwordx4 v2, s[28:31], s65 offen offset:3072 nt lds
    v_mfma_f32_16x16x32_bf16 v[64:67], v[88:91], v[200:203], v[28:31]
    v_exp_f32 v45, v45
    v_mfma_f32_16x16x32_bf16 v[64:67], v[92:95], v[204:207], v[64:67]
    v_exp_f32 v46, v46
    v_mfma_f32_16x16x32_bf16 v[64:67], v[96:99], v[208:211], v[64:67]
    v_exp_f32 v47, v47
    v_mfma_f32_16x16x32_bf16 v[64:67], v[100:103], v[212:215], v[64:67]
    v_cvt_pk_bf16_f32 v42, v44, v45
    v_cvt_pk_bf16_f32 v43, v46, v47
    v_mfma_f32_16x16x32_bf16 v[68:71], v[104:107], v[200:203], v[28:31]
    v_exp_f32 v48, v48
    v_mfma_f32_16x16x32_bf16 v[68:71], v[108:111], v[204:207], v[68:71]
    v_exp_f32 v49, v49
    v_mfma_f32_16x16x32_bf16 v[68:71], v[112:115], v[208:211], v[68:71]
    v_exp_f32 v50, v50
    v_mfma_f32_16x16x32_bf16 v[68:71], v[116:119], v[212:215], v[68:71]
    s_waitcnt lgkmcnt(0)
    v_mfma_f32_16x16x32_bf16 a[0:3], v[120:123], v[40:43], a[0:3]
    v_exp_f32 v51, v51
    v_mfma_f32_16x16x32_bf16 a[4:7], v[124:127], v[40:43], a[4:7]
    v_cvt_pk_bf16_f32 v48, v48, v49
    v_cvt_pk_bf16_f32 v49, v50, v51
    v_mfma_f32_16x16x32_bf16 a[8:11], v[128:131], v[40:43], a[8:11]
    s_add_u32 m0, s58, 8192
    v_mfma_f32_16x16x32_bf16 a[12:15], v[132:135], v[40:43], a[12:15]
    s_waitcnt vmcnt(3)
    buffer_load_dwordx4 v1, s[4:7], s65 offen offset:0 nt lds
    v_mfma_f32_16x16x32_bf16 a[16:19], v[136:139], v[40:43], a[16:19]
    v_exp_f32 v52, v52
    v_mfma_f32_16x16x32_bf16 a[20:23], v[140:143], v[40:43], a[20:23]
    v_exp_f32 v53, v53
    v_mfma_f32_16x16x32_bf16 a[24:27], v[144:147], v[40:43], a[24:27]
    v_exp_f32 v54, v54
    v_mfma_f32_16x16x32_bf16 a[28:31], v[148:151], v[40:43], a[28:31]
    v_max3_f32 v6, v56, v57, v58
    v_max3_f32 v9, v64, v65, v66
    v_mfma_f32_16x16x32_bf16 a[192:195], a[216:219], v[40:43], a[192:195]
    v_max3_f32 v6, v6, v59, v60
    v_max3_f32 v9, v9, v67, v68
    v_mfma_f32_16x16x32_bf16 v[72:75], v[88:91], v[216:219], v[32:35]
    v_max3_f32 v6, v6, v61, v62
    v_max3_f32 v9, v9, v69, v70
    v_mfma_f32_16x16x32_bf16 v[72:75], v[92:95], v[220:223], v[72:75]
    v_max3_f32 v6, v6, v63, v71
    v_max_f32 v6, v6, v9
    v_mfma_f32_16x16x32_bf16 v[72:75], v[96:99], v[224:227], v[72:75]
    v_cmp_lt_f32 vcc, s61, v6
    v_mfma_f32_16x16x32_bf16 v[72:75], v[100:103], v[228:231], v[72:75]
    v_exp_f32 v55, v55
    v_mfma_f32_16x16x32_bf16 v[76:79], v[104:107], v[216:219], v[32:35]
    v_cvt_pk_bf16_f32 v50, v52, v53
    v_cvt_pk_bf16_f32 v51, v54, v55
    v_mfma_f32_16x16x32_bf16 v[76:79], v[108:111], v[220:223], v[76:79]
    s_cbranch_vccnz L_stub2_6
L_back2_6:
    v_mfma_f32_16x16x32_bf16 v[76:79], v[112:115], v[224:227], v[76:79]
    s_waitcnt vmcnt(3)
    buffer_load_dwordx4 v2, s[4:7], s65 offen offset:1024 nt lds
    v_mfma_f32_16x16x32_bf16 v[76:79], v[116:119], v[228:231], v[76:79]
    v_exp_f32 v56, v56
    v_mfma_f32_16x16x32_bf16 a[32:35], v[120:123], v[48:51], a[32:35]
    v_exp_f32 v57, v57
    v_mfma_f32_16x16x32_bf16 a[36:39], v[124:127], v[48:51], a[36:39]
    v_exp_f32 v58, v58
    v_mfma_f32_16x16x32_bf16 a[40:43], v[128:131], v[48:51], a[40:43]
    v_exp_f32 v59, v59
    v_mfma_f32_16x16x32_bf16 a[44:47], v[132:135], v[48:51], a[44:47]
    v_cvt_pk_bf16_f32 v56, v56, v57
    v_cvt_pk_bf16_f32 v57, v58, v59
    v_mfma_f32_16x16x32_bf16 a[48:51], v[136:139], v[48:51], a[48:51]
    v_exp_f32 v60, v60
    v_mfma_f32_16x16x32_bf16 a[52:55], v[140:143], v[48:51], a[52:55]
    v_exp_f32 v61, v61
    v_mfma_f32_16x16x32_bf16 a[56:59], v[144:147], v[48:51], a[56:59]
    v_exp_f32 v62, v62
    v_mfma_f32_16x16x32_bf16 a[60:63], v[148:151], v[48:51], a[60:63]
    v_exp_f32 v63, v63
    v_mfma_f32_16x16x32_bf16 a[196:199], a[216:219], v[48:51], a[196:199]
    v_cvt_pk_bf16_f32 v58, v60, v61
    v_cvt_pk_bf16_f32 v59, v62, v63
    s_barrier
    v_mfma_f32_16x16x32_bf16 v[80:83], v[88:91], v[232:235], v[36:39]
    v_exp_f32 v64, v64
    v_mfma_f32_16x16x32_bf16 v[80:83], v[92:95], v[236:239], v[80:83]
    ds_read_b128 v[88:91], v248 offset:0
    ds_read_b128 v[92:95], v248 offset:256
    v_mfma_f32_16x16x32_bf16 v[80:83], v[96:99], v[240:243], v[80:83]
    s_waitcnt vmcnt(3)
    buffer_load_dwordx4 v1, s[4:7], s65 offen offset:2048 nt lds
    v_mfma_f32_16x16x32_bf16 v[80:83], v[100:103], v[244:247], v[80:83]
    ds_read_b128 v[96:99], v248 offset:512
    ds_read_b128 v[100:103], v248 offset:768
    v_mfma_f32_16x16x32_bf16 v[84:87], v[104:107], v[232:235], v[36:39]
    v_exp_f32 v65, v65
    v_mfma_f32_16x16x32_bf16 v[84:87], v[108:111], v[236:239], v[84:87]
    ds_read_b128 v[104:107], v248 offset:4096
    ds_read_b128 v[108:111], v248 offset:4352
    v_mfma_f32_16x16x32_bf16 v[84:87], v[112:115], v[240:243], v[84:87]
    v_exp_f32 v66, v66
    v_mfma_f32_16x16x32_bf16 v[84:87], v[116:119], v[244:247], v[84:87]
    ds_read_b128 v[112:115], v248 offset:4608
    ds_read_b128 v[116:119], v248 offset:4864
    v_mfma_f32_16x16x32_bf16 a[64:67], v[120:123], v[56:59], a[64:67]
    v_exp_f32 v67, v67
    v_mfma_f32_16x16x32_bf16 a[68:71], v[124:127], v[56:59], a[68:71]
    v_cvt_pk_bf16_f32 v64, v64, v65
    v_cvt_pk_bf16_f32 v65, v66, v67
    v_mfma_f32_16x16x32_bf16 a[72:75], v[128:131], v[56:59], a[72:75]
    v_exp_f32 v68, v68
    v_mfma_f32_16x16x32_bf16 a[76:79], v[132:135], v[56:59], a[76:79]
    v_exp_f32 v69, v69
    v_mfma_f32_16x16x32_bf16 a[80:83], v[136:139], v[56:59], a[80:83]
    v_exp_f32 v70, v70
    v_mfma_f32_16x16x32_bf16 a[84:87], v[140:143], v[56:59], a[84:87]
    v_max3_f32 v6, v72, v73, v74
    v_max3_f32 v9, v80, v81, v82
    v_mfma_f32_16x16x32_bf16 a[88:91], v[144:147], v[56:59], a[88:91]
    v_max3_f32 v6, v6, v75, v76
    v_max3_f32 v9, v9, v83, v84
    v_mfma_f32_16x16x32_bf16 a[92:95], v[148:151], v[56:59], a[92:95]
    v_max3_f32 v6, v6, v77, v78
    v_max3_f32 v9, v9, v85, v86
    v_mfma_f32_16x16x32_bf16 a[200:203], a[216:219], v[56:59], a[200:203]
    s_waitcnt lgkmcnt(0)
    v_mfma_f32_16x16x32_bf16 v[40:43], v[88:91], v[152:155], v[16:19]
    s_waitcnt vmcnt(3)
    buffer_load_dwordx4 v2, s[4:7], s65 offen offset:3072 nt lds
    v_mfma_f32_16x16x32_bf16 v[40:43], v[92:95], v[156:159], v[40:43]
    v_max3_f32 v6, v6, v79, v87
    v_max_f32 v6, v6, v9
    v_mfma_f32_16x16x32_bf16 v[40:43], v[96:99], v[160:163], v[40:43]
    v_cmp_lt_f32 vcc, s61, v6
    v_mfma_f32_16x16x32_bf16 v[40:43], v[100:103], v[164:167], v[40:43]
    v_exp_f32 v71, v71
    v_mfma_f32_16x16x32_bf16 v[44:47], v[104:107], v[152:155], v[16:19]
    v_cvt_pk_bf16_f32 v66, v68, v69
    v_cvt_pk_bf16_f32 v67, v70, v71
    v_mfma_f32_16x16x32_bf16 v[44:47], v[108:111], v[156:159], v[44:47]
    s_cbranch_vccnz L_stub4_7
L_back4_7:
    v_mfma_f32_16x16x32_bf16 v[44:47], v[112:115], v[160:163], v[44:47]
    v_exp_f32 v72, v72
    v_mfma_f32_16x16x32_bf16 v[44:47], v[116:119], v[164:167], v[44:47]
    v_exp_f32 v73, v73
    v_mfma_f32_16x16x32_bf16 a[96:99], v[120:123], v[64:67], a[96:99]
    v_exp_f32 v74, v74
    v_mfma_f32_16x16x32_bf16 a[100:103], v[124:127], v[64:67], a[100:103]
    v_exp_f32 v75, v75
    v_mfma_f32_16x16x32_bf16 a[104:107], v[128:131], v[64:67], a[104:107]
    v_cvt_pk_bf16_f32 v72, v72, v73
    v_cvt_pk_bf16_f32 v73, v74, v75
    v_mfma_f32_16x16x32_bf16 a[108:111], v[132:135], v[64:67], a[108:111]
    v_exp_f32 v76, v76
    v_mfma_f32_16x16x32_bf16 a[112:115], v[136:139], v[64:67], a[112:115]
    s_add_u32 m0, s58, 32768
    s_mov_b32 s65, 90112
    v_mfma_f32_16x16x32_bf16 a[116:119], v[140:143], v[64:67], a[116:119]
    s_waitcnt vmcnt(3)
    buffer_load_dwordx4 v1, s[28:31], s65 offen offset:0 nt lds
    v_mfma_f32_16x16x32_bf16 a[120:123], v[144:147], v[64:67], a[120:123]
    v_exp_f32 v77, v77
    v_mfma_f32_16x16x32_bf16 a[124:127], v[148:151], v[64:67], a[124:127]
    v_exp_f32 v78, v78
    v_mfma_f32_16x16x32_bf16 a[204:207], a[216:219], v[64:67], a[204:207]
    v_exp_f32 v79, v79
    v_mfma_f32_16x16x32_bf16 v[48:51], v[88:91], v[168:171], v[20:23]
    v_cvt_pk_bf16_f32 v74, v76, v77
    v_cvt_pk_bf16_f32 v75, v78, v79
    v_mfma_f32_16x16x32_bf16 v[48:51], v[92:95], v[172:175], v[48:51]
    v_exp_f32 v80, v80
    v_mfma_f32_16x16x32_bf16 v[48:51], v[96:99], v[176:179], v[48:51]
    v_exp_f32 v81, v81
    v_mfma_f32_16x16x32_bf16 v[48:51], v[100:103], v[180:183], v[48:51]
    v_exp_f32 v82, v82
    v_mfma_f32_16x16x32_bf16 v[52:55], v[104:107], v[168:171], v[20:23]
    v_exp_f32 v83, v83
    v_mfma_f32_16x16x32_bf16 v[52:55], v[108:111], v[172:175], v[52:55]
    v_cvt_pk_bf16_f32 v80, v80, v81
    v_cvt_pk_bf16_f32 v81, v82, v83
    v_mfma_f32_16x16x32_bf16 v[52:55], v[112:115], v[176:179], v[52:55]
    v_exp_f32 v84, v84
    v_mfma_f32_16x16x32_bf16 v[52:55], v[116:119], v[180:183], v[52:55]
    v_exp_f32 v85, v85
    v_mfma_f32_16x16x32_bf16 a[128:131], v[120:123], v[72:75], a[128:131]
    s_waitcnt vmcnt(3)
    buffer_load_dwordx4 v2, s[28:31], s65 offen offset:1024 nt lds
    v_mfma_f32_16x16x32_bf16 a[132:135], v[124:127], v[72:75], a[132:135]
    v_exp_f32 v86, v86
    v_mfma_f32_16x16x32_bf16 a[136:139], v[128:131], v[72:75], a[136:139]
    v_max3_f32 v6, v40, v41, v42
    v_max3_f32 v9, v48, v49, v50
    v_mfma_f32_16x16x32_bf16 a[140:143], v[132:135], v[72:75], a[140:143]
    v_max3_f32 v6, v6, v43, v44
    v_max3_f32 v9, v9, v51, v52
    v_mfma_f32_16x16x32_bf16 a[144:147], v[136:139], v[72:75], a[144:147]
    v_max3_f32 v6, v6, v45, v46
    v_max3_f32 v9, v9, v53, v54
    v_mfma_f32_16x16x32_bf16 a[148:151], v[140:143], v[72:75], a[148:151]
    v_max3_f32 v6, v6, v47, v55
    v_max_f32 v6, v6, v9
    v_mfma_f32_16x16x32_bf16 a[152:155], v[144:147], v[72:75], a[152:155]
    v_cmp_lt_f32 vcc, s61, v6
    v_mfma_f32_16x16x32_bf16 a[156:159], v[148:151], v[72:75], a[156:159]
    v_exp_f32 v87, v87
    v_mfma_f32_16x16x32_bf16 a[208:211], a[216:219], v[72:75], a[208:211]
    v_cvt_pk_bf16_f32 v82, v84, v85
    v_cvt_pk_bf16_f32 v83, v86, v87
    v_mfma_f32_16x16x32_bf16 v[56:59], v[88:91], v[184:187], v[24:27]
    s_cbranch_vccnz L_stub0_7
L_back0_7:
    v_mfma_f32_16x16x32_bf16 v[56:59], v[92:95], v[188:191], v[56:59]
    v_exp_f32 v40, v40
    v_mfma_f32_16x16x32_bf16 v[56:59], v[96:99], v[192:195], v[56:59]
    v_exp_f32 v41, v41
    v_mfma_f32_16x16x32_bf16 v[56:59], v[100:103], v[196:199], v[56:59]
    v_exp_f32 v42, v42
    v_mfma_f32_16x16x32_bf16 v[60:63], v[104:107], v[184:187], v[24:27]
    v_exp_f32 v43, v43
    v_mfma_f32_16x16x32_bf16 v[60:63], v[108:111], v[188:191], v[60:63]
    s_waitcnt vmcnt(3)
    buffer_load_dwordx4 v1, s[28:31], s65 offen offset:2048 nt lds
    v_mfma_f32_16x16x32_bf16 v[60:63], v[112:115], v[192:195], v[60:63]
    v_cvt_pk_bf16_f32 v40, v40, v41
    v_cvt_pk_bf16_f32 v41, v42, v43
    v_mfma_f32_16x16x32_bf16 v[60:63], v[116:119], v[196:199], v[60:63]
    v_exp_f32 v44, v44
    v_mfma_f32_16x16x32_bf16 a[160:163], v[120:123], v[80:83], a[160:163]
    ds_read_b64_tr_b16 v[120:121], v249 offset:0
    ds_read_b64_tr_b16 v[122:123], v249 offset:4096
    v_mfma_f32_16x16x32_bf16 a[164:167], v[124:127], v[80:83], a[164:167]
    ds_read_b64_tr_b16 v[124:125], v250 offset:0
    ds_read_b64_tr_b16 v[126:127], v250 offset:4096
    v_mfma_f32_16x16x32_bf16 a[168:171], v[128:131], v[80:83], a[168:171]
    ds_read_b64_tr_b16 v[128:129], v249 offset:256
    ds_read_b64_tr_b16 v[130:131], v249 offset:4352
    v_mfma_f32_16x16x32_bf16 a[172:175], v[132:135], v[80:83], a[172:175]
    ds_read_b64_tr_b16 v[132:133], v250 offset:256
    ds_read_b64_tr_b16 v[134:135], v250 offset:4352
    v_mfma_f32_16x16x32_bf16 a[176:179], v[136:139], v[80:83], a[176:179]
    ds_read_b64_tr_b16 v[136:137], v249 offset:512
    ds_read_b64_tr_b16 v[138:139], v249 offset:4608
    v_mfma_f32_16x16x32_bf16 a[180:183], v[140:143], v[80:83], a[180:183]
    ds_read_b64_tr_b16 v[140:141], v250 offset:512
    ds_read_b64_tr_b16 v[142:143], v250 offset:4608
    v_mfma_f32_16x16x32_bf16 a[184:187], v[144:147], v[80:83], a[184:187]
    ds_read_b64_tr_b16 v[144:145], v249 offset:768
    ds_read_b64_tr_b16 v[146:147], v249 offset:4864
    v_mfma_f32_16x16x32_bf16 a[188:191], v[148:151], v[80:83], a[188:191]
    ds_read_b64_tr_b16 v[148:149], v250 offset:768
    ds_read_b64_tr_b16 v[150:151], v250 offset:4864
    v_mfma_f32_16x16x32_bf16 a[212:215], a[216:219], v[80:83], a[212:215]
    v_exp_f32 v45, v45
    v_mfma_f32_16x16x32_bf16 v[64:67], v[88:91], v[200:203], v[28:31]
    v_exp_f32 v46, v46
    v_mfma_f32_16x16x32_bf16 v[64:67], v[92:95], v[204:207], v[64:67]
    s_waitcnt vmcnt(3)
    buffer_load_dwordx4 v2, s[28:31], s65 offen offset:3072 nt lds
    v_mfma_f32_16x16x32_bf16 v[64:67], v[96:99], v[208:211], v[64:67]
    v_exp_f32 v47, v47
    v_mfma_f32_16x16x32_bf16 v[64:67], v[100:103], v[212:215], v[64:67]
    v_cvt_pk_bf16_f32 v42, v44, v45
    v_cvt_pk_bf16_f32 v43, v46, v47
    v_mfma_f32_16x16x32_bf16 v[68:71], v[104:107], v[200:203], v[28:31]
    v_exp_f32 v48, v48
    v_mfma_f32_16x16x32_bf16 v[68:71], v[108:111], v[204:207], v[68:71]
    v_exp_f32 v49, v49
    v_mfma_f32_16x16x32_bf16 v[68:71], v[112:115], v[208:211], v[68:71]
    v_exp_f32 v50, v50
    v_mfma_f32_16x16x32_bf16 v[68:71], v[116:119], v[212:215], v[68:71]
    s_waitcnt lgkmcnt(0)
    v_mfma_f32_16x16x32_bf16 a[0:3], v[120:123], v[40:43], a[0:3]
    v_exp_f32 v51, v51
    v_mfma_f32_16x16x32_bf16 a[4:7], v[124:127], v[40:43], a[4:7]
    v_cvt_pk_bf16_f32 v48, v48, v49
    v_cvt_pk_bf16_f32 v49, v50, v51
    v_mfma_f32_16x16x32_bf16 a[8:11], v[128:131], v[40:43], a[8:11]
    v_exp_f32 v52, v52
    v_mfma_f32_16x16x32_bf16 a[12:15], v[132:135], v[40:43], a[12:15]
    v_exp_f32 v53, v53
    v_mfma_f32_16x16x32_bf16 a[16:19], v[136:139], v[40:43], a[16:19]
    v_exp_f32 v54, v54
    v_mfma_f32_16x16x32_bf16 a[20:23], v[140:143], v[40:43], a[20:23]
    v_max3_f32 v6, v56, v57, v58
    v_max3_f32 v9, v64, v65, v66
    v_mfma_f32_16x16x32_bf16 a[24:27], v[144:147], v[40:43], a[24:27]
    v_max3_f32 v6, v6, v59, v60
    v_max3_f32 v9, v9, v67, v68
    v_mfma_f32_16x16x32_bf16 a[28:31], v[148:151], v[40:43], a[28:31]
    s_add_u32 m0, s58, 40960
    v_mfma_f32_16x16x32_bf16 a[192:195], a[216:219], v[40:43], a[192:195]
    s_waitcnt vmcnt(3)
    buffer_load_dwordx4 v1, s[4:7], s65 offen offset:0 nt lds
    v_mfma_f32_16x16x32_bf16 v[72:75], v[88:91], v[216:219], v[32:35]
    v_max3_f32 v6, v6, v61, v62
    v_max3_f32 v9, v9, v69, v70
    v_mfma_f32_16x16x32_bf16 v[72:75], v[92:95], v[220:223], v[72:75]
    v_max3_f32 v6, v6, v63, v71
    v_max_f32 v6, v6, v9
    v_mfma_f32_16x16x32_bf16 v[72:75], v[96:99], v[224:227], v[72:75]
    v_cmp_lt_f32 vcc, s61, v6
    v_mfma_f32_16x16x32_bf16 v[72:75], v[100:103], v[228:231], v[72:75]
    v_exp_f32 v55, v55
    v_mfma_f32_16x16x32_bf16 v[76:79], v[104:107], v[216:219], v[32:35]
    v_cvt_pk_bf16_f32 v50, v52, v53
    v_cvt_pk_bf16_f32 v51, v54, v55
    v_mfma_f32_16x16x32_bf16 v[76:79], v[108:111], v[220:223], v[76:79]
    s_cbranch_vccnz L_stub2_7
L_back2_7:
    v_mfma_f32_16x16x32_bf16 v[76:79], v[112:115], v[224:227], v[76:79]
    v_exp_f32 v56, v56
    v_mfma_f32_16x16x32_bf16 v[76:79], v[116:119], v[228:231], v[76:79]
    v_exp_f32 v57, v57
    v_mfma_f32_16x16x32_bf16 a[32:35], v[120:123], v[48:51], a[32:35]
    v_exp_f32 v58, v58
    v_mfma_f32_16x16x32_bf16 a[36:39], v[124:127], v[48:51], a[36:39]
    v_exp_f32 v59, v59
    v_mfma_f32_16x16x32_bf16 a[40:43], v[128:131], v[48:51], a[40:43]
    v_cvt_pk_bf16_f32 v56, v56, v57
    v_cvt_pk_bf16_f32 v57, v58, v59
    v_mfma_f32_16x16x32_bf16 a[44:47], v[132:135], v[48:51], a[44:47]
    s_waitcnt vmcnt(3)
    buffer_load_dwordx4 v2, s[4:7], s65 offen offset:1024 nt lds
    v_mfma_f32_16x16x32_bf16 a[48:51], v[136:139], v[48:51], a[48:51]
    v_exp_f32 v60, v60
    v_mfma_f32_16x16x32_bf16 a[52:55], v[140:143], v[48:51], a[52:55]
    v_exp_f32 v61, v61
    v_mfma_f32_16x16x32_bf16 a[56:59], v[144:147], v[48:51], a[56:59]
    v_exp_f32 v62, v62
    v_mfma_f32_16x16x32_bf16 a[60:63], v[148:151], v[48:51], a[60:63]
    v_exp_f32 v63, v63
    v_mfma_f32_16x16x32_bf16 a[196:199], a[216:219], v[48:51], a[196:199]
    v_cvt_pk_bf16_f32 v58, v60, v61
    v_cvt_pk_bf16_f32 v59, v62, v63
    s_barrier
    v_mfma_f32_16x16x32_bf16 v[80:83], v[88:91], v[232:235], v[36:39]
    v_exp_f32 v64, v64
    v_mfma_f32_16x16x32_bf16 v[80:83], v[92:95], v[236:239], v[80:83]
    ds_read_b128 v[88:91], v248 offset:32768
    ds_read_b128 v[92:95], v248 offset:33024
    v_mfma_f32_16x16x32_bf16 v[80:83], v[96:99], v[240:243], v[80:83]
    v_exp_f32 v65, v65
    v_mfma_f32_16x16x32_bf16 v[80:83], v[100:103], v[244:247], v[80:83]
    ds_read_b128 v[96:99], v248 offset:33280
    ds_read_b128 v[100:103], v248 offset:33536
    v_mfma_f32_16x16x32_bf16 v[84:87], v[104:107], v[232:235], v[36:39]
    v_exp_f32 v66, v66
    v_mfma_f32_16x16x32_bf16 v[84:87], v[108:111], v[236:239], v[84:87]
    ds_read_b128 v[104:107], v248 offset:36864
    ds_read_b128 v[108:111], v248 offset:37120
    v_mfma_f32_16x16x32_bf16 v[84:87], v[112:115], v[240:243], v[84:87]
    v_exp_f32 v67, v67
    v_mfma_f32_16x16x32_bf16 v[84:87], v[116:119], v[244:247], v[84:87]
    ds_read_b128 v[112:115], v248 offset:37376
    ds_read_b128 v[116:119], v248 offset:37632
    v_mfma_f32_16x16x32_bf16 a[64:67], v[120:123], v[56:59], a[64:67]
    s_waitcnt vmcnt(3)
    buffer_load_dwordx4 v1, s[4:7], s65 offen offset:2048 nt lds
    v_mfma_f32_16x16x32_bf16 a[68:71], v[124:127], v[56:59], a[68:71]
    v_cvt_pk_bf16_f32 v64, v64, v65
    v_cvt_pk_bf16_f32 v65, v66, v67
    v_mfma_f32_16x16x32_bf16 a[72:75], v[128:131], v[56:59], a[72:75]
    v_exp_f32 v68, v68
    v_mfma_f32_16x16x32_bf16 a[76:79], v[132:135], v[56:59], a[76:79]
    v_exp_f32 v69, v69
    v_mfma_f32_16x16x32_bf16 a[80:83], v[136:139], v[56:59], a[80:83]
    v_exp_f32 v70, v70
    v_mfma_f32_16x16x32_bf16 a[84:87], v[140:143], v[56:59], a[84:87]
    v_max3_f32 v6, v72, v73, v74
    v_max3_f32 v9, v80, v81, v82
    v_mfma_f32_16x16x32_bf16 a[88:91], v[144:147], v[56:59], a[88:91]
    v_max3_f32 v6, v6, v75, v76
    v_max3_f32 v9, v9, v83, v84
    v_mfma_f32_16x16x32_bf16 a[92:95], v[148:151], v[56:59], a[92:95]
    v_max3_f32 v6, v6, v77, v78
    v_max3_f32 v9, v9, v85, v86
    v_mfma_f32_16x16x32_bf16 a[200:203], a[216:219], v[56:59], a[200:203]
    s_waitcnt lgkmcnt(0)
    v_mfma_f32_16x16x32_bf16 v[40:43], v[88:91], v[152:155], v[16:19]
    v_max3_f32 v6, v6, v79, v87
    v_max_f32 v6, v6, v9
    v_mfma_f32_16x16x32_bf16 v[40:43], v[92:95], v[156:159], v[40:43]
    v_cmp_lt_f32 vcc, s61, v6
    v_mfma_f32_16x16x32_bf16 v[40:43], v[96:99], v[160:163], v[40:43]
    v_exp_f32 v71, v71
    v_mfma_f32_16x16x32_bf16 v[40:43], v[100:103], v[164:167], v[40:43]
    v_cvt_pk_bf16_f32 v66, v68, v69
    v_cvt_pk_bf16_f32 v67, v70, v71
    v_mfma_f32_16x16x32_bf16 v[44:47], v[104:107], v[152:155], v[16:19]
    s_waitcnt vmcnt(3)
    buffer_load_dwordx4 v2, s[4:7], s65 offen offset:3072 nt lds
    v_mfma_f32_16x16x32_bf16 v[44:47], v[108:111], v[156:159], v[44:47]
    s_cbranch_vccnz L_stub4_8
L_back4_8:
    v_mfma_f32_16x16x32_bf16 v[44:47], v[112:115], v[160:163], v[44:47]
    v_exp_f32 v72, v72
    v_mfma_f32_16x16x32_bf16 v[44:47], v[116:119], v[164:167], v[44:47]
    v_exp_f32 v73, v73
    v_mfma_f32_16x16x32_bf16 a[96:99], v[120:123], v[64:67], a[96:99]
    v_exp_f32 v74, v74
    v_mfma_f32_16x16x32_bf16 a[100:103], v[124:127], v[64:67], a[100:103]
    v_exp_f32 v75, v75
    v_mfma_f32_16x16x32_bf16 a[104:107], v[128:131], v[64:67], a[104:107]
    v_cvt_pk_bf16_f32 v72, v72, v73
    v_cvt_pk_bf16_f32 v73, v74, v75
    v_mfma_f32_16x16x32_bf16 a[108:111], v[132:135], v[64:67], a[108:111]
    v_exp_f32 v76, v76
    v_mfma_f32_16x16x32_bf16 a[112:115], v[136:139], v[64:67], a[112:115]
    v_exp_f32 v77, v77
    v_mfma_f32_16x16x32_bf16 a[116:119], v[140:143], v[64:67], a[116:119]
    v_exp_f32 v78, v78
    v_mfma_f32_16x16x32_bf16 a[120:123], v[144:147], v[64:67], a[120:123]
    v_exp_f32 v79, v79
    v_mfma_f32_16x16x32_bf16 a[124:127], v[148:151], v[64:67], a[124:127]
    v_cvt_pk_bf16_f32 v74, v76, v77
    v_cvt_pk_bf16_f32 v75, v78, v79
    v_mfma_f32_16x16x32_bf16 a[204:207], a[216:219], v[64:67], a[204:207]
    v_exp_f32 v80, v80
    v_mfma_f32_16x16x32_bf16 v[48:51], v[88:91], v[168:171], v[20:23]
    s_add_u32 m0, s58, 65536
    s_mov_b32 s65, 98304
    v_mfma_f32_16x16x32_bf16 v[48:51], v[92:95], v[172:175], v[48:51]
    s_waitcnt vmcnt(3)
    buffer_load_dwordx4 v1, s[28:31], s65 offen offset:0 nt lds
    v_mfma_f32_16x16x32_bf16 v[48:51], v[96:99], v[176:179], v[48:51]
    v_exp_f32 v81, v81
    v_mfma_f32_16x16x32_bf16 v[48:51], v[100:103], v[180:183], v[48:51]
    v_exp_f32 v82, v82
    v_mfma_f32_16x16x32_bf16 v[52:55], v[104:107], v[168:171], v[20:23]
    v_exp_f32 v83, v83
    v_mfma_f32_16x16x32_bf16 v[52:55], v[108:111], v[172:175], v[52:55]
    v_cvt_pk_bf16_f32 v80, v80, v81
    v_cvt_pk_bf16_f32 v81, v82, v83
    v_mfma_f32_16x16x32_bf16 v[52:55], v[112:115], v[176:179], v[52:55]
    v_exp_f32 v84, v84
    v_mfma_f32_16x16x32_bf16 v[52:55], v[116:119], v[180:183], v[52:55]
    v_exp_f32 v85, v85
    v_mfma_f32_16x16x32_bf16 a[128:131], v[120:123], v[72:75], a[128:131]
    v_exp_f32 v86, v86
    v_mfma_f32_16x16x32_bf16 a[132:135], v[124:127], v[72:75], a[132:135]
    v_mfma_f32_16x16x32_bf16 a[136:139], v[128:131], v[72:75], a[136:139]
    v_max3_f32 v6, v40, v41, v42
    v_max3_f32 v9, v48, v49, v50
    v_mfma_f32_16x16x32_bf16 a[140:143], v[132:135], v[72:75], a[140:143]
    v_max3_f32 v6, v6, v43, v44
    v_max3_f32 v9, v9, v51, v52
    v_mfma_f32_16x16x32_bf16 a[144:147], v[136:139], v[72:75], a[144:147]
    v_max3_f32 v6, v6, v45, v46
    v_max3_f32 v9, v9, v53, v54
    v_mfma_f32_16x16x32_bf16 a[148:151], v[140:143], v[72:75], a[148:151]
    s_waitcnt vmcnt(3)
    buffer_load_dwordx4 v2, s[28:31], s65 offen offset:1024 nt lds
    v_mfma_f32_16x16x32_bf16 a[152:155], v[144:147], v[72:75], a[152:155]
    v_max3_f32 v6, v6, v47, v55
    v_max_f32 v6, v6, v9
    v_mfma_f32_16x16x32_bf16 a[156:159], v[148:151], v[72:75], a[156:159]
    v_cmp_lt_f32 vcc, s61, v6
    v_mfma_f32_16x16x32_bf16 a[208:211], a[216:219], v[72:75], a[208:211]
    v_exp_f32 v87, v87
    v_mfma_f32_16x16x32_bf16 v[56:59], v[88:91], v[184:187], v[24:27]
    v_cvt_pk_bf16_f32 v82, v84, v85
    v_cvt_pk_bf16_f32 v83, v86, v87
    v_mfma_f32_16x16x32_bf16 v[56:59], v[92:95], v[188:191], v[56:59]
    s_cbranch_vccnz L_stub0_8
L_back0_8:
    v_mfma_f32_16x16x32_bf16 v[56:59], v[96:99], v[192:195], v[56:59]
    v_exp_f32 v40, v40
    v_mfma_f32_16x16x32_bf16 v[56:59], v[100:103], v[196:199], v[56:59]
    v_exp_f32 v41, v41
    v_mfma_f32_16x16x32_bf16 v[60:63], v[104:107], v[184:187], v[24:27]
    v_exp_f32 v42, v42
    v_mfma_f32_16x16x32_bf16 v[60:63], v[108:111], v[188:191], v[60:63]
    v_exp_f32 v43, v43
    v_mfma_f32_16x16x32_bf16 v[60:63], v[112:115], v[192:195], v[60:63]
    v_cvt_pk_bf16_f32 v40, v40, v41
    v_cvt_pk_bf16_f32 v41, v42, v43
    v_mfma_f32_16x16x32_bf16 v[60:63], v[116:119], v[196:199], v[60:63]
    v_exp_f32 v44, v44
    v_mfma_f32_16x16x32_bf16 a[160:163], v[120:123], v[80:83], a[160:163]
    ds_read_b64_tr_b16 v[120:121], v249 offset:32768
    ds_read_b64_tr_b16 v[122:123], v249 offset:36864
    v_mfma_f32_16x16x32_bf16 a[164:167], v[124:127], v[80:83], a[164:167]
    ds_read_b64_tr_b16 v[124:125], v250 offset:32768
    ds_read_b64_tr_b16 v[126:127], v250 offset:36864
    v_mfma_f32_16x16x32_bf16 a[168:171], v[128:131], v[80:83], a[168:171]
    ds_read_b64_tr_b16 v[128:129], v249 offset:33024
    ds_read_b64_tr_b16 v[130:131], v249 offset:37120
    v_mfma_f32_16x16x32_bf16 a[172:175], v[132:135], v[80:83], a[172:175]
    ds_read_b64_tr_b16 v[132:133], v250 offset:33024
    ds_read_b64_tr_b16 v[134:135], v250 offset:37120
    v_mfma_f32_16x16x32_bf16 a[176:179], v[136:139], v[80:83], a[176:179]
    ds_read_b64_tr_b16 v[136:137], v249 offset:33280
    ds_read_b64_tr_b16 v[138:139], v249 offset:37376
    v_mfma_f32_16x16x32_bf16 a[180:183], v[140:143], v[80:83], a[180:183]
    ds_read_b64_tr_b16 v[140:141], v250 offset:33280
    ds_read_b64_tr_b16 v[142:143], v250 offset:37376
    v_mfma_f32_16x16x32_bf16 a[184:187], v[144:147], v[80:83], a[184:187]
    ds_read_b64_tr_b16 v[144:145], v249 offset:33536
    ds_read_b64_tr_b16 v[146:147], v249 offset:37632
    v_mfma_f32_16x16x32_bf16 a[188:191], v[148:151], v[80:83], a[188:191]
    ds_read_b64_tr_b16 v[148:149], v250 offset:33536
    ds_read_b64_tr_b16 v[150:151], v250 offset:37632
    v_mfma_f32_16x16x32_bf16 a[212:215], a[216:219], v[80:83], a[212:215]
    s_waitcnt vmcnt(3)
    buffer_load_dwordx4 v1, s[28:31], s65 offen offset:2048 nt lds
    v_mfma_f32_16x16x32_bf16 v[64:67], v[88:91], v[200:203], v[28:31]
    v_exp_f32 v45, v45
    v_mfma_f32_16x16x32_bf16 v[64:67], v[92:95], v[204:207], v[64:67]
    v_exp_f32 v46, v46
    v_mfma_f32_16x16x32_bf16 v[64:67], v[96:99], v[208:211], v[64:67]
    v_exp_f32 v47, v47
    v_mfma_f32_16x16x32_bf16 v[64:67], v[100:103], v[212:215], v[64:67]
    v_cvt_pk_bf16_f32 v42, v44, v45
    v_cvt_pk_bf16_f32 v43, v46, v47
    v_mfma_f32_16x16x32_bf16 v[68:71], v[104:107], v[200:203], v[28:31]
    v_exp_f32 v48, v48
    v_mfma_f32_16x16x32_bf16 v[68:71], v[108:111], v[204:207], v[68:71]
    v_exp_f32 v49, v49
    v_mfma_f32_16x16x32_bf16 v[68:71], v[112:115], v[208:211], v[68:71]
    s_waitcnt vmcnt(3)
    buffer_load_dwordx4 v2, s[28:31], s65 offen offset:3072 nt lds
    v_mfma_f32_16x16x32_bf16 v[68:71], v[116:119], v[212:215], v[68:71]
    s_waitcnt lgkmcnt(0)
    v_mfma_f32_16x16x32_bf16 a[0:3], v[120:123], v[40:43], a[0:3]
    v_exp_f32 v50, v50
    v_mfma_f32_16x16x32_bf16 a[4:7], v[124:127], v[40:43], a[4:7]
    v_exp_f32 v51, v51
    v_mfma_f32_16x16x32_bf16 a[8:11], v[128:131], v[40:43], a[8:11]
    v_cvt_pk_bf16_f32 v48, v48, v49
    v_cvt_pk_bf16_f32 v49, v50, v51
    v_mfma_f32_16x16x32_bf16 a[12:15], v[132:135], v[40:43], a[12:15]
    v_exp_f32 v52, v52
    v_mfma_f32_16x16x32_bf16 a[16:19], v[136:139], v[40:43], a[16:19]
    v_exp_f32 v53, v53
    v_mfma_f32_16x16x32_bf16 a[20:23], v[140:143], v[40:43], a[20:23]
    v_exp_f32 v54, v54
    v_mfma_f32_16x16x32_bf16 a[24:27], v[144:147], v[40:43], a[24:27]
    v_max3_f32 v6, v56, v57, v58
    v_max3_f32 v9, v64, v65, v66
    v_mfma_f32_16x16x32_bf16 a[28:31], v[148:151], v[40:43], a[28:31]
    v_max3_f32 v6, v6, v59, v60
    v_max3_f32 v9, v9, v67, v68
    v_mfma_f32_16x16x32_bf16 a[192:195], a[216:219], v[40:43], a[192:195]
    v_max3_f32 v6, v6, v61, v62
    v_max3_f32 v9, v9, v69, v70
    v_mfma_f32_16x16x32_bf16 v[72:75], v[88:91], v[216:219], v[32:35]
    v_max3_f32 v6, v6, v63, v71
    v_max_f32 v6, v6, v9
    v_mfma_f32_16x16x32_bf16 v[72:75], v[92:95], v[220:223], v[72:75]
    v_cmp_lt_f32 vcc, s61, v6
    v_mfma_f32_16x16x32_bf16 v[72:75], v[96:99], v[224:227], v[72:75]
    s_add_u32 m0, s58, 73728
    v_mfma_f32_16x16x32_bf16 v[72:75], v[100:103], v[228:231], v[72:75]
    s_waitcnt vmcnt(3)
    buffer_load_dwordx4 v1, s[4:7], s65 offen offset:0 nt lds
    v_mfma_f32_16x16x32_bf16 v[76:79], v[104:107], v[216:219], v[32:35]
    v_exp_f32 v55, v55
    v_mfma_f32_16x16x32_bf16 v[76:79], v[108:111], v[220:223], v[76:79]
    v_cvt_pk_bf16_f32 v50, v52, v53
    v_cvt_pk_bf16_f32 v51, v54, v55
    v_mfma_f32_16x16x32_bf16 v[76:79], v[112:115], v[224:227], v[76:79]
    s_cbranch_vccnz L_stub2_8
L_back2_8:
    v_mfma_f32_16x16x32_bf16 v[76:79], v[116:119], v[228:231], v[76:79]
    v_exp_f32 v56, v56
    v_mfma_f32_16x16x32_bf16 a[32:35], v[120:123], v[48:51], a[32:35]
    v_exp_f32 v57, v57
    v_mfma_f32_16x16x32_bf16 a[36:39], v[124:127], v[48:51], a[36:39]
    v_exp_f32 v58, v58
    v_mfma_f32_16x16x32_bf16 a[40:43], v[128:131], v[48:51], a[40:43]
    v_exp_f32 v59, v59
    v_mfma_f32_16x16x32_bf16 a[44:47], v[132:135], v[48:51], a[44:47]
    v_cvt_pk_bf16_f32 v56, v56, v57
    v_cvt_pk_bf16_f32 v57, v58, v59
    v_mfma_f32_16x16x32_bf16 a[48:51], v[136:139], v[48:51], a[48:51]
    v_exp_f32 v60, v60
    v_mfma_f32_16x16x32_bf16 a[52:55], v[140:143], v[48:51], a[52:55]
    v_exp_f32 v61, v61
    v_mfma_f32_16x16x32_bf16 a[56:59], v[144:147], v[48:51], a[56:59]
    v_exp_f32 v62, v62
    v_mfma_f32_16x16x32_bf16 a[60:63], v[148:151], v[48:51], a[60:63]
    v_exp_f32 v63, v63
    v_mfma_f32_16x16x32_bf16 a[196:199], a[216:219], v[48:51], a[196:199]
    s_waitcnt vmcnt(3)
    buffer_load_dwordx4 v2, s[4:7], s65 offen offset:1024 nt lds
    v_cvt_pk_bf16_f32 v58, v60, v61
    v_cvt_pk_bf16_f32 v59, v62, v63
    s_barrier
    v_mfma_f32_16x16x32_bf16 v[80:83], v[88:91], v[232:235], v[36:39]
    v_exp_f32 v64, v64
    v_mfma_f32_16x16x32_bf16 v[80:83], v[92:95], v[236:239], v[80:83]
    ds_read_b128 v[88:91], v251 offset:0
    ds_read_b128 v[92:95], v251 offset:256
    v_mfma_f32_16x16x32_bf16 v[80:83], v[96:99], v[240:243], v[80:83]
    v_exp_f32 v65, v65
    v_mfma_f32_16x16x32_bf16 v[80:83], v[100:103], v[244:247], v[80:83]
    ds_read_b128 v[96:99], v251 offset:512
    ds_read_b128 v[100:103], v251 offset:768
    v_mfma_f32_16x16x32_bf16 v[84:87], v[104:107], v[232:235], v[36:39]
    v_exp_f32 v66, v66
    v_mfma_f32_16x16x32_bf16 v[84:87], v[108:111], v[236:239], v[84:87]
    ds_read_b128 v[104:107], v251 offset:4096
    ds_read_b128 v[108:111], v251 offset:4352
    v_mfma_f32_16x16x32_bf16 v[84:87], v[112:115], v[240:243], v[84:87]
    v_exp_f32 v67, v67
    v_mfma_f32_16x16x32_bf16 v[84:87], v[116:119], v[244:247], v[84:87]
    ds_read_b128 v[112:115], v251 offset:4608
    ds_read_b128 v[116:119], v251 offset:4864
    v_mfma_f32_16x16x32_bf16 a[64:67], v[120:123], v[56:59], a[64:67]
    v_cvt_pk_bf16_f32 v64, v64, v65
    v_cvt_pk_bf16_f32 v65, v66, v67
    v_mfma_f32_16x16x32_bf16 a[68:71], v[124:127], v[56:59], a[68:71]
    v_exp_f32 v68, v68
    v_mfma_f32_16x16x32_bf16 a[72:75], v[128:131], v[56:59], a[72:75]
    v_exp_f32 v69, v69
    v_mfma_f32_16x16x32_bf16 a[76:79], v[132:135], v[56:59], a[76:79]
    v_exp_f32 v70, v70
    v_mfma_f32_16x16x32_bf16 a[80:83], v[136:139], v[56:59], a[80:83]
    s_waitcnt vmcnt(3)
    buffer_load_dwordx4 v1, s[4:7], s65 offen offset:2048 nt lds
    v_mfma_f32_16x16x32_bf16 a[84:87], v[140:143], v[56:59], a[84:87]
    v_max3_f32 v6, v72, v73, v74
    v_max3_f32 v9, v80, v81, v82
    v_mfma_f32_16x16x32_bf16 a[88:91], v[144:147], v[56:59], a[88:91]
    v_max3_f32 v6, v6, v75, v76
    v_max3_f32 v9, v9, v83, v84
    v_mfma_f32_16x16x32_bf16 a[92:95], v[148:151], v[56:59], a[92:95]
    v_max3_f32 v6, v6, v77, v78
    v_max3_f32 v9, v9, v85, v86
    v_mfma_f32_16x16x32_bf16 a[200:203], a[216:219], v[56:59], a[200:203]
    s_waitcnt lgkmcnt(0)
    v_mfma_f32_16x16x32_bf16 v[40:43], v[88:91], v[152:155], v[16:19]
    v_max3_f32 v6, v6, v79, v87
    v_max_f32 v6, v6, v9
    v_mfma_f32_16x16x32_bf16 v[40:43], v[92:95], v[156:159], v[40:43]
    v_cmp_lt_f32 vcc, s61, v6
    v_mfma_f32_16x16x32_bf16 v[40:43], v[96:99], v[160:163], v[40:43]
    v_exp_f32 v71, v71
    v_mfma_f32_16x16x32_bf16 v[40:43], v[100:103], v[164:167], v[40:43]
    v_cvt_pk_bf16_f32 v66, v68, v69
    v_cvt_pk_bf16_f32 v67, v70, v71
    v_mfma_f32_16x16x32_bf16 v[44:47], v[104:107], v[152:155], v[16:19]
    s_cbranch_vccnz L_stub4_9
L_back4_9:
    v_mfma_f32_16x16x32_bf16 v[44:47], v[108:111], v[156:159], v[44:47]
    v_exp_f32 v72, v72
    v_mfma_f32_16x16x32_bf16 v[44:47], v[112:115], v[160:163], v[44:47]
    v_exp_f32 v73, v73
    v_mfma_f32_16x16x32_bf16 v[44:47], v[116:119], v[164:167], v[44:47]
    v_exp_f32 v74, v74
    v_mfma_f32_16x16x32_bf16 a[96:99], v[120:123], v[64:67], a[96:99]
    v_exp_f32 v75, v75
    v_mfma_f32_16x16x32_bf16 a[100:103], v[124:127], v[64:67], a[100:103]
    s_waitcnt vmcnt(3)
    buffer_load_dwordx4 v2, s[4:7], s65 offen offset:3072 nt lds
    v_mfma_f32_16x16x32_bf16 a[104:107], v[128:131], v[64:67], a[104:107]
    v_cvt_pk_bf16_f32 v72, v72, v73
    v_cvt_pk_bf16_f32 v73, v74, v75
    v_mfma_f32_16x16x32_bf16 a[108:111], v[132:135], v[64:67], a[108:111]
    v_exp_f32 v76, v76
    v_mfma_f32_16x16x32_bf16 a[112:115], v[136:139], v[64:67], a[112:115]
    v_exp_f32 v77, v77
    v_mfma_f32_16x16x32_bf16 a[116:119], v[140:143], v[64:67], a[116:119]
    v_exp_f32 v78, v78
    v_mfma_f32_16x16x32_bf16 a[120:123], v[144:147], v[64:67], a[120:123]
    v_exp_f32 v79, v79
    v_mfma_f32_16x16x32_bf16 a[124:127], v[148:151], v[64:67], a[124:127]
    v_cvt_pk_bf16_f32 v74, v76, v77
    v_cvt_pk_bf16_f32 v75, v78, v79
    v_mfma_f32_16x16x32_bf16 a[204:207], a[216:219], v[64:67], a[204:207]
    v_exp_f32 v80, v80
    v_mfma_f32_16x16x32_bf16 v[48:51], v[88:91], v[168:171], v[20:23]
    v_exp_f32 v81, v81
    v_mfma_f32_16x16x32_bf16 v[48:51], v[92:95], v[172:175], v[48:51]
    v_exp_f32 v82, v82
    v_mfma_f32_16x16x32_bf16 v[48:51], v[96:99], v[176:179], v[48:51]
    v_exp_f32 v83, v83
    v_mfma_f32_16x16x32_bf16 v[48:51], v[100:103], v[180:183], v[48:51]
    v_cvt_pk_bf16_f32 v80, v80, v81
    v_cvt_pk_bf16_f32 v81, v82, v83
    v_mfma_f32_16x16x32_bf16 v[52:55], v[104:107], v[168:171], v[20:23]
    v_exp_f32 v84, v84
    v_mfma_f32_16x16x32_bf16 v[52:55], v[108:111], v[172:175], v[52:55]
    s_add_u32 m0, s58, 98304
    s_mov_b32 s65, 106496
    v_mfma_f32_16x16x32_bf16 v[52:55], v[112:115], v[176:179], v[52:55]
    s_waitcnt vmcnt(3)
    buffer_load_dwordx4 v1, s[28:31], s65 offen offset:0 nt lds
    v_mfma_f32_16x16x32_bf16 v[52:55], v[116:119], v[180:183], v[52:55]
    v_exp_f32 v85, v85
    v_mfma_f32_16x16x32_bf16 a[128:131], v[120:123], v[72:75], a[128:131]
    v_exp_f32 v86, v86
    v_mfma_f32_16x16x32_bf16 a[132:135], v[124:127], v[72:75], a[132:135]
    v_mfma_f32_16x16x32_bf16 a[136:139], v[128:131], v[72:75], a[136:139]
    v_max3_f32 v6, v40, v41, v42
    v_max3_f32 v9, v48, v49, v50
    v_mfma_f32_16x16x32_bf16 a[140:143], v[132:135], v[72:75], a[140:143]
    v_max3_f32 v6, v6, v43, v44
    v_max3_f32 v9, v9, v51, v52
    v_mfma_f32_16x16x32_bf16 a[144:147], v[136:139], v[72:75], a[144:147]
    v_max3_f32 v6, v6, v45, v46
    v_max3_f32 v9, v9, v53, v54
    v_mfma_f32_16x16x32_bf16 a[148:151], v[140:143], v[72:75], a[148:151]
    v_max3_f32 v6, v6, v47, v55
    v_max_f32 v6, v6, v9
    v_mfma_f32_16x16x32_bf16 a[152:155], v[144:147], v[72:75], a[152:155]
    v_cmp_lt_f32 vcc, s61, v6
    v_mfma_f32_16x16x32_bf16 a[156:159], v[148:151], v[72:75], a[156:159]
    v_exp_f32 v87, v87
    v_mfma_f32_16x16x32_bf16 a[208:211], a[216:219], v[72:75], a[208:211]
    v_cvt_pk_bf16_f32 v82, v84, v85
    v_cvt_pk_bf16_f32 v83, v86, v87
    v_mfma_f32_16x16x32_bf16 v[56:59], v[88:91], v[184:187], v[24:27]
    s_cbranch_vccnz L_stub0_9
L_back0_9:
    v_mfma_f32_16x16x32_bf16 v[56:59], v[92:95], v[188:191], v[56:59]
    s_waitcnt vmcnt(3)
    buffer_load_dwordx4 v2, s[28:31], s65 offen offset:1024 nt lds
    v_mfma_f32_16x16x32_bf16 v[56:59], v[96:99], v[192:195], v[56:59]
    v_exp_f32 v40, v40
    v_mfma_f32_16x16x32_bf16 v[56:59], v[100:103], v[196:199], v[56:59]
    v_exp_f32 v41, v41
    v_mfma_f32_16x16x32_bf16 v[60:63], v[104:107], v[184:187], v[24:27]
    v_exp_f32 v42, v42
    v_mfma_f32_16x16x32_bf16 v[60:63], v[108:111], v[188:191], v[60:63]
    v_exp_f32 v43, v43
    v_mfma_f32_16x16x32_bf16 v[60:63], v[112:115], v[192:195], v[60:63]
    v_cvt_pk_bf16_f32 v40, v40, v41
    v_cvt_pk_bf16_f32 v41, v42, v43
    v_mfma_f32_16x16x32_bf16 v[60:63], v[116:119], v[196:199], v[60:63]
    v_exp_f32 v44, v44
    v_mfma_f32_16x16x32_bf16 a[160:163], v[120:123], v[80:83], a[160:163]
    ds_read_b64_tr_b16 v[120:121], v252 offset:0
    ds_read_b64_tr_b16 v[122:123], v252 offset:4096
    v_mfma_f32_16x16x32_bf16 a[164:167], v[124:127], v[80:83], a[164:167]
    ds_read_b64_tr_b16 v[124:125], v253 offset:0
    ds_read_b64_tr_b16 v[126:127], v253 offset:4096
    v_mfma_f32_16x16x32_bf16 a[168:171], v[128:131], v[80:83], a[168:171]
    ds_read_b64_tr_b16 v[128:129], v252 offset:256
    ds_read_b64_tr_b16 v[130:131], v252 offset:4352
    v_mfma_f32_16x16x32_bf16 a[172:175], v[132:135], v[80:83], a[172:175]
    ds_read_b64_tr_b16 v[132:133], v253 offset:256
    ds_read_b64_tr_b16 v[134:135], v253 offset:4352
    v_mfma_f32_16x16x32_bf16 a[176:179], v[136:139], v[80:83], a[176:179]
    ds_read_b64_tr_b16 v[136:137], v252 offset:512
    ds_read_b64_tr_b16 v[138:139], v252 offset:4608
    v_mfma_f32_16x16x32_bf16 a[180:183], v[140:143], v[80:83], a[180:183]
    ds_read_b64_tr_b16 v[140:141], v253 offset:512
    ds_read_b64_tr_b16 v[142:143], v253 offset:4608
    v_mfma_f32_16x16x32_bf16 a[184:187], v[144:147], v[80:83], a[184:187]
    ds_read_b64_tr_b16 v[144:145], v252 offset:768
    ds_read_b64_tr_b16 v[146:147], v252 offset:4864
    v_mfma_f32_16x16x32_bf16 a[188:191], v[148:151], v[80:83], a[188:191]
    ds_read_b64_tr_b16 v[148:149], v253 offset:768
    ds_read_b64_tr_b16 v[150:151], v253 offset:4864
    v_mfma_f32_16x16x32_bf16 a[212:215], a[216:219], v[80:83], a[212:215]
    s_waitcnt vmcnt(3)
    buffer_load_dwordx4 v1, s[28:31], s65 offen offset:2048 nt lds
    v_mfma_f32_16x16x32_bf16 v[64:67], v[88:91], v[200:203], v[28:31]
    v_exp_f32 v45, v45
    v_mfma_f32_16x16x32_bf16 v[64:67], v[92:95], v[204:207], v[64:67]
    v_exp_f32 v46, v46
    v_mfma_f32_16x16x32_bf16 v[64:67], v[96:99], v[208:211], v[64:67]
    v_exp_f32 v47, v47
    v_mfma_f32_16x16x32_bf16 v[64:67], v[100:103], v[212:215], v[64:67]
    v_cvt_pk_bf16_f32 v42, v44, v45
    v_cvt_pk_bf16_f32 v43, v46, v47
    v_mfma_f32_16x16x32_bf16 v[68:71], v[104:107], v[200:203], v[28:31]
    v_exp_f32 v48, v48
    v_mfma_f32_16x16x32_bf16 v[68:71], v[108:111], v[204:207], v[68:71]
    v_exp_f32 v49, v49
    v_mfma_f32_16x16x32_bf16 v[68:71], v[112:115], v[208:211], v[68:71]
    v_exp_f32 v50, v50
    v_mfma_f32_16x16x32_bf16 v[68:71], v[116:119], v[212:215], v[68:71]
    s_waitcnt lgkmcnt(0)
    v_mfma_f32_16x16x32_bf16 a[0:3], v[120:123], v[40:43], a[0:3]
    v_exp_f32 v51, v51
    v_mfma_f32_16x16x32_bf16 a[4:7], v[124:127], v[40:43], a[4:7]
    v_cvt_pk_bf16_f32 v48, v48, v49
    v_cvt_pk_bf16_f32 v49, v50, v51
    v_mfma_f32_16x16x32_bf16 a[8:11], v[128:131], v[40:43], a[8:11]
    v_exp_f32 v52, v52
    v_mfma_f32_16x16x32_bf16 a[12:15], v[132:135], v[40:43], a[12:15]
    s_waitcnt vmcnt(3)
    buffer_load_dwordx4 v2, s[28:31], s65 offen offset:3072 nt lds
    v_mfma_f32_16x16x32_bf16 a[16:19], v[136:139], v[40:43], a[16:19]
    v_exp_f32 v53, v53
    v_mfma_f32_16x16x32_bf16 a[20:23], v[140:143], v[40:43], a[20:23]
    v_exp_f32 v54, v54
    v_mfma_f32_16x16x32_bf16 a[24:27], v[144:147], v[40:43], a[24:27]
    v_max3_f32 v6, v56, v57, v58
    v_max3_f32 v9, v64, v65, v66
    v_mfma_f32_16x16x32_bf16 a[28:31], v[148:151], v[40:43], a[28:31]
    v_max3_f32 v6, v6, v59, v60
    v_max3_f32 v9, v9, v67, v68
    v_mfma_f32_16x16x32_bf16 a[192:195], a[216:219], v[40:43], a[192:195]
    v_max3_f32 v6, v6, v61, v62
    v_max3_f32 v9, v9, v69, v70
    v_mfma_f32_16x16x32_bf16 v[72:75], v[88:91], v[216:219], v[32:35]
    v_max3_f32 v6, v6, v63, v71
    v_max_f32 v6, v6, v9
    v_mfma_f32_16x16x32_bf16 v[72:75], v[92:95], v[220:223], v[72:75]
    v_cmp_lt_f32 vcc, s61, v6
    v_mfma_f32_16x16x32_bf16 v[72:75], v[96:99], v[224:227], v[72:75]
    v_exp_f32 v55, v55
    v_mfma_f32_16x16x32_bf16 v[72:75], v[100:103], v[228:231], v[72:75]
    v_cvt_pk_bf16_f32 v50, v52, v53
    v_cvt_pk_bf16_f32 v51, v54, v55
    v_mfma_f32_16x16x32_bf16 v[76:79], v[104:107], v[216:219], v[32:35]
    s_cbranch_vccnz L_stub2_9
L_back2_9:
    v_mfma_f32_16x16x32_bf16 v[76:79], v[108:111], v[220:223], v[76:79]
    v_exp_f32 v56, v56
    v_mfma_f32_16x16x32_bf16 v[76:79], v[112:115], v[224:227], v[76:79]
    v_exp_f32 v57, v57
    v_mfma_f32_16x16x32_bf16 v[76:79], v[116:119], v[228:231], v[76:79]
    s_add_u32 m0, s58, 106496
    v_mfma_f32_16x16x32_bf16 a[32:35], v[120:123], v[48:51], a[32:35]
    s_waitcnt vmcnt(3)
    buffer_load_dwordx4 v1, s[4:7], s65 offen offset:0 nt lds
    v_mfma_f32_16x16x32_bf16 a[36:39], v[124:127], v[48:51], a[36:39]
    v_exp_f32 v58, v58
    v_mfma_f32_16x16x32_bf16 a[40:43], v[128:131], v[48:51], a[40:43]
    v_exp_f32 v59, v59
    v_mfma_f32_16x16x32_bf16 a[44:47], v[132:135], v[48:51], a[44:47]
    v_cvt_pk_bf16_f32 v56, v56, v57
    v_cvt_pk_bf16_f32 v57, v58, v59
    v_mfma_f32_16x16x32_bf16 a[48:51], v[136:139], v[48:51], a[48:51]
    v_exp_f32 v60, v60
    v_mfma_f32_16x16x32_bf16 a[52:55], v[140:143], v[48:51], a[52:55]
    v_exp_f32 v61, v61
    v_mfma_f32_16x16x32_bf16 a[56:59], v[144:147], v[48:51], a[56:59]
    v_exp_f32 v62, v62
    v_mfma_f32_16x16x32_bf16 a[60:63], v[148:151], v[48:51], a[60:63]
    v_exp_f32 v63, v63
    v_mfma_f32_16x16x32_bf16 a[196:199], a[216:219], v[48:51], a[196:199]
    v_cvt_pk_bf16_f32 v58, v60, v61
    v_cvt_pk_bf16_f32 v59, v62, v63
    s_barrier
    v_mfma_f32_16x16x32_bf16 v[80:83], v[88:91], v[232:235], v[36:39]
    v_exp_f32 v64, v64
    v_mfma_f32_16x16x32_bf16 v[80:83], v[92:95], v[236:239], v[80:83]
    ds_read_b128 v[88:91], v3 offset:0
    ds_read_b128 v[92:95], v3 offset:256
    v_mfma_f32_16x16x32_bf16 v[80:83], v[96:99], v[240:243], v[80:83]
    v_exp_f32 v65, v65
    v_mfma_f32_16x16x32_bf16 v[80:83], v[100:103], v[244:247], v[80:83]
    ds_read_b128 v[96:99], v3 offset:512
    ds_read_b128 v[100:103], v3 offset:768
    v_mfma_f32_16x16x32_bf16 v[84:87], v[104:107], v[232:235], v[36:39]
    s_waitcnt vmcnt(3)
    buffer_load_dwordx4 v2, s[4:7], s65 offen offset:1024 nt lds
    v_mfma_f32_16x16x32_bf16 v[84:87], v[108:111], v[236:239], v[84:87]
    ds_read_b128 v[104:107], v3 offset:4096
    ds_read_b128 v[108:111], v3 offset:4352
    v_mfma_f32_16x16x32_bf16 v[84:87], v[112:115], v[240:243], v[84:87]
    v_exp_f32 v66, v66
    v_mfma_f32_16x16x32_bf16 v[84:87], v[116:119], v[244:247], v[84:87]
    ds_read_b128 v[112:115], v3 offset:4608
    ds_read_b128 v[116:119], v3 offset:4864
    v_mfma_f32_16x16x32_bf16 a[64:67], v[120:123], v[56:59], a[64:67]
    v_exp_f32 v67, v67
    v_mfma_f32_16x16x32_bf16 a[68:71], v[124:127], v[56:59], a[68:71]
    v_cvt_pk_bf16_f32 v64, v64, v65
    v_cvt_pk_bf16_f32 v65, v66, v67
    v_mfma_f32_16x16x32_bf16 a[72:75], v[128:131], v[56:59], a[72:75]
    v_exp_f32 v68, v68
    v_mfma_f32_16x16x32_bf16 a[76:79], v[132:135], v[56:59], a[76:79]
    v_exp_f32 v69, v69
    v_mfma_f32_16x16x32_bf16 a[80:83], v[136:139], v[56:59], a[80:83]
    v_exp_f32 v70, v70
    v_mfma_f32_16x16x32_bf16 a[84:87], v[140:143], v[56:59], a[84:87]
    v_max3_f32 v6, v72, v73, v74
    v_max3_f32 v9, v80, v81, v82
    v_mfma_f32_16x16x32_bf16 a[88:91], v[144:147], v[56:59], a[88:91]
    v_max3_f32 v6, v6, v75, v76
    v_max3_f32 v9, v9, v83, v84
    v_mfma_f32_16x16x32_bf16 a[92:95], v[148:151], v[56:59], a[92:95]
    v_max3_f32 v6, v6, v77, v78
    v_max3_f32 v9, v9, v85, v86
    v_mfma_f32_16x16x32_bf16 a[200:203], a[216:219], v[56:59], a[200:203]
    s_waitcnt lgkmcnt(0)
    v_mfma_f32_16x16x32_bf16 v[40:43], v[88:91], v[152:155], v[16:19]
    s_waitcnt vmcnt(3)
    buffer_load_dwordx4 v1, s[4:7], s65 offen offset:2048 nt lds
    v_mfma_f32_16x16x32_bf16 v[40:43], v[92:95], v[156:159], v[40:43]
    v_max3_f32 v6, v6, v79, v87
    v_max_f32 v6, v6, v9
    v_mfma_f32_16x16x32_bf16 v[40:43], v[96:99], v[160:163], v[40:43]
    v_cmp_lt_f32 vcc, s61, v6
    v_mfma_f32_16x16x32_bf16 v[40:43], v[100:103], v[164:167], v[40:43]
    v_exp_f32 v71, v71
    v_mfma_f32_16x16x32_bf16 v[44:47], v[104:107], v[152:155], v[16:19]
    v_cvt_pk_bf16_f32 v66, v68, v69
    v_cvt_pk_bf16_f32 v67, v70, v71
    v_mfma_f32_16x16x32_bf16 v[44:47], v[108:111], v[156:159], v[44:47]
    s_cbranch_vccnz L_stub4_10
L_back4_10:
    v_mfma_f32_16x16x32_bf16 v[44:47], v[112:115], v[160:163], v[44:47]
    v_exp_f32 v72, v72
    v_mfma_f32_16x16x32_bf16 v[44:47], v[116:119], v[164:167], v[44:47]
    v_exp_f32 v73, v73
    v_mfma_f32_16x16x32_bf16 a[96:99], v[120:123], v[64:67], a[96:99]
    v_exp_f32 v74, v74
    v_mfma_f32_16x16x32_bf16 a[100:103], v[124:127], v[64:67], a[100:103]
    v_exp_f32 v75, v75
    v_mfma_f32_16x16x32_bf16 a[104:107], v[128:131], v[64:67], a[104:107]
    v_cvt_pk_bf16_f32 v72, v72, v73
    v_cvt_pk_bf16_f32 v73, v74, v75
    v_mfma_f32_16x16x32_bf16 a[108:111], v[132:135], v[64:67], a[108:111]
    v_exp_f32 v76, v76
    v_mfma_f32_16x16x32_bf16 a[112:115], v[136:139], v[64:67], a[112:115]
    v_exp_f32 v77, v77
    v_mfma_f32_16x16x32_bf16 a[116:119], v[140:143], v[64:67], a[116:119]
    s_waitcnt vmcnt(3)
    buffer_load_dwordx4 v2, s[4:7], s65 offen offset:3072 nt lds
    v_mfma_f32_16x16x32_bf16 a[120:123], v[144:147], v[64:67], a[120:123]
    v_exp_f32 v78, v78
    v_mfma_f32_16x16x32_bf16 a[124:127], v[148:151], v[64:67], a[124:127]
    v_exp_f32 v79, v79
    v_mfma_f32_16x16x32_bf16 a[204:207], a[216:219], v[64:67], a[204:207]
    v_cvt_pk_bf16_f32 v74, v76, v77
    v_cvt_pk_bf16_f32 v75, v78, v79
    v_mfma_f32_16x16x32_bf16 v[48:51], v[88:91], v[168:171], v[20:23]
    v_exp_f32 v80, v80
    v_mfma_f32_16x16x32_bf16 v[48:51], v[92:95], v[172:175], v[48:51]
    v_exp_f32 v81, v81
    v_mfma_f32_16x16x32_bf16 v[48:51], v[96:99], v[176:179], v[48:51]
    v_exp_f32 v82, v82
    v_mfma_f32_16x16x32_bf16 v[48:51], v[100:103], v[180:183], v[48:51]
    v_exp_f32 v83, v83
    v_mfma_f32_16x16x32_bf16 v[52:55], v[104:107], v[168:171], v[20:23]
    v_cvt_pk_bf16_f32 v80, v80, v81
    v_cvt_pk_bf16_f32 v81, v82, v83
    v_mfma_f32_16x16x32_bf16 v[52:55], v[108:111], v[172:175], v[52:55]
    v_exp_f32 v84, v84
    v_mfma_f32_16x16x32_bf16 v[52:55], v[112:115], v[176:179], v[52:55]
    v_exp_f32 v85, v85
    v_mfma_f32_16x16x32_bf16 v[52:55], v[116:119], v[180:183], v[52:55]
    v_exp_f32 v86, v86
    v_mfma_f32_16x16x32_bf16 a[128:131], v[120:123], v[72:75], a[128:131]
    v_mfma_f32_16x16x32_bf16 a[132:135], v[124:127], v[72:75], a[132:135]
    v_mfma_f32_16x16x32_bf16 a[136:139], v[128:131], v[72:75], a[136:139]
    s_add_u32 m0, s58, 131072
    s_mov_b32 s65, 114688
    v_mfma_f32_16x16x32_bf16 a[140:143], v[132:135], v[72:75], a[140:143]
    s_waitcnt vmcnt(3)
    buffer_load_dwordx4 v1, s[28:31], s65 offen offset:0 nt lds
    v_mfma_f32_16x16x32_bf16 a[144:147], v[136:139], v[72:75], a[144:147]
    v_max3_f32 v6, v40, v41, v42
    v_max3_f32 v9, v48, v49, v50
    v_mfma_f32_16x16x32_bf16 a[148:151], v[140:143], v[72:75], a[148:151]
    v_max3_f32 v6, v6, v43, v44
    v_max3_f32 v9, v9, v51, v52
    v_mfma_f32_16x16x32_bf16 a[152:155], v[144:147], v[72:75], a[152:155]
    v_max3_f32 v6, v6, v45, v46
    v_max3_f32 v9, v9, v53, v54
    v_mfma_f32_16x16x32_bf16 a[156:159], v[148:151], v[72:75], a[156:159]
    v_max3_f32 v6, v6, v47, v55
    v_max_f32 v6, v6, v9
    v_mfma_f32_16x16x32_bf16 a[208:211], a[216:219], v[72:75], a[208:211]
    v_cmp_lt_f32 vcc, s61, v6
    v_mfma_f32_16x16x32_bf16 v[56:59], v[88:91], v[184:187], v[24:27]
    v_exp_f32 v87, v87
    v_mfma_f32_16x16x32_bf16 v[56:59], v[92:95], v[188:191], v[56:59]
    v_cvt_pk_bf16_f32 v82, v84, v85
    v_cvt_pk_bf16_f32 v83, v86, v87
    v_mfma_f32_16x16x32_bf16 v[56:59], v[96:99], v[192:195], v[56:59]
    s_cbranch_vccnz L_stub0_10
L_back0_10:
    v_mfma_f32_16x16x32_bf16 v[56:59], v[100:103], v[196:199], v[56:59]
    v_exp_f32 v40, v40
    v_mfma_f32_16x16x32_bf16 v[60:63], v[104:107], v[184:187], v[24:27]
    v_exp_f32 v41, v41
    v_mfma_f32_16x16x32_bf16 v[60:63], v[108:111], v[188:191], v[60:63]
    v_exp_f32 v42, v42
    v_mfma_f32_16x16x32_bf16 v[60:63], v[112:115], v[192:195], v[60:63]
    s_waitcnt vmcnt(3)
    buffer_load_dwordx4 v2, s[28:31], s65 offen offset:1024 nt lds
    v_mfma_f32_16x16x32_bf16 v[60:63], v[116:119], v[196:199], v[60:63]
    v_exp_f32 v43, v43
    v_mfma_f32_16x16x32_bf16 a[160:163], v[120:123], v[80:83], a[160:163]
    ds_read_b64_tr_b16 v[120:121], v4 offset:0
    ds_read_b64_tr_b16 v[122:123], v4 offset:4096
    v_mfma_f32_16x16x32_bf16 a[164:167], v[124:127], v[80:83], a[164:167]
    ds_read_b64_tr_b16 v[124:125], v5 offset:0
    ds_read_b64_tr_b16 v[126:127], v5 offset:4096
    v_mfma_f32_16x16x32_bf16 a[168:171], v[128:131], v[80:83], a[168:171]
    ds_read_b64_tr_b16 v[128:129], v4 offset:256
    ds_read_b64_tr_b16 v[130:131], v4 offset:4352
    v_mfma_f32_16x16x32_bf16 a[172:175], v[132:135], v[80:83], a[172:175]
    ds_read_b64_tr_b16 v[132:133], v5 offset:256
    ds_read_b64_tr_b16 v[134:135], v5 offset:4352
    v_mfma_f32_16x16x32_bf16 a[176:179], v[136:139], v[80:83], a[176:179]
    ds_read_b64_tr_b16 v[136:137], v4 offset:512
    ds_read_b64_tr_b16 v[138:139], v4 offset:4608
    v_mfma_f32_16x16x32_bf16 a[180:183], v[140:143], v[80:83], a[180:183]
    ds_read_b64_tr_b16 v[140:141], v5 offset:512
    ds_read_b64_tr_b16 v[142:143], v5 offset:4608
    v_mfma_f32_16x16x32_bf16 a[184:187], v[144:147], v[80:83], a[184:187]
    ds_read_b64_tr_b16 v[144:145], v4 offset:768
    ds_read_b64_tr_b16 v[146:147], v4 offset:4864
    v_mfma_f32_16x16x32_bf16 a[188:191], v[148:151], v[80:83], a[188:191]
    ds_read_b64_tr_b16 v[148:149], v5 offset:768
    ds_read_b64_tr_b16 v[150:151], v5 offset:4864
    v_mfma_f32_16x16x32_bf16 a[212:215], a[216:219], v[80:83], a[212:215]
    v_cvt_pk_bf16_f32 v40, v40, v41
    v_cvt_pk_bf16_f32 v41, v42, v43
    v_mfma_f32_16x16x32_bf16 v[64:67], v[88:91], v[200:203], v[28:31]
    v_exp_f32 v44, v44
    v_mfma_f32_16x16x32_bf16 v[64:67], v[92:95], v[204:207], v[64:67]
    v_exp_f32 v45, v45
    v_mfma_f32_16x16x32_bf16 v[64:67], v[96:99], v[208:211], v[64:67]
    v_exp_f32 v46, v46
    v_mfma_f32_16x16x32_bf16 v[64:67], v[100:103], v[212:215], v[64:67]
    s_waitcnt vmcnt(3)
    buffer_load_dwordx4 v1, s[28:31], s65 offen offset:2048 nt lds
    v_mfma_f32_16x16x32_bf16 v[68:71], v[104:107], v[200:203], v[28:31]
    v_exp_f32 v47, v47
    v_mfma_f32_16x16x32_bf16 v[68:71], v[108:111], v[204:207], v[68:71]
    v_cvt_pk_bf16_f32 v42, v44, v45
    v_cvt_pk_bf16_f32 v43, v46, v47
    v_mfma_f32_16x16x32_bf16 v[68:71], v[112:115], v[208:211], v[68:71]
    v_exp_f32 v48, v48
    v_mfma_f32_16x16x32_bf16 v[68:71], v[116:119], v[212:215], v[68:71]
    s_waitcnt lgkmcnt(0)
    v_mfma_f32_16x16x32_bf16 a[0:3], v[120:123], v[40:43], a[0:3]
    v_exp_f32 v49, v49
    v_mfma_f32_16x16x32_bf16 a[4:7], v[124:127], v[40:43], a[4:7]
    v_exp_f32 v50, v50
    v_mfma_f32_16x16x32_bf16 a[8:11], v[128:131], v[40:43], a[8:11]
    v_exp_f32 v51, v51
    v_mfma_f32_16x16x32_bf16 a[12:15], v[132:135], v[40:43], a[12:15]
    v_cvt_pk_bf16_f32 v48, v48, v49
    v_cvt_pk_bf16_f32 v49, v50, v51
    v_mfma_f32_16x16x32_bf16 a[16:19], v[136:139], v[40:43], a[16:19]
    v_exp_f32 v52, v52
    v_mfma_f32_16x16x32_bf16 a[20:23], v[140:143], v[40:43], a[20:23]
    v_exp_f32 v53, v53
    v_mfma_f32_16x16x32_bf16 a[24:27], v[144:147], v[40:43], a[24:27]
    v_exp_f32 v54, v54
    v_mfma_f32_16x16x32_bf16 a[28:31], v[148:151], v[40:43], a[28:31]
    v_max3_f32 v6, v56, v57, v58
    v_max3_f32 v9, v64, v65, v66
    v_mfma_f32_16x16x32_bf16 a[192:195], a[216:219], v[40:43], a[192:195]
    s_waitcnt vmcnt(3)
    buffer_load_dwordx4 v2, s[28:31], s65 offen offset:3072 nt lds
    v_mfma_f32_16x16x32_bf16 v[72:75], v[88:91], v[216:219], v[32:35]
    v_max3_f32 v6, v6, v59, v60
    v_max3_f32 v9, v9, v67, v68
    v_mfma_f32_16x16x32_bf16 v[72:75], v[92:95], v[220:223], v[72:75]
    v_max3_f32 v6, v6, v61, v62
    v_max3_f32 v9, v9, v69, v70
    v_mfma_f32_16x16x32_bf16 v[72:75], v[96:99], v[224:227], v[72:75]
    v_max3_f32 v6, v6, v63, v71
    v_max_f32 v6, v6, v9
    v_mfma_f32_16x16x32_bf16 v[72:75], v[100:103], v[228:231], v[72:75]
    v_cmp_lt_f32 vcc, s61, v6
    v_mfma_f32_16x16x32_bf16 v[76:79], v[104:107], v[216:219], v[32:35]
    v_exp_f32 v55, v55
    v_mfma_f32_16x16x32_bf16 v[76:79], v[108:111], v[220:223], v[76:79]
    v_cvt_pk_bf16_f32 v50, v52, v53
    v_cvt_pk_bf16_f32 v51, v54, v55
    v_mfma_f32_16x16x32_bf16 v[76:79], v[112:115], v[224:227], v[76:79]
    s_cbranch_vccnz L_stub2_10
L_back2_10:
    v_mfma_f32_16x16x32_bf16 v[76:79], v[116:119], v[228:231], v[76:79]
    v_exp_f32 v56, v56
    v_mfma_f32_16x16x32_bf16 a[32:35], v[120:123], v[48:51], a[32:35]
    v_exp_f32 v57, v57
    v_mfma_f32_16x16x32_bf16 a[36:39], v[124:127], v[48:51], a[36:39]
    v_exp_f32 v58, v58
    v_mfma_f32_16x16x32_bf16 a[40:43], v[128:131], v[48:51], a[40:43]
    v_exp_f32 v59, v59
    v_mfma_f32_16x16x32_bf16 a[44:47], v[132:135], v[48:51], a[44:47]
    v_cvt_pk_bf16_f32 v56, v56, v57
    v_cvt_pk_bf16_f32 v57, v58, v59
    v_mfma_f32_16x16x32_bf16 a[48:51], v[136:139], v[48:51], a[48:51]
    s_add_u32 m0, s58, 139264
    v_mfma_f32_16x16x32_bf16 a[52:55], v[140:143], v[48:51], a[52:55]
    s_waitcnt vmcnt(3)
    buffer_load_dwordx4 v1, s[4:7], s65 offen offset:0 nt lds
    v_mfma_f32_16x16x32_bf16 a[56:59], v[144:147], v[48:51], a[56:59]
    global_load_dword v13, v[10:11], off
    v_mfma_f32_16x16x32_bf16 a[60:63], v[148:151], v[48:51], a[60:63]
    v_exp_f32 v60, v60
    v_mfma_f32_16x16x32_bf16 a[196:199], a[216:219], v[48:51], a[196:199]
    v_exp_f32 v61, v61
    v_exp_f32 v62, v62
    v_exp_f32 v63, v63
    v_cvt_pk_bf16_f32 v58, v60, v61
    v_cvt_pk_bf16_f32 v59, v62, v63
    s_barrier
    v_mfma_f32_16x16x32_bf16 v[80:83], v[88:91], v[232:235], v[36:39]
    v_exp_f32 v64, v64
    v_mfma_f32_16x16x32_bf16 v[80:83], v[92:95], v[236:239], v[80:83]
    ds_read_b128 v[88:91], v3 offset:32768
    ds_read_b128 v[92:95], v3 offset:33024
    v_mfma_f32_16x16x32_bf16 v[80:83], v[96:99], v[240:243], v[80:83]
    v_exp_f32 v65, v65
    v_mfma_f32_16x16x32_bf16 v[80:83], v[100:103], v[244:247], v[80:83]
    ds_read_b128 v[96:99], v3 offset:33280
    ds_read_b128 v[100:103], v3 offset:33536
    v_mfma_f32_16x16x32_bf16 v[84:87], v[104:107], v[232:235], v[36:39]
    v_exp_f32 v66, v66
    v_mfma_f32_16x16x32_bf16 v[84:87], v[108:111], v[236:239], v[84:87]
    ds_read_b128 v[104:107], v3 offset:36864
    ds_read_b128 v[108:111], v3 offset:37120
    v_mfma_f32_16x16x32_bf16 v[84:87], v[112:115], v[240:243], v[84:87]
    v_exp_f32 v67, v67
    v_mfma_f32_16x16x32_bf16 v[84:87], v[116:119], v[244:247], v[84:87]
    ds_read_b128 v[112:115], v3 offset:37376
    ds_read_b128 v[116:119], v3 offset:37632
    v_mfma_f32_16x16x32_bf16 a[64:67], v[120:123], v[56:59], a[64:67]
    v_cvt_pk_bf16_f32 v64, v64, v65
    v_cvt_pk_bf16_f32 v65, v66, v67
    v_mfma_f32_16x16x32_bf16 a[68:71], v[124:127], v[56:59], a[68:71]
    s_waitcnt vmcnt(4)
    buffer_load_dwordx4 v2, s[4:7], s65 offen offset:1024 nt lds
    v_mfma_f32_16x16x32_bf16 a[72:75], v[128:131], v[56:59], a[72:75]
    v_exp_f32 v68, v68
    v_mfma_f32_16x16x32_bf16 a[76:79], v[132:135], v[56:59], a[76:79]
    v_exp_f32 v69, v69
    v_mfma_f32_16x16x32_bf16 a[80:83], v[136:139], v[56:59], a[80:83]
    v_exp_f32 v70, v70
    v_mfma_f32_16x16x32_bf16 a[84:87], v[140:143], v[56:59], a[84:87]
    v_max3_f32 v6, v72, v73, v74
    v_max3_f32 v9, v80, v81, v82
    v_mfma_f32_16x16x32_bf16 a[88:91], v[144:147], v[56:59], a[88:91]
    v_max3_f32 v6, v6, v75, v76
    v_max3_f32 v9, v9, v83, v84
    v_mfma_f32_16x16x32_bf16 a[92:95], v[148:151], v[56:59], a[92:95]
    v_max3_f32 v6, v6, v77, v78
    v_max3_f32 v9, v9, v85, v86
    v_mfma_f32_16x16x32_bf16 a[200:203], a[216:219], v[56:59], a[200:203]
    s_waitcnt lgkmcnt(0)
    v_mfma_f32_16x16x32_bf16 v[40:43], v[88:91], v[152:155], v[16:19]
    v_max3_f32 v6, v6, v79, v87
    v_max_f32 v6, v6, v9
    v_mfma_f32_16x16x32_bf16 v[40:43], v[92:95], v[156:159], v[40:43]
    v_cmp_lt_f32 vcc, s61, v6
    v_mfma_f32_16x16x32_bf16 v[40:43], v[96:99], v[160:163], v[40:43]
    v_exp_f32 v71, v71
    v_mfma_f32_16x16x32_bf16 v[40:43], v[100:103], v[164:167], v[40:43]
    v_cvt_pk_bf16_f32 v66, v68, v69
    v_cvt_pk_bf16_f32 v67, v70, v71
    v_mfma_f32_16x16x32_bf16 v[44:47], v[104:107], v[152:155], v[16:19]
    s_cbranch_vccnz L_stub4_11
L_back4_11:
    v_mfma_f32_16x16x32_bf16 v[44:47], v[108:111], v[156:159], v[44:47]
    s_waitcnt vmcnt(4)
    buffer_load_dwordx4 v1, s[4:7], s65 offen offset:2048 nt lds
    v_mfma_f32_16x16x32_bf16 v[44:47], v[112:115], v[160:163], v[44:47]
    v_exp_f32 v72, v72
    v_mfma_f32_16x16x32_bf16 v[44:47], v[116:119], v[164:167], v[44:47]
    v_exp_f32 v73, v73
    v_mfma_f32_16x16x32_bf16 a[96:99], v[120:123], v[64:67], a[96:99]
    v_exp_f32 v74, v74
    v_mfma_f32_16x16x32_bf16 a[100:103], v[124:127], v[64:67], a[100:103]
    v_exp_f32 v75, v75
    v_mfma_f32_16x16x32_bf16 a[104:107], v[128:131], v[64:67], a[104:107]
    v_cvt_pk_bf16_f32 v72, v72, v73
    v_cvt_pk_bf16_f32 v73, v74, v75
    v_mfma_f32_16x16x32_bf16 a[108:111], v[132:135], v[64:67], a[108:111]
    v_exp_f32 v76, v76
    v_mfma_f32_16x16x32_bf16 a[112:115], v[136:139], v[64:67], a[112:115]
    v_exp_f32 v77, v77
    v_mfma_f32_16x16x32_bf16 a[116:119], v[140:143], v[64:67], a[116:119]
    v_exp_f32 v78, v78
    v_mfma_f32_16x16x32_bf16 a[120:123], v[144:147], v[64:67], a[120:123]
    v_exp_f32 v79, v79
    v_mfma_f32_16x16x32_bf16 a[124:127], v[148:151], v[64:67], a[124:127]
    v_cvt_pk_bf16_f32 v74, v76, v77
    v_cvt_pk_bf16_f32 v75, v78, v79
    v_mfma_f32_16x16x32_bf16 a[204:207], a[216:219], v[64:67], a[204:207]
    v_exp_f32 v80, v80
    v_mfma_f32_16x16x32_bf16 v[48:51], v[88:91], v[168:171], v[20:23]
    v_exp_f32 v81, v81
    v_mfma_f32_16x16x32_bf16 v[48:51], v[92:95], v[172:175], v[48:51]
    s_waitcnt vmcnt(4)
    buffer_load_dwordx4 v2, s[4:7], s65 offen offset:3072 nt lds
    v_mfma_f32_16x16x32_bf16 v[48:51], v[96:99], v[176:179], v[48:51]
    v_exp_f32 v82, v82
    v_mfma_f32_16x16x32_bf16 v[48:51], v[100:103], v[180:183], v[48:51]
    v_exp_f32 v83, v83
    v_mfma_f32_16x16x32_bf16 v[52:55], v[104:107], v[168:171], v[20:23]
    v_cvt_pk_bf16_f32 v80, v80, v81
    v_cvt_pk_bf16_f32 v81, v82, v83
    v_mfma_f32_16x16x32_bf16 v[52:55], v[108:111], v[172:175], v[52:55]
    v_exp_f32 v84, v84
    v_mfma_f32_16x16x32_bf16 v[52:55], v[112:115], v[176:179], v[52:55]
    v_exp_f32 v85, v85
    v_mfma_f32_16x16x32_bf16 v[52:55], v[116:119], v[180:183], v[52:55]
    v_exp_f32 v86, v86
    v_mfma_f32_16x16x32_bf16 a[128:131], v[120:123], v[72:75], a[128:131]
    v_mfma_f32_16x16x32_bf16 a[132:135], v[124:127], v[72:75], a[132:135]
    v_mfma_f32_16x16x32_bf16 a[136:139], v[128:131], v[72:75], a[136:139]
    v_max3_f32 v6, v40, v41, v42
    v_max3_f32 v9, v48, v49, v50
    v_mfma_f32_16x16x32_bf16 a[140:143], v[132:135], v[72:75], a[140:143]
    v_max3_f32 v6, v6, v43, v44
    v_max3_f32 v9, v9, v51, v52
    v_mfma_f32_16x16x32_bf16 a[144:147], v[136:139], v[72:75], a[144:147]
    v_max3_f32 v6, v6, v45, v46
    v_max3_f32 v9, v9, v53, v54
    v_mfma_f32_16x16x32_bf16 a[148:151], v[140:143], v[72:75], a[148:151]
    v_max3_f32 v6, v6, v47, v55
    v_max_f32 v6, v6, v9
    v_mfma_f32_16x16x32_bf16 a[152:155], v[144:147], v[72:75], a[152:155]
    v_cmp_lt_f32 vcc, s61, v6
    v_mfma_f32_16x16x32_bf16 a[156:159], v[148:151], v[72:75], a[156:159]
    s_add_u32 m0, s58, 0
    s_mov_b32 s65, 122880
    v_mfma_f32_16x16x32_bf16 a[208:211], a[216:219], v[72:75], a[208:211]
    s_waitcnt vmcnt(4)
    buffer_load_dwordx4 v1, s[28:31], s65 offen offset:0 nt lds
    v_mfma_f32_16x16x32_bf16 v[56:59], v[88:91], v[184:187], v[24:27]
    v_exp_f32 v87, v87
    v_mfma_f32_16x16x32_bf16 v[56:59], v[92:95], v[188:191], v[56:59]
    v_cvt_pk_bf16_f32 v82, v84, v85
    v_cvt_pk_bf16_f32 v83, v86, v87
    v_mfma_f32_16x16x32_bf16 v[56:59], v[96:99], v[192:195], v[56:59]
    s_cbranch_vccnz L_stub0_11
L_back0_11:
    v_mfma_f32_16x16x32_bf16 v[56:59], v[100:103], v[196:199], v[56:59]
    v_exp_f32 v40, v40
    v_mfma_f32_16x16x32_bf16 v[60:63], v[104:107], v[184:187], v[24:27]
    v_exp_f32 v41, v41
    v_mfma_f32_16x16x32_bf16 v[60:63], v[108:111], v[188:191], v[60:63]
    v_exp_f32 v42, v42
    v_mfma_f32_16x16x32_bf16 v[60:63], v[112:115], v[192:195], v[60:63]
    v_exp_f32 v43, v43
    v_mfma_f32_16x16x32_bf16 v[60:63], v[116:119], v[196:199], v[60:63]
    v_cvt_pk_bf16_f32 v40, v40, v41
    v_cvt_pk_bf16_f32 v41, v42, v43
    v_mfma_f32_16x16x32_bf16 a[160:163], v[120:123], v[80:83], a[160:163]
    ds_read_b64_tr_b16 v[120:121], v4 offset:32768
    ds_read_b64_tr_b16 v[122:123], v4 offset:36864
    v_mfma_f32_16x16x32_bf16 a[164:167], v[124:127], v[80:83], a[164:167]
    ds_read_b64_tr_b16 v[124:125], v5 offset:32768
    ds_read_b64_tr_b16 v[126:127], v5 offset:36864
    v_mfma_f32_16x16x32_bf16 a[168:171], v[128:131], v[80:83], a[168:171]
    ds_read_b64_tr_b16 v[128:129], v4 offset:33024
    ds_read_b64_tr_b16 v[130:131], v4 offset:37120
    v_mfma_f32_16x16x32_bf16 a[172:175], v[132:135], v[80:83], a[172:175]
    ds_read_b64_tr_b16 v[132:133], v5 offset:33024
    ds_read_b64_tr_b16 v[134:135], v5 offset:37120
    v_mfma_f32_16x16x32_bf16 a[176:179], v[136:139], v[80:83], a[176:179]
    ds_read_b64_tr_b16 v[136:137], v4 offset:33280
    ds_read_b64_tr_b16 v[138:139], v4 offset:37376
    v_mfma_f32_16x16x32_bf16 a[180:183], v[140:143], v[80:83], a[180:183]
    ds_read_b64_tr_b16 v[140:141], v5 offset:33280
    ds_read_b64_tr_b16 v[142:143], v5 offset:37376
    v_mfma_f32_16x16x32_bf16 a[184:187], v[144:147], v[80:83], a[184:187]
    ds_read_b64_tr_b16 v[144:145], v4 offset:33536
    ds_read_b64_tr_b16 v[146:147], v4 offset:37632
    v_mfma_f32_16x16x32_bf16 a[188:191], v[148:151], v[80:83], a[188:191]
    ds_read_b64_tr_b16 v[148:149], v5 offset:33536
    ds_read_b64_tr_b16 v[150:151], v5 offset:37632
    v_mfma_f32_16x16x32_bf16 a[212:215], a[216:219], v[80:83], a[212:215]
    s_waitcnt vmcnt(3)
    buffer_load_dwordx4 v2, s[28:31], s65 offen offset:1024 nt lds
    v_mfma_f32_16x16x32_bf16 v[64:67], v[88:91], v[200:203], v[28:31]
    v_exp_f32 v44, v44
    v_mfma_f32_16x16x32_bf16 v[64:67], v[92:95], v[204:207], v[64:67]
    v_exp_f32 v45, v45
    v_mfma_f32_16x16x32_bf16 v[64:67], v[96:99], v[208:211], v[64:67]
    v_exp_f32 v46, v46
    v_mfma_f32_16x16x32_bf16 v[64:67], v[100:103], v[212:215], v[64:67]
    v_exp_f32 v47, v47
    v_mfma_f32_16x16x32_bf16 v[68:71], v[104:107], v[200:203], v[28:31]
    v_cvt_pk_bf16_f32 v42, v44, v45
    v_cvt_pk_bf16_f32 v43, v46, v47
    v_mfma_f32_16x16x32_bf16 v[68:71], v[108:111], v[204:207], v[68:71]
    v_exp_f32 v48, v48
    v_mfma_f32_16x16x32_bf16 v[68:71], v[112:115], v[208:211], v[68:71]
    v_exp_f32 v49, v49
    v_mfma_f32_16x16x32_bf16 v[68:71], v[116:119], v[212:215], v[68:71]
    s_waitcnt lgkmcnt(0)
    v_mfma_f32_16x16x32_bf16 a[0:3], v[120:123], v[40:43], a[0:3]
    s_waitcnt vmcnt(3)
    buffer_load_dwordx4 v1, s[28:31], s65 offen offset:2048 nt lds
    v_mfma_f32_16x16x32_bf16 a[4:7], v[124:127], v[40:43], a[4:7]
    v_exp_f32 v50, v50
    v_mfma_f32_16x16x32_bf16 a[8:11], v[128:131], v[40:43], a[8:11]
    v_exp_f32 v51, v51
    v_mfma_f32_16x16x32_bf16 a[12:15], v[132:135], v[40:43], a[12:15]
    v_cvt_pk_bf16_f32 v48, v48, v49
    v_cvt_pk_bf16_f32 v49, v50, v51
    v_mfma_f32_16x16x32_bf16 a[16:19], v[136:139], v[40:43], a[16:19]
    v_exp_f32 v52, v52
    v_mfma_f32_16x16x32_bf16 a[20:23], v[140:143], v[40:43], a[20:23]
    v_exp_f32 v53, v53
    v_mfma_f32_16x16x32_bf16 a[24:27], v[144:147], v[40:43], a[24:27]
    v_exp_f32 v54, v54
    v_mfma_f32_16x16x32_bf16 a[28:31], v[148:151], v[40:43], a[28:31]
    v_max3_f32 v6, v56, v57, v58
    v_max3_f32 v9, v64, v65, v66
    v_mfma_f32_16x16x32_bf16 a[192:195], a[216:219], v[40:43], a[192:195]
    v_max3_f32 v6, v6, v59, v60
    v_max3_f32 v9, v9, v67, v68
    v_mfma_f32_16x16x32_bf16 v[72:75], v[88:91], v[216:219], v[32:35]
    v_max3_f32 v6, v6, v61, v62
    v_max3_f32 v9, v9, v69, v70
    v_mfma_f32_16x16x32_bf16 v[72:75], v[92:95], v[220:223], v[72:75]
    v_max3_f32 v6, v6, v63, v71
    v_max_f32 v6, v6, v9
    v_mfma_f32_16x16x32_bf16 v[72:75], v[96:99], v[224:227], v[72:75]
    v_cmp_lt_f32 vcc, s61, v6
    v_mfma_f32_16x16x32_bf16 v[72:75], v[100:103], v[228:231], v[72:75]
    v_exp_f32 v55, v55
    v_mfma_f32_16x16x32_bf16 v[76:79], v[104:107], v[216:219], v[32:35]
    s_waitcnt vmcnt(3)
    buffer_load_dwordx4 v2, s[28:31], s65 offen offset:3072 nt lds
    v_mfma_f32_16x16x32_bf16 v[76:79], v[108:111], v[220:223], v[76:79]
    v_cvt_pk_bf16_f32 v50, v52, v53
    v_cvt_pk_bf16_f32 v51, v54, v55
    v_mfma_f32_16x16x32_bf16 v[76:79], v[112:115], v[224:227], v[76:79]
    s_cbranch_vccnz L_stub2_11
L_back2_11:
    v_mfma_f32_16x16x32_bf16 v[76:79], v[116:119], v[228:231], v[76:79]
    v_exp_f32 v56, v56
    v_mfma_f32_16x16x32_bf16 a[32:35], v[120:123], v[48:51], a[32:35]
    v_exp_f32 v57, v57
    v_mfma_f32_16x16x32_bf16 a[36:39], v[124:127], v[48:51], a[36:39]
    v_exp_f32 v58, v58
    v_mfma_f32_16x16x32_bf16 a[40:43], v[128:131], v[48:51], a[40:43]
    v_exp_f32 v59, v59
    v_mfma_f32_16x16x32_bf16 a[44:47], v[132:135], v[48:51], a[44:47]
    v_cvt_pk_bf16_f32 v56, v56, v57
    v_cvt_pk_bf16_f32 v57, v58, v59
    v_mfma_f32_16x16x32_bf16 a[48:51], v[136:139], v[48:51], a[48:51]
    v_exp_f32 v60, v60
    v_mfma_f32_16x16x32_bf16 a[52:55], v[140:143], v[48:51], a[52:55]
    v_exp_f32 v61, v61
    v_mfma_f32_16x16x32_bf16 a[56:59], v[144:147], v[48:51], a[56:59]
    v_exp_f32 v62, v62
    v_mfma_f32_16x16x32_bf16 a[60:63], v[148:151], v[48:51], a[60:63]
    v_exp_f32 v63, v63
    v_mfma_f32_16x16x32_bf16 a[196:199], a[216:219], v[48:51], a[196:199]
    v_cvt_pk_bf16_f32 v58, v60, v61
    v_cvt_pk_bf16_f32 v59, v62, v63
    s_barrier
    v_mfma_f32_16x16x32_bf16 v[80:83], v[88:91], v[232:235], v[36:39]
    s_add_u32 m0, s58, 8192
    v_mfma_f32_16x16x32_bf16 v[80:83], v[92:95], v[236:239], v[80:83]
    ds_read_b128 v[88:91], v248 offset:0
    ds_read_b128 v[92:95], v248 offset:256
    v_mfma_f32_16x16x32_bf16 v[80:83], v[96:99], v[240:243], v[80:83]
    s_waitcnt vmcnt(3)
    buffer_load_dwordx4 v1, s[4:7], s65 offen offset:0 nt lds
    v_mfma_f32_16x16x32_bf16 v[80:83], v[100:103], v[244:247], v[80:83]
    ds_read_b128 v[96:99], v248 offset:512
    ds_read_b128 v[100:103], v248 offset:768
    v_mfma_f32_16x16x32_bf16 v[84:87], v[104:107], v[232:235], v[36:39]
    v_exp_f32 v64, v64
    v_mfma_f32_16x16x32_bf16 v[84:87], v[108:111], v[236:239], v[84:87]
    ds_read_b128 v[104:107], v248 offset:4096
    ds_read_b128 v[108:111], v248 offset:4352
    v_mfma_f32_16x16x32_bf16 v[84:87], v[112:115], v[240:243], v[84:87]
    v_exp_f32 v65, v65
    v_mfma_f32_16x16x32_bf16 v[84:87], v[116:119], v[244:247], v[84:87]
    ds_read_b128 v[112:115], v248 offset:4608
    ds_read_b128 v[116:119], v248 offset:4864
    v_mfma_f32_16x16x32_bf16 a[64:67], v[120:123], v[56:59], a[64:67]
    v_exp_f32 v66, v66
    v_mfma_f32_16x16x32_bf16 a[68:71], v[124:127], v[56:59], a[68:71]
    v_exp_f32 v67, v67
    v_mfma_f32_16x16x32_bf16 a[72:75], v[128:131], v[56:59], a[72:75]
    v_cvt_pk_bf16_f32 v64, v64, v65
    v_cvt_pk_bf16_f32 v65, v66, v67
    v_mfma_f32_16x16x32_bf16 a[76:79], v[132:135], v[56:59], a[76:79]
    v_exp_f32 v68, v68
    v_mfma_f32_16x16x32_bf16 a[80:83], v[136:139], v[56:59], a[80:83]
    v_exp_f32 v69, v69
    v_mfma_f32_16x16x32_bf16 a[84:87], v[140:143], v[56:59], a[84:87]
    v_exp_f32 v70, v70
    v_mfma_f32_16x16x32_bf16 a[88:91], v[144:147], v[56:59], a[88:91]
    s_waitcnt vmcnt(3)
    buffer_load_dwordx4 v2, s[4:7], s65 offen offset:1024 nt lds
    v_mfma_f32_16x16x32_bf16 a[92:95], v[148:151], v[56:59], a[92:95]
    v_max3_f32 v6, v72, v73, v74
    v_max3_f32 v9, v80, v81, v82
    v_mfma_f32_16x16x32_bf16 a[200:203], a[216:219], v[56:59], a[200:203]
    s_waitcnt lgkmcnt(0)
    v_mfma_f32_16x16x32_bf16 v[40:43], v[88:91], v[152:155], v[16:19]
    v_max3_f32 v6, v6, v75, v76
    v_max3_f32 v9, v9, v83, v84
    v_mfma_f32_16x16x32_bf16 v[40:43], v[92:95], v[156:159], v[40:43]
    v_max3_f32 v6, v6, v77, v78
    v_max3_f32 v9, v9, v85, v86
    v_mfma_f32_16x16x32_bf16 v[40:43], v[96:99], v[160:163], v[40:43]
    v_max3_f32 v6, v6, v79, v87
    v_max_f32 v6, v6, v9
    v_mfma_f32_16x16x32_bf16 v[40:43], v[100:103], v[164:167], v[40:43]
    v_cmp_lt_f32 vcc, s61, v6
    v_mfma_f32_16x16x32_bf16 v[44:47], v[104:107], v[152:155], v[16:19]
    v_exp_f32 v71, v71
    v_mfma_f32_16x16x32_bf16 v[44:47], v[108:111], v[156:159], v[44:47]
    v_cvt_pk_bf16_f32 v66, v68, v69
    v_cvt_pk_bf16_f32 v67, v70, v71
    v_mfma_f32_16x16x32_bf16 v[44:47], v[112:115], v[160:163], v[44:47]
    s_cbranch_vccnz L_stub4_12
L_back4_12:
    v_mfma_f32_16x16x32_bf16 v[44:47], v[116:119], v[164:167], v[44:47]
    v_exp_f32 v72, v72
    v_mfma_f32_16x16x32_bf16 a[96:99], v[120:123], v[64:67], a[96:99]
    v_exp_f32 v73, v73
    v_mfma_f32_16x16x32_bf16 a[100:103], v[124:127], v[64:67], a[100:103]
    v_exp_f32 v74, v74
    v_mfma_f32_16x16x32_bf16 a[104:107], v[128:131], v[64:67], a[104:107]
    s_waitcnt vmcnt(3)
    buffer_load_dwordx4 v1, s[4:7], s65 offen offset:2048 nt lds
    v_mfma_f32_16x16x32_bf16 a[108:111], v[132:135], v[64:67], a[108:111]
    v_exp_f32 v75, v75
    v_mfma_f32_16x16x32_bf16 a[112:115], v[136:139], v[64:67], a[112:115]
    v_cvt_pk_bf16_f32 v72, v72, v73
    v_cvt_pk_bf16_f32 v73, v74, v75
    v_mfma_f32_16x16x32_bf16 a[116:119], v[140:143], v[64:67], a[116:119]
    v_exp_f32 v76, v76
    v_mfma_f32_16x16x32_bf16 a[120:123], v[144:147], v[64:67], a[120:123]
    v_exp_f32 v77, v77
    v_mfma_f32_16x16x32_bf16 a[124:127], v[148:151], v[64:67], a[124:127]
    v_exp_f32 v78, v78
    v_mfma_f32_16x16x32_bf16 a[204:207], a[216:219], v[64:67], a[204:207]
    v_exp_f32 v79, v79
    v_mfma_f32_16x16x32_bf16 v[48:51], v[88:91], v[168:171], v[20:23]
    v_cvt_pk_bf16_f32 v74, v76, v77
    v_cvt_pk_bf16_f32 v75, v78, v79
    v_mfma_f32_16x16x32_bf16 v[48:51], v[92:95], v[172:175], v[48:51]
    v_exp_f32 v80, v80
    v_mfma_f32_16x16x32_bf16 v[48:51], v[96:99], v[176:179], v[48:51]
    v_exp_f32 v81, v81
    v_mfma_f32_16x16x32_bf16 v[48:51], v[100:103], v[180:183], v[48:51]
    v_exp_f32 v82, v82
    v_mfma_f32_16x16x32_bf16 v[52:55], v[104:107], v[168:171], v[20:23]
    v_exp_f32 v83, v83
    v_mfma_f32_16x16x32_bf16 v[52:55], v[108:111], v[172:175], v[52:55]
    v_cvt_pk_bf16_f32 v80, v80, v81
    v_cvt_pk_bf16_f32 v81, v82, v83
    v_mfma_f32_16x16x32_bf16 v[52:55], v[112:115], v[176:179], v[52:55]
    s_waitcnt vmcnt(3)
    buffer_load_dwordx4 v2, s[4:7], s65 offen offset:3072 nt lds
    v_mfma_f32_16x16x32_bf16 v[52:55], v[116:119], v[180:183], v[52:55]
    v_exp_f32 v84, v84
    v_mfma_f32_16x16x32_bf16 a[128:131], v[120:123], v[72:75], a[128:131]
    v_exp_f32 v85, v85
    v_mfma_f32_16x16x32_bf16 a[132:135], v[124:127], v[72:75], a[132:135]
    v_exp_f32 v86, v86
    v_mfma_f32_16x16x32_bf16 a[136:139], v[128:131], v[72:75], a[136:139]
    v_max3_f32 v6, v40, v41, v42
    v_max3_f32 v9, v48, v49, v50
    v_mfma_f32_16x16x32_bf16 a[140:143], v[132:135], v[72:75], a[140:143]
    v_max3_f32 v6, v6, v43, v44
    v_max3_f32 v9, v9, v51, v52
    v_mfma_f32_16x16x32_bf16 a[144:147], v[136:139], v[72:75], a[144:147]
    v_max3_f32 v6, v6, v45, v46
    v_max3_f32 v9, v9, v53, v54
    v_mfma_f32_16x16x32_bf16 a[148:151], v[140:143], v[72:75], a[148:151]
    v_max3_f32 v6, v6, v47, v55
    v_max_f32 v6, v6, v9
    v_mfma_f32_16x16x32_bf16 a[152:155], v[144:147], v[72:75], a[152:155]
    v_cmp_lt_f32 vcc, s61, v6
    v_mfma_f32_16x16x32_bf16 a[156:159], v[148:151], v[72:75], a[156:159]
    v_exp_f32 v87, v87
    v_mfma_f32_16x16x32_bf16 a[208:211], a[216:219], v[72:75], a[208:211]
    v_cvt_pk_bf16_f32 v82, v84, v85
    v_cvt_pk_bf16_f32 v83, v86, v87
    v_mfma_f32_16x16x32_bf16 v[56:59], v[88:91], v[184:187], v[24:27]
    s_cbranch_vccnz L_stub0_12
L_back0_12:
    v_mfma_f32_16x16x32_bf16 v[56:59], v[92:95], v[188:191], v[56:59]
    v_exp_f32 v40, v40
    v_mfma_f32_16x16x32_bf16 v[56:59], v[96:99], v[192:195], v[56:59]
    v_exp_f32 v41, v41
    v_mfma_f32_16x16x32_bf16 v[56:59], v[100:103], v[196:199], v[56:59]
    s_add_u32 m0, s58, 32768
    s_mov_b32 s65, 131072
    v_mfma_f32_16x16x32_bf16 v[60:63], v[104:107], v[184:187], v[24:27]
    s_waitcnt vmcnt(3)
    buffer_load_dwordx4 v1, s[28:31], s65 offen offset:0 nt lds
    v_mfma_f32_16x16x32_bf16 v[60:63], v[108:111], v[188:191], v[60:63]
    v_exp_f32 v42, v42
    v_mfma_f32_16x16x32_bf16 v[60:63], v[112:115], v[192:195], v[60:63]
    v_exp_f32 v43, v43
    v_mfma_f32_16x16x32_bf16 v[60:63], v[116:119], v[196:199], v[60:63]
    v_cvt_pk_bf16_f32 v40, v40, v41
    v_cvt_pk_bf16_f32 v41, v42, v43
    v_mfma_f32_16x16x32_bf16 a[160:163], v[120:123], v[80:83], a[160:163]
    ds_read_b64_tr_b16 v[120:121], v249 offset:0
    ds_read_b64_tr_b16 v[122:123], v249 offset:4096
    v_mfma_f32_16x16x32_bf16 a[164:167], v[124:127], v[80:83], a[164:167]
    ds_read_b64_tr_b16 v[124:125], v250 offset:0
    ds_read_b64_tr_b16 v[126:127], v250 offset:4096
    v_mfma_f32_16x16x32_bf16 a[168:171], v[128:131], v[80:83], a[168:171]
    ds_read_b64_tr_b16 v[128:129], v249 offset:256
    ds_read_b64_tr_b16 v[130:131], v249 offset:4352
    v_mfma_f32_16x16x32_bf16 a[172:175], v[132:135], v[80:83], a[172:175]
    ds_read_b64_tr_b16 v[132:133], v250 offset:256
    ds_read_b64_tr_b16 v[134:135], v250 offset:4352
    v_mfma_f32_16x16x32_bf16 a[176:179], v[136:139], v[80:83], a[176:179]
    ds_read_b64_tr_b16 v[136:137], v249 offset:512
    ds_read_b64_tr_b16 v[138:139], v249 offset:4608
    v_mfma_f32_16x16x32_bf16 a[180:183], v[140:143], v[80:83], a[180:183]
    ds_read_b64_tr_b16 v[140:141], v250 offset:512
    ds_read_b64_tr_b16 v[142:143], v250 offset:4608
    v_mfma_f32_16x16x32_bf16 a[184:187], v[144:147], v[80:83], a[184:187]
    ds_read_b64_tr_b16 v[144:145], v249 offset:768
    ds_read_b64_tr_b16 v[146:147], v249 offset:4864
    v_mfma_f32_16x16x32_bf16 a[188:191], v[148:151], v[80:83], a[188:191]
    ds_read_b64_tr_b16 v[148:149], v250 offset:768
    ds_read_b64_tr_b16 v[150:151], v250 offset:4864
    v_mfma_f32_16x16x32_bf16 a[212:215], a[216:219], v[80:83], a[212:215]
    s_waitcnt vmcnt(3)
    buffer_load_dwordx4 v2, s[28:31], s65 offen offset:1024 nt lds
    v_mfma_f32_16x16x32_bf16 v[64:67], v[88:91], v[200:203], v[28:31]
    v_exp_f32 v44, v44
    v_mfma_f32_16x16x32_bf16 v[64:67], v[92:95], v[204:207], v[64:67]
    v_exp_f32 v45, v45
    v_mfma_f32_16x16x32_bf16 v[64:67], v[96:99], v[208:211], v[64:67]
    v_exp_f32 v46, v46
    v_mfma_f32_16x16x32_bf16 v[64:67], v[100:103], v[212:215], v[64:67]
    v_exp_f32 v47, v47
    v_mfma_f32_16x16x32_bf16 v[68:71], v[104:107], v[200:203], v[28:31]
    v_cvt_pk_bf16_f32 v42, v44, v45
    v_cvt_pk_bf16_f32 v43, v46, v47
    v_mfma_f32_16x16x32_bf16 v[68:71], v[108:111], v[204:207], v[68:71]
    v_exp_f32 v48, v48
    v_mfma_f32_16x16x32_bf16 v[68:71], v[112:115], v[208:211], v[68:71]
    v_exp_f32 v49, v49
    v_mfma_f32_16x16x32_bf16 v[68:71], v[116:119], v[212:215], v[68:71]
    s_waitcnt lgkmcnt(0)
    v_mfma_f32_16x16x32_bf16 a[0:3], v[120:123], v[40:43], a[0:3]
    v_exp_f32 v50, v50
    v_mfma_f32_16x16x32_bf16 a[4:7], v[124:127], v[40:43], a[4:7]
    v_exp_f32 v51, v51
    v_mfma_f32_16x16x32_bf16 a[8:11], v[128:131], v[40:43], a[8:11]
    v_cvt_pk_bf16_f32 v48, v48, v49
    v_cvt_pk_bf16_f32 v49, v50, v51
    v_mfma_f32_16x16x32_bf16 a[12:15], v[132:135], v[40:43], a[12:15]
    v_exp_f32 v52, v52
    v_mfma_f32_16x16x32_bf16 a[16:19], v[136:139], v[40:43], a[16:19]
    s_waitcnt vmcnt(3)
    buffer_load_dwordx4 v1, s[28:31], s65 offen offset:2048 nt lds
    v_mfma_f32_16x16x32_bf16 a[20:23], v[140:143], v[40:43], a[20:23]
    v_exp_f32 v53, v53
    v_mfma_f32_16x16x32_bf16 a[24:27], v[144:147], v[40:43], a[24:27]
    v_exp_f32 v54, v54
    v_mfma_f32_16x16x32_bf16 a[28:31], v[148:151], v[40:43], a[28:31]
    v_max3_f32 v6, v56, v57, v58
    v_max3_f32 v9, v64, v65, v66
    v_mfma_f32_16x16x32_bf16 a[192:195], a[216:219], v[40:43], a[192:195]
    v_max3_f32 v6, v6, v59, v60
    v_max3_f32 v9, v9, v67, v68
    v_mfma_f32_16x16x32_bf16 v[72:75], v[88:91], v[216:219], v[32:35]
    v_max3_f32 v6, v6, v61, v62
    v_max3_f32 v9, v9, v69, v70
    v_mfma_f32_16x16x32_bf16 v[72:75], v[92:95], v[220:223], v[72:75]
    v_max3_f32 v6, v6, v63, v71
    v_max_f32 v6, v6, v9
    v_mfma_f32_16x16x32_bf16 v[72:75], v[96:99], v[224:227], v[72:75]
    v_cmp_lt_f32 vcc, s61, v6
    v_mfma_f32_16x16x32_bf16 v[72:75], v[100:103], v[228:231], v[72:75]
    v_exp_f32 v55, v55
    v_mfma_f32_16x16x32_bf16 v[76:79], v[104:107], v[216:219], v[32:35]
    v_cvt_pk_bf16_f32 v50, v52, v53
    v_cvt_pk_bf16_f32 v51, v54, v55
    v_mfma_f32_16x16x32_bf16 v[76:79], v[108:111], v[220:223], v[76:79]
    s_cbranch_vccnz L_stub2_12
L_back2_12:
    v_mfma_f32_16x16x32_bf16 v[76:79], v[112:115], v[224:227], v[76:79]
    v_exp_f32 v56, v56
    v_mfma_f32_16x16x32_bf16 v[76:79], v[116:119], v[228:231], v[76:79]
    v_exp_f32 v57, v57
    v_mfma_f32_16x16x32_bf16 a[32:35], v[120:123], v[48:51], a[32:35]
    v_exp_f32 v58, v58
    v_mfma_f32_16x16x32_bf16 a[36:39], v[124:127], v[48:51], a[36:39]
    s_waitcnt vmcnt(3)
    buffer_load_dwordx4 v2, s[28:31], s65 offen offset:3072 nt lds
    v_mfma_f32_16x16x32_bf16 a[40:43], v[128:131], v[48:51], a[40:43]
    v_exp_f32 v59, v59
    v_mfma_f32_16x16x32_bf16 a[44:47], v[132:135], v[48:51], a[44:47]
    v_cvt_pk_bf16_f32 v56, v56, v57
    v_cvt_pk_bf16_f32 v57, v58, v59
    v_mfma_f32_16x16x32_bf16 a[48:51], v[136:139], v[48:51], a[48:51]
    v_exp_f32 v60, v60
    v_mfma_f32_16x16x32_bf16 a[52:55], v[140:143], v[48:51], a[52:55]
    v_exp_f32 v61, v61
    v_mfma_f32_16x16x32_bf16 a[56:59], v[144:147], v[48:51], a[56:59]
    v_exp_f32 v62, v62
    v_mfma_f32_16x16x32_bf16 a[60:63], v[148:151], v[48:51], a[60:63]
    v_exp_f32 v63, v63
    v_mfma_f32_16x16x32_bf16 a[196:199], a[216:219], v[48:51], a[196:199]
    v_cvt_pk_bf16_f32 v58, v60, v61
    v_cvt_pk_bf16_f32 v59, v62, v63
    s_barrier
    v_mfma_f32_16x16x32_bf16 v[80:83], v[88:91], v[232:235], v[36:39]
    v_exp_f32 v64, v64
    v_mfma_f32_16x16x32_bf16 v[80:83], v[92:95], v[236:239], v[80:83]
    ds_read_b128 v[88:91], v248 offset:32768
    ds_read_b128 v[92:95], v248 offset:33024
    v_mfma_f32_16x16x32_bf16 v[80:83], v[96:99], v[240:243], v[80:83]
    v_exp_f32 v65, v65
    v_mfma_f32_16x16x32_bf16 v[80:83], v[100:103], v[244:247], v[80:83]
    ds_read_b128 v[96:99], v248 offset:33280
    ds_read_b128 v[100:103], v248 offset:33536
    v_mfma_f32_16x16x32_bf16 v[84:87], v[104:107], v[232:235], v[36:39]
    v_exp_f32 v66, v66
    v_mfma_f32_16x16x32_bf16 v[84:87], v[108:111], v[236:239], v[84:87]
    ds_read_b128 v[104:107], v248 offset:36864
    ds_read_b128 v[108:111], v248 offset:37120
    v_mfma_f32_16x16x32_bf16 v[84:87], v[112:115], v[240:243], v[84:87]
    s_add_u32 m0, s58, 40960
    v_mfma_f32_16x16x32_bf16 v[84:87], v[116:119], v[244:247], v[84:87]
    ds_read_b128 v[112:115], v248 offset:37376
    ds_read_b128 v[116:119], v248 offset:37632
    v_mfma_f32_16x16x32_bf16 a[64:67], v[120:123], v[56:59], a[64:67]
    s_waitcnt vmcnt(3)
    buffer_load_dwordx4 v1, s[4:7], s65 offen offset:0 nt lds
    v_mfma_f32_16x16x32_bf16 a[68:71], v[124:127], v[56:59], a[68:71]
    v_exp_f32 v67, v67
    v_mfma_f32_16x16x32_bf16 a[72:75], v[128:131], v[56:59], a[72:75]
    v_cvt_pk_bf16_f32 v64, v64, v65
    v_cvt_pk_bf16_f32 v65, v66, v67
    v_mfma_f32_16x16x32_bf16 a[76:79], v[132:135], v[56:59], a[76:79]
    v_exp_f32 v68, v68
    v_mfma_f32_16x16x32_bf16 a[80:83], v[136:139], v[56:59], a[80:83]
    v_exp_f32 v69, v69
    v_mfma_f32_16x16x32_bf16 a[84:87], v[140:143], v[56:59], a[84:87]
    v_exp_f32 v70, v70
    v_mfma_f32_16x16x32_bf16 a[88:91], v[144:147], v[56:59], a[88:91]
    v_max3_f32 v6, v72, v73, v74
    v_max3_f32 v9, v80, v81, v82
    v_mfma_f32_16x16x32_bf16 a[92:95], v[148:151], v[56:59], a[92:95]
    v_max3_f32 v6, v6, v75, v76
    v_max3_f32 v9, v9, v83, v84
    v_mfma_f32_16x16x32_bf16 a[200:203], a[216:219], v[56:59], a[200:203]
    s_waitcnt lgkmcnt(0)
    v_mfma_f32_16x16x32_bf16 v[40:43], v[88:91], v[152:155], v[16:19]
    v_max3_f32 v6, v6, v77, v78
    v_max3_f32 v9, v9, v85, v86
    v_mfma_f32_16x16x32_bf16 v[40:43], v[92:95], v[156:159], v[40:43]
    s_waitcnt vmcnt(3)
    buffer_load_dwordx4 v2, s[4:7], s65 offen offset:1024 nt lds
    v_mfma_f32_16x16x32_bf16 v[40:43], v[96:99], v[160:163], v[40:43]
    v_max3_f32 v6, v6, v79, v87
    v_max_f32 v6, v6, v9
    v_mfma_f32_16x16x32_bf16 v[40:43], v[100:103], v[164:167], v[40:43]
    v_cmp_lt_f32 vcc, s61, v6
    v_mfma_f32_16x16x32_bf16 v[44:47], v[104:107], v[152:155], v[16:19]
    v_exp_f32 v71, v71
    v_mfma_f32_16x16x32_bf16 v[44:47], v[108:111], v[156:159], v[44:47]
    v_cvt_pk_bf16_f32 v66, v68, v69
    v_cvt_pk_bf16_f32 v67, v70, v71
    v_mfma_f32_16x16x32_bf16 v[44:47], v[112:115], v[160:163], v[44:47]
    s_cbranch_vccnz L_stub4_13
L_back4_13:
    v_mfma_f32_16x16x32_bf16 v[44:47], v[116:119], v[164:167], v[44:47]
    v_exp_f32 v72, v72
    v_mfma_f32_16x16x32_bf16 a[96:99], v[120:123], v[64:67], a[96:99]
    v_exp_f32 v73, v73
    v_mfma_f32_16x16x32_bf16 a[100:103], v[124:127], v[64:67], a[100:103]
    v_exp_f32 v74, v74
    v_mfma_f32_16x16x32_bf16 a[104:107], v[128:131], v[64:67], a[104:107]
    v_exp_f32 v75, v75
    v_mfma_f32_16x16x32_bf16 a[108:111], v[132:135], v[64:67], a[108:111]
    v_cvt_pk_bf16_f32 v72, v72, v73
    v_cvt_pk_bf16_f32 v73, v74, v75
    v_mfma_f32_16x16x32_bf16 a[112:115], v[136:139], v[64:67], a[112:115]
    v_exp_f32 v76, v76
    v_mfma_f32_16x16x32_bf16 a[116:119], v[140:143], v[64:67], a[116:119]
    v_exp_f32 v77, v77
    v_mfma_f32_16x16x32_bf16 a[120:123], v[144:147], v[64:67], a[120:123]
    v_exp_f32 v78, v78
    v_mfma_f32_16x16x32_bf16 a[124:127], v[148:151], v[64:67], a[124:127]
    s_waitcnt vmcnt(3)
    buffer_load_dwordx4 v1, s[4:7], s65 offen offset:2048 nt lds
    v_mfma_f32_16x16x32_bf16 a[204:207], a[216:219], v[64:67], a[204:207]
    v_exp_f32 v79, v79
    v_mfma_f32_16x16x32_bf16 v[48:51], v[88:91], v[168:171], v[20:23]
    v_cvt_pk_bf16_f32 v74, v76, v77
    v_cvt_pk_bf16_f32 v75, v78, v79
    v_mfma_f32_16x16x32_bf16 v[48:51], v[92:95], v[172:175], v[48:51]
    v_exp_f32 v80, v80
    v_mfma_f32_16x16x32_bf16 v[48:51], v[96:99], v[176:179], v[48:51]
    v_exp_f32 v81, v81
    v_mfma_f32_16x16x32_bf16 v[48:51], v[100:103], v[180:183], v[48:51]
    v_exp_f32 v82, v82
    v_mfma_f32_16x16x32_bf16 v[52:55], v[104:107], v[168:171], v[20:23]
    v_exp_f32 v83, v83
    v_mfma_f32_16x16x32_bf16 v[52:55], v[108:111], v[172:175], v[52:55]
    v_cvt_pk_bf16_f32 v80, v80, v81
    v_cvt_pk_bf16_f32 v81, v82, v83
    v_mfma_f32_16x16x32_bf16 v[52:55], v[112:115], v[176:179], v[52:55]
    v_exp_f32 v84, v84
    v_mfma_f32_16x16x32_bf16 v[52:55], v[116:119], v[180:183], v[52:55]
    v_exp_f32 v85, v85
    v_mfma_f32_16x16x32_bf16 a[128:131], v[120:123], v[72:75], a[128:131]
    v_exp_f32 v86, v86
    v_mfma_f32_16x16x32_bf16 a[132:135], v[124:127], v[72:75], a[132:135]
    v_mfma_f32_16x16x32_bf16 a[136:139], v[128:131], v[72:75], a[136:139]
    v_max3_f32 v6, v40, v41, v42
    v_max3_f32 v9, v48, v49, v50
    v_mfma_f32_16x16x32_bf16 a[140:143], v[132:135], v[72:75], a[140:143]
    s_waitcnt vmcnt(3)
    buffer_load_dwordx4 v2, s[4:7], s65 offen offset:3072 nt lds
    v_mfma_f32_16x16x32_bf16 a[144:147], v[136:139], v[72:75], a[144:147]
    v_max3_f32 v6, v6, v43, v44
    v_max3_f32 v9, v9, v51, v52
    v_mfma_f32_16x16x32_bf16 a[148:151], v[140:143], v[72:75], a[148:151]
    v_max3_f32 v6, v6, v45, v46
    v_max3_f32 v9, v9, v53, v54
    v_mfma_f32_16x16x32_bf16 a[152:155], v[144:147], v[72:75], a[152:155]
    v_max3_f32 v6, v6, v47, v55
    v_max_f32 v6, v6, v9
    v_mfma_f32_16x16x32_bf16 a[156:159], v[148:151], v[72:75], a[156:159]
    v_cmp_lt_f32 vcc, s61, v6
    v_mfma_f32_16x16x32_bf16 a[208:211], a[216:219], v[72:75], a[208:211]
    v_exp_f32 v87, v87
    v_mfma_f32_16x16x32_bf16 v[56:59], v[88:91], v[184:187], v[24:27]
    v_cvt_pk_bf16_f32 v82, v84, v85
    v_cvt_pk_bf16_f32 v83, v86, v87
    v_mfma_f32_16x16x32_bf16 v[56:59], v[92:95], v[188:191], v[56:59]
    s_cbranch_vccnz L_stub0_13
L_back0_13:
    v_mfma_f32_16x16x32_bf16 v[56:59], v[96:99], v[192:195], v[56:59]
    v_exp_f32 v40, v40
    v_mfma_f32_16x16x32_bf16 v[56:59], v[100:103], v[196:199], v[56:59]
    v_exp_f32 v41, v41
    v_mfma_f32_16x16x32_bf16 v[60:63], v[104:107], v[184:187], v[24:27]
    v_exp_f32 v42, v42
    v_mfma_f32_16x16x32_bf16 v[60:63], v[108:111], v[188:191], v[60:63]
    v_exp_f32 v43, v43
    v_mfma_f32_16x16x32_bf16 v[60:63], v[112:115], v[192:195], v[60:63]
    v_cvt_pk_bf16_f32 v40, v40, v41
    v_cvt_pk_bf16_f32 v41, v42, v43
    v_mfma_f32_16x16x32_bf16 v[60:63], v[116:119], v[196:199], v[60:63]
    v_exp_f32 v44, v44
    v_mfma_f32_16x16x32_bf16 a[160:163], v[120:123], v[80:83], a[160:163]
    ds_read_b64_tr_b16 v[120:121], v249 offset:32768
    ds_read_b64_tr_b16 v[122:123], v249 offset:36864
    v_mfma_f32_16x16x32_bf16 a[164:167], v[124:127], v[80:83], a[164:167]
    ds_read_b64_tr_b16 v[124:125], v250 offset:32768
    ds_read_b64_tr_b16 v[126:127], v250 offset:36864
    v_mfma_f32_16x16x32_bf16 a[168:171], v[128:131], v[80:83], a[168:171]
    ds_read_b64_tr_b16 v[128:129], v249 offset:33024
    ds_read_b64_tr_b16 v[130:131], v249 offset:37120
    v_mfma_f32_16x16x32_bf16 a[172:175], v[132:135], v[80:83], a[172:175]
    ds_read_b64_tr_b16 v[132:133], v250 offset:33024
    ds_read_b64_tr_b16 v[134:135], v250 offset:37120
    v_mfma_f32_16x16x32_bf16 a[176:179], v[136:139], v[80:83], a[176:179]
    ds_read_b64_tr_b16 v[136:137], v249 offset:33280
    ds_read_b64_tr_b16 v[138:139], v249 offset:37376
    v_mfma_f32_16x16x32_bf16 a[180:183], v[140:143], v[80:83], a[180:183]
    ds_read_b64_tr_b16 v[140:141], v250 offset:33280
    ds_read_b64_tr_b16 v[142:143], v250 offset:37376
    v_mfma_f32_16x16x32_bf16 a[184:187], v[144:147], v[80:83], a[184:187]
    ds_read_b64_tr_b16 v[144:145], v249 offset:33536
    ds_read_b64_tr_b16 v[146:147], v249 offset:37632
    v_mfma_f32_16x16x32_bf16 a[188:191], v[148:151], v[80:83], a[188:191]
    ds_read_b64_tr_b16 v[148:149], v250 offset:33536
    ds_read_b64_tr_b16 v[150:151], v250 offset:37632
    v_mfma_f32_16x16x32_bf16 a[212:215], a[216:219], v[80:83], a[212:215]
    s_add_u32 m0, s58, 65536
    s_mov_b32 s65, 139264
    v_mfma_f32_16x16x32_bf16 v[64:67], v[88:91], v[200:203], v[28:31]
    s_waitcnt vmcnt(3)
    buffer_load_dwordx4 v1, s[28:31], s65 offen offset:0 nt lds
    v_mfma_f32_16x16x32_bf16 v[64:67], v[92:95], v[204:207], v[64:67]
    v_exp_f32 v45, v45
    v_mfma_f32_16x16x32_bf16 v[64:67], v[96:99], v[208:211], v[64:67]
    v_exp_f32 v46, v46
    v_mfma_f32_16x16x32_bf16 v[64:67], v[100:103], v[212:215], v[64:67]
    v_exp_f32 v47, v47
    v_mfma_f32_16x16x32_bf16 v[68:71], v[104:107], v[200:203], v[28:31]
    s_waitcnt vmcnt(3)
    buffer_load_dwordx4 v2, s[28:31], s65 offen offset:1024 nt lds
    v_mfma_f32_16x16x32_bf16 v[68:71], v[108:111], v[204:207], v[68:71]
    v_cvt_pk_bf16_f32 v42, v44, v45
    v_cvt_pk_bf16_f32 v43, v46, v47
    v_mfma_f32_16x16x32_bf16 v[68:71], v[112:115], v[208:211], v[68:71]
    v_exp_f32 v48, v48
    v_mfma_f32_16x16x32_bf16 v[68:71], v[116:119], v[212:215], v[68:71]
    s_waitcnt lgkmcnt(0)
    v_mfma_f32_16x16x32_bf16 a[0:3], v[120:123], v[40:43], a[0:3]
    v_exp_f32 v49, v49
    v_mfma_f32_16x16x32_bf16 a[4:7], v[124:127], v[40:43], a[4:7]
    v_exp_f32 v50, v50
    v_mfma_f32_16x16x32_bf16 a[8:11], v[128:131], v[40:43], a[8:11]
    v_exp_f32 v51, v51
    v_mfma_f32_16x16x32_bf16 a[12:15], v[132:135], v[40:43], a[12:15]
    v_cvt_pk_bf16_f32 v48, v48, v49
    v_cvt_pk_bf16_f32 v49, v50, v51
    v_mfma_f32_16x16x32_bf16 a[16:19], v[136:139], v[40:43], a[16:19]
    v_exp_f32 v52, v52
    v_mfma_f32_16x16x32_bf16 a[20:23], v[140:143], v[40:43], a[20:23]
    v_exp_f32 v53, v53
    v_mfma_f32_16x16x32_bf16 a[24:27], v[144:147], v[40:43], a[24:27]
    v_exp_f32 v54, v54
    v_mfma_f32_16x16x32_bf16 a[28:31], v[148:151], v[40:43], a[28:31]
    v_max3_f32 v6, v56, v57, v58
    v_max3_f32 v9, v64, v65, v66
    v_mfma_f32_16x16x32_bf16 a[192:195], a[216:219], v[40:43], a[192:195]
    v_max3_f32 v6, v6, v59, v60
    v_max3_f32 v9, v9, v67, v68
    v_mfma_f32_16x16x32_bf16 v[72:75], v[88:91], v[216:219], v[32:35]
    s_waitcnt vmcnt(3)
    buffer_load_dwordx4 v1, s[28:31], s65 offen offset:2048 nt lds
    v_mfma_f32_16x16x32_bf16 v[72:75], v[92:95], v[220:223], v[72:75]
    v_max3_f32 v6, v6, v61, v62
    v_max3_f32 v9, v9, v69, v70
    v_mfma_f32_16x16x32_bf16 v[72:75], v[96:99], v[224:227], v[72:75]
    v_max3_f32 v6, v6, v63, v71
    v_max_f32 v6, v6, v9
    v_mfma_f32_16x16x32_bf16 v[72:75], v[100:103], v[228:231], v[72:75]
    v_cmp_lt_f32 vcc, s61, v6
    v_mfma_f32_16x16x32_bf16 v[76:79], v[104:107], v[216:219], v[32:35]
    v_exp_f32 v55, v55
    v_mfma_f32_16x16x32_bf16 v[76:79], v[108:111], v[220:223], v[76:79]
    v_cvt_pk_bf16_f32 v50, v52, v53
    v_cvt_pk_bf16_f32 v51, v54, v55
    v_mfma_f32_16x16x32_bf16 v[76:79], v[112:115], v[224:227], v[76:79]
    s_cbranch_vccnz L_stub2_13
L_back2_13:
    v_mfma_f32_16x16x32_bf16 v[76:79], v[116:119], v[228:231], v[76:79]
    v_exp_f32 v56, v56
    v_mfma_f32_16x16x32_bf16 a[32:35], v[120:123], v[48:51], a[32:35]
    v_exp_f32 v57, v57
    v_mfma_f32_16x16x32_bf16 a[36:39], v[124:127], v[48:51], a[36:39]
    v_exp_f32 v58, v58
    v_mfma_f32_16x16x32_bf16 a[40:43], v[128:131], v[48:51], a[40:43]
    v_exp_f32 v59, v59
    v_mfma_f32_16x16x32_bf16 a[44:47], v[132:135], v[48:51], a[44:47]
    v_cvt_pk_bf16_f32 v56, v56, v57
    v_cvt_pk_bf16_f32 v57, v58, v59
    v_mfma_f32_16x16x32_bf16 a[48:51], v[136:139], v[48:51], a[48:51]
    v_exp_f32 v60, v60
    v_mfma_f32_16x16x32_bf16 a[52:55], v[140:143], v[48:51], a[52:55]
    v_exp_f32 v61, v61
    v_mfma_f32_16x16x32_bf16 a[56:59], v[144:147], v[48:51], a[56:59]
    s_waitcnt vmcnt(3)
    buffer_load_dwordx4 v2, s[28:31], s65 offen offset:3072 nt lds
    v_mfma_f32_16x16x32_bf16 a[60:63], v[148:151], v[48:51], a[60:63]
    v_exp_f32 v62, v62
    v_mfma_f32_16x16x32_bf16 a[196:199], a[216:219], v[48:51], a[196:199]
    v_exp_f32 v63, v63
    v_cvt_pk_bf16_f32 v58, v60, v61
    v_cvt_pk_bf16_f32 v59, v62, v63
    s_barrier
    v_mfma_f32_16x16x32_bf16 v[80:83], v[88:91], v[232:235], v[36:39]
    v_exp_f32 v64, v64
    v_mfma_f32_16x16x32_bf16 v[80:83], v[92:95], v[236:239], v[80:83]
    ds_read_b128 v[88:91], v251 offset:0
    ds_read_b128 v[92:95], v251 offset:256
    v_mfma_f32_16x16x32_bf16 v[80:83], v[96:99], v[240:243], v[80:83]
    v_exp_f32 v65, v65
    v_mfma_f32_16x16x32_bf16 v[80:83], v[100:103], v[244:247], v[80:83]
    ds_read_b128 v[96:99], v251 offset:512
    ds_read_b128 v[100:103], v251 offset:768
    v_mfma_f32_16x16x32_bf16 v[84:87], v[104:107], v[232:235], v[36:39]
    v_exp_f32 v66, v66
    v_mfma_f32_16x16x32_bf16 v[84:87], v[108:111], v[236:239], v[84:87]
    ds_read_b128 v[104:107], v251 offset:4096
    ds_read_b128 v[108:111], v251 offset:4352
    v_mfma_f32_16x16x32_bf16 v[84:87], v[112:115], v[240:243], v[84:87]
    v_exp_f32 v67, v67
    v_mfma_f32_16x16x32_bf16 v[84:87], v[116:119], v[244:247], v[84:87]
    ds_read_b128 v[112:115], v251 offset:4608
    ds_read_b128 v[116:119], v251 offset:4864
    v_mfma_f32_16x16x32_bf16 a[64:67], v[120:123], v[56:59], a[64:67]
    v_cvt_pk_bf16_f32 v64, v64, v65
    v_cvt_pk_bf16_f32 v65, v66, v67
    v_mfma_f32_16x16x32_bf16 a[68:71], v[124:127], v[56:59], a[68:71]
    v_exp_f32 v68, v68
    v_mfma_f32_16x16x32_bf16 a[72:75], v[128:131], v[56:59], a[72:75]
    s_add_u32 m0, s58, 73728
    v_mfma_f32_16x16x32_bf16 a[76:79], v[132:135], v[56:59], a[76:79]
    s_waitcnt vmcnt(3)
    buffer_load_dwordx4 v1, s[4:7], s65 offen offset:0 nt lds
    v_mfma_f32_16x16x32_bf16 a[80:83], v[136:139], v[56:59], a[80:83]
    v_exp_f32 v69, v69
    v_mfma_f32_16x16x32_bf16 a[84:87], v[140:143], v[56:59], a[84:87]
    v_exp_f32 v70, v70
    v_mfma_f32_16x16x32_bf16 a[88:91], v[144:147], v[56:59], a[88:91]
    v_max3_f32 v6, v72, v73, v74
    v_max3_f32 v9, v80, v81, v82
    v_mfma_f32_16x16x32_bf16 a[92:95], v[148:151], v[56:59], a[92:95]
    v_max3_f32 v6, v6, v75, v76
    v_max3_f32 v9, v9, v83, v84
    v_mfma_f32_16x16x32_bf16 a[200:203], a[216:219], v[56:59], a[200:203]
    s_waitcnt lgkmcnt(0)
    v_mfma_f32_16x16x32_bf16 v[40:43], v[88:91], v[152:155], v[16:19]
    v_max3_f32 v6, v6, v77, v78
    v_max3_f32 v9, v9, v85, v86
    v_mfma_f32_16x16x32_bf16 v[40:43], v[92:95], v[156:159], v[40:43]
    v_max3_f32 v6, v6, v79, v87
    v_max_f32 v6, v6, v9
    v_mfma_f32_16x16x32_bf16 v[40:43], v[96:99], v[160:163], v[40:43]
    v_cmp_lt_f32 vcc, s61, v6
    v_mfma_f32_16x16x32_bf16 v[40:43], v[100:103], v[164:167], v[40:43]
    v_exp_f32 v71, v71
    v_mfma_f32_16x16x32_bf16 v[44:47], v[104:107], v[152:155], v[16:19]
    v_cvt_pk_bf16_f32 v66, v68, v69
    v_cvt_pk_bf16_f32 v67, v70, v71
    v_mfma_f32_16x16x32_bf16 v[44:47], v[108:111], v[156:159], v[44:47]
    s_cbranch_vccnz L_stub4_14
L_back4_14:
    v_mfma_f32_16x16x32_bf16 v[44:47], v[112:115], v[160:163], v[44:47]
    s_waitcnt vmcnt(3)
    buffer_load_dwordx4 v2, s[4:7], s65 offen offset:1024 nt lds
    v_mfma_f32_16x16x32_bf16 v[44:47], v[116:119], v[164:167], v[44:47]
    v_exp_f32 v72, v72
    v_mfma_f32_16x16x32_bf16 a[96:99], v[120:123], v[64:67], a[96:99]
    v_exp_f32 v73, v73
    v_mfma_f32_16x16x32_bf16 a[100:103], v[124:127], v[64:67], a[100:103]
    v_exp_f32 v74, v74
    v_mfma_f32_16x16x32_bf16 a[104:107], v[128:131], v[64:67], a[104:107]
    v_exp_f32 v75, v75
    v_mfma_f32_16x16x32_bf16 a[108:111], v[132:135], v[64:67], a[108:111]
    v_cvt_pk_bf16_f32 v72, v72, v73
    v_cvt_pk_bf16_f32 v73, v74, v75
    v_mfma_f32_16x16x32_bf16 a[112:115], v[136:139], v[64:67], a[112:115]
    v_exp_f32 v76, v76
    v_mfma_f32_16x16x32_bf16 a[116:119], v[140:143], v[64:67], a[116:119]
    v_exp_f32 v77, v77
    v_mfma_f32_16x16x32_bf16 a[120:123], v[144:147], v[64:67], a[120:123]
    v_exp_f32 v78, v78
    v_mfma_f32_16x16x32_bf16 a[124:127], v[148:151], v[64:67], a[124:127]
    v_exp_f32 v79, v79
    v_mfma_f32_16x16x32_bf16 a[204:207], a[216:219], v[64:67], a[204:207]
    v_cvt_pk_bf16_f32 v74, v76, v77
    v_cvt_pk_bf16_f32 v75, v78, v79
    v_mfma_f32_16x16x32_bf16 v[48:51], v[88:91], v[168:171], v[20:23]
    v_exp_f32 v80, v80
    v_mfma_f32_16x16x32_bf16 v[48:51], v[92:95], v[172:175], v[48:51]
    v_exp_f32 v81, v81
    v_mfma_f32_16x16x32_bf16 v[48:51], v[96:99], v[176:179], v[48:51]
    v_exp_f32 v82, v82
    v_mfma_f32_16x16x32_bf16 v[48:51], v[100:103], v[180:183], v[48:51]
    s_waitcnt vmcnt(3)
    buffer_load_dwordx4 v1, s[4:7], s65 offen offset:2048 nt lds
    v_mfma_f32_16x16x32_bf16 v[52:55], v[104:107], v[168:171], v[20:23]
    v_exp_f32 v83, v83
    v_mfma_f32_16x16x32_bf16 v[52:55], v[108:111], v[172:175], v[52:55]
    v_cvt_pk_bf16_f32 v80, v80, v81
    v_cvt_pk_bf16_f32 v81, v82, v83
    v_mfma_f32_16x16x32_bf16 v[52:55], v[112:115], v[176:179], v[52:55]
    v_exp_f32 v84, v84
    v_mfma_f32_16x16x32_bf16 v[52:55], v[116:119], v[180:183], v[52:55]
    v_exp_f32 v85, v85
    v_mfma_f32_16x16x32_bf16 a[128:131], v[120:123], v[72:75], a[128:131]
    v_exp_f32 v86, v86
    v_mfma_f32_16x16x32_bf16 a[132:135], v[124:127], v[72:75], a[132:135]
    v_mfma_f32_16x16x32_bf16 a[136:139], v[128:131], v[72:75], a[136:139]
    v_max3_f32 v6, v40, v41, v42
    v_max3_f32 v9, v48, v49, v50
    v_mfma_f32_16x16x32_bf16 a[140:143], v[132:135], v[72:75], a[140:143]
    v_max3_f32 v6, v6, v43, v44
    v_max3_f32 v9, v9, v51, v52
    v_mfma_f32_16x16x32_bf16 a[144:147], v[136:139], v[72:75], a[144:147]
    v_max3_f32 v6, v6, v45, v46
    v_max3_f32 v9, v9, v53, v54
    v_mfma_f32_16x16x32_bf16 a[148:151], v[140:143], v[72:75], a[148:151]
    v_max3_f32 v6, v6, v47, v55
    v_max_f32 v6, v6, v9
    v_mfma_f32_16x16x32_bf16 a[152:155], v[144:147], v[72:75], a[152:155]
    v_cmp_lt_f32 vcc, s61, v6
    v_mfma_f32_16x16x32_bf16 a[156:159], v[148:151], v[72:75], a[156:159]
    v_exp_f32 v87, v87
    v_mfma_f32_16x16x32_bf16 a[208:211], a[216:219], v[72:75], a[208:211]
    s_waitcnt vmcnt(3)
    buffer_load_dwordx4 v2, s[4:7], s65 offen offset:3072 nt lds
    v_mfma_f32_16x16x32_bf16 v[56:59], v[88:91], v[184:187], v[24:27]
    v_cvt_pk_bf16_f32 v82, v84, v85
    v_cvt_pk_bf16_f32 v83, v86, v87
    v_mfma_f32_16x16x32_bf16 v[56:59], v[92:95], v[188:191], v[56:59]
    s_cbranch_vccnz L_stub0_14
L_back0_14:
    v_mfma_f32_16x16x32_bf16 v[56:59], v[96:99], v[192:195], v[56:59]
    v_exp_f32 v40, v40
    v_mfma_f32_16x16x32_bf16 v[56:59], v[100:103], v[196:199], v[56:59]
    v_exp_f32 v41, v41
    v_mfma_f32_16x16x32_bf16 v[60:63], v[104:107], v[184:187], v[24:27]
    v_exp_f32 v42, v42
    v_mfma_f32_16x16x32_bf16 v[60:63], v[108:111], v[188:191], v[60:63]
    v_exp_f32 v43, v43
    v_mfma_f32_16x16x32_bf16 v[60:63], v[112:115], v[192:195], v[60:63]
    v_cvt_pk_bf16_f32 v40, v40, v41
    v_cvt_pk_bf16_f32 v41, v42, v43
    v_mfma_f32_16x16x32_bf16 v[60:63], v[116:119], v[196:199], v[60:63]
    v_exp_f32 v44, v44
    v_mfma_f32_16x16x32_bf16 a[160:163], v[120:123], v[80:83], a[160:163]
    ds_read_b64_tr_b16 v[120:121], v252 offset:0
    ds_read_b64_tr_b16 v[122:123], v252 offset:4096
    v_mfma_f32_16x16x32_bf16 a[164:167], v[124:127], v[80:83], a[164:167]
    ds_read_b64_tr_b16 v[124:125], v253 offset:0
    ds_read_b64_tr_b16 v[126:127], v253 offset:4096
    v_mfma_f32_16x16x32_bf16 a[168:171], v[128:131], v[80:83], a[168:171]
    ds_read_b64_tr_b16 v[128:129], v252 offset:256
    ds_read_b64_tr_b16 v[130:131], v252 offset:4352
    v_mfma_f32_16x16x32_bf16 a[172:175], v[132:135], v[80:83], a[172:175]
    ds_read_b64_tr_b16 v[132:133], v253 offset:256
    ds_read_b64_tr_b16 v[134:135], v253 offset:4352
    v_mfma_f32_16x16x32_bf16 a[176:179], v[136:139], v[80:83], a[176:179]
    ds_read_b64_tr_b16 v[136:137], v252 offset:512
    ds_read_b64_tr_b16 v[138:139], v252 offset:4608
    v_mfma_f32_16x16x32_bf16 a[180:183], v[140:143], v[80:83], a[180:183]
    ds_read_b64_tr_b16 v[140:141], v253 offset:512
    ds_read_b64_tr_b16 v[142:143], v253 offset:4608
    v_mfma_f32_16x16x32_bf16 a[184:187], v[144:147], v[80:83], a[184:187]
    ds_read_b64_tr_b16 v[144:145], v252 offset:768
    ds_read_b64_tr_b16 v[146:147], v252 offset:4864
    v_mfma_f32_16x16x32_bf16 a[188:191], v[148:151], v[80:83], a[188:191]
    ds_read_b64_tr_b16 v[148:149], v253 offset:768
    ds_read_b64_tr_b16 v[150:151], v253 offset:4864
    v_mfma_f32_16x16x32_bf16 a[212:215], a[216:219], v[80:83], a[212:215]
    s_add_u32 m0, s58, 98304
    s_mov_b32 s65, 147456
    v_mfma_f32_16x16x32_bf16 v[64:67], v[88:91], v[200:203], v[28:31]
    s_waitcnt vmcnt(3)
    buffer_load_dwordx4 v1, s[28:31], s65 offen offset:0 nt lds
    v_mfma_f32_16x16x32_bf16 v[64:67], v[92:95], v[204:207], v[64:67]
    v_exp_f32 v45, v45
    v_mfma_f32_16x16x32_bf16 v[64:67], v[96:99], v[208:211], v[64:67]
    v_exp_f32 v46, v46
    v_mfma_f32_16x16x32_bf16 v[64:67], v[100:103], v[212:215], v[64:67]
    v_exp_f32 v47, v47
    v_mfma_f32_16x16x32_bf16 v[68:71], v[104:107], v[200:203], v[28:31]
    v_cvt_pk_bf16_f32 v42, v44, v45
    v_cvt_pk_bf16_f32 v43, v46, v47
    v_mfma_f32_16x16x32_bf16 v[68:71], v[108:111], v[204:207], v[68:71]
    v_exp_f32 v48, v48
    v_mfma_f32_16x16x32_bf16 v[68:71], v[112:115], v[208:211], v[68:71]
    v_exp_f32 v49, v49
    v_mfma_f32_16x16x32_bf16 v[68:71], v[116:119], v[212:215], v[68:71]
    s_waitcnt lgkmcnt(0)
    v_mfma_f32_16x16x32_bf16 a[0:3], v[120:123], v[40:43], a[0:3]
    v_exp_f32 v50, v50
    v_mfma_f32_16x16x32_bf16 a[4:7], v[124:127], v[40:43], a[4:7]
    s_waitcnt vmcnt(3)
    buffer_load_dwordx4 v2, s[28:31], s65 offen offset:1024 nt lds
    v_mfma_f32_16x16x32_bf16 a[8:11], v[128:131], v[40:43], a[8:11]
    v_exp_f32 v51, v51
    v_mfma_f32_16x16x32_bf16 a[12:15], v[132:135], v[40:43], a[12:15]
    v_cvt_pk_bf16_f32 v48, v48, v49
    v_cvt_pk_bf16_f32 v49, v50, v51
    v_mfma_f32_16x16x32_bf16 a[16:19], v[136:139], v[40:43], a[16:19]
    v_exp_f32 v52, v52
    v_mfma_f32_16x16x32_bf16 a[20:23], v[140:143], v[40:43], a[20:23]
    v_exp_f32 v53, v53
    v_mfma_f32_16x16x32_bf16 a[24:27], v[144:147], v[40:43], a[24:27]
    v_exp_f32 v54, v54
    v_mfma_f32_16x16x32_bf16 a[28:31], v[148:151], v[40:43], a[28:31]
    v_max3_f32 v6, v56, v57, v58
    v_max3_f32 v9, v64, v65, v66
    v_mfma_f32_16x16x32_bf16 a[192:195], a[216:219], v[40:43], a[192:195]
    v_max3_f32 v6, v6, v59, v60
    v_max3_f32 v9, v9, v67, v68
    v_mfma_f32_16x16x32_bf16 v[72:75], v[88:91], v[216:219], v[32:35]
    v_max3_f32 v6, v6, v61, v62
    v_max3_f32 v9, v9, v69, v70
    v_mfma_f32_16x16x32_bf16 v[72:75], v[92:95], v[220:223], v[72:75]
    v_max3_f32 v6, v6, v63, v71
    v_max_f32 v6, v6, v9
    v_mfma_f32_16x16x32_bf16 v[72:75], v[96:99], v[224:227], v[72:75]
    v_cmp_lt_f32 vcc, s61, v6
    v_mfma_f32_16x16x32_bf16 v[72:75], v[100:103], v[228:231], v[72:75]
    v_exp_f32 v55, v55
    v_mfma_f32_16x16x32_bf16 v[76:79], v[104:107], v[216:219], v[32:35]
    v_cvt_pk_bf16_f32 v50, v52, v53
    v_cvt_pk_bf16_f32 v51, v54, v55
    v_mfma_f32_16x16x32_bf16 v[76:79], v[108:111], v[220:223], v[76:79]
    s_waitcnt vmcnt(3)
    buffer_load_dwordx4 v1, s[28:31], s65 offen offset:2048 nt lds
    v_mfma_f32_16x16x32_bf16 v[76:79], v[112:115], v[224:227], v[76:79]
    s_cbranch_vccnz L_stub2_14
L_back2_14:
    v_mfma_f32_16x16x32_bf16 v[76:79], v[116:119], v[228:231], v[76:79]
    v_exp_f32 v56, v56
    v_mfma_f32_16x16x32_bf16 a[32:35], v[120:123], v[48:51], a[32:35]
    v_exp_f32 v57, v57
    v_mfma_f32_16x16x32_bf16 a[36:39], v[124:127], v[48:51], a[36:39]
    v_exp_f32 v58, v58
    v_mfma_f32_16x16x32_bf16 a[40:43], v[128:131], v[48:51], a[40:43]
    v_exp_f32 v59, v59
    v_mfma_f32_16x16x32_bf16 a[44:47], v[132:135], v[48:51], a[44:47]
    v_cvt_pk_bf16_f32 v56, v56, v57
    v_cvt_pk_bf16_f32 v57, v58, v59
    v_mfma_f32_16x16x32_bf16 a[48:51], v[136:139], v[48:51], a[48:51]
    v_exp_f32 v60, v60
    v_mfma_f32_16x16x32_bf16 a[52:55], v[140:143], v[48:51], a[52:55]
    v_exp_f32 v61, v61
    v_mfma_f32_16x16x32_bf16 a[56:59], v[144:147], v[48:51], a[56:59]
    v_exp_f32 v62, v62
    v_mfma_f32_16x16x32_bf16 a[60:63], v[148:151], v[48:51], a[60:63]
    v_exp_f32 v63, v63
    v_mfma_f32_16x16x32_bf16 a[196:199], a[216:219], v[48:51], a[196:199]
    v_cvt_pk_bf16_f32 v58, v60, v61
    v_cvt_pk_bf16_f32 v59, v62, v63
    s_barrier
    v_mfma_f32_16x16x32_bf16 v[80:83], v[88:91], v[232:235], v[36:39]
    v_exp_f32 v64, v64
    v_mfma_f32_16x16x32_bf16 v[80:83], v[92:95], v[236:239], v[80:83]
    ds_read_b128 v[88:91], v3 offset:0
    ds_read_b128 v[92:95], v3 offset:256
    v_mfma_f32_16x16x32_bf16 v[80:83], v[96:99], v[240:243], v[80:83]
    s_waitcnt vmcnt(3)
    buffer_load_dwordx4 v2, s[28:31], s65 offen offset:3072 nt lds
    v_mfma_f32_16x16x32_bf16 v[80:83], v[100:103], v[244:247], v[80:83]
    ds_read_b128 v[96:99], v3 offset:512
    ds_read_b128 v[100:103], v3 offset:768
    v_mfma_f32_16x16x32_bf16 v[84:87], v[104:107], v[232:235], v[36:39]
    v_exp_f32 v65, v65
    v_mfma_f32_16x16x32_bf16 v[84:87], v[108:111], v[236:239], v[84:87]
    ds_read_b128 v[104:107], v3 offset:4096
    ds_read_b128 v[108:111], v3 offset:4352
    v_mfma_f32_16x16x32_bf16 v[84:87], v[112:115], v[240:243], v[84:87]
    v_exp_f32 v66, v66
    v_mfma_f32_16x16x32_bf16 v[84:87], v[116:119], v[244:247], v[84:87]
    ds_read_b128 v[112:115], v3 offset:4608
    ds_read_b128 v[116:119], v3 offset:4864
    v_mfma_f32_16x16x32_bf16 a[64:67], v[120:123], v[56:59], a[64:67]
    v_exp_f32 v67, v67
    v_mfma_f32_16x16x32_bf16 a[68:71], v[124:127], v[56:59], a[68:71]
    v_cvt_pk_bf16_f32 v64, v64, v65
    v_cvt_pk_bf16_f32 v65, v66, v67
    v_mfma_f32_16x16x32_bf16 a[72:75], v[128:131], v[56:59], a[72:75]
    v_exp_f32 v68, v68
    v_mfma_f32_16x16x32_bf16 a[76:79], v[132:135], v[56:59], a[76:79]
    v_exp_f32 v69, v69
    v_mfma_f32_16x16x32_bf16 a[80:83], v[136:139], v[56:59], a[80:83]
    v_exp_f32 v70, v70
    v_mfma_f32_16x16x32_bf16 a[84:87], v[140:143], v[56:59], a[84:87]
    v_max3_f32 v6, v72, v73, v74
    v_max3_f32 v9, v80, v81, v82
    v_mfma_f32_16x16x32_bf16 a[88:91], v[144:147], v[56:59], a[88:91]
    v_max3_f32 v6, v6, v75, v76
    v_max3_f32 v9, v9, v83, v84
    v_mfma_f32_16x16x32_bf16 a[92:95], v[148:151], v[56:59], a[92:95]
    s_add_u32 m0, s58, 106496
    v_mfma_f32_16x16x32_bf16 a[200:203], a[216:219], v[56:59], a[200:203]
    s_waitcnt lgkmcnt(0)
    v_mfma_f32_16x16x32_bf16 v[40:43], v[88:91], v[152:155], v[16:19]
    s_waitcnt vmcnt(3)
    buffer_load_dwordx4 v1, s[4:7], s65 offen offset:0 nt lds
    v_mfma_f32_16x16x32_bf16 v[40:43], v[92:95], v[156:159], v[40:43]
    v_max3_f32 v6, v6, v77, v78
    v_max3_f32 v9, v9, v85, v86
    v_mfma_f32_16x16x32_bf16 v[40:43], v[96:99], v[160:163], v[40:43]
    v_max3_f32 v6, v6, v79, v87
    v_max_f32 v6, v6, v9
    v_mfma_f32_16x16x32_bf16 v[40:43], v[100:103], v[164:167], v[40:43]
    v_cmp_lt_f32 vcc, s61, v6
    v_mfma_f32_16x16x32_bf16 v[44:47], v[104:107], v[152:155], v[16:19]
    v_exp_f32 v71, v71
    v_mfma_f32_16x16x32_bf16 v[44:47], v[108:111], v[156:159], v[44:47]
    v_cvt_pk_bf16_f32 v66, v68, v69
    v_cvt_pk_bf16_f32 v67, v70, v71
    v_mfma_f32_16x16x32_bf16 v[44:47], v[112:115], v[160:163], v[44:47]
    s_cbranch_vccnz L_stub4_15
L_back4_15:
    v_mfma_f32_16x16x32_bf16 v[44:47], v[116:119], v[164:167], v[44:47]
    v_exp_f32 v72, v72
    v_mfma_f32_16x16x32_bf16 a[96:99], v[120:123], v[64:67], a[96:99]
    v_exp_f32 v73, v73
    v_mfma_f32_16x16x32_bf16 a[100:103], v[124:127], v[64:67], a[100:103]
    v_exp_f32 v74, v74
    v_mfma_f32_16x16x32_bf16 a[104:107], v[128:131], v[64:67], a[104:107]
    v_exp_f32 v75, v75
    v_mfma_f32_16x16x32_bf16 a[108:111], v[132:135], v[64:67], a[108:111]
    s_waitcnt vmcnt(3)
    buffer_load_dwordx4 v2, s[4:7], s65 offen offset:1024 nt lds
    v_mfma_f32_16x16x32_bf16 a[112:115], v[136:139], v[64:67], a[112:115]
    v_cvt_pk_bf16_f32 v72, v72, v73
    v_cvt_pk_bf16_f32 v73, v74, v75
    v_mfma_f32_16x16x32_bf16 a[116:119], v[140:143], v[64:67], a[116:119]
    v_exp_f32 v76, v76
    v_mfma_f32_16x16x32_bf16 a[120:123], v[144:147], v[64:67], a[120:123]
    v_exp_f32 v77, v77
    v_mfma_f32_16x16x32_bf16 a[124:127], v[148:151], v[64:67], a[124:127]
    v_exp_f32 v78, v78
    v_mfma_f32_16x16x32_bf16 a[204:207], a[216:219], v[64:67], a[204:207]
    v_exp_f32 v79, v79
    v_mfma_f32_16x16x32_bf16 v[48:51], v[88:91], v[168:171], v[20:23]
    v_cvt_pk_bf16_f32 v74, v76, v77
    v_cvt_pk_bf16_f32 v75, v78, v79
    v_mfma_f32_16x16x32_bf16 v[48:51], v[92:95], v[172:175], v[48:51]
    v_exp_f32 v80, v80
    v_mfma_f32_16x16x32_bf16 v[48:51], v[96:99], v[176:179], v[48:51]
    v_exp_f32 v81, v81
    v_mfma_f32_16x16x32_bf16 v[48:51], v[100:103], v[180:183], v[48:51]
    v_exp_f32 v82, v82
    v_mfma_f32_16x16x32_bf16 v[52:55], v[104:107], v[168:171], v[20:23]
    v_exp_f32 v83, v83
    v_mfma_f32_16x16x32_bf16 v[52:55], v[108:111], v[172:175], v[52:55]
    v_cvt_pk_bf16_f32 v80, v80, v81
    v_cvt_pk_bf16_f32 v81, v82, v83
    v_mfma_f32_16x16x32_bf16 v[52:55], v[112:115], v[176:179], v[52:55]
    v_exp_f32 v84, v84
    v_mfma_f32_16x16x32_bf16 v[52:55], v[116:119], v[180:183], v[52:55]
    v_exp_f32 v85, v85
    v_mfma_f32_16x16x32_bf16 a[128:131], v[120:123], v[72:75], a[128:131]
    s_waitcnt vmcnt(3)
    buffer_load_dwordx4 v1, s[4:7], s65 offen offset:2048 nt lds
    v_mfma_f32_16x16x32_bf16 a[132:135], v[124:127], v[72:75], a[132:135]
    v_exp_f32 v86, v86
    v_mfma_f32_16x16x32_bf16 a[136:139], v[128:131], v[72:75], a[136:139]
    v_max3_f32 v6, v40, v41, v42
    v_max3_f32 v9, v48, v49, v50
    v_mfma_f32_16x16x32_bf16 a[140:143], v[132:135], v[72:75], a[140:143]
    v_max3_f32 v6, v6, v43, v44
    v_max3_f32 v9, v9, v51, v52
    v_mfma_f32_16x16x32_bf16 a[144:147], v[136:139], v[72:75], a[144:147]
    v_max3_f32 v6, v6, v45, v46
    v_max3_f32 v9, v9, v53, v54
    v_mfma_f32_16x16x32_bf16 a[148:151], v[140:143], v[72:75], a[148:151]
    v_max3_f32 v6, v6, v47, v55
    v_max_f32 v6, v6, v9
    v_mfma_f32_16x16x32_bf16 a[152:155], v[144:147], v[72:75], a[152:155]
    v_cmp_lt_f32 vcc, s61, v6
    v_mfma_f32_16x16x32_bf16 a[156:159], v[148:151], v[72:75], a[156:159]
    v_exp_f32 v87, v87
    v_mfma_f32_16x16x32_bf16 a[208:211], a[216:219], v[72:75], a[208:211]
    v_cvt_pk_bf16_f32 v82, v84, v85
    v_cvt_pk_bf16_f32 v83, v86, v87
    v_mfma_f32_16x16x32_bf16 v[56:59], v[88:91], v[184:187], v[24:27]
    s_cbranch_vccnz L_stub0_15
L_back0_15:
    v_mfma_f32_16x16x32_bf16 v[56:59], v[92:95], v[188:191], v[56:59]
    v_exp_f32 v40, v40
    v_mfma_f32_16x16x32_bf16 v[56:59], v[96:99], v[192:195], v[56:59]
    v_exp_f32 v41, v41
    v_mfma_f32_16x16x32_bf16 v[56:59], v[100:103], v[196:199], v[56:59]
    v_exp_f32 v42, v42
    v_mfma_f32_16x16x32_bf16 v[60:63], v[104:107], v[184:187], v[24:27]
    s_waitcnt vmcnt(3)
    buffer_load_dwordx4 v2, s[4:7], s65 offen offset:3072 nt lds
    v_mfma_f32_16x16x32_bf16 v[60:63], v[108:111], v[188:191], v[60:63]
    v_exp_f32 v43, v43
    v_mfma_f32_16x16x32_bf16 v[60:63], v[112:115], v[192:195], v[60:63]
    v_cvt_pk_bf16_f32 v40, v40, v41
    v_cvt_pk_bf16_f32 v41, v42, v43
    v_mfma_f32_16x16x32_bf16 v[60:63], v[116:119], v[196:199], v[60:63]
    v_exp_f32 v44, v44
    v_mfma_f32_16x16x32_bf16 a[160:163], v[120:123], v[80:83], a[160:163]
    ds_read_b64_tr_b16 v[120:121], v4 offset:0
    ds_read_b64_tr_b16 v[122:123], v4 offset:4096
    v_mfma_f32_16x16x32_bf16 a[164:167], v[124:127], v[80:83], a[164:167]
    ds_read_b64_tr_b16 v[124:125], v5 offset:0
    ds_read_b64_tr_b16 v[126:127], v5 offset:4096
    v_mfma_f32_16x16x32_bf16 a[168:171], v[128:131], v[80:83], a[168:171]
    ds_read_b64_tr_b16 v[128:129], v4 offset:256
    ds_read_b64_tr_b16 v[130:131], v4 offset:4352
    v_mfma_f32_16x16x32_bf16 a[172:175], v[132:135], v[80:83], a[172:175]
    ds_read_b64_tr_b16 v[132:133], v5 offset:256
    ds_read_b64_tr_b16 v[134:135], v5 offset:4352
    v_mfma_f32_16x16x32_bf16 a[176:179], v[136:139], v[80:83], a[176:179]
    ds_read_b64_tr_b16 v[136:137], v4 offset:512
    ds_read_b64_tr_b16 v[138:139], v4 offset:4608
    v_mfma_f32_16x16x32_bf16 a[180:183], v[140:143], v[80:83], a[180:183]
    ds_read_b64_tr_b16 v[140:141], v5 offset:512
    ds_read_b64_tr_b16 v[142:143], v5 offset:4608
    v_mfma_f32_16x16x32_bf16 a[184:187], v[144:147], v[80:83], a[184:187]
    ds_read_b64_tr_b16 v[144:145], v4 offset:768
    ds_read_b64_tr_b16 v[146:147], v4 offset:4864
    v_mfma_f32_16x16x32_bf16 a[188:191], v[148:151], v[80:83], a[188:191]
    ds_read_b64_tr_b16 v[148:149], v5 offset:768
    ds_read_b64_tr_b16 v[150:151], v5 offset:4864
    v_mfma_f32_16x16x32_bf16 a[212:215], a[216:219], v[80:83], a[212:215]
    v_exp_f32 v45, v45
    v_mfma_f32_16x16x32_bf16 v[64:67], v[88:91], v[200:203], v[28:31]
    s_add_u32 m0, s58, 131072
    s_mov_b32 s65, 155648
    v_mfma_f32_16x16x32_bf16 v[64:67], v[92:95], v[204:207], v[64:67]
    s_waitcnt vmcnt(3)
    buffer_load_dwordx4 v1, s[28:31], s65 offen offset:0 nt lds
    v_mfma_f32_16x16x32_bf16 v[64:67], v[96:99], v[208:211], v[64:67]
    v_exp_f32 v46, v46
    v_mfma_f32_16x16x32_bf16 v[64:67], v[100:103], v[212:215], v[64:67]
    v_exp_f32 v47, v47
    v_mfma_f32_16x16x32_bf16 v[68:71], v[104:107], v[200:203], v[28:31]
    v_cvt_pk_bf16_f32 v42, v44, v45
    v_cvt_pk_bf16_f32 v43, v46, v47
    v_mfma_f32_16x16x32_bf16 v[68:71], v[108:111], v[204:207], v[68:71]
    v_exp_f32 v48, v48
    v_mfma_f32_16x16x32_bf16 v[68:71], v[112:115], v[208:211], v[68:71]
    v_exp_f32 v49, v49
    v_mfma_f32_16x16x32_bf16 v[68:71], v[116:119], v[212:215], v[68:71]
    s_waitcnt lgkmcnt(0)
    v_mfma_f32_16x16x32_bf16 a[0:3], v[120:123], v[40:43], a[0:3]
    v_exp_f32 v50, v50
    v_mfma_f32_16x16x32_bf16 a[4:7], v[124:127], v[40:43], a[4:7]
    v_exp_f32 v51, v51
    v_mfma_f32_16x16x32_bf16 a[8:11], v[128:131], v[40:43], a[8:11]
    v_cvt_pk_bf16_f32 v48, v48, v49
    v_cvt_pk_bf16_f32 v49, v50, v51
    v_mfma_f32_16x16x32_bf16 a[12:15], v[132:135], v[40:43], a[12:15]
    v_exp_f32 v52, v52
    v_mfma_f32_16x16x32_bf16 a[16:19], v[136:139], v[40:43], a[16:19]
    v_exp_f32 v53, v53
    v_mfma_f32_16x16x32_bf16 a[20:23], v[140:143], v[40:43], a[20:23]
    v_exp_f32 v54, v54
    v_mfma_f32_16x16x32_bf16 a[24:27], v[144:147], v[40:43], a[24:27]
    s_waitcnt vmcnt(3)
    buffer_load_dwordx4 v2, s[28:31], s65 offen offset:1024 nt lds
    v_mfma_f32_16x16x32_bf16 a[28:31], v[148:151], v[40:43], a[28:31]
    v_max3_f32 v6, v56, v57, v58
    v_max3_f32 v9, v64, v65, v66
    v_mfma_f32_16x16x32_bf16 a[192:195], a[216:219], v[40:43], a[192:195]
    v_max3_f32 v6, v6, v59, v60
    v_max3_f32 v9, v9, v67, v68
    v_mfma_f32_16x16x32_bf16 v[72:75], v[88:91], v[216:219], v[32:35]
    v_max3_f32 v6, v6, v61, v62
    v_max3_f32 v9, v9, v69, v70
    v_mfma_f32_16x16x32_bf16 v[72:75], v[92:95], v[220:223], v[72:75]
    v_max3_f32 v6, v6, v63, v71
    v_max_f32 v6, v6, v9
    v_mfma_f32_16x16x32_bf16 v[72:75], v[96:99], v[224:227], v[72:75]
    v_cmp_lt_f32 vcc, s61, v6
    v_mfma_f32_16x16x32_bf16 v[72:75], v[100:103], v[228:231], v[72:75]
    v_exp_f32 v55, v55
    v_mfma_f32_16x16x32_bf16 v[76:79], v[104:107], v[216:219], v[32:35]
    v_cvt_pk_bf16_f32 v50, v52, v53
    v_cvt_pk_bf16_f32 v51, v54, v55
    v_mfma_f32_16x16x32_bf16 v[76:79], v[108:111], v[220:223], v[76:79]
    s_cbranch_vccnz L_stub2_15
L_back2_15:
    v_mfma_f32_16x16x32_bf16 v[76:79], v[112:115], v[224:227], v[76:79]
    v_exp_f32 v56, v56
    v_mfma_f32_16x16x32_bf16 v[76:79], v[116:119], v[228:231], v[76:79]
    v_exp_f32 v57, v57
    v_mfma_f32_16x16x32_bf16 a[32:35], v[120:123], v[48:51], a[32:35]
    v_exp_f32 v58, v58
    v_mfma_f32_16x16x32_bf16 a[36:39], v[124:127], v[48:51], a[36:39]
    v_exp_f32 v59, v59
    v_mfma_f32_16x16x32_bf16 a[40:43], v[128:131], v[48:51], a[40:43]
    s_waitcnt vmcnt(3)
    buffer_load_dwordx4 v1, s[28:31], s65 offen offset:2048 nt lds
    v_mfma_f32_16x16x32_bf16 a[44:47], v[132:135], v[48:51], a[44:47]
    v_cvt_pk_bf16_f32 v56, v56, v57
    v_cvt_pk_bf16_f32 v57, v58, v59
    v_mfma_f32_16x16x32_bf16 a[48:51], v[136:139], v[48:51], a[48:51]
    v_exp_f32 v60, v60
    v_mfma_f32_16x16x32_bf16 a[52:55], v[140:143], v[48:51], a[52:55]
    v_exp_f32 v61, v61
    v_mfma_f32_16x16x32_bf16 a[56:59], v[144:147], v[48:51], a[56:59]
    v_exp_f32 v62, v62
    v_mfma_f32_16x16x32_bf16 a[60:63], v[148:151], v[48:51], a[60:63]
    v_exp_f32 v63, v63
    v_mfma_f32_16x16x32_bf16 a[196:199], a[216:219], v[48:51], a[196:199]
    v_cvt_pk_bf16_f32 v58, v60, v61
    v_cvt_pk_bf16_f32 v59, v62, v63
    s_barrier
    v_mfma_f32_16x16x32_bf16 v[80:83], v[88:91], v[232:235], v[36:39]
    v_exp_f32 v64, v64
    v_mfma_f32_16x16x32_bf16 v[80:83], v[92:95], v[236:239], v[80:83]
    ds_read_b128 v[88:91], v3 offset:32768
    ds_read_b128 v[92:95], v3 offset:33024
    v_mfma_f32_16x16x32_bf16 v[80:83], v[96:99], v[240:243], v[80:83]
    v_exp_f32 v65, v65
    v_mfma_f32_16x16x32_bf16 v[80:83], v[100:103], v[244:247], v[80:83]
    ds_read_b128 v[96:99], v3 offset:33280
    ds_read_b128 v[100:103], v3 offset:33536
    v_mfma_f32_16x16x32_bf16 v[84:87], v[104:107], v[232:235], v[36:39]
    v_exp_f32 v66, v66
    v_mfma_f32_16x16x32_bf16 v[84:87], v[108:111], v[236:239], v[84:87]
    ds_read_b128 v[104:107], v3 offset:36864
    ds_read_b128 v[108:111], v3 offset:37120
    v_mfma_f32_16x16x32_bf16 v[84:87], v[112:115], v[240:243], v[84:87]
    s_waitcnt vmcnt(3)
    buffer_load_dwordx4 v2, s[28:31], s65 offen offset:3072 nt lds
    v_mfma_f32_16x16x32_bf16 v[84:87], v[116:119], v[244:247], v[84:87]
    ds_read_b128 v[112:115], v3 offset:37376
    ds_read_b128 v[116:119], v3 offset:37632
    v_mfma_f32_16x16x32_bf16 a[64:67], v[120:123], v[56:59], a[64:67]
    v_exp_f32 v67, v67
    v_mfma_f32_16x16x32_bf16 a[68:71], v[124:127], v[56:59], a[68:71]
    v_cvt_pk_bf16_f32 v64, v64, v65
    v_cvt_pk_bf16_f32 v65, v66, v67
    v_mfma_f32_16x16x32_bf16 a[72:75], v[128:131], v[56:59], a[72:75]
    v_exp_f32 v68, v68
    v_mfma_f32_16x16x32_bf16 a[76:79], v[132:135], v[56:59], a[76:79]
    v_exp_f32 v69, v69
    v_mfma_f32_16x16x32_bf16 a[80:83], v[136:139], v[56:59], a[80:83]
    v_exp_f32 v70, v70
    v_mfma_f32_16x16x32_bf16 a[84:87], v[140:143], v[56:59], a[84:87]
    v_max3_f32 v6, v72, v73, v74
    v_max3_f32 v9, v80, v81, v82
    v_mfma_f32_16x16x32_bf16 a[88:91], v[144:147], v[56:59], a[88:91]
    v_max3_f32 v6, v6, v75, v76
    v_max3_f32 v9, v9, v83, v84
    v_mfma_f32_16x16x32_bf16 a[92:95], v[148:151], v[56:59], a[92:95]
    v_max3_f32 v6, v6, v77, v78
    v_max3_f32 v9, v9, v85, v86
    v_mfma_f32_16x16x32_bf16 a[200:203], a[216:219], v[56:59], a[200:203]
    s_waitcnt lgkmcnt(0)
    v_mfma_f32_16x16x32_bf16 v[40:43], v[88:91], v[152:155], v[16:19]
    v_max3_f32 v6, v6, v79, v87
    v_max_f32 v6, v6, v9
    v_mfma_f32_16x16x32_bf16 v[40:43], v[92:95], v[156:159], v[40:43]
    v_cmp_lt_f32 vcc, s61, v6
    v_mfma_f32_16x16x32_bf16 v[40:43], v[96:99], v[160:163], v[40:43]
    v_exp_f32 v71, v71
    v_mfma_f32_16x16x32_bf16 v[40:43], v[100:103], v[164:167], v[40:43]
    s_add_u32 m0, s58, 139264
    v_mfma_f32_16x16x32_bf16 v[44:47], v[104:107], v[152:155], v[16:19]
    s_waitcnt vmcnt(3)
    buffer_load_dwordx4 v1, s[4:7], s65 offen offset:0 nt lds
    v_mfma_f32_16x16x32_bf16 v[44:47], v[108:111], v[156:159], v[44:47]
    v_cvt_pk_bf16_f32 v66, v68, v69
    v_cvt_pk_bf16_f32 v67, v70, v71
    v_mfma_f32_16x16x32_bf16 v[44:47], v[112:115], v[160:163], v[44:47]
    s_cbranch_vccnz L_stub4_16
L_back4_16:
    v_mfma_f32_16x16x32_bf16 v[44:47], v[116:119], v[164:167], v[44:47]
    v_exp_f32 v72, v72
    v_mfma_f32_16x16x32_bf16 a[96:99], v[120:123], v[64:67], a[96:99]
    v_exp_f32 v73, v73
    v_mfma_f32_16x16x32_bf16 a[100:103], v[124:127], v[64:67], a[100:103]
    v_exp_f32 v74, v74
    v_mfma_f32_16x16x32_bf16 a[104:107], v[128:131], v[64:67], a[104:107]
    v_exp_f32 v75, v75
    v_mfma_f32_16x16x32_bf16 a[108:111], v[132:135], v[64:67], a[108:111]
    v_cvt_pk_bf16_f32 v72, v72, v73
    v_cvt_pk_bf16_f32 v73, v74, v75
    v_mfma_f32_16x16x32_bf16 a[112:115], v[136:139], v[64:67], a[112:115]
    v_exp_f32 v76, v76
    v_mfma_f32_16x16x32_bf16 a[116:119], v[140:143], v[64:67], a[116:119]
    v_exp_f32 v77, v77
    v_mfma_f32_16x16x32_bf16 a[120:123], v[144:147], v[64:67], a[120:123]
    v_exp_f32 v78, v78
    v_mfma_f32_16x16x32_bf16 a[124:127], v[148:151], v[64:67], a[124:127]
    v_exp_f32 v79, v79
    v_mfma_f32_16x16x32_bf16 a[204:207], a[216:219], v[64:67], a[204:207]
    s_waitcnt vmcnt(3)
    buffer_load_dwordx4 v2, s[4:7], s65 offen offset:1024 nt lds
    v_mfma_f32_16x16x32_bf16 v[48:51], v[88:91], v[168:171], v[20:23]
    v_cvt_pk_bf16_f32 v74, v76, v77
    v_cvt_pk_bf16_f32 v75, v78, v79
    v_mfma_f32_16x16x32_bf16 v[48:51], v[92:95], v[172:175], v[48:51]
    v_exp_f32 v80, v80
    v_mfma_f32_16x16x32_bf16 v[48:51], v[96:99], v[176:179], v[48:51]
    v_exp_f32 v81, v81
    v_mfma_f32_16x16x32_bf16 v[48:51], v[100:103], v[180:183], v[48:51]
    v_exp_f32 v82, v82
    v_mfma_f32_16x16x32_bf16 v[52:55], v[104:107], v[168:171], v[20:23]
    v_exp_f32 v83, v83
    v_mfma_f32_16x16x32_bf16 v[52:55], v[108:111], v[172:175], v[52:55]
    v_cvt_pk_bf16_f32 v80, v80, v81
    v_cvt_pk_bf16_f32 v81, v82, v83
    v_mfma_f32_16x16x32_bf16 v[52:55], v[112:115], v[176:179], v[52:55]
    v_exp_f32 v84, v84
    v_mfma_f32_16x16x32_bf16 v[52:55], v[116:119], v[180:183], v[52:55]
    v_exp_f32 v85, v85
    v_mfma_f32_16x16x32_bf16 a[128:131], v[120:123], v[72:75], a[128:131]
    v_exp_f32 v86, v86
    v_mfma_f32_16x16x32_bf16 a[132:135], v[124:127], v[72:75], a[132:135]
    v_mfma_f32_16x16x32_bf16 a[136:139], v[128:131], v[72:75], a[136:139]
    v_max3_f32 v6, v40, v41, v42
    v_max3_f32 v9, v48, v49, v50
    v_mfma_f32_16x16x32_bf16 a[140:143], v[132:135], v[72:75], a[140:143]
    v_max3_f32 v6, v6, v43, v44
    v_max3_f32 v9, v9, v51, v52
    v_mfma_f32_16x16x32_bf16 a[144:147], v[136:139], v[72:75], a[144:147]
    v_max3_f32 v6, v6, v45, v46
    v_max3_f32 v9, v9, v53, v54
    v_mfma_f32_16x16x32_bf16 a[148:151], v[140:143], v[72:75], a[148:151]
    s_waitcnt vmcnt(3)
    buffer_load_dwordx4 v1, s[4:7], s65 offen offset:2048 nt lds
    v_mfma_f32_16x16x32_bf16 a[152:155], v[144:147], v[72:75], a[152:155]
    v_max3_f32 v6, v6, v47, v55
    v_max_f32 v6, v6, v9
    v_mfma_f32_16x16x32_bf16 a[156:159], v[148:151], v[72:75], a[156:159]
    v_cmp_lt_f32 vcc, s61, v6
    v_mfma_f32_16x16x32_bf16 a[208:211], a[216:219], v[72:75], a[208:211]
    v_exp_f32 v87, v87
    v_mfma_f32_16x16x32_bf16 v[56:59], v[88:91], v[184:187], v[24:27]
    v_cvt_pk_bf16_f32 v82, v84, v85
    v_cvt_pk_bf16_f32 v83, v86, v87
    v_mfma_f32_16x16x32_bf16 v[56:59], v[92:95], v[188:191], v[56:59]
    s_cbranch_vccnz L_stub0_16
L_back0_16:
    v_mfma_f32_16x16x32_bf16 v[56:59], v[96:99], v[192:195], v[56:59]
    v_exp_f32 v40, v40
    v_mfma_f32_16x16x32_bf16 v[56:59], v[100:103], v[196:199], v[56:59]
    v_exp_f32 v41, v41
    v_mfma_f32_16x16x32_bf16 v[60:63], v[104:107], v[184:187], v[24:27]
    v_exp_f32 v42, v42
    v_mfma_f32_16x16x32_bf16 v[60:63], v[108:111], v[188:191], v[60:63]
    v_exp_f32 v43, v43
    v_mfma_f32_16x16x32_bf16 v[60:63], v[112:115], v[192:195], v[60:63]
    v_cvt_pk_bf16_f32 v40, v40, v41
    v_cvt_pk_bf16_f32 v41, v42, v43
    v_mfma_f32_16x16x32_bf16 v[60:63], v[116:119], v[196:199], v[60:63]
    v_exp_f32 v44, v44
    v_mfma_f32_16x16x32_bf16 a[160:163], v[120:123], v[80:83], a[160:163]
    ds_read_b64_tr_b16 v[120:121], v4 offset:32768
    ds_read_b64_tr_b16 v[122:123], v4 offset:36864
    v_mfma_f32_16x16x32_bf16 a[164:167], v[124:127], v[80:83], a[164:167]
    ds_read_b64_tr_b16 v[124:125], v5 offset:32768
    ds_read_b64_tr_b16 v[126:127], v5 offset:36864
    v_mfma_f32_16x16x32_bf16 a[168:171], v[128:131], v[80:83], a[168:171]
    ds_read_b64_tr_b16 v[128:129], v4 offset:33024
    ds_read_b64_tr_b16 v[130:131], v4 offset:37120
    v_mfma_f32_16x16x32_bf16 a[172:175], v[132:135], v[80:83], a[172:175]
    ds_read_b64_tr_b16 v[132:133], v5 offset:33024
    ds_read_b64_tr_b16 v[134:135], v5 offset:37120
    v_mfma_f32_16x16x32_bf16 a[176:179], v[136:139], v[80:83], a[176:179]
    ds_read_b64_tr_b16 v[136:137], v4 offset:33280
    ds_read_b64_tr_b16 v[138:139], v4 offset:37376
    v_mfma_f32_16x16x32_bf16 a[180:183], v[140:143], v[80:83], a[180:183]
    ds_read_b64_tr_b16 v[140:141], v5 offset:33280
    ds_read_b64_tr_b16 v[142:143], v5 offset:37376
    v_mfma_f32_16x16x32_bf16 a[184:187], v[144:147], v[80:83], a[184:187]
    ds_read_b64_tr_b16 v[144:145], v4 offset:33536
    ds_read_b64_tr_b16 v[146:147], v4 offset:37632
    v_mfma_f32_16x16x32_bf16 a[188:191], v[148:151], v[80:83], a[188:191]
    ds_read_b64_tr_b16 v[148:149], v5 offset:33536
    ds_read_b64_tr_b16 v[150:151], v5 offset:37632
    v_mfma_f32_16x16x32_bf16 a[212:215], a[216:219], v[80:83], a[212:215]
    s_waitcnt vmcnt(3)
    buffer_load_dwordx4 v2, s[4:7], s65 offen offset:3072 nt lds
    v_mfma_f32_16x16x32_bf16 v[64:67], v[88:91], v[200:203], v[28:31]
    v_exp_f32 v45, v45
    v_mfma_f32_16x16x32_bf16 v[64:67], v[92:95], v[204:207], v[64:67]
    v_exp_f32 v46, v46
    v_mfma_f32_16x16x32_bf16 v[64:67], v[96:99], v[208:211], v[64:67]
    v_exp_f32 v47, v47
    v_mfma_f32_16x16x32_bf16 v[64:67], v[100:103], v[212:215], v[64:67]
    v_cvt_pk_bf16_f32 v42, v44, v45
    v_cvt_pk_bf16_f32 v43, v46, v47
    v_mfma_f32_16x16x32_bf16 v[68:71], v[104:107], v[200:203], v[28:31]
    v_exp_f32 v48, v48
    v_mfma_f32_16x16x32_bf16 v[68:71], v[108:111], v[204:207], v[68:71]
    s_add_u32 m0, s58, 0
    s_mov_b32 s65, 163840
    v_mfma_f32_16x16x32_bf16 v[68:71], v[112:115], v[208:211], v[68:71]
    s_waitcnt vmcnt(3)
    buffer_load_dwordx4 v1, s[28:31], s65 offen offset:0 nt lds
    v_mfma_f32_16x16x32_bf16 v[68:71], v[116:119], v[212:215], v[68:71]
    s_waitcnt lgkmcnt(0)
    v_mfma_f32_16x16x32_bf16 a[0:3], v[120:123], v[40:43], a[0:3]
    v_exp_f32 v49, v49
    v_mfma_f32_16x16x32_bf16 a[4:7], v[124:127], v[40:43], a[4:7]
    v_exp_f32 v50, v50
    v_mfma_f32_16x16x32_bf16 a[8:11], v[128:131], v[40:43], a[8:11]
    v_exp_f32 v51, v51
    v_mfma_f32_16x16x32_bf16 a[12:15], v[132:135], v[40:43], a[12:15]
    v_cvt_pk_bf16_f32 v48, v48, v49
    v_cvt_pk_bf16_f32 v49, v50, v51
    v_mfma_f32_16x16x32_bf16 a[16:19], v[136:139], v[40:43], a[16:19]
    v_exp_f32 v52, v52
    v_mfma_f32_16x16x32_bf16 a[20:23], v[140:143], v[40:43], a[20:23]
    v_exp_f32 v53, v53
    v_mfma_f32_16x16x32_bf16 a[24:27], v[144:147], v[40:43], a[24:27]
    v_exp_f32 v54, v54
    v_mfma_f32_16x16x32_bf16 a[28:31], v[148:151], v[40:43], a[28:31]
    v_max3_f32 v6, v56, v57, v58
    v_max3_f32 v9, v64, v65, v66
    v_mfma_f32_16x16x32_bf16 a[192:195], a[216:219], v[40:43], a[192:195]
    v_max3_f32 v6, v6, v59, v60
    v_max3_f32 v9, v9, v67, v68
    v_mfma_f32_16x16x32_bf16 v[72:75], v[88:91], v[216:219], v[32:35]
    v_max3_f32 v6, v6, v61, v62
    v_max3_f32 v9, v9, v69, v70
    v_mfma_f32_16x16x32_bf16 v[72:75], v[92:95], v[220:223], v[72:75]
    v_max3_f32 v6, v6, v63, v71
    v_max_f32 v6, v6, v9
    v_mfma_f32_16x16x32_bf16 v[72:75], v[96:99], v[224:227], v[72:75]
    s_waitcnt vmcnt(3)
    buffer_load_dwordx4 v2, s[28:31], s65 offen offset:1024 nt lds
    v_mfma_f32_16x16x32_bf16 v[72:75], v[100:103], v[228:231], v[72:75]
    v_cmp_lt_f32 vcc, s61, v6
    v_mfma_f32_16x16x32_bf16 v[76:79], v[104:107], v[216:219], v[32:35]
    v_exp_f32 v55, v55
    v_mfma_f32_16x16x32_bf16 v[76:79], v[108:111], v[220:223], v[76:79]
    v_cvt_pk_bf16_f32 v50, v52, v53
    v_cvt_pk_bf16_f32 v51, v54, v55
    v_mfma_f32_16x16x32_bf16 v[76:79], v[112:115], v[224:227], v[76:79]
    s_cbranch_vccnz L_stub2_16
L_back2_16:
    v_mfma_f32_16x16x32_bf16 v[76:79], v[116:119], v[228:231], v[76:79]
    v_exp_f32 v56, v56
    v_mfma_f32_16x16x32_bf16 a[32:35], v[120:123], v[48:51], a[32:35]
    v_exp_f32 v57, v57
    v_mfma_f32_16x16x32_bf16 a[36:39], v[124:127], v[48:51], a[36:39]
    v_exp_f32 v58, v58
    v_mfma_f32_16x16x32_bf16 a[40:43], v[128:131], v[48:51], a[40:43]
    v_exp_f32 v59, v59
    v_mfma_f32_16x16x32_bf16 a[44:47], v[132:135], v[48:51], a[44:47]
    v_cvt_pk_bf16_f32 v56, v56, v57
    v_cvt_pk_bf16_f32 v57, v58, v59
    v_mfma_f32_16x16x32_bf16 a[48:51], v[136:139], v[48:51], a[48:51]
    v_exp_f32 v60, v60
    v_mfma_f32_16x16x32_bf16 a[52:55], v[140:143], v[48:51], a[52:55]
    v_exp_f32 v61, v61
    v_mfma_f32_16x16x32_bf16 a[56:59], v[144:147], v[48:51], a[56:59]
    v_exp_f32 v62, v62
    v_mfma_f32_16x16x32_bf16 a[60:63], v[148:151], v[48:51], a[60:63]
    s_waitcnt vmcnt(3)
    buffer_load_dwordx4 v1, s[28:31], s65 offen offset:2048 nt lds
    v_mfma_f32_16x16x32_bf16 a[196:199], a[216:219], v[48:51], a[196:199]
    v_exp_f32 v63, v63
    v_cvt_pk_bf16_f32 v58, v60, v61
    v_cvt_pk_bf16_f32 v59, v62, v63
    s_barrier
    v_mfma_f32_16x16x32_bf16 v[80:83], v[88:91], v[232:235], v[36:39]
    v_exp_f32 v64, v64
    v_mfma_f32_16x16x32_bf16 v[80:83], v[92:95], v[236:239], v[80:83]
    ds_read_b128 v[88:91], v248 offset:0
    ds_read_b128 v[92:95], v248 offset:256
    v_mfma_f32_16x16x32_bf16 v[80:83], v[96:99], v[240:243], v[80:83]
    v_exp_f32 v65, v65
    v_mfma_f32_16x16x32_bf16 v[80:83], v[100:103], v[244:247], v[80:83]
    ds_read_b128 v[96:99], v248 offset:512
    ds_read_b128 v[100:103], v248 offset:768
    v_mfma_f32_16x16x32_bf16 v[84:87], v[104:107], v[232:235], v[36:39]
    v_exp_f32 v66, v66
    v_mfma_f32_16x16x32_bf16 v[84:87], v[108:111], v[236:239], v[84:87]
    ds_read_b128 v[104:107], v248 offset:4096
    ds_read_b128 v[108:111], v248 offset:4352
    v_mfma_f32_16x16x32_bf16 v[84:87], v[112:115], v[240:243], v[84:87]
    v_exp_f32 v67, v67
    v_mfma_f32_16x16x32_bf16 v[84:87], v[116:119], v[244:247], v[84:87]
    ds_read_b128 v[112:115], v248 offset:4608
    ds_read_b128 v[116:119], v248 offset:4864
    v_mfma_f32_16x16x32_bf16 a[64:67], v[120:123], v[56:59], a[64:67]
    v_cvt_pk_bf16_f32 v64, v64, v65
    v_cvt_pk_bf16_f32 v65, v66, v67
    v_mfma_f32_16x16x32_bf16 a[68:71], v[124:127], v[56:59], a[68:71]
    v_exp_f32 v68, v68
    v_mfma_f32_16x16x32_bf16 a[72:75], v[128:131], v[56:59], a[72:75]
    v_exp_f32 v69, v69
    v_mfma_f32_16x16x32_bf16 a[76:79], v[132:135], v[56:59], a[76:79]
    s_waitcnt vmcnt(3)
    buffer_load_dwordx4 v2, s[28:31], s65 offen offset:3072 nt lds
    v_mfma_f32_16x16x32_bf16 a[80:83], v[136:139], v[56:59], a[80:83]
    v_exp_f32 v70, v70
    v_mfma_f32_16x16x32_bf16 a[84:87], v[140:143], v[56:59], a[84:87]
    v_max3_f32 v6, v72, v73, v74
    v_max3_f32 v9, v80, v81, v82
    v_mfma_f32_16x16x32_bf16 a[88:91], v[144:147], v[56:59], a[88:91]
    v_max3_f32 v6, v6, v75, v76
    v_max3_f32 v9, v9, v83, v84
    v_mfma_f32_16x16x32_bf16 a[92:95], v[148:151], v[56:59], a[92:95]
    v_max3_f32 v6, v6, v77, v78
    v_max3_f32 v9, v9, v85, v86
    v_mfma_f32_16x16x32_bf16 a[200:203], a[216:219], v[56:59], a[200:203]
    s_waitcnt lgkmcnt(0)
    v_mfma_f32_16x16x32_bf16 v[40:43], v[88:91], v[152:155], v[16:19]
    v_max3_f32 v6, v6, v79, v87
    v_max_f32 v6, v6, v9
    v_mfma_f32_16x16x32_bf16 v[40:43], v[92:95], v[156:159], v[40:43]
    v_cmp_lt_f32 vcc, s61, v6
    v_mfma_f32_16x16x32_bf16 v[40:43], v[96:99], v[160:163], v[40:43]
    v_exp_f32 v71, v71
    v_mfma_f32_16x16x32_bf16 v[40:43], v[100:103], v[164:167], v[40:43]
    v_cvt_pk_bf16_f32 v66, v68, v69
    v_cvt_pk_bf16_f32 v67, v70, v71
    v_mfma_f32_16x16x32_bf16 v[44:47], v[104:107], v[152:155], v[16:19]
    s_cbranch_vccnz L_stub4_17
L_back4_17:
    v_mfma_f32_16x16x32_bf16 v[44:47], v[108:111], v[156:159], v[44:47]
    v_exp_f32 v72, v72
    v_mfma_f32_16x16x32_bf16 v[44:47], v[112:115], v[160:163], v[44:47]
    v_exp_f32 v73, v73
    v_mfma_f32_16x16x32_bf16 v[44:47], v[116:119], v[164:167], v[44:47]
    v_exp_f32 v74, v74
    v_mfma_f32_16x16x32_bf16 a[96:99], v[120:123], v[64:67], a[96:99]
    s_add_u32 m0, s58, 8192
    v_mfma_f32_16x16x32_bf16 a[100:103], v[124:127], v[64:67], a[100:103]
    s_waitcnt vmcnt(3)
    buffer_load_dwordx4 v1, s[4:7], s65 offen offset:0 nt lds
    v_mfma_f32_16x16x32_bf16 a[104:107], v[128:131], v[64:67], a[104:107]
    v_exp_f32 v75, v75
    v_mfma_f32_16x16x32_bf16 a[108:111], v[132:135], v[64:67], a[108:111]
    v_cvt_pk_bf16_f32 v72, v72, v73
    v_cvt_pk_bf16_f32 v73, v74, v75
    v_mfma_f32_16x16x32_bf16 a[112:115], v[136:139], v[64:67], a[112:115]
    v_exp_f32 v76, v76
    v_mfma_f32_16x16x32_bf16 a[116:119], v[140:143], v[64:67], a[116:119]
    v_exp_f32 v77, v77
    v_mfma_f32_16x16x32_bf16 a[120:123], v[144:147], v[64:67], a[120:123]
    v_exp_f32 v78, v78
    v_mfma_f32_16x16x32_bf16 a[124:127], v[148:151], v[64:67], a[124:127]
    v_exp_f32 v79, v79
    v_mfma_f32_16x16x32_bf16 a[204:207], a[216:219], v[64:67], a[204:207]
    v_cvt_pk_bf16_f32 v74, v76, v77
    v_cvt_pk_bf16_f32 v75, v78, v79
    v_mfma_f32_16x16x32_bf16 v[48:51], v[88:91], v[168:171], v[20:23]
    v_exp_f32 v80, v80
    v_mfma_f32_16x16x32_bf16 v[48:51], v[92:95], v[172:175], v[48:51]
    v_exp_f32 v81, v81
    v_mfma_f32_16x16x32_bf16 v[48:51], v[96:99], v[176:179], v[48:51]
    v_exp_f32 v82, v82
    v_mfma_f32_16x16x32_bf16 v[48:51], v[100:103], v[180:183], v[48:51]
    v_exp_f32 v83, v83
    v_mfma_f32_16x16x32_bf16 v[52:55], v[104:107], v[168:171], v[20:23]
    s_waitcnt vmcnt(3)
    buffer_load_dwordx4 v2, s[4:7], s65 offen offset:1024 nt lds
    v_mfma_f32_16x16x32_bf16 v[52:55], v[108:111], v[172:175], v[52:55]
    v_cvt_pk_bf16_f32 v80, v80, v81
    v_cvt_pk_bf16_f32 v81, v82, v83
    v_mfma_f32_16x16x32_bf16 v[52:55], v[112:115], v[176:179], v[52:55]
    v_exp_f32 v84, v84
    v_mfma_f32_16x16x32_bf16 v[52:55], v[116:119], v[180:183], v[52:55]
    v_exp_f32 v85, v85
    v_mfma_f32_16x16x32_bf16 a[128:131], v[120:123], v[72:75], a[128:131]
    v_exp_f32 v86, v86
    v_mfma_f32_16x16x32_bf16 a[132:135], v[124:127], v[72:75], a[132:135]
    v_mfma_f32_16x16x32_bf16 a[136:139], v[128:131], v[72:75], a[136:139]
    v_max3_f32 v6, v40, v41, v42
    v_max3_f32 v9, v48, v49, v50
    v_mfma_f32_16x16x32_bf16 a[140:143], v[132:135], v[72:75], a[140:143]
    v_max3_f32 v6, v6, v43, v44
    v_max3_f32 v9, v9, v51, v52
    v_mfma_f32_16x16x32_bf16 a[144:147], v[136:139], v[72:75], a[144:147]
    v_max3_f32 v6, v6, v45, v46
    v_max3_f32 v9, v9, v53, v54
    v_mfma_f32_16x16x32_bf16 a[148:151], v[140:143], v[72:75], a[148:151]
    v_max3_f32 v6, v6, v47, v55
    v_max_f32 v6, v6, v9
    v_mfma_f32_16x16x32_bf16 a[152:155], v[144:147], v[72:75], a[152:155]
    v_cmp_lt_f32 vcc, s61, v6
    v_mfma_f32_16x16x32_bf16 a[156:159], v[148:151], v[72:75], a[156:159]
    v_exp_f32 v87, v87
    v_mfma_f32_16x16x32_bf16 a[208:211], a[216:219], v[72:75], a[208:211]
    v_cvt_pk_bf16_f32 v82, v84, v85
    v_cvt_pk_bf16_f32 v83, v86, v87
    v_mfma_f32_16x16x32_bf16 v[56:59], v[88:91], v[184:187], v[24:27]
    s_waitcnt vmcnt(3)
    buffer_load_dwordx4 v1, s[4:7], s65 offen offset:2048 nt lds
    v_mfma_f32_16x16x32_bf16 v[56:59], v[92:95], v[188:191], v[56:59]
    s_cbranch_vccnz L_stub0_17
L_back0_17:
    v_mfma_f32_16x16x32_bf16 v[56:59], v[96:99], v[192:195], v[56:59]
    v_exp_f32 v40, v40
    v_mfma_f32_16x16x32_bf16 v[56:59], v[100:103], v[196:199], v[56:59]
    v_exp_f32 v41, v41
    v_mfma_f32_16x16x32_bf16 v[60:63], v[104:107], v[184:187], v[24:27]
    v_exp_f32 v42, v42
    v_mfma_f32_16x16x32_bf16 v[60:63], v[108:111], v[188:191], v[60:63]
    v_exp_f32 v43, v43
    v_mfma_f32_16x16x32_bf16 v[60:63], v[112:115], v[192:195], v[60:63]
    v_cvt_pk_bf16_f32 v40, v40, v41
    v_cvt_pk_bf16_f32 v41, v42, v43
    v_mfma_f32_16x16x32_bf16 v[60:63], v[116:119], v[196:199], v[60:63]
    v_exp_f32 v44, v44
    v_mfma_f32_16x16x32_bf16 a[160:163], v[120:123], v[80:83], a[160:163]
    ds_read_b64_tr_b16 v[120:121], v249 offset:0
    ds_read_b64_tr_b16 v[122:123], v249 offset:4096
    v_mfma_f32_16x16x32_bf16 a[164:167], v[124:127], v[80:83], a[164:167]
    ds_read_b64_tr_b16 v[124:125], v250 offset:0
    ds_read_b64_tr_b16 v[126:127], v250 offset:4096
    v_mfma_f32_16x16x32_bf16 a[168:171], v[128:131], v[80:83], a[168:171]
    ds_read_b64_tr_b16 v[128:129], v249 offset:256
    ds_read_b64_tr_b16 v[130:131], v249 offset:4352
    v_mfma_f32_16x16x32_bf16 a[172:175], v[132:135], v[80:83], a[172:175]
    ds_read_b64_tr_b16 v[132:133], v250 offset:256
    ds_read_b64_tr_b16 v[134:135], v250 offset:4352
    v_mfma_f32_16x16x32_bf16 a[176:179], v[136:139], v[80:83], a[176:179]
    ds_read_b64_tr_b16 v[136:137], v249 offset:512
    ds_read_b64_tr_b16 v[138:139], v249 offset:4608
    v_mfma_f32_16x16x32_bf16 a[180:183], v[140:143], v[80:83], a[180:183]
    ds_read_b64_tr_b16 v[140:141], v250 offset:512
    ds_read_b64_tr_b16 v[142:143], v250 offset:4608
    v_mfma_f32_16x16x32_bf16 a[184:187], v[144:147], v[80:83], a[184:187]
    ds_read_b64_tr_b16 v[144:145], v249 offset:768
    ds_read_b64_tr_b16 v[146:147], v249 offset:4864
    v_mfma_f32_16x16x32_bf16 a[188:191], v[148:151], v[80:83], a[188:191]
    ds_read_b64_tr_b16 v[148:149], v250 offset:768
    ds_read_b64_tr_b16 v[150:151], v250 offset:4864
    v_mfma_f32_16x16x32_bf16 a[212:215], a[216:219], v[80:83], a[212:215]
    s_waitcnt vmcnt(3)
    buffer_load_dwordx4 v2, s[4:7], s65 offen offset:3072 nt lds
    v_mfma_f32_16x16x32_bf16 v[64:67], v[88:91], v[200:203], v[28:31]
    v_exp_f32 v45, v45
    v_mfma_f32_16x16x32_bf16 v[64:67], v[92:95], v[204:207], v[64:67]
    v_exp_f32 v46, v46
    v_mfma_f32_16x16x32_bf16 v[64:67], v[96:99], v[208:211], v[64:67]
    v_exp_f32 v47, v47
    v_mfma_f32_16x16x32_bf16 v[64:67], v[100:103], v[212:215], v[64:67]
    v_cvt_pk_bf16_f32 v42, v44, v45
    v_cvt_pk_bf16_f32 v43, v46, v47
    v_mfma_f32_16x16x32_bf16 v[68:71], v[104:107], v[200:203], v[28:31]
    v_exp_f32 v48, v48
    v_mfma_f32_16x16x32_bf16 v[68:71], v[108:111], v[204:207], v[68:71]
    v_exp_f32 v49, v49
    v_mfma_f32_16x16x32_bf16 v[68:71], v[112:115], v[208:211], v[68:71]
    v_exp_f32 v50, v50
    v_mfma_f32_16x16x32_bf16 v[68:71], v[116:119], v[212:215], v[68:71]
    s_waitcnt lgkmcnt(0)
    v_mfma_f32_16x16x32_bf16 a[0:3], v[120:123], v[40:43], a[0:3]
    v_exp_f32 v51, v51
    v_mfma_f32_16x16x32_bf16 a[4:7], v[124:127], v[40:43], a[4:7]
    v_cvt_pk_bf16_f32 v48, v48, v49
    v_cvt_pk_bf16_f32 v49, v50, v51
    v_mfma_f32_16x16x32_bf16 a[8:11], v[128:131], v[40:43], a[8:11]
    s_add_u32 m0, s58, 32768
    s_mov_b32 s65, 172032
    v_mfma_f32_16x16x32_bf16 a[12:15], v[132:135], v[40:43], a[12:15]
    s_waitcnt vmcnt(3)
    buffer_load_dwordx4 v1, s[28:31], s65 offen offset:0 nt lds
    v_mfma_f32_16x16x32_bf16 a[16:19], v[136:139], v[40:43], a[16:19]
    v_exp_f32 v52, v52
    v_mfma_f32_16x16x32_bf16 a[20:23], v[140:143], v[40:43], a[20:23]
    v_exp_f32 v53, v53
    v_mfma_f32_16x16x32_bf16 a[24:27], v[144:147], v[40:43], a[24:27]
    v_exp_f32 v54, v54
    v_mfma_f32_16x16x32_bf16 a[28:31], v[148:151], v[40:43], a[28:31]
    v_max3_f32 v6, v56, v57, v58
    v_max3_f32 v9, v64, v65, v66
    v_mfma_f32_16x16x32_bf16 a[192:195], a[216:219], v[40:43], a[192:195]
    v_max3_f32 v6, v6, v59, v60
    v_max3_f32 v9, v9, v67, v68
    v_mfma_f32_16x16x32_bf16 v[72:75], v[88:91], v[216:219], v[32:35]
    v_max3_f32 v6, v6, v61, v62
    v_max3_f32 v9, v9, v69, v70
    v_mfma_f32_16x16x32_bf16 v[72:75], v[92:95], v[220:223], v[72:75]
    v_max3_f32 v6, v6, v63, v71
    v_max_f32 v6, v6, v9
    v_mfma_f32_16x16x32_bf16 v[72:75], v[96:99], v[224:227], v[72:75]
    v_cmp_lt_f32 vcc, s61, v6
    v_mfma_f32_16x16x32_bf16 v[72:75], v[100:103], v[228:231], v[72:75]
    v_exp_f32 v55, v55
    v_mfma_f32_16x16x32_bf16 v[76:79], v[104:107], v[216:219], v[32:35]
    v_cvt_pk_bf16_f32 v50, v52, v53
    v_cvt_pk_bf16_f32 v51, v54, v55
    v_mfma_f32_16x16x32_bf16 v[76:79], v[108:111], v[220:223], v[76:79]
    s_cbranch_vccnz L_stub2_17
L_back2_17:
    v_mfma_f32_16x16x32_bf16 v[76:79], v[112:115], v[224:227], v[76:79]
    v_exp_f32 v56, v56
    v_mfma_f32_16x16x32_bf16 v[76:79], v[116:119], v[228:231], v[76:79]
    s_waitcnt vmcnt(3)
    buffer_load_dwordx4 v2, s[28:31], s65 offen offset:1024 nt lds
    v_mfma_f32_16x16x32_bf16 a[32:35], v[120:123], v[48:51], a[32:35]
    v_exp_f32 v57, v57
    v_mfma_f32_16x16x32_bf16 a[36:39], v[124:127], v[48:51], a[36:39]
    v_exp_f32 v58, v58
    v_mfma_f32_16x16x32_bf16 a[40:43], v[128:131], v[48:51], a[40:43]
    v_exp_f32 v59, v59
    v_mfma_f32_16x16x32_bf16 a[44:47], v[132:135], v[48:51], a[44:47]
    v_cvt_pk_bf16_f32 v56, v56, v57
    v_cvt_pk_bf16_f32 v57, v58, v59
    v_mfma_f32_16x16x32_bf16 a[48:51], v[136:139], v[48:51], a[48:51]
    v_exp_f32 v60, v60
    v_mfma_f32_16x16x32_bf16 a[52:55], v[140:143], v[48:51], a[52:55]
    v_exp_f32 v61, v61
    v_mfma_f32_16x16x32_bf16 a[56:59], v[144:147], v[48:51], a[56:59]
    v_exp_f32 v62, v62
    v_mfma_f32_16x16x32_bf16 a[60:63], v[148:151], v[48:51], a[60:63]
    v_exp_f32 v63, v63
    v_mfma_f32_16x16x32_bf16 a[196:199], a[216:219], v[48:51], a[196:199]
    v_cvt_pk_bf16_f32 v58, v60, v61
    v_cvt_pk_bf16_f32 v59, v62, v63
    s_barrier
    v_mfma_f32_16x16x32_bf16 v[80:83], v[88:91], v[232:235], v[36:39]
    v_exp_f32 v64, v64
    v_mfma_f32_16x16x32_bf16 v[80:83], v[92:95], v[236:239], v[80:83]
    ds_read_b128 v[88:91], v248 offset:32768
    ds_read_b128 v[92:95], v248 offset:33024
    v_mfma_f32_16x16x32_bf16 v[80:83], v[96:99], v[240:243], v[80:83]
    v_exp_f32 v65, v65
    v_mfma_f32_16x16x32_bf16 v[80:83], v[100:103], v[244:247], v[80:83]
    ds_read_b128 v[96:99], v248 offset:33280
    ds_read_b128 v[100:103], v248 offset:33536
    v_mfma_f32_16x16x32_bf16 v[84:87], v[104:107], v[232:235], v[36:39]
    s_waitcnt vmcnt(3)
    buffer_load_dwordx4 v1, s[28:31], s65 offen offset:2048 nt lds
    v_mfma_f32_16x16x32_bf16 v[84:87], v[108:111], v[236:239], v[84:87]
    ds_read_b128 v[104:107], v248 offset:36864
    ds_read_b128 v[108:111], v248 offset:37120
    v_mfma_f32_16x16x32_bf16 v[84:87], v[112:115], v[240:243], v[84:87]
    v_exp_f32 v66, v66
    v_mfma_f32_16x16x32_bf16 v[84:87], v[116:119], v[244:247], v[84:87]
    ds_read_b128 v[112:115], v248 offset:37376
    ds_read_b128 v[116:119], v248 offset:37632
    v_mfma_f32_16x16x32_bf16 a[64:67], v[120:123], v[56:59], a[64:67]
    v_exp_f32 v67, v67
    v_mfma_f32_16x16x32_bf16 a[68:71], v[124:127], v[56:59], a[68:71]
    v_cvt_pk_bf16_f32 v64, v64, v65
    v_cvt_pk_bf16_f32 v65, v66, v67
    v_mfma_f32_16x16x32_bf16 a[72:75], v[128:131], v[56:59], a[72:75]
    v_exp_f32 v68, v68
    v_mfma_f32_16x16x32_bf16 a[76:79], v[132:135], v[56:59], a[76:79]
    v_exp_f32 v69, v69
    v_mfma_f32_16x16x32_bf16 a[80:83], v[136:139], v[56:59], a[80:83]
    v_exp_f32 v70, v70
    v_mfma_f32_16x16x32_bf16 a[84:87], v[140:143], v[56:59], a[84:87]
    v_max3_f32 v6, v72, v73, v74
    v_max3_f32 v9, v80, v81, v82
    v_mfma_f32_16x16x32_bf16 a[88:91], v[144:147], v[56:59], a[88:91]
    v_max3_f32 v6, v6, v75, v76
    v_max3_f32 v9, v9, v83, v84
    v_mfma_f32_16x16x32_bf16 a[92:95], v[148:151], v[56:59], a[92:95]
    v_max3_f32 v6, v6, v77, v78
    v_max3_f32 v9, v9, v85, v86
    v_mfma_f32_16x16x32_bf16 a[200:203], a[216:219], v[56:59], a[200:203]
    s_waitcnt lgkmcnt(0)
    v_mfma_f32_16x16x32_bf16 v[40:43], v[88:91], v[152:155], v[16:19]
    s_waitcnt vmcnt(3)
    buffer_load_dwordx4 v2, s[28:31], s65 offen offset:3072 nt lds
    v_mfma_f32_16x16x32_bf16 v[40:43], v[92:95], v[156:159], v[40:43]
    v_max3_f32 v6, v6, v79, v87
    v_max_f32 v6, v6, v9
    v_mfma_f32_16x16x32_bf16 v[40:43], v[96:99], v[160:163], v[40:43]
    v_cmp_lt_f32 vcc, s61, v6
    v_mfma_f32_16x16x32_bf16 v[40:43], v[100:103], v[164:167], v[40:43]
    v_exp_f32 v71, v71
    v_mfma_f32_16x16x32_bf16 v[44:47], v[104:107], v[152:155], v[16:19]
    v_cvt_pk_bf16_f32 v66, v68, v69
    v_cvt_pk_bf16_f32 v67, v70, v71
    v_mfma_f32_16x16x32_bf16 v[44:47], v[108:111], v[156:159], v[44:47]
    s_cbranch_vccnz L_stub4_18
L_back4_18:
    v_mfma_f32_16x16x32_bf16 v[44:47], v[112:115], v[160:163], v[44:47]
    v_exp_f32 v72, v72
    v_mfma_f32_16x16x32_bf16 v[44:47], v[116:119], v[164:167], v[44:47]
    v_exp_f32 v73, v73
    v_mfma_f32_16x16x32_bf16 a[96:99], v[120:123], v[64:67], a[96:99]
    v_exp_f32 v74, v74
    v_mfma_f32_16x16x32_bf16 a[100:103], v[124:127], v[64:67], a[100:103]
    v_exp_f32 v75, v75
    v_mfma_f32_16x16x32_bf16 a[104:107], v[128:131], v[64:67], a[104:107]
    v_cvt_pk_bf16_f32 v72, v72, v73
    v_cvt_pk_bf16_f32 v73, v74, v75
    v_mfma_f32_16x16x32_bf16 a[108:111], v[132:135], v[64:67], a[108:111]
    v_exp_f32 v76, v76
    v_mfma_f32_16x16x32_bf16 a[112:115], v[136:139], v[64:67], a[112:115]
    v_exp_f32 v77, v77
    v_mfma_f32_16x16x32_bf16 a[116:119], v[140:143], v[64:67], a[116:119]
    s_add_u32 m0, s58, 40960
    v_mfma_f32_16x16x32_bf16 a[120:123], v[144:147], v[64:67], a[120:123]
    s_waitcnt vmcnt(3)
    buffer_load_dwordx4 v1, s[4:7], s65 offen offset:0 nt lds
    v_mfma_f32_16x16x32_bf16 a[124:127], v[148:151], v[64:67], a[124:127]
    v_exp_f32 v78, v78
    v_mfma_f32_16x16x32_bf16 a[204:207], a[216:219], v[64:67], a[204:207]
    v_exp_f32 v79, v79
    v_mfma_f32_16x16x32_bf16 v[48:51], v[88:91], v[168:171], v[20:23]
    v_cvt_pk_bf16_f32 v74, v76, v77
    v_cvt_pk_bf16_f32 v75, v78, v79
    v_mfma_f32_16x16x32_bf16 v[48:51], v[92:95], v[172:175], v[48:51]
    v_exp_f32 v80, v80
    v_mfma_f32_16x16x32_bf16 v[48:51], v[96:99], v[176:179], v[48:51]
    v_exp_f32 v81, v81
    v_mfma_f32_16x16x32_bf16 v[48:51], v[100:103], v[180:183], v[48:51]
    v_exp_f32 v82, v82
    v_mfma_f32_16x16x32_bf16 v[52:55], v[104:107], v[168:171], v[20:23]
    v_exp_f32 v83, v83
    v_mfma_f32_16x16x32_bf16 v[52:55], v[108:111], v[172:175], v[52:55]
    v_cvt_pk_bf16_f32 v80, v80, v81
    v_cvt_pk_bf16_f32 v81, v82, v83
    v_mfma_f32_16x16x32_bf16 v[52:55], v[112:115], v[176:179], v[52:55]
    v_exp_f32 v84, v84
    v_mfma_f32_16x16x32_bf16 v[52:55], v[116:119], v[180:183], v[52:55]
    v_exp_f32 v85, v85
    v_mfma_f32_16x16x32_bf16 a[128:131], v[120:123], v[72:75], a[128:131]
    v_exp_f32 v86, v86
    v_mfma_f32_16x16x32_bf16 a[132:135], v[124:127], v[72:75], a[132:135]
    s_waitcnt vmcnt(3)
    buffer_load_dwordx4 v2, s[4:7], s65 offen offset:1024 nt lds
    v_mfma_f32_16x16x32_bf16 a[136:139], v[128:131], v[72:75], a[136:139]
    v_max3_f32 v6, v40, v41, v42
    v_max3_f32 v9, v48, v49, v50
    v_mfma_f32_16x16x32_bf16 a[140:143], v[132:135], v[72:75], a[140:143]
    v_max3_f32 v6, v6, v43, v44
    v_max3_f32 v9, v9, v51, v52
    v_mfma_f32_16x16x32_bf16 a[144:147], v[136:139], v[72:75], a[144:147]
    v_max3_f32 v6, v6, v45, v46
    v_max3_f32 v9, v9, v53, v54
    v_mfma_f32_16x16x32_bf16 a[148:151], v[140:143], v[72:75], a[148:151]
    v_max3_f32 v6, v6, v47, v55
    v_max_f32 v6, v6, v9
    v_mfma_f32_16x16x32_bf16 a[152:155], v[144:147], v[72:75], a[152:155]
    v_cmp_lt_f32 vcc, s61, v6
    v_mfma_f32_16x16x32_bf16 a[156:159], v[148:151], v[72:75], a[156:159]
    v_exp_f32 v87, v87
    v_mfma_f32_16x16x32_bf16 a[208:211], a[216:219], v[72:75], a[208:211]
    v_cvt_pk_bf16_f32 v82, v84, v85
    v_cvt_pk_bf16_f32 v83, v86, v87
    v_mfma_f32_16x16x32_bf16 v[56:59], v[88:91], v[184:187], v[24:27]
    s_cbranch_vccnz L_stub0_18
L_back0_18:
    v_mfma_f32_16x16x32_bf16 v[56:59], v[92:95], v[188:191], v[56:59]
    v_exp_f32 v40, v40
    v_mfma_f32_16x16x32_bf16 v[56:59], v[96:99], v[192:195], v[56:59]
    v_exp_f32 v41, v41
    v_mfma_f32_16x16x32_bf16 v[56:59], v[100:103], v[196:199], v[56:59]
    v_exp_f32 v42, v42
    v_mfma_f32_16x16x32_bf16 v[60:63], v[104:107], v[184:187], v[24:27]
    v_exp_f32 v43, v43
    v_mfma_f32_16x16x32_bf16 v[60:63], v[108:111], v[188:191], v[60:63]
    s_waitcnt vmcnt(3)
    buffer_load_dwordx4 v1, s[4:7], s65 offen offset:2048 nt lds
    v_mfma_f32_16x16x32_bf16 v[60:63], v[112:115], v[192:195], v[60:63]
    v_cvt_pk_bf16_f32 v40, v40, v41
    v_cvt_pk_bf16_f32 v41, v42, v43
    v_mfma_f32_16x16x32_bf16 v[60:63], v[116:119], v[196:199], v[60:63]
    v_exp_f32 v44, v44
    v_mfma_f32_16x16x32_bf16 a[160:163], v[120:123], v[80:83], a[160:163]
    ds_read_b64_tr_b16 v[120:121], v249 offset:32768
    ds_read_b64_tr_b16 v[122:123], v249 offset:36864
    v_mfma_f32_16x16x32_bf16 a[164:167], v[124:127], v[80:83], a[164:167]
    ds_read_b64_tr_b16 v[124:125], v250 offset:32768
    ds_read_b64_tr_b16 v[126:127], v250 offset:36864
    v_mfma_f32_16x16x32_bf16 a[168:171], v[128:131], v[80:83], a[168:171]
    ds_read_b64_tr_b16 v[128:129], v249 offset:33024
    ds_read_b64_tr_b16 v[130:131], v249 offset:37120
    v_mfma_f32_16x16x32_bf16 a[172:175], v[132:135], v[80:83], a[172:175]
    ds_read_b64_tr_b16 v[132:133], v250 offset:33024
    ds_read_b64_tr_b16 v[134:135], v250 offset:37120
    v_mfma_f32_16x16x32_bf16 a[176:179], v[136:139], v[80:83], a[176:179]
    ds_read_b64_tr_b16 v[136:137], v249 offset:33280
    ds_read_b64_tr_b16 v[138:139], v249 offset:37376
    v_mfma_f32_16x16x32_bf16 a[180:183], v[140:143], v[80:83], a[180:183]
    ds_read_b64_tr_b16 v[140:141], v250 offset:33280
    ds_read_b64_tr_b16 v[142:143], v250 offset:37376
    v_mfma_f32_16x16x32_bf16 a[184:187], v[144:147], v[80:83], a[184:187]
    ds_read_b64_tr_b16 v[144:145], v249 offset:33536
    ds_read_b64_tr_b16 v[146:147], v249 offset:37632
    v_mfma_f32_16x16x32_bf16 a[188:191], v[148:151], v[80:83], a[188:191]
    ds_read_b64_tr_b16 v[148:149], v250 offset:33536
    ds_read_b64_tr_b16 v[150:151], v250 offset:37632
    v_mfma_f32_16x16x32_bf16 a[212:215], a[216:219], v[80:83], a[212:215]
    v_exp_f32 v45, v45
    v_mfma_f32_16x16x32_bf16 v[64:67], v[88:91], v[200:203], v[28:31]
    v_exp_f32 v46, v46
    v_mfma_f32_16x16x32_bf16 v[64:67], v[92:95], v[204:207], v[64:67]
    v_exp_f32 v47, v47
    v_mfma_f32_16x16x32_bf16 v[64:67], v[96:99], v[208:211], v[64:67]
    s_waitcnt vmcnt(3)
    buffer_load_dwordx4 v2, s[4:7], s65 offen offset:3072 nt lds
    v_mfma_f32_16x16x32_bf16 v[64:67], v[100:103], v[212:215], v[64:67]
    v_cvt_pk_bf16_f32 v42, v44, v45
    v_cvt_pk_bf16_f32 v43, v46, v47
    v_mfma_f32_16x16x32_bf16 v[68:71], v[104:107], v[200:203], v[28:31]
    v_exp_f32 v48, v48
    v_mfma_f32_16x16x32_bf16 v[68:71], v[108:111], v[204:207], v[68:71]
    v_exp_f32 v49, v49
    v_mfma_f32_16x16x32_bf16 v[68:71], v[112:115], v[208:211], v[68:71]
    v_exp_f32 v50, v50
    v_mfma_f32_16x16x32_bf16 v[68:71], v[116:119], v[212:215], v[68:71]
    s_waitcnt lgkmcnt(0)
    v_mfma_f32_16x16x32_bf16 a[0:3], v[120:123], v[40:43], a[0:3]
    v_exp_f32 v51, v51
    v_mfma_f32_16x16x32_bf16 a[4:7], v[124:127], v[40:43], a[4:7]
    v_cvt_pk_bf16_f32 v48, v48, v49
    v_cvt_pk_bf16_f32 v49, v50, v51
    v_mfma_f32_16x16x32_bf16 a[8:11], v[128:131], v[40:43], a[8:11]
    v_exp_f32 v52, v52
    v_mfma_f32_16x16x32_bf16 a[12:15], v[132:135], v[40:43], a[12:15]
    v_exp_f32 v53, v53
    v_mfma_f32_16x16x32_bf16 a[16:19], v[136:139], v[40:43], a[16:19]
    v_exp_f32 v54, v54
    v_mfma_f32_16x16x32_bf16 a[20:23], v[140:143], v[40:43], a[20:23]
    v_max3_f32 v6, v56, v57, v58
    v_max3_f32 v9, v64, v65, v66
    v_mfma_f32_16x16x32_bf16 a[24:27], v[144:147], v[40:43], a[24:27]
    v_max3_f32 v6, v6, v59, v60
    v_max3_f32 v9, v9, v67, v68
    v_mfma_f32_16x16x32_bf16 a[28:31], v[148:151], v[40:43], a[28:31]
    s_add_u32 m0, s58, 65536
    s_mov_b32 s65, 180224
    v_mfma_f32_16x16x32_bf16 a[192:195], a[216:219], v[40:43], a[192:195]
    s_waitcnt vmcnt(3)
    buffer_load_dwordx4 v1, s[28:31], s65 offen offset:0 nt lds
    v_mfma_f32_16x16x32_bf16 v[72:75], v[88:91], v[216:219], v[32:35]
    v_max3_f32 v6, v6, v61, v62
    v_max3_f32 v9, v9, v69, v70
    v_mfma_f32_16x16x32_bf16 v[72:75], v[92:95], v[220:223], v[72:75]
    v_max3_f32 v6, v6, v63, v71
    v_max_f32 v6, v6, v9
    v_mfma_f32_16x16x32_bf16 v[72:75], v[96:99], v[224:227], v[72:75]
    v_cmp_lt_f32 vcc, s61, v6
    v_mfma_f32_16x16x32_bf16 v[72:75], v[100:103], v[228:231], v[72:75]
    v_exp_f32 v55, v55
    v_mfma_f32_16x16x32_bf16 v[76:79], v[104:107], v[216:219], v[32:35]
    v_cvt_pk_bf16_f32 v50, v52, v53
    v_cvt_pk_bf16_f32 v51, v54, v55
    v_mfma_f32_16x16x32_bf16 v[76:79], v[108:111], v[220:223], v[76:79]
    s_cbranch_vccnz L_stub2_18
L_back2_18:
    v_mfma_f32_16x16x32_bf16 v[76:79], v[112:115], v[224:227], v[76:79]
    v_exp_f32 v56, v56
    v_mfma_f32_16x16x32_bf16 v[76:79], v[116:119], v[228:231], v[76:79]
    v_exp_f32 v57, v57
    v_mfma_f32_16x16x32_bf16 a[32:35], v[120:123], v[48:51], a[32:35]
    v_exp_f32 v58, v58
    v_mfma_f32_16x16x32_bf16 a[36:39], v[124:127], v[48:51], a[36:39]
    v_exp_f32 v59, v59
    v_mfma_f32_16x16x32_bf16 a[40:43], v[128:131], v[48:51], a[40:43]
    v_cvt_pk_bf16_f32 v56, v56, v57
    v_cvt_pk_bf16_f32 v57, v58, v59
    v_mfma_f32_16x16x32_bf16 a[44:47], v[132:135], v[48:51], a[44:47]
    s_waitcnt vmcnt(3)
    buffer_load_dwordx4 v2, s[28:31], s65 offen offset:1024 nt lds
    v_mfma_f32_16x16x32_bf16 a[48:51], v[136:139], v[48:51], a[48:51]
    v_exp_f32 v60, v60
    v_mfma_f32_16x16x32_bf16 a[52:55], v[140:143], v[48:51], a[52:55]
    v_exp_f32 v61, v61
    v_mfma_f32_16x16x32_bf16 a[56:59], v[144:147], v[48:51], a[56:59]
    v_exp_f32 v62, v62
    v_mfma_f32_16x16x32_bf16 a[60:63], v[148:151], v[48:51], a[60:63]
    v_exp_f32 v63, v63
    v_mfma_f32_16x16x32_bf16 a[196:199], a[216:219], v[48:51], a[196:199]
    v_cvt_pk_bf16_f32 v58, v60, v61
    v_cvt_pk_bf16_f32 v59, v62, v63
    s_barrier
    v_mfma_f32_16x16x32_bf16 v[80:83], v[88:91], v[232:235], v[36:39]
    v_exp_f32 v64, v64
    v_mfma_f32_16x16x32_bf16 v[80:83], v[92:95], v[236:239], v[80:83]
    ds_read_b128 v[88:91], v251 offset:0
    ds_read_b128 v[92:95], v251 offset:256
    v_mfma_f32_16x16x32_bf16 v[80:83], v[96:99], v[240:243], v[80:83]
    v_exp_f32 v65, v65
    v_mfma_f32_16x16x32_bf16 v[80:83], v[100:103], v[244:247], v[80:83]
    ds_read_b128 v[96:99], v251 offset:512
    ds_read_b128 v[100:103], v251 offset:768
    v_mfma_f32_16x16x32_bf16 v[84:87], v[104:107], v[232:235], v[36:39]
    v_exp_f32 v66, v66
    v_mfma_f32_16x16x32_bf16 v[84:87], v[108:111], v[236:239], v[84:87]
    ds_read_b128 v[104:107], v251 offset:4096
    ds_read_b128 v[108:111], v251 offset:4352
    v_mfma_f32_16x16x32_bf16 v[84:87], v[112:115], v[240:243], v[84:87]
    v_exp_f32 v67, v67
    v_mfma_f32_16x16x32_bf16 v[84:87], v[116:119], v[244:247], v[84:87]
    ds_read_b128 v[112:115], v251 offset:4608
    ds_read_b128 v[116:119], v251 offset:4864
    v_mfma_f32_16x16x32_bf16 a[64:67], v[120:123], v[56:59], a[64:67]
    s_waitcnt vmcnt(3)
    buffer_load_dwordx4 v1, s[28:31], s65 offen offset:2048 nt lds
    v_mfma_f32_16x16x32_bf16 a[68:71], v[124:127], v[56:59], a[68:71]
    v_cvt_pk_bf16_f32 v64, v64, v65
    v_cvt_pk_bf16_f32 v65, v66, v67
    v_mfma_f32_16x16x32_bf16 a[72:75], v[128:131], v[56:59], a[72:75]
    v_exp_f32 v68, v68
    v_mfma_f32_16x16x32_bf16 a[76:79], v[132:135], v[56:59], a[76:79]
    v_exp_f32 v69, v69
    v_mfma_f32_16x16x32_bf16 a[80:83], v[136:139], v[56:59], a[80:83]
    v_exp_f32 v70, v70
    v_mfma_f32_16x16x32_bf16 a[84:87], v[140:143], v[56:59], a[84:87]
    v_max3_f32 v6, v72, v73, v74
    v_max3_f32 v9, v80, v81, v82
    v_mfma_f32_16x16x32_bf16 a[88:91], v[144:147], v[56:59], a[88:91]
    v_max3_f32 v6, v6, v75, v76
    v_max3_f32 v9, v9, v83, v84
    v_mfma_f32_16x16x32_bf16 a[92:95], v[148:151], v[56:59], a[92:95]
    v_max3_f32 v6, v6, v77, v78
    v_max3_f32 v9, v9, v85, v86
    v_mfma_f32_16x16x32_bf16 a[200:203], a[216:219], v[56:59], a[200:203]
    s_waitcnt lgkmcnt(0)
    v_mfma_f32_16x16x32_bf16 v[40:43], v[88:91], v[152:155], v[16:19]
    v_max3_f32 v6, v6, v79, v87
    v_max_f32 v6, v6, v9
    v_mfma_f32_16x16x32_bf16 v[40:43], v[92:95], v[156:159], v[40:43]
    v_cmp_lt_f32 vcc, s61, v6
    v_mfma_f32_16x16x32_bf16 v[40:43], v[96:99], v[160:163], v[40:43]
    v_exp_f32 v71, v71
    v_mfma_f32_16x16x32_bf16 v[40:43], v[100:103], v[164:167], v[40:43]
    v_cvt_pk_bf16_f32 v66, v68, v69
    v_cvt_pk_bf16_f32 v67, v70, v71
    v_mfma_f32_16x16x32_bf16 v[44:47], v[104:107], v[152:155], v[16:19]
    s_waitcnt vmcnt(3)
    buffer_load_dwordx4 v2, s[28:31], s65 offen offset:3072 nt lds
    v_mfma_f32_16x16x32_bf16 v[44:47], v[108:111], v[156:159], v[44:47]
    s_cbranch_vccnz L_stub4_19
L_back4_19:
    v_mfma_f32_16x16x32_bf16 v[44:47], v[112:115], v[160:163], v[44:47]
    v_exp_f32 v72, v72
    v_mfma_f32_16x16x32_bf16 v[44:47], v[116:119], v[164:167], v[44:47]
    v_exp_f32 v73, v73
    v_mfma_f32_16x16x32_bf16 a[96:99], v[120:123], v[64:67], a[96:99]
    v_exp_f32 v74, v74
    v_mfma_f32_16x16x32_bf16 a[100:103], v[124:127], v[64:67], a[100:103]
    v_exp_f32 v75, v75
    v_mfma_f32_16x16x32_bf16 a[104:107], v[128:131], v[64:67], a[104:107]
    v_cvt_pk_bf16_f32 v72, v72, v73
    v_cvt_pk_bf16_f32 v73, v74, v75
    v_mfma_f32_16x16x32_bf16 a[108:111], v[132:135], v[64:67], a[108:111]
    v_exp_f32 v76, v76
    v_mfma_f32_16x16x32_bf16 a[112:115], v[136:139], v[64:67], a[112:115]
    v_exp_f32 v77, v77
    v_mfma_f32_16x16x32_bf16 a[116:119], v[140:143], v[64:67], a[116:119]
    v_exp_f32 v78, v78
    v_mfma_f32_16x16x32_bf16 a[120:123], v[144:147], v[64:67], a[120:123]
    v_exp_f32 v79, v79
    v_mfma_f32_16x16x32_bf16 a[124:127], v[148:151], v[64:67], a[124:127]
    v_cvt_pk_bf16_f32 v74, v76, v77
    v_cvt_pk_bf16_f32 v75, v78, v79
    v_mfma_f32_16x16x32_bf16 a[204:207], a[216:219], v[64:67], a[204:207]
    v_exp_f32 v80, v80
    v_mfma_f32_16x16x32_bf16 v[48:51], v[88:91], v[168:171], v[20:23]
    v_exp_f32 v81, v81
    v_mfma_f32_16x16x32_bf16 v[48:51], v[92:95], v[172:175], v[48:51]
    s_add_u32 m0, s58, 73728
    v_mfma_f32_16x16x32_bf16 v[48:51], v[96:99], v[176:179], v[48:51]
    s_waitcnt vmcnt(3)
    buffer_load_dwordx4 v1, s[4:7], s65 offen offset:0 nt lds
    v_mfma_f32_16x16x32_bf16 v[48:51], v[100:103], v[180:183], v[48:51]
    v_exp_f32 v82, v82
    v_mfma_f32_16x16x32_bf16 v[52:55], v[104:107], v[168:171], v[20:23]
    v_exp_f32 v83, v83
    v_mfma_f32_16x16x32_bf16 v[52:55], v[108:111], v[172:175], v[52:55]
    v_cvt_pk_bf16_f32 v80, v80, v81
    v_cvt_pk_bf16_f32 v81, v82, v83
    v_mfma_f32_16x16x32_bf16 v[52:55], v[112:115], v[176:179], v[52:55]
    v_exp_f32 v84, v84
    v_mfma_f32_16x16x32_bf16 v[52:55], v[116:119], v[180:183], v[52:55]
    v_exp_f32 v85, v85
    v_mfma_f32_16x16x32_bf16 a[128:131], v[120:123], v[72:75], a[128:131]
    v_exp_f32 v86, v86
    v_mfma_f32_16x16x32_bf16 a[132:135], v[124:127], v[72:75], a[132:135]
    v_mfma_f32_16x16x32_bf16 a[136:139], v[128:131], v[72:75], a[136:139]
    v_max3_f32 v6, v40, v41, v42
    v_max3_f32 v9, v48, v49, v50
    v_mfma_f32_16x16x32_bf16 a[140:143], v[132:135], v[72:75], a[140:143]
    v_max3_f32 v6, v6, v43, v44
    v_max3_f32 v9, v9, v51, v52
    v_mfma_f32_16x16x32_bf16 a[144:147], v[136:139], v[72:75], a[144:147]
    v_max3_f32 v6, v6, v45, v46
    v_max3_f32 v9, v9, v53, v54
    v_mfma_f32_16x16x32_bf16 a[148:151], v[140:143], v[72:75], a[148:151]
    v_max3_f32 v6, v6, v47, v55
    v_max_f32 v6, v6, v9
    v_mfma_f32_16x16x32_bf16 a[152:155], v[144:147], v[72:75], a[152:155]
    s_waitcnt vmcnt(3)
    buffer_load_dwordx4 v2, s[4:7], s65 offen offset:1024 nt lds
    v_mfma_f32_16x16x32_bf16 a[156:159], v[148:151], v[72:75], a[156:159]
    v_cmp_lt_f32 vcc, s61, v6
    v_mfma_f32_16x16x32_bf16 a[208:211], a[216:219], v[72:75], a[208:211]
    v_exp_f32 v87, v87
    v_mfma_f32_16x16x32_bf16 v[56:59], v[88:91], v[184:187], v[24:27]
    v_cvt_pk_bf16_f32 v82, v84, v85
    v_cvt_pk_bf16_f32 v83, v86, v87
    v_mfma_f32_16x16x32_bf16 v[56:59], v[92:95], v[188:191], v[56:59]
    s_cbranch_vccnz L_stub0_19
L_back0_19:
    v_mfma_f32_16x16x32_bf16 v[56:59], v[96:99], v[192:195], v[56:59]
    v_exp_f32 v40, v40
    v_mfma_f32_16x16x32_bf16 v[56:59], v[100:103], v[196:199], v[56:59]
    v_exp_f32 v41, v41
    v_mfma_f32_16x16x32_bf16 v[60:63], v[104:107], v[184:187], v[24:27]
    v_exp_f32 v42, v42
    v_mfma_f32_16x16x32_bf16 v[60:63], v[108:111], v[188:191], v[60:63]
    v_exp_f32 v43, v43
    v_mfma_f32_16x16x32_bf16 v[60:63], v[112:115], v[192:195], v[60:63]
    v_cvt_pk_bf16_f32 v40, v40, v41
    v_cvt_pk_bf16_f32 v41, v42, v43
    v_mfma_f32_16x16x32_bf16 v[60:63], v[116:119], v[196:199], v[60:63]
    v_exp_f32 v44, v44
    v_mfma_f32_16x16x32_bf16 a[160:163], v[120:123], v[80:83], a[160:163]
    ds_read_b64_tr_b16 v[120:121], v252 offset:0
    ds_read_b64_tr_b16 v[122:123], v252 offset:4096
    v_mfma_f32_16x16x32_bf16 a[164:167], v[124:127], v[80:83], a[164:167]
    ds_read_b64_tr_b16 v[124:125], v253 offset:0
    ds_read_b64_tr_b16 v[126:127], v253 offset:4096
    v_mfma_f32_16x16x32_bf16 a[168:171], v[128:131], v[80:83], a[168:171]
    ds_read_b64_tr_b16 v[128:129], v252 offset:256
    ds_read_b64_tr_b16 v[130:131], v252 offset:4352
    v_mfma_f32_16x16x32_bf16 a[172:175], v[132:135], v[80:83], a[172:175]
    ds_read_b64_tr_b16 v[132:133], v253 offset:256
    ds_read_b64_tr_b16 v[134:135], v253 offset:4352
    v_mfma_f32_16x16x32_bf16 a[176:179], v[136:139], v[80:83], a[176:179]
    ds_read_b64_tr_b16 v[136:137], v252 offset:512
    ds_read_b64_tr_b16 v[138:139], v252 offset:4608
    v_mfma_f32_16x16x32_bf16 a[180:183], v[140:143], v[80:83], a[180:183]
    ds_read_b64_tr_b16 v[140:141], v253 offset:512
    ds_read_b64_tr_b16 v[142:143], v253 offset:4608
    v_mfma_f32_16x16x32_bf16 a[184:187], v[144:147], v[80:83], a[184:187]
    ds_read_b64_tr_b16 v[144:145], v252 offset:768
    ds_read_b64_tr_b16 v[146:147], v252 offset:4864
    v_mfma_f32_16x16x32_bf16 a[188:191], v[148:151], v[80:83], a[188:191]
    ds_read_b64_tr_b16 v[148:149], v253 offset:768
    ds_read_b64_tr_b16 v[150:151], v253 offset:4864
    v_mfma_f32_16x16x32_bf16 a[212:215], a[216:219], v[80:83], a[212:215]
    s_waitcnt vmcnt(3)
    buffer_load_dwordx4 v1, s[4:7], s65 offen offset:2048 nt lds
    v_mfma_f32_16x16x32_bf16 v[64:67], v[88:91], v[200:203], v[28:31]
    v_exp_f32 v45, v45
    v_mfma_f32_16x16x32_bf16 v[64:67], v[92:95], v[204:207], v[64:67]
    v_exp_f32 v46, v46
    v_mfma_f32_16x16x32_bf16 v[64:67], v[96:99], v[208:211], v[64:67]
    v_exp_f32 v47, v47
    v_mfma_f32_16x16x32_bf16 v[64:67], v[100:103], v[212:215], v[64:67]
    v_cvt_pk_bf16_f32 v42, v44, v45
    v_cvt_pk_bf16_f32 v43, v46, v47
    v_mfma_f32_16x16x32_bf16 v[68:71], v[104:107], v[200:203], v[28:31]
    v_exp_f32 v48, v48
    v_mfma_f32_16x16x32_bf16 v[68:71], v[108:111], v[204:207], v[68:71]
    v_exp_f32 v49, v49
    v_mfma_f32_16x16x32_bf16 v[68:71], v[112:115], v[208:211], v[68:71]
    v_exp_f32 v50, v50
    v_mfma_f32_16x16x32_bf16 v[68:71], v[116:119], v[212:215], v[68:71]
    s_waitcnt lgkmcnt(0)
    v_mfma_f32_16x16x32_bf16 a[0:3], v[120:123], v[40:43], a[0:3]
    s_waitcnt vmcnt(3)
    buffer_load_dwordx4 v2, s[4:7], s65 offen offset:3072 nt lds
    v_mfma_f32_16x16x32_bf16 a[4:7], v[124:127], v[40:43], a[4:7]
    v_exp_f32 v51, v51
    v_mfma_f32_16x16x32_bf16 a[8:11], v[128:131], v[40:43], a[8:11]
    v_cvt_pk_bf16_f32 v48, v48, v49
    v_cvt_pk_bf16_f32 v49, v50, v51
    v_mfma_f32_16x16x32_bf16 a[12:15], v[132:135], v[40:43], a[12:15]
    v_exp_f32 v52, v52
    v_mfma_f32_16x16x32_bf16 a[16:19], v[136:139], v[40:43], a[16:19]
    v_exp_f32 v53, v53
    v_mfma_f32_16x16x32_bf16 a[20:23], v[140:143], v[40:43], a[20:23]
    v_exp_f32 v54, v54
    v_mfma_f32_16x16x32_bf16 a[24:27], v[144:147], v[40:43], a[24:27]
    v_max3_f32 v6, v56, v57, v58
    v_max3_f32 v9, v64, v65, v66
    v_mfma_f32_16x16x32_bf16 a[28:31], v[148:151], v[40:43], a[28:31]
    v_max3_f32 v6, v6, v59, v60
    v_max3_f32 v9, v9, v67, v68
    v_mfma_f32_16x16x32_bf16 a[192:195], a[216:219], v[40:43], a[192:195]
    v_max3_f32 v6, v6, v61, v62
    v_max3_f32 v9, v9, v69, v70
    v_mfma_f32_16x16x32_bf16 v[72:75], v[88:91], v[216:219], v[32:35]
    v_max3_f32 v6, v6, v63, v71
    v_max_f32 v6, v6, v9
    v_mfma_f32_16x16x32_bf16 v[72:75], v[92:95], v[220:223], v[72:75]
    v_cmp_lt_f32 vcc, s61, v6
    v_mfma_f32_16x16x32_bf16 v[72:75], v[96:99], v[224:227], v[72:75]
    v_exp_f32 v55, v55
    v_mfma_f32_16x16x32_bf16 v[72:75], v[100:103], v[228:231], v[72:75]
    s_add_u32 m0, s58, 98304
    s_mov_b32 s65, 188416
    v_mfma_f32_16x16x32_bf16 v[76:79], v[104:107], v[216:219], v[32:35]
    s_waitcnt vmcnt(3)
    buffer_load_dwordx4 v1, s[28:31], s65 offen offset:0 nt lds
    v_mfma_f32_16x16x32_bf16 v[76:79], v[108:111], v[220:223], v[76:79]
    v_cvt_pk_bf16_f32 v50, v52, v53
    v_cvt_pk_bf16_f32 v51, v54, v55
    v_mfma_f32_16x16x32_bf16 v[76:79], v[112:115], v[224:227], v[76:79]
    s_cbranch_vccnz L_stub2_19
L_back2_19:
    v_mfma_f32_16x16x32_bf16 v[76:79], v[116:119], v[228:231], v[76:79]
    v_exp_f32 v56, v56
    v_mfma_f32_16x16x32_bf16 a[32:35], v[120:123], v[48:51], a[32:35]
    v_exp_f32 v57, v57
    v_mfma_f32_16x16x32_bf16 a[36:39], v[124:127], v[48:51], a[36:39]
    v_exp_f32 v58, v58
    v_mfma_f32_16x16x32_bf16 a[40:43], v[128:131], v[48:51], a[40:43]
    v_exp_f32 v59, v59
    v_mfma_f32_16x16x32_bf16 a[44:47], v[132:135], v[48:51], a[44:47]
    v_cvt_pk_bf16_f32 v56, v56, v57
    v_cvt_pk_bf16_f32 v57, v58, v59
    v_mfma_f32_16x16x32_bf16 a[48:51], v[136:139], v[48:51], a[48:51]
    v_exp_f32 v60, v60
    v_mfma_f32_16x16x32_bf16 a[52:55], v[140:143], v[48:51], a[52:55]
    v_exp_f32 v61, v61
    v_mfma_f32_16x16x32_bf16 a[56:59], v[144:147], v[48:51], a[56:59]
    v_exp_f32 v62, v62
    v_mfma_f32_16x16x32_bf16 a[60:63], v[148:151], v[48:51], a[60:63]
    v_exp_f32 v63, v63
    v_mfma_f32_16x16x32_bf16 a[196:199], a[216:219], v[48:51], a[196:199]
    s_waitcnt vmcnt(3)
    buffer_load_dwordx4 v2, s[28:31], s65 offen offset:1024 nt lds
    v_cvt_pk_bf16_f32 v58, v60, v61
    v_cvt_pk_bf16_f32 v59, v62, v63
    s_barrier
    v_mfma_f32_16x16x32_bf16 v[80:83], v[88:91], v[232:235], v[36:39]
    v_exp_f32 v64, v64
    v_mfma_f32_16x16x32_bf16 v[80:83], v[92:95], v[236:239], v[80:83]
    ds_read_b128 v[88:91], v3 offset:0
    ds_read_b128 v[92:95], v3 offset:256
    v_mfma_f32_16x16x32_bf16 v[80:83], v[96:99], v[240:243], v[80:83]
    v_exp_f32 v65, v65
    v_mfma_f32_16x16x32_bf16 v[80:83], v[100:103], v[244:247], v[80:83]
    ds_read_b128 v[96:99], v3 offset:512
    ds_read_b128 v[100:103], v3 offset:768
    v_mfma_f32_16x16x32_bf16 v[84:87], v[104:107], v[232:235], v[36:39]
    v_exp_f32 v66, v66
    v_mfma_f32_16x16x32_bf16 v[84:87], v[108:111], v[236:239], v[84:87]
    ds_read_b128 v[104:107], v3 offset:4096
    ds_read_b128 v[108:111], v3 offset:4352
    v_mfma_f32_16x16x32_bf16 v[84:87], v[112:115], v[240:243], v[84:87]
    v_exp_f32 v67, v67
    v_mfma_f32_16x16x32_bf16 v[84:87], v[116:119], v[244:247], v[84:87]
    ds_read_b128 v[112:115], v3 offset:4608
    ds_read_b128 v[116:119], v3 offset:4864
    v_mfma_f32_16x16x32_bf16 a[64:67], v[120:123], v[56:59], a[64:67]
    v_cvt_pk_bf16_f32 v64, v64, v65
    v_cvt_pk_bf16_f32 v65, v66, v67
    v_mfma_f32_16x16x32_bf16 a[68:71], v[124:127], v[56:59], a[68:71]
    v_exp_f32 v68, v68
    v_mfma_f32_16x16x32_bf16 a[72:75], v[128:131], v[56:59], a[72:75]
    v_exp_f32 v69, v69
    v_mfma_f32_16x16x32_bf16 a[76:79], v[132:135], v[56:59], a[76:79]
    v_exp_f32 v70, v70
    v_mfma_f32_16x16x32_bf16 a[80:83], v[136:139], v[56:59], a[80:83]
    v_max3_f32 v6, v72, v73, v74
    v_max3_f32 v9, v80, v81, v82
    v_mfma_f32_16x16x32_bf16 a[84:87], v[140:143], v[56:59], a[84:87]
    s_waitcnt vmcnt(3)
    buffer_load_dwordx4 v1, s[28:31], s65 offen offset:2048 nt lds
    v_mfma_f32_16x16x32_bf16 a[88:91], v[144:147], v[56:59], a[88:91]
    v_max3_f32 v6, v6, v75, v76
    v_max3_f32 v9, v9, v83, v84
    v_mfma_f32_16x16x32_bf16 a[92:95], v[148:151], v[56:59], a[92:95]
    v_max3_f32 v6, v6, v77, v78
    v_max3_f32 v9, v9, v85, v86
    v_mfma_f32_16x16x32_bf16 a[200:203], a[216:219], v[56:59], a[200:203]
    s_waitcnt lgkmcnt(0)
    v_mfma_f32_16x16x32_bf16 v[40:43], v[88:91], v[152:155], v[16:19]
    v_max3_f32 v6, v6, v79, v87
    v_max_f32 v6, v6, v9
    v_mfma_f32_16x16x32_bf16 v[40:43], v[92:95], v[156:159], v[40:43]
    v_cmp_lt_f32 vcc, s61, v6
    v_mfma_f32_16x16x32_bf16 v[40:43], v[96:99], v[160:163], v[40:43]
    v_exp_f32 v71, v71
    v_mfma_f32_16x16x32_bf16 v[40:43], v[100:103], v[164:167], v[40:43]
    v_cvt_pk_bf16_f32 v66, v68, v69
    v_cvt_pk_bf16_f32 v67, v70, v71
    v_mfma_f32_16x16x32_bf16 v[44:47], v[104:107], v[152:155], v[16:19]
    s_cbranch_vccnz L_stub4_20
L_back4_20:
    v_mfma_f32_16x16x32_bf16 v[44:47], v[108:111], v[156:159], v[44:47]
    v_exp_f32 v72, v72
    v_mfma_f32_16x16x32_bf16 v[44:47], v[112:115], v[160:163], v[44:47]
    v_exp_f32 v73, v73
    v_mfma_f32_16x16x32_bf16 v[44:47], v[116:119], v[164:167], v[44:47]
    v_exp_f32 v74, v74
    v_mfma_f32_16x16x32_bf16 a[96:99], v[120:123], v[64:67], a[96:99]
    v_exp_f32 v75, v75
    v_mfma_f32_16x16x32_bf16 a[100:103], v[124:127], v[64:67], a[100:103]
    s_waitcnt vmcnt(3)
    buffer_load_dwordx4 v2, s[28:31], s65 offen offset:3072 nt lds
    v_mfma_f32_16x16x32_bf16 a[104:107], v[128:131], v[64:67], a[104:107]
    v_cvt_pk_bf16_f32 v72, v72, v73
    v_cvt_pk_bf16_f32 v73, v74, v75
    v_mfma_f32_16x16x32_bf16 a[108:111], v[132:135], v[64:67], a[108:111]
    v_exp_f32 v76, v76
    v_mfma_f32_16x16x32_bf16 a[112:115], v[136:139], v[64:67], a[112:115]
    v_exp_f32 v77, v77
    v_mfma_f32_16x16x32_bf16 a[116:119], v[140:143], v[64:67], a[116:119]
    v_exp_f32 v78, v78
    v_mfma_f32_16x16x32_bf16 a[120:123], v[144:147], v[64:67], a[120:123]
    v_exp_f32 v79, v79
    v_mfma_f32_16x16x32_bf16 a[124:127], v[148:151], v[64:67], a[124:127]
    v_cvt_pk_bf16_f32 v74, v76, v77
    v_cvt_pk_bf16_f32 v75, v78, v79
    v_mfma_f32_16x16x32_bf16 a[204:207], a[216:219], v[64:67], a[204:207]
    v_exp_f32 v80, v80
    v_mfma_f32_16x16x32_bf16 v[48:51], v[88:91], v[168:171], v[20:23]
    v_exp_f32 v81, v81
    v_mfma_f32_16x16x32_bf16 v[48:51], v[92:95], v[172:175], v[48:51]
    v_exp_f32 v82, v82
    v_mfma_f32_16x16x32_bf16 v[48:51], v[96:99], v[176:179], v[48:51]
    v_exp_f32 v83, v83
    v_mfma_f32_16x16x32_bf16 v[48:51], v[100:103], v[180:183], v[48:51]
    v_cvt_pk_bf16_f32 v80, v80, v81
    v_cvt_pk_bf16_f32 v81, v82, v83
    v_mfma_f32_16x16x32_bf16 v[52:55], v[104:107], v[168:171], v[20:23]
    v_exp_f32 v84, v84
    v_mfma_f32_16x16x32_bf16 v[52:55], v[108:111], v[172:175], v[52:55]
    s_add_u32 m0, s58, 106496
    v_mfma_f32_16x16x32_bf16 v[52:55], v[112:115], v[176:179], v[52:55]
    s_waitcnt vmcnt(3)
    buffer_load_dwordx4 v1, s[4:7], s65 offen offset:0 nt lds
    v_mfma_f32_16x16x32_bf16 v[52:55], v[116:119], v[180:183], v[52:55]
    v_exp_f32 v85, v85
    v_mfma_f32_16x16x32_bf16 a[128:131], v[120:123], v[72:75], a[128:131]
    v_exp_f32 v86, v86
    v_mfma_f32_16x16x32_bf16 a[132:135], v[124:127], v[72:75], a[132:135]
    v_mfma_f32_16x16x32_bf16 a[136:139], v[128:131], v[72:75], a[136:139]
    v_max3_f32 v6, v40, v41, v42
    v_max3_f32 v9, v48, v49, v50
    v_mfma_f32_16x16x32_bf16 a[140:143], v[132:135], v[72:75], a[140:143]
    v_max3_f32 v6, v6, v43, v44
    v_max3_f32 v9, v9, v51, v52
    v_mfma_f32_16x16x32_bf16 a[144:147], v[136:139], v[72:75], a[144:147]
    v_max3_f32 v6, v6, v45, v46
    v_max3_f32 v9, v9, v53, v54
    v_mfma_f32_16x16x32_bf16 a[148:151], v[140:143], v[72:75], a[148:151]
    v_max3_f32 v6, v6, v47, v55
    v_max_f32 v6, v6, v9
    v_mfma_f32_16x16x32_bf16 a[152:155], v[144:147], v[72:75], a[152:155]
    v_cmp_lt_f32 vcc, s61, v6
    v_mfma_f32_16x16x32_bf16 a[156:159], v[148:151], v[72:75], a[156:159]
    v_exp_f32 v87, v87
    v_mfma_f32_16x16x32_bf16 a[208:211], a[216:219], v[72:75], a[208:211]
    v_cvt_pk_bf16_f32 v82, v84, v85
    v_cvt_pk_bf16_f32 v83, v86, v87
    v_mfma_f32_16x16x32_bf16 v[56:59], v[88:91], v[184:187], v[24:27]
    s_cbranch_vccnz L_stub0_20
L_back0_20:
    v_mfma_f32_16x16x32_bf16 v[56:59], v[92:95], v[188:191], v[56:59]
    v_exp_f32 v40, v40
    v_mfma_f32_16x16x32_bf16 v[56:59], v[96:99], v[192:195], v[56:59]
    s_waitcnt vmcnt(3)
    buffer_load_dwordx4 v2, s[4:7], s65 offen offset:1024 nt lds
    v_mfma_f32_16x16x32_bf16 v[56:59], v[100:103], v[196:199], v[56:59]
    v_exp_f32 v41, v41
    v_mfma_f32_16x16x32_bf16 v[60:63], v[104:107], v[184:187], v[24:27]
    v_exp_f32 v42, v42
    v_mfma_f32_16x16x32_bf16 v[60:63], v[108:111], v[188:191], v[60:63]
    v_exp_f32 v43, v43
    v_mfma_f32_16x16x32_bf16 v[60:63], v[112:115], v[192:195], v[60:63]
    v_cvt_pk_bf16_f32 v40, v40, v41
    v_cvt_pk_bf16_f32 v41, v42, v43
    v_mfma_f32_16x16x32_bf16 v[60:63], v[116:119], v[196:199], v[60:63]
    v_exp_f32 v44, v44
    v_mfma_f32_16x16x32_bf16 a[160:163], v[120:123], v[80:83], a[160:163]
    ds_read_b64_tr_b16 v[120:121], v4 offset:0
    ds_read_b64_tr_b16 v[122:123], v4 offset:4096
    v_mfma_f32_16x16x32_bf16 a[164:167], v[124:127], v[80:83], a[164:167]
    ds_read_b64_tr_b16 v[124:125], v5 offset:0
    ds_read_b64_tr_b16 v[126:127], v5 offset:4096
    v_mfma_f32_16x16x32_bf16 a[168:171], v[128:131], v[80:83], a[168:171]
    ds_read_b64_tr_b16 v[128:129], v4 offset:256
    ds_read_b64_tr_b16 v[130:131], v4 offset:4352
    v_mfma_f32_16x16x32_bf16 a[172:175], v[132:135], v[80:83], a[172:175]
    ds_read_b64_tr_b16 v[132:133], v5 offset:256
    ds_read_b64_tr_b16 v[134:135], v5 offset:4352
    v_mfma_f32_16x16x32_bf16 a[176:179], v[136:139], v[80:83], a[176:179]
    ds_read_b64_tr_b16 v[136:137], v4 offset:512
    ds_read_b64_tr_b16 v[138:139], v4 offset:4608
    v_mfma_f32_16x16x32_bf16 a[180:183], v[140:143], v[80:83], a[180:183]
    ds_read_b64_tr_b16 v[140:141], v5 offset:512
    ds_read_b64_tr_b16 v[142:143], v5 offset:4608
    v_mfma_f32_16x16x32_bf16 a[184:187], v[144:147], v[80:83], a[184:187]
    ds_read_b64_tr_b16 v[144:145], v4 offset:768
    ds_read_b64_tr_b16 v[146:147], v4 offset:4864
    v_mfma_f32_16x16x32_bf16 a[188:191], v[148:151], v[80:83], a[188:191]
    ds_read_b64_tr_b16 v[148:149], v5 offset:768
    ds_read_b64_tr_b16 v[150:151], v5 offset:4864
    v_mfma_f32_16x16x32_bf16 a[212:215], a[216:219], v[80:83], a[212:215]
    s_waitcnt vmcnt(3)
    buffer_load_dwordx4 v1, s[4:7], s65 offen offset:2048 nt lds
    v_mfma_f32_16x16x32_bf16 v[64:67], v[88:91], v[200:203], v[28:31]
    v_exp_f32 v45, v45
    v_mfma_f32_16x16x32_bf16 v[64:67], v[92:95], v[204:207], v[64:67]
    v_exp_f32 v46, v46
    v_mfma_f32_16x16x32_bf16 v[64:67], v[96:99], v[208:211], v[64:67]
    v_exp_f32 v47, v47
    v_mfma_f32_16x16x32_bf16 v[64:67], v[100:103], v[212:215], v[64:67]
    v_cvt_pk_bf16_f32 v42, v44, v45
    v_cvt_pk_bf16_f32 v43, v46, v47
    v_mfma_f32_16x16x32_bf16 v[68:71], v[104:107], v[200:203], v[28:31]
    v_exp_f32 v48, v48
    v_mfma_f32_16x16x32_bf16 v[68:71], v[108:111], v[204:207], v[68:71]
    v_exp_f32 v49, v49
    v_mfma_f32_16x16x32_bf16 v[68:71], v[112:115], v[208:211], v[68:71]
    v_exp_f32 v50, v50
    v_mfma_f32_16x16x32_bf16 v[68:71], v[116:119], v[212:215], v[68:71]
    s_waitcnt lgkmcnt(0)
    v_mfma_f32_16x16x32_bf16 a[0:3], v[120:123], v[40:43], a[0:3]
    v_exp_f32 v51, v51
    v_mfma_f32_16x16x32_bf16 a[4:7], v[124:127], v[40:43], a[4:7]
    v_cvt_pk_bf16_f32 v48, v48, v49
    v_cvt_pk_bf16_f32 v49, v50, v51
    v_mfma_f32_16x16x32_bf16 a[8:11], v[128:131], v[40:43], a[8:11]
    v_exp_f32 v52, v52
    v_mfma_f32_16x16x32_bf16 a[12:15], v[132:135], v[40:43], a[12:15]
    v_exp_f32 v53, v53
    v_mfma_f32_16x16x32_bf16 a[16:19], v[136:139], v[40:43], a[16:19]
    s_waitcnt vmcnt(3)
    buffer_load_dwordx4 v2, s[4:7], s65 offen offset:3072 nt lds
    v_mfma_f32_16x16x32_bf16 a[20:23], v[140:143], v[40:43], a[20:23]
    v_exp_f32 v54, v54
    v_mfma_f32_16x16x32_bf16 a[24:27], v[144:147], v[40:43], a[24:27]
    v_max3_f32 v6, v56, v57, v58
    v_max3_f32 v9, v64, v65, v66
    v_mfma_f32_16x16x32_bf16 a[28:31], v[148:151], v[40:43], a[28:31]
    v_max3_f32 v6, v6, v59, v60
    v_max3_f32 v9, v9, v67, v68
    v_mfma_f32_16x16x32_bf16 a[192:195], a[216:219], v[40:43], a[192:195]
    v_max3_f32 v6, v6, v61, v62
    v_max3_f32 v9, v9, v69, v70
    v_mfma_f32_16x16x32_bf16 v[72:75], v[88:91], v[216:219], v[32:35]
    v_max3_f32 v6, v6, v63, v71
    v_max_f32 v6, v6, v9
    v_mfma_f32_16x16x32_bf16 v[72:75], v[92:95], v[220:223], v[72:75]
    v_cmp_lt_f32 vcc, s61, v6
    v_mfma_f32_16x16x32_bf16 v[72:75], v[96:99], v[224:227], v[72:75]
    v_exp_f32 v55, v55
    v_mfma_f32_16x16x32_bf16 v[72:75], v[100:103], v[228:231], v[72:75]
    v_cvt_pk_bf16_f32 v50, v52, v53
    v_cvt_pk_bf16_f32 v51, v54, v55
    v_mfma_f32_16x16x32_bf16 v[76:79], v[104:107], v[216:219], v[32:35]
    s_cbranch_vccnz L_stub2_20
L_back2_20:
    v_mfma_f32_16x16x32_bf16 v[76:79], v[108:111], v[220:223], v[76:79]
    v_exp_f32 v56, v56
    v_mfma_f32_16x16x32_bf16 v[76:79], v[112:115], v[224:227], v[76:79]
    v_exp_f32 v57, v57
    v_mfma_f32_16x16x32_bf16 v[76:79], v[116:119], v[228:231], v[76:79]
    v_exp_f32 v58, v58
    v_mfma_f32_16x16x32_bf16 a[32:35], v[120:123], v[48:51], a[32:35]
    s_add_u32 m0, s58, 131072
    s_mov_b32 s65, 196608
    v_mfma_f32_16x16x32_bf16 a[36:39], v[124:127], v[48:51], a[36:39]
    s_waitcnt vmcnt(3)
    buffer_load_dwordx4 v1, s[28:31], s65 offen offset:0 nt lds
    v_mfma_f32_16x16x32_bf16 a[40:43], v[128:131], v[48:51], a[40:43]
    v_exp_f32 v59, v59
    v_mfma_f32_16x16x32_bf16 a[44:47], v[132:135], v[48:51], a[44:47]
    v_cvt_pk_bf16_f32 v56, v56, v57
    v_cvt_pk_bf16_f32 v57, v58, v59
    v_mfma_f32_16x16x32_bf16 a[48:51], v[136:139], v[48:51], a[48:51]
    v_exp_f32 v60, v60
    v_mfma_f32_16x16x32_bf16 a[52:55], v[140:143], v[48:51], a[52:55]
    v_exp_f32 v61, v61
    v_mfma_f32_16x16x32_bf16 a[56:59], v[144:147], v[48:51], a[56:59]
    global_load_dword v13, v[10:11], off
    v_mfma_f32_16x16x32_bf16 a[60:63], v[148:151], v[48:51], a[60:63]
    v_exp_f32 v62, v62
    v_mfma_f32_16x16x32_bf16 a[196:199], a[216:219], v[48:51], a[196:199]
    v_exp_f32 v63, v63
    v_cvt_pk_bf16_f32 v58, v60, v61
    v_cvt_pk_bf16_f32 v59, v62, v63
    s_barrier
    v_mfma_f32_16x16x32_bf16 v[80:83], v[88:91], v[232:235], v[36:39]
    v_exp_f32 v64, v64
    v_mfma_f32_16x16x32_bf16 v[80:83], v[92:95], v[236:239], v[80:83]
    ds_read_b128 v[88:91], v3 offset:32768
    ds_read_b128 v[92:95], v3 offset:33024
    v_mfma_f32_16x16x32_bf16 v[80:83], v[96:99], v[240:243], v[80:83]
    v_exp_f32 v65, v65
    v_mfma_f32_16x16x32_bf16 v[80:83], v[100:103], v[244:247], v[80:83]
    ds_read_b128 v[96:99], v3 offset:33280
    ds_read_b128 v[100:103], v3 offset:33536
    v_mfma_f32_16x16x32_bf16 v[84:87], v[104:107], v[232:235], v[36:39]
    s_waitcnt vmcnt(4)
    buffer_load_dwordx4 v2, s[28:31], s65 offen offset:1024 nt lds
    v_mfma_f32_16x16x32_bf16 v[84:87], v[108:111], v[236:239], v[84:87]
    ds_read_b128 v[104:107], v3 offset:36864
    ds_read_b128 v[108:111], v3 offset:37120
    v_mfma_f32_16x16x32_bf16 v[84:87], v[112:115], v[240:243], v[84:87]
    v_exp_f32 v66, v66
    v_mfma_f32_16x16x32_bf16 v[84:87], v[116:119], v[244:247], v[84:87]
    ds_read_b128 v[112:115], v3 offset:37376
    ds_read_b128 v[116:119], v3 offset:37632
    v_mfma_f32_16x16x32_bf16 a[64:67], v[120:123], v[56:59], a[64:67]
    v_exp_f32 v67, v67
    v_mfma_f32_16x16x32_bf16 a[68:71], v[124:127], v[56:59], a[68:71]
    v_cvt_pk_bf16_f32 v64, v64, v65
    v_cvt_pk_bf16_f32 v65, v66, v67
    v_mfma_f32_16x16x32_bf16 a[72:75], v[128:131], v[56:59], a[72:75]
    v_exp_f32 v68, v68
    v_mfma_f32_16x16x32_bf16 a[76:79], v[132:135], v[56:59], a[76:79]
    v_exp_f32 v69, v69
    v_mfma_f32_16x16x32_bf16 a[80:83], v[136:139], v[56:59], a[80:83]
    v_exp_f32 v70, v70
    v_mfma_f32_16x16x32_bf16 a[84:87], v[140:143], v[56:59], a[84:87]
    v_max3_f32 v6, v72, v73, v74
    v_max3_f32 v9, v80, v81, v82
    v_mfma_f32_16x16x32_bf16 a[88:91], v[144:147], v[56:59], a[88:91]
    v_max3_f32 v6, v6, v75, v76
    v_max3_f32 v9, v9, v83, v84
    v_mfma_f32_16x16x32_bf16 a[92:95], v[148:151], v[56:59], a[92:95]
    v_max3_f32 v6, v6, v77, v78
    v_max3_f32 v9, v9, v85, v86
    v_mfma_f32_16x16x32_bf16 a[200:203], a[216:219], v[56:59], a[200:203]
    s_waitcnt lgkmcnt(0)
    v_mfma_f32_16x16x32_bf16 v[40:43], v[88:91], v[152:155], v[16:19]
    v_max3_f32 v6, v6, v79, v87
    v_max_f32 v6, v6, v9
    v_mfma_f32_16x16x32_bf16 v[40:43], v[92:95], v[156:159], v[40:43]
    s_waitcnt vmcnt(4)
    buffer_load_dwordx4 v1, s[28:31], s65 offen offset:2048 nt lds
    v_mfma_f32_16x16x32_bf16 v[40:43], v[96:99], v[160:163], v[40:43]
    v_cmp_lt_f32 vcc, s61, v6
    v_mfma_f32_16x16x32_bf16 v[40:43], v[100:103], v[164:167], v[40:43]
    v_exp_f32 v71, v71
    v_mfma_f32_16x16x32_bf16 v[44:47], v[104:107], v[152:155], v[16:19]
    v_cvt_pk_bf16_f32 v66, v68, v69
    v_cvt_pk_bf16_f32 v67, v70, v71
    v_mfma_f32_16x16x32_bf16 v[44:47], v[108:111], v[156:159], v[44:47]
    s_cbranch_vccnz L_stub4_21
L_back4_21:
    v_mfma_f32_16x16x32_bf16 v[44:47], v[112:115], v[160:163], v[44:47]
    v_exp_f32 v72, v72
    v_mfma_f32_16x16x32_bf16 v[44:47], v[116:119], v[164:167], v[44:47]
    v_exp_f32 v73, v73
    v_mfma_f32_16x16x32_bf16 a[96:99], v[120:123], v[64:67], a[96:99]
    v_exp_f32 v74, v74
    v_mfma_f32_16x16x32_bf16 a[100:103], v[124:127], v[64:67], a[100:103]
    v_exp_f32 v75, v75
    v_mfma_f32_16x16x32_bf16 a[104:107], v[128:131], v[64:67], a[104:107]
    v_cvt_pk_bf16_f32 v72, v72, v73
    v_cvt_pk_bf16_f32 v73, v74, v75
    v_mfma_f32_16x16x32_bf16 a[108:111], v[132:135], v[64:67], a[108:111]
    v_exp_f32 v76, v76
    v_mfma_f32_16x16x32_bf16 a[112:115], v[136:139], v[64:67], a[112:115]
    v_exp_f32 v77, v77
    v_mfma_f32_16x16x32_bf16 a[116:119], v[140:143], v[64:67], a[116:119]
    v_exp_f32 v78, v78
    v_mfma_f32_16x16x32_bf16 a[120:123], v[144:147], v[64:67], a[120:123]
    s_waitcnt vmcnt(4)
    buffer_load_dwordx4 v2, s[28:31], s65 offen offset:3072 nt lds
    v_mfma_f32_16x16x32_bf16 a[124:127], v[148:151], v[64:67], a[124:127]
    v_exp_f32 v79, v79
    v_mfma_f32_16x16x32_bf16 a[204:207], a[216:219], v[64:67], a[204:207]
    v_cvt_pk_bf16_f32 v74, v76, v77
    v_cvt_pk_bf16_f32 v75, v78, v79
    v_mfma_f32_16x16x32_bf16 v[48:51], v[88:91], v[168:171], v[20:23]
    v_exp_f32 v80, v80
    v_mfma_f32_16x16x32_bf16 v[48:51], v[92:95], v[172:175], v[48:51]
    v_exp_f32 v81, v81
    v_mfma_f32_16x16x32_bf16 v[48:51], v[96:99], v[176:179], v[48:51]
    v_exp_f32 v82, v82
    v_mfma_f32_16x16x32_bf16 v[48:51], v[100:103], v[180:183], v[48:51]
    v_exp_f32 v83, v83
    v_mfma_f32_16x16x32_bf16 v[52:55], v[104:107], v[168:171], v[20:23]
    v_cvt_pk_bf16_f32 v80, v80, v81
    v_cvt_pk_bf16_f32 v81, v82, v83
    v_mfma_f32_16x16x32_bf16 v[52:55], v[108:111], v[172:175], v[52:55]
    v_exp_f32 v84, v84
    v_mfma_f32_16x16x32_bf16 v[52:55], v[112:115], v[176:179], v[52:55]
    v_exp_f32 v85, v85
    v_mfma_f32_16x16x32_bf16 v[52:55], v[116:119], v[180:183], v[52:55]
    v_exp_f32 v86, v86
    v_mfma_f32_16x16x32_bf16 a[128:131], v[120:123], v[72:75], a[128:131]
    v_mfma_f32_16x16x32_bf16 a[132:135], v[124:127], v[72:75], a[132:135]
    v_mfma_f32_16x16x32_bf16 a[136:139], v[128:131], v[72:75], a[136:139]
    s_add_u32 m0, s58, 139264
    v_mfma_f32_16x16x32_bf16 a[140:143], v[132:135], v[72:75], a[140:143]
    s_waitcnt vmcnt(4)
    buffer_load_dwordx4 v1, s[4:7], s65 offen offset:0 nt lds
    v_mfma_f32_16x16x32_bf16 a[144:147], v[136:139], v[72:75], a[144:147]
    v_max3_f32 v6, v40, v41, v42
    v_max3_f32 v9, v48, v49, v50
    v_mfma_f32_16x16x32_bf16 a[148:151], v[140:143], v[72:75], a[148:151]
    v_max3_f32 v6, v6, v43, v44
    v_max3_f32 v9, v9, v51, v52
    v_mfma_f32_16x16x32_bf16 a[152:155], v[144:147], v[72:75], a[152:155]
    v_max3_f32 v6, v6, v45, v46
    v_max3_f32 v9, v9, v53, v54
    v_mfma_f32_16x16x32_bf16 a[156:159], v[148:151], v[72:75], a[156:159]
    v_max3_f32 v6, v6, v47, v55
    v_max_f32 v6, v6, v9
    v_mfma_f32_16x16x32_bf16 a[208:211], a[216:219], v[72:75], a[208:211]
    v_cmp_lt_f32 vcc, s61, v6
    v_mfma_f32_16x16x32_bf16 v[56:59], v[88:91], v[184:187], v[24:27]
    v_exp_f32 v87, v87
    v_mfma_f32_16x16x32_bf16 v[56:59], v[92:95], v[188:191], v[56:59]
    v_cvt_pk_bf16_f32 v82, v84, v85
    v_cvt_pk_bf16_f32 v83, v86, v87
    v_mfma_f32_16x16x32_bf16 v[56:59], v[96:99], v[192:195], v[56:59]
    s_cbranch_vccnz L_stub0_21
L_back0_21:
    v_mfma_f32_16x16x32_bf16 v[56:59], v[100:103], v[196:199], v[56:59]
    v_exp_f32 v40, v40
    v_mfma_f32_16x16x32_bf16 v[60:63], v[104:107], v[184:187], v[24:27]
    v_exp_f32 v41, v41
    v_mfma_f32_16x16x32_bf16 v[60:63], v[108:111], v[188:191], v[60:63]
    v_exp_f32 v42, v42
    v_mfma_f32_16x16x32_bf16 v[60:63], v[112:115], v[192:195], v[60:63]
    v_exp_f32 v43, v43
    v_mfma_f32_16x16x32_bf16 v[60:63], v[116:119], v[196:199], v[60:63]
    s_waitcnt vmcnt(3)
    buffer_load_dwordx4 v2, s[4:7], s65 offen offset:1024 nt lds
    v_mfma_f32_16x16x32_bf16 a[160:163], v[120:123], v[80:83], a[160:163]
    ds_read_b64_tr_b16 v[120:121], v4 offset:32768
    ds_read_b64_tr_b16 v[122:123], v4 offset:36864
    v_mfma_f32_16x16x32_bf16 a[164:167], v[124:127], v[80:83], a[164:167]
    ds_read_b64_tr_b16 v[124:125], v5 offset:32768
    ds_read_b64_tr_b16 v[126:127], v5 offset:36864
    v_mfma_f32_16x16x32_bf16 a[168:171], v[128:131], v[80:83], a[168:171]
    ds_read_b64_tr_b16 v[128:129], v4 offset:33024
    ds_read_b64_tr_b16 v[130:131], v4 offset:37120
    v_mfma_f32_16x16x32_bf16 a[172:175], v[132:135], v[80:83], a[172:175]
    ds_read_b64_tr_b16 v[132:133], v5 offset:33024
    ds_read_b64_tr_b16 v[134:135], v5 offset:37120
    v_mfma_f32_16x16x32_bf16 a[176:179], v[136:139], v[80:83], a[176:179]
    ds_read_b64_tr_b16 v[136:137], v4 offset:33280
    ds_read_b64_tr_b16 v[138:139], v4 offset:37376
    v_mfma_f32_16x16x32_bf16 a[180:183], v[140:143], v[80:83], a[180:183]
    ds_read_b64_tr_b16 v[140:141], v5 offset:33280
    ds_read_b64_tr_b16 v[142:143], v5 offset:37376
    v_mfma_f32_16x16x32_bf16 a[184:187], v[144:147], v[80:83], a[184:187]
    ds_read_b64_tr_b16 v[144:145], v4 offset:33536
    ds_read_b64_tr_b16 v[146:147], v4 offset:37632
    v_mfma_f32_16x16x32_bf16 a[188:191], v[148:151], v[80:83], a[188:191]
    ds_read_b64_tr_b16 v[148:149], v5 offset:33536
    ds_read_b64_tr_b16 v[150:151], v5 offset:37632
    v_mfma_f32_16x16x32_bf16 a[212:215], a[216:219], v[80:83], a[212:215]
    v_cvt_pk_bf16_f32 v40, v40, v41
    v_cvt_pk_bf16_f32 v41, v42, v43
    v_mfma_f32_16x16x32_bf16 v[64:67], v[88:91], v[200:203], v[28:31]
    v_exp_f32 v44, v44
    v_mfma_f32_16x16x32_bf16 v[64:67], v[92:95], v[204:207], v[64:67]
    v_exp_f32 v45, v45
    v_mfma_f32_16x16x32_bf16 v[64:67], v[96:99], v[208:211], v[64:67]
    v_exp_f32 v46, v46
    v_mfma_f32_16x16x32_bf16 v[64:67], v[100:103], v[212:215], v[64:67]
    s_waitcnt vmcnt(3)
    buffer_load_dwordx4 v1, s[4:7], s65 offen offset:2048 nt lds
    v_mfma_f32_16x16x32_bf16 v[68:71], v[104:107], v[200:203], v[28:31]
    v_exp_f32 v47, v47
    v_mfma_f32_16x16x32_bf16 v[68:71], v[108:111], v[204:207], v[68:71]
    v_cvt_pk_bf16_f32 v42, v44, v45
    v_cvt_pk_bf16_f32 v43, v46, v47
    v_mfma_f32_16x16x32_bf16 v[68:71], v[112:115], v[208:211], v[68:71]
    v_exp_f32 v48, v48
    v_mfma_f32_16x16x32_bf16 v[68:71], v[116:119], v[212:215], v[68:71]
    s_waitcnt lgkmcnt(0)
    v_mfma_f32_16x16x32_bf16 a[0:3], v[120:123], v[40:43], a[0:3]
    v_exp_f32 v49, v49
    v_mfma_f32_16x16x32_bf16 a[4:7], v[124:127], v[40:43], a[4:7]
    v_exp_f32 v50, v50
    v_mfma_f32_16x16x32_bf16 a[8:11], v[128:131], v[40:43], a[8:11]
    v_exp_f32 v51, v51
    v_mfma_f32_16x16x32_bf16 a[12:15], v[132:135], v[40:43], a[12:15]
    v_cvt_pk_bf16_f32 v48, v48, v49
    v_cvt_pk_bf16_f32 v49, v50, v51
    v_mfma_f32_16x16x32_bf16 a[16:19], v[136:139], v[40:43], a[16:19]
    v_exp_f32 v52, v52
    v_mfma_f32_16x16x32_bf16 a[20:23], v[140:143], v[40:43], a[20:23]
    v_exp_f32 v53, v53
    v_mfma_f32_16x16x32_bf16 a[24:27], v[144:147], v[40:43], a[24:27]
    v_exp_f32 v54, v54
    v_mfma_f32_16x16x32_bf16 a[28:31], v[148:151], v[40:43], a[28:31]
    v_max3_f32 v6, v56, v57, v58
    v_max3_f32 v9, v64, v65, v66
    v_mfma_f32_16x16x32_bf16 a[192:195], a[216:219], v[40:43], a[192:195]
    s_waitcnt vmcnt(3)
    buffer_load_dwordx4 v2, s[4:7], s65 offen offset:3072 nt lds
    v_mfma_f32_16x16x32_bf16 v[72:75], v[88:91], v[216:219], v[32:35]
    v_max3_f32 v6, v6, v59, v60
    v_max3_f32 v9, v9, v67, v68
    v_mfma_f32_16x16x32_bf16 v[72:75], v[92:95], v[220:223], v[72:75]
    v_max3_f32 v6, v6, v61, v62
    v_max3_f32 v9, v9, v69, v70
    v_mfma_f32_16x16x32_bf16 v[72:75], v[96:99], v[224:227], v[72:75]
    v_max3_f32 v6, v6, v63, v71
    v_max_f32 v6, v6, v9
    v_mfma_f32_16x16x32_bf16 v[72:75], v[100:103], v[228:231], v[72:75]
    v_cmp_lt_f32 vcc, s61, v6
    v_mfma_f32_16x16x32_bf16 v[76:79], v[104:107], v[216:219], v[32:35]
    v_exp_f32 v55, v55
    v_mfma_f32_16x16x32_bf16 v[76:79], v[108:111], v[220:223], v[76:79]
    v_cvt_pk_bf16_f32 v50, v52, v53
    v_cvt_pk_bf16_f32 v51, v54, v55
    v_mfma_f32_16x16x32_bf16 v[76:79], v[112:115], v[224:227], v[76:79]
    s_cbranch_vccnz L_stub2_21
L_back2_21:
    v_mfma_f32_16x16x32_bf16 v[76:79], v[116:119], v[228:231], v[76:79]
    v_exp_f32 v56, v56
    v_mfma_f32_16x16x32_bf16 a[32:35], v[120:123], v[48:51], a[32:35]
    v_exp_f32 v57, v57
    v_mfma_f32_16x16x32_bf16 a[36:39], v[124:127], v[48:51], a[36:39]
    v_exp_f32 v58, v58
    v_mfma_f32_16x16x32_bf16 a[40:43], v[128:131], v[48:51], a[40:43]
    v_exp_f32 v59, v59
    v_mfma_f32_16x16x32_bf16 a[44:47], v[132:135], v[48:51], a[44:47]
    v_cvt_pk_bf16_f32 v56, v56, v57
    v_cvt_pk_bf16_f32 v57, v58, v59
    v_mfma_f32_16x16x32_bf16 a[48:51], v[136:139], v[48:51], a[48:51]
    v_exp_f32 v60, v60
    v_mfma_f32_16x16x32_bf16 a[52:55], v[140:143], v[48:51], a[52:55]
    s_add_u32 m0, s58, 0
    s_mov_b32 s65, 204800
    v_mfma_f32_16x16x32_bf16 a[56:59], v[144:147], v[48:51], a[56:59]
    s_waitcnt vmcnt(3)
    buffer_load_dwordx4 v1, s[28:31], s65 offen offset:0 nt lds
    v_mfma_f32_16x16x32_bf16 a[60:63], v[148:151], v[48:51], a[60:63]
    v_exp_f32 v61, v61
    v_mfma_f32_16x16x32_bf16 a[196:199], a[216:219], v[48:51], a[196:199]
    v_exp_f32 v62, v62
    v_exp_f32 v63, v63
    v_cvt_pk_bf16_f32 v58, v60, v61
    v_cvt_pk_bf16_f32 v59, v62, v63
    s_barrier
    v_mfma_f32_16x16x32_bf16 v[80:83], v[88:91], v[232:235], v[36:39]
    v_exp_f32 v64, v64
    v_mfma_f32_16x16x32_bf16 v[80:83], v[92:95], v[236:239], v[80:83]
    ds_read_b128 v[88:91], v248 offset:0
    ds_read_b128 v[92:95], v248 offset:256
    v_mfma_f32_16x16x32_bf16 v[80:83], v[96:99], v[240:243], v[80:83]
    v_exp_f32 v65, v65
    v_mfma_f32_16x16x32_bf16 v[80:83], v[100:103], v[244:247], v[80:83]
    ds_read_b128 v[96:99], v248 offset:512
    ds_read_b128 v[100:103], v248 offset:768
    v_mfma_f32_16x16x32_bf16 v[84:87], v[104:107], v[232:235], v[36:39]
    v_exp_f32 v66, v66
    v_mfma_f32_16x16x32_bf16 v[84:87], v[108:111], v[236:239], v[84:87]
    ds_read_b128 v[104:107], v248 offset:4096
    ds_read_b128 v[108:111], v248 offset:4352
    v_mfma_f32_16x16x32_bf16 v[84:87], v[112:115], v[240:243], v[84:87]
    v_exp_f32 v67, v67
    v_mfma_f32_16x16x32_bf16 v[84:87], v[116:119], v[244:247], v[84:87]
    ds_read_b128 v[112:115], v248 offset:4608
    ds_read_b128 v[116:119], v248 offset:4864
    v_mfma_f32_16x16x32_bf16 a[64:67], v[120:123], v[56:59], a[64:67]
    v_cvt_pk_bf16_f32 v64, v64, v65
    v_cvt_pk_bf16_f32 v65, v66, v67
    v_mfma_f32_16x16x32_bf16 a[68:71], v[124:127], v[56:59], a[68:71]
    s_waitcnt vmcnt(3)
    buffer_load_dwordx4 v2, s[28:31], s65 offen offset:1024 nt lds
    v_mfma_f32_16x16x32_bf16 a[72:75], v[128:131], v[56:59], a[72:75]
    v_exp_f32 v68, v68
    v_mfma_f32_16x16x32_bf16 a[76:79], v[132:135], v[56:59], a[76:79]
    v_exp_f32 v69, v69
    v_mfma_f32_16x16x32_bf16 a[80:83], v[136:139], v[56:59], a[80:83]
    v_exp_f32 v70, v70
    v_mfma_f32_16x16x32_bf16 a[84:87], v[140:143], v[56:59], a[84:87]
    v_max3_f32 v6, v72, v73, v74
    v_max3_f32 v9, v80, v81, v82
    v_mfma_f32_16x16x32_bf16 a[88:91], v[144:147], v[56:59], a[88:91]
    v_max3_f32 v6, v6, v75, v76
    v_max3_f32 v9, v9, v83, v84
    v_mfma_f32_16x16x32_bf16 a[92:95], v[148:151], v[56:59], a[92:95]
    v_max3_f32 v6, v6, v77, v78
    v_max3_f32 v9, v9, v85, v86
    v_mfma_f32_16x16x32_bf16 a[200:203], a[216:219], v[56:59], a[200:203]
    s_waitcnt lgkmcnt(0)
    v_mfma_f32_16x16x32_bf16 v[40:43], v[88:91], v[152:155], v[16:19]
    v_max3_f32 v6, v6, v79, v87
    v_max_f32 v6, v6, v9
    v_mfma_f32_16x16x32_bf16 v[40:43], v[92:95], v[156:159], v[40:43]
    v_cmp_lt_f32 vcc, s61, v6
    v_mfma_f32_16x16x32_bf16 v[40:43], v[96:99], v[160:163], v[40:43]
    v_exp_f32 v71, v71
    v_mfma_f32_16x16x32_bf16 v[40:43], v[100:103], v[164:167], v[40:43]
    v_cvt_pk_bf16_f32 v66, v68, v69
    v_cvt_pk_bf16_f32 v67, v70, v71
    v_mfma_f32_16x16x32_bf16 v[44:47], v[104:107], v[152:155], v[16:19]
    s_cbranch_vccnz L_stub4_22
L_back4_22:
    v_mfma_f32_16x16x32_bf16 v[44:47], v[108:111], v[156:159], v[44:47]
    s_waitcnt vmcnt(3)
    buffer_load_dwordx4 v1, s[28:31], s65 offen offset:2048 nt lds
    v_mfma_f32_16x16x32_bf16 v[44:47], v[112:115], v[160:163], v[44:47]
    v_exp_f32 v72, v72
    v_mfma_f32_16x16x32_bf16 v[44:47], v[116:119], v[164:167], v[44:47]
    v_exp_f32 v73, v73
    v_mfma_f32_16x16x32_bf16 a[96:99], v[120:123], v[64:67], a[96:99]
    v_exp_f32 v74, v74
    v_mfma_f32_16x16x32_bf16 a[100:103], v[124:127], v[64:67], a[100:103]
    v_exp_f32 v75, v75
    v_mfma_f32_16x16x32_bf16 a[104:107], v[128:131], v[64:67], a[104:107]
    v_cvt_pk_bf16_f32 v72, v72, v73
    v_cvt_pk_bf16_f32 v73, v74, v75
    v_mfma_f32_16x16x32_bf16 a[108:111], v[132:135], v[64:67], a[108:111]
    v_exp_f32 v76, v76
    v_mfma_f32_16x16x32_bf16 a[112:115], v[136:139], v[64:67], a[112:115]
    v_exp_f32 v77, v77
    v_mfma_f32_16x16x32_bf16 a[116:119], v[140:143], v[64:67], a[116:119]
    v_exp_f32 v78, v78
    v_mfma_f32_16x16x32_bf16 a[120:123], v[144:147], v[64:67], a[120:123]
    v_exp_f32 v79, v79
    v_mfma_f32_16x16x32_bf16 a[124:127], v[148:151], v[64:67], a[124:127]
    v_cvt_pk_bf16_f32 v74, v76, v77
    v_cvt_pk_bf16_f32 v75, v78, v79
    v_mfma_f32_16x16x32_bf16 a[204:207], a[216:219], v[64:67], a[204:207]
    v_exp_f32 v80, v80
    v_mfma_f32_16x16x32_bf16 v[48:51], v[88:91], v[168:171], v[20:23]
    v_exp_f32 v81, v81
    v_mfma_f32_16x16x32_bf16 v[48:51], v[92:95], v[172:175], v[48:51]
    v_exp_f32 v82, v82
    v_mfma_f32_16x16x32_bf16 v[48:51], v[96:99], v[176:179], v[48:51]
    s_waitcnt vmcnt(3)
    buffer_load_dwordx4 v2, s[28:31], s65 offen offset:3072 nt lds
    v_mfma_f32_16x16x32_bf16 v[48:51], v[100:103], v[180:183], v[48:51]
    v_exp_f32 v83, v83
    v_mfma_f32_16x16x32_bf16 v[52:55], v[104:107], v[168:171], v[20:23]
    v_cvt_pk_bf16_f32 v80, v80, v81
    v_cvt_pk_bf16_f32 v81, v82, v83
    v_mfma_f32_16x16x32_bf16 v[52:55], v[108:111], v[172:175], v[52:55]
    v_exp_f32 v84, v84
    v_mfma_f32_16x16x32_bf16 v[52:55], v[112:115], v[176:179], v[52:55]
    v_exp_f32 v85, v85
    v_mfma_f32_16x16x32_bf16 v[52:55], v[116:119], v[180:183], v[52:55]
    v_exp_f32 v86, v86
    v_mfma_f32_16x16x32_bf16 a[128:131], v[120:123], v[72:75], a[128:131]
    v_mfma_f32_16x16x32_bf16 a[132:135], v[124:127], v[72:75], a[132:135]
    v_mfma_f32_16x16x32_bf16 a[136:139], v[128:131], v[72:75], a[136:139]
    v_max3_f32 v6, v40, v41, v42
    v_max3_f32 v9, v48, v49, v50
    v_mfma_f32_16x16x32_bf16 a[140:143], v[132:135], v[72:75], a[140:143]
    v_max3_f32 v6, v6, v43, v44
    v_max3_f32 v9, v9, v51, v52
    v_mfma_f32_16x16x32_bf16 a[144:147], v[136:139], v[72:75], a[144:147]
    v_max3_f32 v6, v6, v45, v46
    v_max3_f32 v9, v9, v53, v54
    v_mfma_f32_16x16x32_bf16 a[148:151], v[140:143], v[72:75], a[148:151]
    v_max3_f32 v6, v6, v47, v55
    v_max_f32 v6, v6, v9
    v_mfma_f32_16x16x32_bf16 a[152:155], v[144:147], v[72:75], a[152:155]
    v_cmp_lt_f32 vcc, s61, v6
    v_mfma_f32_16x16x32_bf16 a[156:159], v[148:151], v[72:75], a[156:159]
    s_add_u32 m0, s58, 8192
    v_mfma_f32_16x16x32_bf16 a[208:211], a[216:219], v[72:75], a[208:211]
    s_waitcnt vmcnt(3)
    buffer_load_dwordx4 v1, s[4:7], s65 offen offset:0 nt lds
    v_mfma_f32_16x16x32_bf16 v[56:59], v[88:91], v[184:187], v[24:27]
    v_exp_f32 v87, v87
    v_mfma_f32_16x16x32_bf16 v[56:59], v[92:95], v[188:191], v[56:59]
    v_cvt_pk_bf16_f32 v82, v84, v85
    v_cvt_pk_bf16_f32 v83, v86, v87
    v_mfma_f32_16x16x32_bf16 v[56:59], v[96:99], v[192:195], v[56:59]
    s_cbranch_vccnz L_stub0_22
L_back0_22:
    v_mfma_f32_16x16x32_bf16 v[56:59], v[100:103], v[196:199], v[56:59]
    v_exp_f32 v40, v40
    v_mfma_f32_16x16x32_bf16 v[60:63], v[104:107], v[184:187], v[24:27]
    v_exp_f32 v41, v41
    v_mfma_f32_16x16x32_bf16 v[60:63], v[108:111], v[188:191], v[60:63]
    v_exp_f32 v42, v42
    v_mfma_f32_16x16x32_bf16 v[60:63], v[112:115], v[192:195], v[60:63]
    v_exp_f32 v43, v43
    v_mfma_f32_16x16x32_bf16 v[60:63], v[116:119], v[196:199], v[60:63]
    v_cvt_pk_bf16_f32 v40, v40, v41
    v_cvt_pk_bf16_f32 v41, v42, v43
    v_mfma_f32_16x16x32_bf16 a[160:163], v[120:123], v[80:83], a[160:163]
    ds_read_b64_tr_b16 v[120:121], v249 offset:0
    ds_read_b64_tr_b16 v[122:123], v249 offset:4096
    v_mfma_f32_16x16x32_bf16 a[164:167], v[124:127], v[80:83], a[164:167]
    ds_read_b64_tr_b16 v[124:125], v250 offset:0
    ds_read_b64_tr_b16 v[126:127], v250 offset:4096
    v_mfma_f32_16x16x32_bf16 a[168:171], v[128:131], v[80:83], a[168:171]
    ds_read_b64_tr_b16 v[128:129], v249 offset:256
    ds_read_b64_tr_b16 v[130:131], v249 offset:4352
    v_mfma_f32_16x16x32_bf16 a[172:175], v[132:135], v[80:83], a[172:175]
    ds_read_b64_tr_b16 v[132:133], v250 offset:256
    ds_read_b64_tr_b16 v[134:135], v250 offset:4352
    v_mfma_f32_16x16x32_bf16 a[176:179], v[136:139], v[80:83], a[176:179]
    ds_read_b64_tr_b16 v[136:137], v249 offset:512
    ds_read_b64_tr_b16 v[138:139], v249 offset:4608
    v_mfma_f32_16x16x32_bf16 a[180:183], v[140:143], v[80:83], a[180:183]
    ds_read_b64_tr_b16 v[140:141], v250 offset:512
    ds_read_b64_tr_b16 v[142:143], v250 offset:4608
    v_mfma_f32_16x16x32_bf16 a[184:187], v[144:147], v[80:83], a[184:187]
    ds_read_b64_tr_b16 v[144:145], v249 offset:768
    ds_read_b64_tr_b16 v[146:147], v249 offset:4864
    v_mfma_f32_16x16x32_bf16 a[188:191], v[148:151], v[80:83], a[188:191]
    ds_read_b64_tr_b16 v[148:149], v250 offset:768
    ds_read_b64_tr_b16 v[150:151], v250 offset:4864
    v_mfma_f32_16x16x32_bf16 a[212:215], a[216:219], v[80:83], a[212:215]
    s_waitcnt vmcnt(3)
    buffer_load_dwordx4 v2, s[4:7], s65 offen offset:1024 nt lds
    v_mfma_f32_16x16x32_bf16 v[64:67], v[88:91], v[200:203], v[28:31]
    v_exp_f32 v44, v44
    v_mfma_f32_16x16x32_bf16 v[64:67], v[92:95], v[204:207], v[64:67]
    v_exp_f32 v45, v45
    v_mfma_f32_16x16x32_bf16 v[64:67], v[96:99], v[208:211], v[64:67]
    v_exp_f32 v46, v46
    v_mfma_f32_16x16x32_bf16 v[64:67], v[100:103], v[212:215], v[64:67]
    v_exp_f32 v47, v47
    v_mfma_f32_16x16x32_bf16 v[68:71], v[104:107], v[200:203], v[28:31]
    v_cvt_pk_bf16_f32 v42, v44, v45
    v_cvt_pk_bf16_f32 v43, v46, v47
    v_mfma_f32_16x16x32_bf16 v[68:71], v[108:111], v[204:207], v[68:71]
    v_exp_f32 v48, v48
    v_mfma_f32_16x16x32_bf16 v[68:71], v[112:115], v[208:211], v[68:71]
    v_exp_f32 v49, v49
    v_mfma_f32_16x16x32_bf16 v[68:71], v[116:119], v[212:215], v[68:71]
    s_waitcnt lgkmcnt(0)
    v_mfma_f32_16x16x32_bf16 a[0:3], v[120:123], v[40:43], a[0:3]
    s_waitcnt vmcnt(3)
    buffer_load_dwordx4 v1, s[4:7], s65 offen offset:2048 nt lds
    v_mfma_f32_16x16x32_bf16 a[4:7], v[124:127], v[40:43], a[4:7]
    v_exp_f32 v50, v50
    v_mfma_f32_16x16x32_bf16 a[8:11], v[128:131], v[40:43], a[8:11]
    v_exp_f32 v51, v51
    v_mfma_f32_16x16x32_bf16 a[12:15], v[132:135], v[40:43], a[12:15]
    v_cvt_pk_bf16_f32 v48, v48, v49
    v_cvt_pk_bf16_f32 v49, v50, v51
    v_mfma_f32_16x16x32_bf16 a[16:19], v[136:139], v[40:43], a[16:19]
    v_exp_f32 v52, v52
    v_mfma_f32_16x16x32_bf16 a[20:23], v[140:143], v[40:43], a[20:23]
    v_exp_f32 v53, v53
    v_mfma_f32_16x16x32_bf16 a[24:27], v[144:147], v[40:43], a[24:27]
    v_exp_f32 v54, v54
    v_mfma_f32_16x16x32_bf16 a[28:31], v[148:151], v[40:43], a[28:31]
    v_max3_f32 v6, v56, v57, v58
    v_max3_f32 v9, v64, v65, v66
    v_mfma_f32_16x16x32_bf16 a[192:195], a[216:219], v[40:43], a[192:195]
    v_max3_f32 v6, v6, v59, v60
    v_max3_f32 v9, v9, v67, v68
    v_mfma_f32_16x16x32_bf16 v[72:75], v[88:91], v[216:219], v[32:35]
    v_max3_f32 v6, v6, v61, v62
    v_max3_f32 v9, v9, v69, v70
    v_mfma_f32_16x16x32_bf16 v[72:75], v[92:95], v[220:223], v[72:75]
    v_max3_f32 v6, v6, v63, v71
    v_max_f32 v6, v6, v9
    v_mfma_f32_16x16x32_bf16 v[72:75], v[96:99], v[224:227], v[72:75]
    v_cmp_lt_f32 vcc, s61, v6
    v_mfma_f32_16x16x32_bf16 v[72:75], v[100:103], v[228:231], v[72:75]
    v_exp_f32 v55, v55
    v_mfma_f32_16x16x32_bf16 v[76:79], v[104:107], v[216:219], v[32:35]
    s_waitcnt vmcnt(3)
    buffer_load_dwordx4 v2, s[4:7], s65 offen offset:3072 nt lds
    v_mfma_f32_16x16x32_bf16 v[76:79], v[108:111], v[220:223], v[76:79]
    v_cvt_pk_bf16_f32 v50, v52, v53
    v_cvt_pk_bf16_f32 v51, v54, v55
    v_mfma_f32_16x16x32_bf16 v[76:79], v[112:115], v[224:227], v[76:79]
    s_cbranch_vccnz L_stub2_22
L_back2_22:
    v_mfma_f32_16x16x32_bf16 v[76:79], v[116:119], v[228:231], v[76:79]
    v_exp_f32 v56, v56
    v_mfma_f32_16x16x32_bf16 a[32:35], v[120:123], v[48:51], a[32:35]
    v_exp_f32 v57, v57
    v_mfma_f32_16x16x32_bf16 a[36:39], v[124:127], v[48:51], a[36:39]
    v_exp_f32 v58, v58
    v_mfma_f32_16x16x32_bf16 a[40:43], v[128:131], v[48:51], a[40:43]
    v_exp_f32 v59, v59
    v_mfma_f32_16x16x32_bf16 a[44:47], v[132:135], v[48:51], a[44:47]
    v_cvt_pk_bf16_f32 v56, v56, v57
    v_cvt_pk_bf16_f32 v57, v58, v59
    v_mfma_f32_16x16x32_bf16 a[48:51], v[136:139], v[48:51], a[48:51]
    v_exp_f32 v60, v60
    v_mfma_f32_16x16x32_bf16 a[52:55], v[140:143], v[48:51], a[52:55]
    v_exp_f32 v61, v61
    v_mfma_f32_16x16x32_bf16 a[56:59], v[144:147], v[48:51], a[56:59]
    v_exp_f32 v62, v62
    v_mfma_f32_16x16x32_bf16 a[60:63], v[148:151], v[48:51], a[60:63]
    v_exp_f32 v63, v63
    v_mfma_f32_16x16x32_bf16 a[196:199], a[216:219], v[48:51], a[196:199]
    v_cvt_pk_bf16_f32 v58, v60, v61
    v_cvt_pk_bf16_f32 v59, v62, v63
    s_barrier
    v_mfma_f32_16x16x32_bf16 v[80:83], v[88:91], v[232:235], v[36:39]
    v_exp_f32 v64, v64
    v_mfma_f32_16x16x32_bf16 v[80:83], v[92:95], v[236:239], v[80:83]
    ds_read_b128 v[88:91], v248 offset:32768
    ds_read_b128 v[92:95], v248 offset:33024
    v_mfma_f32_16x16x32_bf16 v[80:83], v[96:99], v[240:243], v[80:83]
    s_add_u32 m0, s58, 32768
    s_mov_b32 s65, 212992
    v_mfma_f32_16x16x32_bf16 v[80:83], v[100:103], v[244:247], v[80:83]
    ds_read_b128 v[96:99], v248 offset:33280
    ds_read_b128 v[100:103], v248 offset:33536
    v_mfma_f32_16x16x32_bf16 v[84:87], v[104:107], v[232:235], v[36:39]
    s_waitcnt vmcnt(3)
    buffer_load_dwordx4 v1, s[28:31], s65 offen offset:0 nt lds
    v_mfma_f32_16x16x32_bf16 v[84:87], v[108:111], v[236:239], v[84:87]
    ds_read_b128 v[104:107], v248 offset:36864
    ds_read_b128 v[108:111], v248 offset:37120
    v_mfma_f32_16x16x32_bf16 v[84:87], v[112:115], v[240:243], v[84:87]
    v_exp_f32 v65, v65
    v_mfma_f32_16x16x32_bf16 v[84:87], v[116:119], v[244:247], v[84:87]
    ds_read_b128 v[112:115], v248 offset:37376
    ds_read_b128 v[116:119], v248 offset:37632
    v_mfma_f32_16x16x32_bf16 a[64:67], v[120:123], v[56:59], a[64:67]
    v_exp_f32 v66, v66
    v_mfma_f32_16x16x32_bf16 a[68:71], v[124:127], v[56:59], a[68:71]
    v_exp_f32 v67, v67
    v_mfma_f32_16x16x32_bf16 a[72:75], v[128:131], v[56:59], a[72:75]
    v_cvt_pk_bf16_f32 v64, v64, v65
    v_cvt_pk_bf16_f32 v65, v66, v67
    v_mfma_f32_16x16x32_bf16 a[76:79], v[132:135], v[56:59], a[76:79]
    v_exp_f32 v68, v68
    v_mfma_f32_16x16x32_bf16 a[80:83], v[136:139], v[56:59], a[80:83]
    v_exp_f32 v69, v69
    v_mfma_f32_16x16x32_bf16 a[84:87], v[140:143], v[56:59], a[84:87]
    v_exp_f32 v70, v70
    v_mfma_f32_16x16x32_bf16 a[88:91], v[144:147], v[56:59], a[88:91]
    s_waitcnt vmcnt(3)
    buffer_load_dwordx4 v2, s[28:31], s65 offen offset:1024 nt lds
    v_mfma_f32_16x16x32_bf16 a[92:95], v[148:151], v[56:59], a[92:95]
    v_max3_f32 v6, v72, v73, v74
    v_max3_f32 v9, v80, v81, v82
    v_mfma_f32_16x16x32_bf16 a[200:203], a[216:219], v[56:59], a[200:203]
    s_waitcnt lgkmcnt(0)
    v_mfma_f32_16x16x32_bf16 v[40:43], v[88:91], v[152:155], v[16:19]
    v_max3_f32 v6, v6, v75, v76
    v_max3_f32 v9, v9, v83, v84
    v_mfma_f32_16x16x32_bf16 v[40:43], v[92:95], v[156:159], v[40:43]
    v_max3_f32 v6, v6, v77, v78
    v_max3_f32 v9, v9, v85, v86
    v_mfma_f32_16x16x32_bf16 v[40:43], v[96:99], v[160:163], v[40:43]
    v_max3_f32 v6, v6, v79, v87
    v_max_f32 v6, v6, v9
    v_mfma_f32_16x16x32_bf16 v[40:43], v[100:103], v[164:167], v[40:43]
    v_cmp_lt_f32 vcc, s61, v6
    v_mfma_f32_16x16x32_bf16 v[44:47], v[104:107], v[152:155], v[16:19]
    v_exp_f32 v71, v71
    v_mfma_f32_16x16x32_bf16 v[44:47], v[108:111], v[156:159], v[44:47]
    v_cvt_pk_bf16_f32 v66, v68, v69
    v_cvt_pk_bf16_f32 v67, v70, v71
    v_mfma_f32_16x16x32_bf16 v[44:47], v[112:115], v[160:163], v[44:47]
    s_cbranch_vccnz L_stub4_23
L_back4_23:
    v_mfma_f32_16x16x32_bf16 v[44:47], v[116:119], v[164:167], v[44:47]
    v_exp_f32 v72, v72
    v_mfma_f32_16x16x32_bf16 a[96:99], v[120:123], v[64:67], a[96:99]
    v_exp_f32 v73, v73
    v_mfma_f32_16x16x32_bf16 a[100:103], v[124:127], v[64:67], a[100:103]
    v_exp_f32 v74, v74
    v_mfma_f32_16x16x32_bf16 a[104:107], v[128:131], v[64:67], a[104:107]
    s_waitcnt vmcnt(3)
    buffer_load_dwordx4 v1, s[28:31], s65 offen offset:2048 nt lds
    v_mfma_f32_16x16x32_bf16 a[108:111], v[132:135], v[64:67], a[108:111]
    v_exp_f32 v75, v75
    v_mfma_f32_16x16x32_bf16 a[112:115], v[136:139], v[64:67], a[112:115]
    v_cvt_pk_bf16_f32 v72, v72, v73
    v_cvt_pk_bf16_f32 v73, v74, v75
    v_mfma_f32_16x16x32_bf16 a[116:119], v[140:143], v[64:67], a[116:119]
    v_exp_f32 v76, v76
    v_mfma_f32_16x16x32_bf16 a[120:123], v[144:147], v[64:67], a[120:123]
    v_exp_f32 v77, v77
    v_mfma_f32_16x16x32_bf16 a[124:127], v[148:151], v[64:67], a[124:127]
    v_exp_f32 v78, v78
    v_mfma_f32_16x16x32_bf16 a[204:207], a[216:219], v[64:67], a[204:207]
    v_exp_f32 v79, v79
    v_mfma_f32_16x16x32_bf16 v[48:51], v[88:91], v[168:171], v[20:23]
    v_cvt_pk_bf16_f32 v74, v76, v77
    v_cvt_pk_bf16_f32 v75, v78, v79
    v_mfma_f32_16x16x32_bf16 v[48:51], v[92:95], v[172:175], v[48:51]
    v_exp_f32 v80, v80
    v_mfma_f32_16x16x32_bf16 v[48:51], v[96:99], v[176:179], v[48:51]
    v_exp_f32 v81, v81
    v_mfma_f32_16x16x32_bf16 v[48:51], v[100:103], v[180:183], v[48:51]
    v_exp_f32 v82, v82
    v_mfma_f32_16x16x32_bf16 v[52:55], v[104:107], v[168:171], v[20:23]
    v_exp_f32 v83, v83
    v_mfma_f32_16x16x32_bf16 v[52:55], v[108:111], v[172:175], v[52:55]
    v_cvt_pk_bf16_f32 v80, v80, v81
    v_cvt_pk_bf16_f32 v81, v82, v83
    v_mfma_f32_16x16x32_bf16 v[52:55], v[112:115], v[176:179], v[52:55]
    v_exp_f32 v84, v84
    v_mfma_f32_16x16x32_bf16 v[52:55], v[116:119], v[180:183], v[52:55]
    s_waitcnt vmcnt(3)
    buffer_load_dwordx4 v2, s[28:31], s65 offen offset:3072 nt lds
    v_mfma_f32_16x16x32_bf16 a[128:131], v[120:123], v[72:75], a[128:131]
    v_exp_f32 v85, v85
    v_mfma_f32_16x16x32_bf16 a[132:135], v[124:127], v[72:75], a[132:135]
    v_exp_f32 v86, v86
    v_mfma_f32_16x16x32_bf16 a[136:139], v[128:131], v[72:75], a[136:139]
    v_max3_f32 v6, v40, v41, v42
    v_max3_f32 v9, v48, v49, v50
    v_mfma_f32_16x16x32_bf16 a[140:143], v[132:135], v[72:75], a[140:143]
    v_max3_f32 v6, v6, v43, v44
    v_max3_f32 v9, v9, v51, v52
    v_mfma_f32_16x16x32_bf16 a[144:147], v[136:139], v[72:75], a[144:147]
    v_max3_f32 v6, v6, v45, v46
    v_max3_f32 v9, v9, v53, v54
    v_mfma_f32_16x16x32_bf16 a[148:151], v[140:143], v[72:75], a[148:151]
    v_max3_f32 v6, v6, v47, v55
    v_max_f32 v6, v6, v9
    v_mfma_f32_16x16x32_bf16 a[152:155], v[144:147], v[72:75], a[152:155]
    v_cmp_lt_f32 vcc, s61, v6
    v_mfma_f32_16x16x32_bf16 a[156:159], v[148:151], v[72:75], a[156:159]
    v_exp_f32 v87, v87
    v_mfma_f32_16x16x32_bf16 a[208:211], a[216:219], v[72:75], a[208:211]
    v_cvt_pk_bf16_f32 v82, v84, v85
    v_cvt_pk_bf16_f32 v83, v86, v87
    v_mfma_f32_16x16x32_bf16 v[56:59], v[88:91], v[184:187], v[24:27]
    s_cbranch_vccnz L_stub0_23
L_back0_23:
    v_mfma_f32_16x16x32_bf16 v[56:59], v[92:95], v[188:191], v[56:59]
    v_exp_f32 v40, v40
    v_mfma_f32_16x16x32_bf16 v[56:59], v[96:99], v[192:195], v[56:59]
    v_exp_f32 v41, v41
    v_mfma_f32_16x16x32_bf16 v[56:59], v[100:103], v[196:199], v[56:59]
    s_add_u32 m0, s58, 40960
    v_mfma_f32_16x16x32_bf16 v[60:63], v[104:107], v[184:187], v[24:27]
    s_waitcnt vmcnt(3)
    buffer_load_dwordx4 v1, s[4:7], s65 offen offset:0 nt lds
    v_mfma_f32_16x16x32_bf16 v[60:63], v[108:111], v[188:191], v[60:63]
    v_exp_f32 v42, v42
    v_mfma_f32_16x16x32_bf16 v[60:63], v[112:115], v[192:195], v[60:63]
    v_exp_f32 v43, v43
    v_mfma_f32_16x16x32_bf16 v[60:63], v[116:119], v[196:199], v[60:63]
    v_cvt_pk_bf16_f32 v40, v40, v41
    v_cvt_pk_bf16_f32 v41, v42, v43
    v_mfma_f32_16x16x32_bf16 a[160:163], v[120:123], v[80:83], a[160:163]
    ds_read_b64_tr_b16 v[120:121], v249 offset:32768
    ds_read_b64_tr_b16 v[122:123], v249 offset:36864
    v_mfma_f32_16x16x32_bf16 a[164:167], v[124:127], v[80:83], a[164:167]
    ds_read_b64_tr_b16 v[124:125], v250 offset:32768
    ds_read_b64_tr_b16 v[126:127], v250 offset:36864
    v_mfma_f32_16x16x32_bf16 a[168:171], v[128:131], v[80:83], a[168:171]
    ds_read_b64_tr_b16 v[128:129], v249 offset:33024
    ds_read_b64_tr_b16 v[130:131], v249 offset:37120
    v_mfma_f32_16x16x32_bf16 a[172:175], v[132:135], v[80:83], a[172:175]
    ds_read_b64_tr_b16 v[132:133], v250 offset:33024
    ds_read_b64_tr_b16 v[134:135], v250 offset:37120
    v_mfma_f32_16x16x32_bf16 a[176:179], v[136:139], v[80:83], a[176:179]
    ds_read_b64_tr_b16 v[136:137], v249 offset:33280
    ds_read_b64_tr_b16 v[138:139], v249 offset:37376
    v_mfma_f32_16x16x32_bf16 a[180:183], v[140:143], v[80:83], a[180:183]
    ds_read_b64_tr_b16 v[140:141], v250 offset:33280
    ds_read_b64_tr_b16 v[142:143], v250 offset:37376
    v_mfma_f32_16x16x32_bf16 a[184:187], v[144:147], v[80:83], a[184:187]
    ds_read_b64_tr_b16 v[144:145], v249 offset:33536
    ds_read_b64_tr_b16 v[146:147], v249 offset:37632
    v_mfma_f32_16x16x32_bf16 a[188:191], v[148:151], v[80:83], a[188:191]
    ds_read_b64_tr_b16 v[148:149], v250 offset:33536
    ds_read_b64_tr_b16 v[150:151], v250 offset:37632
    v_mfma_f32_16x16x32_bf16 a[212:215], a[216:219], v[80:83], a[212:215]
    s_waitcnt vmcnt(3)
    buffer_load_dwordx4 v2, s[4:7], s65 offen offset:1024 nt lds
    v_mfma_f32_16x16x32_bf16 v[64:67], v[88:91], v[200:203], v[28:31]
    v_exp_f32 v44, v44
    v_mfma_f32_16x16x32_bf16 v[64:67], v[92:95], v[204:207], v[64:67]
    v_exp_f32 v45, v45
    v_mfma_f32_16x16x32_bf16 v[64:67], v[96:99], v[208:211], v[64:67]
    v_exp_f32 v46, v46
    v_mfma_f32_16x16x32_bf16 v[64:67], v[100:103], v[212:215], v[64:67]
    v_exp_f32 v47, v47
    v_mfma_f32_16x16x32_bf16 v[68:71], v[104:107], v[200:203], v[28:31]
    v_cvt_pk_bf16_f32 v42, v44, v45
    v_cvt_pk_bf16_f32 v43, v46, v47
    v_mfma_f32_16x16x32_bf16 v[68:71], v[108:111], v[204:207], v[68:71]
    v_exp_f32 v48, v48
    v_mfma_f32_16x16x32_bf16 v[68:71], v[112:115], v[208:211], v[68:71]
    v_exp_f32 v49, v49
    v_mfma_f32_16x16x32_bf16 v[68:71], v[116:119], v[212:215], v[68:71]
    s_waitcnt lgkmcnt(0)
    v_mfma_f32_16x16x32_bf16 a[0:3], v[120:123], v[40:43], a[0:3]
    v_exp_f32 v50, v50
    v_mfma_f32_16x16x32_bf16 a[4:7], v[124:127], v[40:43], a[4:7]
    v_exp_f32 v51, v51
    v_mfma_f32_16x16x32_bf16 a[8:11], v[128:131], v[40:43], a[8:11]
    v_cvt_pk_bf16_f32 v48, v48, v49
    v_cvt_pk_bf16_f32 v49, v50, v51
    v_mfma_f32_16x16x32_bf16 a[12:15], v[132:135], v[40:43], a[12:15]
    v_exp_f32 v52, v52
    v_mfma_f32_16x16x32_bf16 a[16:19], v[136:139], v[40:43], a[16:19]
    v_exp_f32 v53, v53
    v_mfma_f32_16x16x32_bf16 a[20:23], v[140:143], v[40:43], a[20:23]
    s_waitcnt vmcnt(3)
    buffer_load_dwordx4 v1, s[4:7], s65 offen offset:2048 nt lds
    v_mfma_f32_16x16x32_bf16 a[24:27], v[144:147], v[40:43], a[24:27]
    v_exp_f32 v54, v54
    v_mfma_f32_16x16x32_bf16 a[28:31], v[148:151], v[40:43], a[28:31]
    v_max3_f32 v6, v56, v57, v58
    v_max3_f32 v9, v64, v65, v66
    v_mfma_f32_16x16x32_bf16 a[192:195], a[216:219], v[40:43], a[192:195]
    v_max3_f32 v6, v6, v59, v60
    v_max3_f32 v9, v9, v67, v68
    v_mfma_f32_16x16x32_bf16 v[72:75], v[88:91], v[216:219], v[32:35]
    v_max3_f32 v6, v6, v61, v62
    v_max3_f32 v9, v9, v69, v70
    v_mfma_f32_16x16x32_bf16 v[72:75], v[92:95], v[220:223], v[72:75]
    v_max3_f32 v6, v6, v63, v71
    v_max_f32 v6, v6, v9
    v_mfma_f32_16x16x32_bf16 v[72:75], v[96:99], v[224:227], v[72:75]
    v_cmp_lt_f32 vcc, s61, v6
    v_mfma_f32_16x16x32_bf16 v[72:75], v[100:103], v[228:231], v[72:75]
    v_exp_f32 v55, v55
    v_mfma_f32_16x16x32_bf16 v[76:79], v[104:107], v[216:219], v[32:35]
    v_cvt_pk_bf16_f32 v50, v52, v53
    v_cvt_pk_bf16_f32 v51, v54, v55
    v_mfma_f32_16x16x32_bf16 v[76:79], v[108:111], v[220:223], v[76:79]
    s_cbranch_vccnz L_stub2_23
L_back2_23:
    v_mfma_f32_16x16x32_bf16 v[76:79], v[112:115], v[224:227], v[76:79]
    v_exp_f32 v56, v56
    v_mfma_f32_16x16x32_bf16 v[76:79], v[116:119], v[228:231], v[76:79]
    v_exp_f32 v57, v57
    v_mfma_f32_16x16x32_bf16 a[32:35], v[120:123], v[48:51], a[32:35]
    v_exp_f32 v58, v58
    v_mfma_f32_16x16x32_bf16 a[36:39], v[124:127], v[48:51], a[36:39]
    s_waitcnt vmcnt(3)
    buffer_load_dwordx4 v2, s[4:7], s65 offen offset:3072 nt lds
    v_mfma_f32_16x16x32_bf16 a[40:43], v[128:131], v[48:51], a[40:43]
    v_exp_f32 v59, v59
    v_mfma_f32_16x16x32_bf16 a[44:47], v[132:135], v[48:51], a[44:47]
    v_cvt_pk_bf16_f32 v56, v56, v57
    v_cvt_pk_bf16_f32 v57, v58, v59
    v_mfma_f32_16x16x32_bf16 a[48:51], v[136:139], v[48:51], a[48:51]
    v_exp_f32 v60, v60
    v_mfma_f32_16x16x32_bf16 a[52:55], v[140:143], v[48:51], a[52:55]
    v_exp_f32 v61, v61
    v_mfma_f32_16x16x32_bf16 a[56:59], v[144:147], v[48:51], a[56:59]
    v_exp_f32 v62, v62
    v_mfma_f32_16x16x32_bf16 a[60:63], v[148:151], v[48:51], a[60:63]
    v_exp_f32 v63, v63
    v_mfma_f32_16x16x32_bf16 a[196:199], a[216:219], v[48:51], a[196:199]
    v_cvt_pk_bf16_f32 v58, v60, v61
    v_cvt_pk_bf16_f32 v59, v62, v63
    s_barrier
    v_mfma_f32_16x16x32_bf16 v[80:83], v[88:91], v[232:235], v[36:39]
    v_exp_f32 v64, v64
    v_mfma_f32_16x16x32_bf16 v[80:83], v[92:95], v[236:239], v[80:83]
    ds_read_b128 v[88:91], v251 offset:0
    ds_read_b128 v[92:95], v251 offset:256
    v_mfma_f32_16x16x32_bf16 v[80:83], v[96:99], v[240:243], v[80:83]
    v_exp_f32 v65, v65
    v_mfma_f32_16x16x32_bf16 v[80:83], v[100:103], v[244:247], v[80:83]
    ds_read_b128 v[96:99], v251 offset:512
    ds_read_b128 v[100:103], v251 offset:768
    v_mfma_f32_16x16x32_bf16 v[84:87], v[104:107], v[232:235], v[36:39]
    v_exp_f32 v66, v66
    v_mfma_f32_16x16x32_bf16 v[84:87], v[108:111], v[236:239], v[84:87]
    ds_read_b128 v[104:107], v251 offset:4096
    ds_read_b128 v[108:111], v251 offset:4352
    v_mfma_f32_16x16x32_bf16 v[84:87], v[112:115], v[240:243], v[84:87]
    s_add_u32 m0, s58, 65536
    s_mov_b32 s65, 221184
    v_mfma_f32_16x16x32_bf16 v[84:87], v[116:119], v[244:247], v[84:87]
    ds_read_b128 v[112:115], v251 offset:4608
    ds_read_b128 v[116:119], v251 offset:4864
    v_mfma_f32_16x16x32_bf16 a[64:67], v[120:123], v[56:59], a[64:67]
    s_waitcnt vmcnt(3)
    buffer_load_dwordx4 v1, s[28:31], s65 offen offset:0 nt lds
    v_mfma_f32_16x16x32_bf16 a[68:71], v[124:127], v[56:59], a[68:71]
    v_exp_f32 v67, v67
    v_mfma_f32_16x16x32_bf16 a[72:75], v[128:131], v[56:59], a[72:75]
    v_cvt_pk_bf16_f32 v64, v64, v65
    v_cvt_pk_bf16_f32 v65, v66, v67
    v_mfma_f32_16x16x32_bf16 a[76:79], v[132:135], v[56:59], a[76:79]
    v_exp_f32 v68, v68
    v_mfma_f32_16x16x32_bf16 a[80:83], v[136:139], v[56:59], a[80:83]
    v_exp_f32 v69, v69
    v_mfma_f32_16x16x32_bf16 a[84:87], v[140:143], v[56:59], a[84:87]
    v_exp_f32 v70, v70
    v_mfma_f32_16x16x32_bf16 a[88:91], v[144:147], v[56:59], a[88:91]
    v_max3_f32 v6, v72, v73, v74
    v_max3_f32 v9, v80, v81, v82
    v_mfma_f32_16x16x32_bf16 a[92:95], v[148:151], v[56:59], a[92:95]
    v_max3_f32 v6, v6, v75, v76
    v_max3_f32 v9, v9, v83, v84
    v_mfma_f32_16x16x32_bf16 a[200:203], a[216:219], v[56:59], a[200:203]
    s_waitcnt lgkmcnt(0)
    v_mfma_f32_16x16x32_bf16 v[40:43], v[88:91], v[152:155], v[16:19]
    v_max3_f32 v6, v6, v77, v78
    v_max3_f32 v9, v9, v85, v86
    v_mfma_f32_16x16x32_bf16 v[40:43], v[92:95], v[156:159], v[40:43]
    v_max3_f32 v6, v6, v79, v87
    v_max_f32 v6, v6, v9
    v_mfma_f32_16x16x32_bf16 v[40:43], v[96:99], v[160:163], v[40:43]
    s_waitcnt vmcnt(3)
    buffer_load_dwordx4 v2, s[28:31], s65 offen offset:1024 nt lds
    v_mfma_f32_16x16x32_bf16 v[40:43], v[100:103], v[164:167], v[40:43]
    v_cmp_lt_f32 vcc, s61, v6
    v_mfma_f32_16x16x32_bf16 v[44:47], v[104:107], v[152:155], v[16:19]
    v_exp_f32 v71, v71
    v_mfma_f32_16x16x32_bf16 v[44:47], v[108:111], v[156:159], v[44:47]
    v_cvt_pk_bf16_f32 v66, v68, v69
    v_cvt_pk_bf16_f32 v67, v70, v71
    v_mfma_f32_16x16x32_bf16 v[44:47], v[112:115], v[160:163], v[44:47]
    s_cbranch_vccnz L_stub4_24
L_back4_24:
    v_mfma_f32_16x16x32_bf16 v[44:47], v[116:119], v[164:167], v[44:47]
    v_exp_f32 v72, v72
    v_mfma_f32_16x16x32_bf16 a[96:99], v[120:123], v[64:67], a[96:99]
    v_exp_f32 v73, v73
    v_mfma_f32_16x16x32_bf16 a[100:103], v[124:127], v[64:67], a[100:103]
    v_exp_f32 v74, v74
    v_mfma_f32_16x16x32_bf16 a[104:107], v[128:131], v[64:67], a[104:107]
    v_exp_f32 v75, v75
    v_mfma_f32_16x16x32_bf16 a[108:111], v[132:135], v[64:67], a[108:111]
    v_cvt_pk_bf16_f32 v72, v72, v73
    v_cvt_pk_bf16_f32 v73, v74, v75
    v_mfma_f32_16x16x32_bf16 a[112:115], v[136:139], v[64:67], a[112:115]
    v_exp_f32 v76, v76
    v_mfma_f32_16x16x32_bf16 a[116:119], v[140:143], v[64:67], a[116:119]
    v_exp_f32 v77, v77
    v_mfma_f32_16x16x32_bf16 a[120:123], v[144:147], v[64:67], a[120:123]
    v_exp_f32 v78, v78
    v_mfma_f32_16x16x32_bf16 a[124:127], v[148:151], v[64:67], a[124:127]
    s_waitcnt vmcnt(3)
    buffer_load_dwordx4 v1, s[28:31], s65 offen offset:2048 nt lds
    v_mfma_f32_16x16x32_bf16 a[204:207], a[216:219], v[64:67], a[204:207]
    v_exp_f32 v79, v79
    v_mfma_f32_16x16x32_bf16 v[48:51], v[88:91], v[168:171], v[20:23]
    v_cvt_pk_bf16_f32 v74, v76, v77
    v_cvt_pk_bf16_f32 v75, v78, v79
    v_mfma_f32_16x16x32_bf16 v[48:51], v[92:95], v[172:175], v[48:51]
    v_exp_f32 v80, v80
    v_mfma_f32_16x16x32_bf16 v[48:51], v[96:99], v[176:179], v[48:51]
    v_exp_f32 v81, v81
    v_mfma_f32_16x16x32_bf16 v[48:51], v[100:103], v[180:183], v[48:51]
    v_exp_f32 v82, v82
    v_mfma_f32_16x16x32_bf16 v[52:55], v[104:107], v[168:171], v[20:23]
    v_exp_f32 v83, v83
    v_mfma_f32_16x16x32_bf16 v[52:55], v[108:111], v[172:175], v[52:55]
    v_cvt_pk_bf16_f32 v80, v80, v81
    v_cvt_pk_bf16_f32 v81, v82, v83
    v_mfma_f32_16x16x32_bf16 v[52:55], v[112:115], v[176:179], v[52:55]
    v_exp_f32 v84, v84
    v_mfma_f32_16x16x32_bf16 v[52:55], v[116:119], v[180:183], v[52:55]
    v_exp_f32 v85, v85
    v_mfma_f32_16x16x32_bf16 a[128:131], v[120:123], v[72:75], a[128:131]
    v_exp_f32 v86, v86
    v_mfma_f32_16x16x32_bf16 a[132:135], v[124:127], v[72:75], a[132:135]
    v_mfma_f32_16x16x32_bf16 a[136:139], v[128:131], v[72:75], a[136:139]
    v_max3_f32 v6, v40, v41, v42
    v_max3_f32 v9, v48, v49, v50
    v_mfma_f32_16x16x32_bf16 a[140:143], v[132:135], v[72:75], a[140:143]
    v_max3_f32 v6, v6, v43, v44
    v_max3_f32 v9, v9, v51, v52
    v_mfma_f32_16x16x32_bf16 a[144:147], v[136:139], v[72:75], a[144:147]
    s_waitcnt vmcnt(3)
    buffer_load_dwordx4 v2, s[28:31], s65 offen offset:3072 nt lds
    v_mfma_f32_16x16x32_bf16 a[148:151], v[140:143], v[72:75], a[148:151]
    v_max3_f32 v6, v6, v45, v46
    v_max3_f32 v9, v9, v53, v54
    v_mfma_f32_16x16x32_bf16 a[152:155], v[144:147], v[72:75], a[152:155]
    v_max3_f32 v6, v6, v47, v55
    v_max_f32 v6, v6, v9
    v_mfma_f32_16x16x32_bf16 a[156:159], v[148:151], v[72:75], a[156:159]
    v_cmp_lt_f32 vcc, s61, v6
    v_mfma_f32_16x16x32_bf16 a[208:211], a[216:219], v[72:75], a[208:211]
    v_exp_f32 v87, v87
    v_mfma_f32_16x16x32_bf16 v[56:59], v[88:91], v[184:187], v[24:27]
    v_cvt_pk_bf16_f32 v82, v84, v85
    v_cvt_pk_bf16_f32 v83, v86, v87
    v_mfma_f32_16x16x32_bf16 v[56:59], v[92:95], v[188:191], v[56:59]
    s_cbranch_vccnz L_stub0_24
L_back0_24:
    v_mfma_f32_16x16x32_bf16 v[56:59], v[96:99], v[192:195], v[56:59]
    v_exp_f32 v40, v40
    v_mfma_f32_16x16x32_bf16 v[56:59], v[100:103], v[196:199], v[56:59]
    v_exp_f32 v41, v41
    v_mfma_f32_16x16x32_bf16 v[60:63], v[104:107], v[184:187], v[24:27]
    v_exp_f32 v42, v42
    v_mfma_f32_16x16x32_bf16 v[60:63], v[108:111], v[188:191], v[60:63]
    v_exp_f32 v43, v43
    v_mfma_f32_16x16x32_bf16 v[60:63], v[112:115], v[192:195], v[60:63]
    v_cvt_pk_bf16_f32 v40, v40, v41
    v_cvt_pk_bf16_f32 v41, v42, v43
    v_mfma_f32_16x16x32_bf16 v[60:63], v[116:119], v[196:199], v[60:63]
    v_exp_f32 v44, v44
    v_mfma_f32_16x16x32_bf16 a[160:163], v[120:123], v[80:83], a[160:163]
    ds_read_b64_tr_b16 v[120:121], v252 offset:0
    ds_read_b64_tr_b16 v[122:123], v252 offset:4096
    v_mfma_f32_16x16x32_bf16 a[164:167], v[124:127], v[80:83], a[164:167]
    ds_read_b64_tr_b16 v[124:125], v253 offset:0
    ds_read_b64_tr_b16 v[126:127], v253 offset:4096
    v_mfma_f32_16x16x32_bf16 a[168:171], v[128:131], v[80:83], a[168:171]
    ds_read_b64_tr_b16 v[128:129], v252 offset:256
    ds_read_b64_tr_b16 v[130:131], v252 offset:4352
    v_mfma_f32_16x16x32_bf16 a[172:175], v[132:135], v[80:83], a[172:175]
    ds_read_b64_tr_b16 v[132:133], v253 offset:256
    ds_read_b64_tr_b16 v[134:135], v253 offset:4352
    v_mfma_f32_16x16x32_bf16 a[176:179], v[136:139], v[80:83], a[176:179]
    ds_read_b64_tr_b16 v[136:137], v252 offset:512
    ds_read_b64_tr_b16 v[138:139], v252 offset:4608
    v_mfma_f32_16x16x32_bf16 a[180:183], v[140:143], v[80:83], a[180:183]
    ds_read_b64_tr_b16 v[140:141], v253 offset:512
    ds_read_b64_tr_b16 v[142:143], v253 offset:4608
    v_mfma_f32_16x16x32_bf16 a[184:187], v[144:147], v[80:83], a[184:187]
    ds_read_b64_tr_b16 v[144:145], v252 offset:768
    ds_read_b64_tr_b16 v[146:147], v252 offset:4864
    v_mfma_f32_16x16x32_bf16 a[188:191], v[148:151], v[80:83], a[188:191]
    ds_read_b64_tr_b16 v[148:149], v253 offset:768
    ds_read_b64_tr_b16 v[150:151], v253 offset:4864
    v_mfma_f32_16x16x32_bf16 a[212:215], a[216:219], v[80:83], a[212:215]
    s_add_u32 m0, s58, 73728
    v_mfma_f32_16x16x32_bf16 v[64:67], v[88:91], v[200:203], v[28:31]
    s_waitcnt vmcnt(3)
    buffer_load_dwordx4 v1, s[4:7], s65 offen offset:0 nt lds
    v_mfma_f32_16x16x32_bf16 v[64:67], v[92:95], v[204:207], v[64:67]
    v_exp_f32 v45, v45
    v_mfma_f32_16x16x32_bf16 v[64:67], v[96:99], v[208:211], v[64:67]
    v_exp_f32 v46, v46
    v_mfma_f32_16x16x32_bf16 v[64:67], v[100:103], v[212:215], v[64:67]
    v_exp_f32 v47, v47
    v_mfma_f32_16x16x32_bf16 v[68:71], v[104:107], v[200:203], v[28:31]
    s_waitcnt vmcnt(3)
    buffer_load_dwordx4 v2, s[4:7], s65 offen offset:1024 nt lds
    v_mfma_f32_16x16x32_bf16 v[68:71], v[108:111], v[204:207], v[68:71]
    v_cvt_pk_bf16_f32 v42, v44, v45
    v_cvt_pk_bf16_f32 v43, v46, v47
    v_mfma_f32_16x16x32_bf16 v[68:71], v[112:115], v[208:211], v[68:71]
    v_exp_f32 v48, v48
    v_mfma_f32_16x16x32_bf16 v[68:71], v[116:119], v[212:215], v[68:71]
    s_waitcnt lgkmcnt(0)
    v_mfma_f32_16x16x32_bf16 a[0:3], v[120:123], v[40:43], a[0:3]
    v_exp_f32 v49, v49
    v_mfma_f32_16x16x32_bf16 a[4:7], v[124:127], v[40:43], a[4:7]
    v_exp_f32 v50, v50
    v_mfma_f32_16x16x32_bf16 a[8:11], v[128:131], v[40:43], a[8:11]
    v_exp_f32 v51, v51
    v_mfma_f32_16x16x32_bf16 a[12:15], v[132:135], v[40:43], a[12:15]
    v_cvt_pk_bf16_f32 v48, v48, v49
    v_cvt_pk_bf16_f32 v49, v50, v51
    v_mfma_f32_16x16x32_bf16 a[16:19], v[136:139], v[40:43], a[16:19]
    v_exp_f32 v52, v52
    v_mfma_f32_16x16x32_bf16 a[20:23], v[140:143], v[40:43], a[20:23]
    v_exp_f32 v53, v53
    v_mfma_f32_16x16x32_bf16 a[24:27], v[144:147], v[40:43], a[24:27]
    v_exp_f32 v54, v54
    v_mfma_f32_16x16x32_bf16 a[28:31], v[148:151], v[40:43], a[28:31]
    v_max3_f32 v6, v56, v57, v58
    v_max3_f32 v9, v64, v65, v66
    v_mfma_f32_16x16x32_bf16 a[192:195], a[216:219], v[40:43], a[192:195]
    v_max3_f32 v6, v6, v59, v60
    v_max3_f32 v9, v9, v67, v68
    v_mfma_f32_16x16x32_bf16 v[72:75], v[88:91], v[216:219], v[32:35]
    v_max3_f32 v6, v6, v61, v62
    v_max3_f32 v9, v9, v69, v70
    v_mfma_f32_16x16x32_bf16 v[72:75], v[92:95], v[220:223], v[72:75]
    s_waitcnt vmcnt(3)
    buffer_load_dwordx4 v1, s[4:7], s65 offen offset:2048 nt lds
    v_mfma_f32_16x16x32_bf16 v[72:75], v[96:99], v[224:227], v[72:75]
    v_max3_f32 v6, v6, v63, v71
    v_max_f32 v6, v6, v9
    v_mfma_f32_16x16x32_bf16 v[72:75], v[100:103], v[228:231], v[72:75]
    v_cmp_lt_f32 vcc, s61, v6
    v_mfma_f32_16x16x32_bf16 v[76:79], v[104:107], v[216:219], v[32:35]
    v_exp_f32 v55, v55
    v_mfma_f32_16x16x32_bf16 v[76:79], v[108:111], v[220:223], v[76:79]
    v_cvt_pk_bf16_f32 v50, v52, v53
    v_cvt_pk_bf16_f32 v51, v54, v55
    v_mfma_f32_16x16x32_bf16 v[76:79], v[112:115], v[224:227], v[76:79]
    s_cbranch_vccnz L_stub2_24
L_back2_24:
    v_mfma_f32_16x16x32_bf16 v[76:79], v[116:119], v[228:231], v[76:79]
    v_exp_f32 v56, v56
    v_mfma_f32_16x16x32_bf16 a[32:35], v[120:123], v[48:51], a[32:35]
    v_exp_f32 v57, v57
    v_mfma_f32_16x16x32_bf16 a[36:39], v[124:127], v[48:51], a[36:39]
    v_exp_f32 v58, v58
    v_mfma_f32_16x16x32_bf16 a[40:43], v[128:131], v[48:51], a[40:43]
    v_exp_f32 v59, v59
    v_mfma_f32_16x16x32_bf16 a[44:47], v[132:135], v[48:51], a[44:47]
    v_cvt_pk_bf16_f32 v56, v56, v57
    v_cvt_pk_bf16_f32 v57, v58, v59
    v_mfma_f32_16x16x32_bf16 a[48:51], v[136:139], v[48:51], a[48:51]
    v_exp_f32 v60, v60
    v_mfma_f32_16x16x32_bf16 a[52:55], v[140:143], v[48:51], a[52:55]
    v_exp_f32 v61, v61
    v_mfma_f32_16x16x32_bf16 a[56:59], v[144:147], v[48:51], a[56:59]
    s_waitcnt vmcnt(3)
    buffer_load_dwordx4 v2, s[4:7], s65 offen offset:3072 nt lds
    v_mfma_f32_16x16x32_bf16 a[60:63], v[148:151], v[48:51], a[60:63]
    v_exp_f32 v62, v62
    v_mfma_f32_16x16x32_bf16 a[196:199], a[216:219], v[48:51], a[196:199]
    v_exp_f32 v63, v63
    v_cvt_pk_bf16_f32 v58, v60, v61
    v_cvt_pk_bf16_f32 v59, v62, v63
    s_barrier
    v_mfma_f32_16x16x32_bf16 v[80:83], v[88:91], v[232:235], v[36:39]
    v_exp_f32 v64, v64
    v_mfma_f32_16x16x32_bf16 v[80:83], v[92:95], v[236:239], v[80:83]
    ds_read_b128 v[88:91], v3 offset:0
    ds_read_b128 v[92:95], v3 offset:256
    v_mfma_f32_16x16x32_bf16 v[80:83], v[96:99], v[240:243], v[80:83]
    v_exp_f32 v65, v65
    v_mfma_f32_16x16x32_bf16 v[80:83], v[100:103], v[244:247], v[80:83]
    ds_read_b128 v[96:99], v3 offset:512
    ds_read_b128 v[100:103], v3 offset:768
    v_mfma_f32_16x16x32_bf16 v[84:87], v[104:107], v[232:235], v[36:39]
    v_exp_f32 v66, v66
    v_mfma_f32_16x16x32_bf16 v[84:87], v[108:111], v[236:239], v[84:87]
    ds_read_b128 v[104:107], v3 offset:4096
    ds_read_b128 v[108:111], v3 offset:4352
    v_mfma_f32_16x16x32_bf16 v[84:87], v[112:115], v[240:243], v[84:87]
    v_exp_f32 v67, v67
    v_mfma_f32_16x16x32_bf16 v[84:87], v[116:119], v[244:247], v[84:87]
    ds_read_b128 v[112:115], v3 offset:4608
    ds_read_b128 v[116:119], v3 offset:4864
    v_mfma_f32_16x16x32_bf16 a[64:67], v[120:123], v[56:59], a[64:67]
    v_cvt_pk_bf16_f32 v64, v64, v65
    v_cvt_pk_bf16_f32 v65, v66, v67
    v_mfma_f32_16x16x32_bf16 a[68:71], v[124:127], v[56:59], a[68:71]
    v_exp_f32 v68, v68
    v_mfma_f32_16x16x32_bf16 a[72:75], v[128:131], v[56:59], a[72:75]
    s_add_u32 m0, s58, 98304
    s_mov_b32 s65, 229376
    v_mfma_f32_16x16x32_bf16 a[76:79], v[132:135], v[56:59], a[76:79]
    s_waitcnt vmcnt(3)
    buffer_load_dwordx4 v1, s[28:31], s65 offen offset:0 nt lds
    v_mfma_f32_16x16x32_bf16 a[80:83], v[136:139], v[56:59], a[80:83]
    v_exp_f32 v69, v69
    v_mfma_f32_16x16x32_bf16 a[84:87], v[140:143], v[56:59], a[84:87]
    v_exp_f32 v70, v70
    v_mfma_f32_16x16x32_bf16 a[88:91], v[144:147], v[56:59], a[88:91]
    v_max3_f32 v6, v72, v73, v74
    v_max3_f32 v9, v80, v81, v82
    v_mfma_f32_16x16x32_bf16 a[92:95], v[148:151], v[56:59], a[92:95]
    v_max3_f32 v6, v6, v75, v76
    v_max3_f32 v9, v9, v83, v84
    v_mfma_f32_16x16x32_bf16 a[200:203], a[216:219], v[56:59], a[200:203]
    s_waitcnt lgkmcnt(0)
    v_mfma_f32_16x16x32_bf16 v[40:43], v[88:91], v[152:155], v[16:19]
    v_max3_f32 v6, v6, v77, v78
    v_max3_f32 v9, v9, v85, v86
    v_mfma_f32_16x16x32_bf16 v[40:43], v[92:95], v[156:159], v[40:43]
    v_max3_f32 v6, v6, v79, v87
    v_max_f32 v6, v6, v9
    v_mfma_f32_16x16x32_bf16 v[40:43], v[96:99], v[160:163], v[40:43]
    v_cmp_lt_f32 vcc, s61, v6
    v_mfma_f32_16x16x32_bf16 v[40:43], v[100:103], v[164:167], v[40:43]
    v_exp_f32 v71, v71
    v_mfma_f32_16x16x32_bf16 v[44:47], v[104:107], v[152:155], v[16:19]
    v_cvt_pk_bf16_f32 v66, v68, v69
    v_cvt_pk_bf16_f32 v67, v70, v71
    v_mfma_f32_16x16x32_bf16 v[44:47], v[108:111], v[156:159], v[44:47]
    s_cbranch_vccnz L_stub4_25
L_back4_25:
    v_mfma_f32_16x16x32_bf16 v[44:47], v[112:115], v[160:163], v[44:47]
    v_exp_f32 v72, v72
    v_mfma_f32_16x16x32_bf16 v[44:47], v[116:119], v[164:167], v[44:47]
    s_waitcnt vmcnt(3)
    buffer_load_dwordx4 v2, s[28:31], s65 offen offset:1024 nt lds
    v_mfma_f32_16x16x32_bf16 a[96:99], v[120:123], v[64:67], a[96:99]
    v_exp_f32 v73, v73
    v_mfma_f32_16x16x32_bf16 a[100:103], v[124:127], v[64:67], a[100:103]
    v_exp_f32 v74, v74
    v_mfma_f32_16x16x32_bf16 a[104:107], v[128:131], v[64:67], a[104:107]
    v_exp_f32 v75, v75
    v_mfma_f32_16x16x32_bf16 a[108:111], v[132:135], v[64:67], a[108:111]
    v_cvt_pk_bf16_f32 v72, v72, v73
    v_cvt_pk_bf16_f32 v73, v74, v75
    v_mfma_f32_16x16x32_bf16 a[112:115], v[136:139], v[64:67], a[112:115]
    v_exp_f32 v76, v76
    v_mfma_f32_16x16x32_bf16 a[116:119], v[140:143], v[64:67], a[116:119]
    v_exp_f32 v77, v77
    v_mfma_f32_16x16x32_bf16 a[120:123], v[144:147], v[64:67], a[120:123]
    v_exp_f32 v78, v78
    v_mfma_f32_16x16x32_bf16 a[124:127], v[148:151], v[64:67], a[124:127]
    v_exp_f32 v79, v79
    v_mfma_f32_16x16x32_bf16 a[204:207], a[216:219], v[64:67], a[204:207]
    v_cvt_pk_bf16_f32 v74, v76, v77
    v_cvt_pk_bf16_f32 v75, v78, v79
    v_mfma_f32_16x16x32_bf16 v[48:51], v[88:91], v[168:171], v[20:23]
    v_exp_f32 v80, v80
    v_mfma_f32_16x16x32_bf16 v[48:51], v[92:95], v[172:175], v[48:51]
    v_exp_f32 v81, v81
    v_mfma_f32_16x16x32_bf16 v[48:51], v[96:99], v[176:179], v[48:51]
    v_exp_f32 v82, v82
    v_mfma_f32_16x16x32_bf16 v[48:51], v[100:103], v[180:183], v[48:51]
    s_waitcnt vmcnt(3)
    buffer_load_dwordx4 v1, s[28:31], s65 offen offset:2048 nt lds
    v_mfma_f32_16x16x32_bf16 v[52:55], v[104:107], v[168:171], v[20:23]
    v_exp_f32 v83, v83
    v_mfma_f32_16x16x32_bf16 v[52:55], v[108:111], v[172:175], v[52:55]
    v_cvt_pk_bf16_f32 v80, v80, v81
    v_cvt_pk_bf16_f32 v81, v82, v83
    v_mfma_f32_16x16x32_bf16 v[52:55], v[112:115], v[176:179], v[52:55]
    v_exp_f32 v84, v84
    v_mfma_f32_16x16x32_bf16 v[52:55], v[116:119], v[180:183], v[52:55]
    v_exp_f32 v85, v85
    v_mfma_f32_16x16x32_bf16 a[128:131], v[120:123], v[72:75], a[128:131]
    v_exp_f32 v86, v86
    v_mfma_f32_16x16x32_bf16 a[132:135], v[124:127], v[72:75], a[132:135]
    v_mfma_f32_16x16x32_bf16 a[136:139], v[128:131], v[72:75], a[136:139]
    v_max3_f32 v6, v40, v41, v42
    v_max3_f32 v9, v48, v49, v50
    v_mfma_f32_16x16x32_bf16 a[140:143], v[132:135], v[72:75], a[140:143]
    v_max3_f32 v6, v6, v43, v44
    v_max3_f32 v9, v9, v51, v52
    v_mfma_f32_16x16x32_bf16 a[144:147], v[136:139], v[72:75], a[144:147]
    v_max3_f32 v6, v6, v45, v46
    v_max3_f32 v9, v9, v53, v54
    v_mfma_f32_16x16x32_bf16 a[148:151], v[140:143], v[72:75], a[148:151]
    v_max3_f32 v6, v6, v47, v55
    v_max_f32 v6, v6, v9
    v_mfma_f32_16x16x32_bf16 a[152:155], v[144:147], v[72:75], a[152:155]
    v_cmp_lt_f32 vcc, s61, v6
    v_mfma_f32_16x16x32_bf16 a[156:159], v[148:151], v[72:75], a[156:159]
    v_exp_f32 v87, v87
    v_mfma_f32_16x16x32_bf16 a[208:211], a[216:219], v[72:75], a[208:211]
    v_cvt_pk_bf16_f32 v82, v84, v85
    v_cvt_pk_bf16_f32 v83, v86, v87
    v_mfma_f32_16x16x32_bf16 v[56:59], v[88:91], v[184:187], v[24:27]
    s_waitcnt vmcnt(3)
    buffer_load_dwordx4 v2, s[28:31], s65 offen offset:3072 nt lds
    v_mfma_f32_16x16x32_bf16 v[56:59], v[92:95], v[188:191], v[56:59]
    s_cbranch_vccnz L_stub0_25
L_back0_25:
    v_mfma_f32_16x16x32_bf16 v[56:59], v[96:99], v[192:195], v[56:59]
    v_exp_f32 v40, v40
    v_mfma_f32_16x16x32_bf16 v[56:59], v[100:103], v[196:199], v[56:59]
    v_exp_f32 v41, v41
    v_mfma_f32_16x16x32_bf16 v[60:63], v[104:107], v[184:187], v[24:27]
    v_exp_f32 v42, v42
    v_mfma_f32_16x16x32_bf16 v[60:63], v[108:111], v[188:191], v[60:63]
    v_exp_f32 v43, v43
    v_mfma_f32_16x16x32_bf16 v[60:63], v[112:115], v[192:195], v[60:63]
    v_cvt_pk_bf16_f32 v40, v40, v41
    v_cvt_pk_bf16_f32 v41, v42, v43
    v_mfma_f32_16x16x32_bf16 v[60:63], v[116:119], v[196:199], v[60:63]
    v_exp_f32 v44, v44
    v_mfma_f32_16x16x32_bf16 a[160:163], v[120:123], v[80:83], a[160:163]
    ds_read_b64_tr_b16 v[120:121], v4 offset:0
    ds_read_b64_tr_b16 v[122:123], v4 offset:4096
    v_mfma_f32_16x16x32_bf16 a[164:167], v[124:127], v[80:83], a[164:167]
    ds_read_b64_tr_b16 v[124:125], v5 offset:0
    ds_read_b64_tr_b16 v[126:127], v5 offset:4096
    v_mfma_f32_16x16x32_bf16 a[168:171], v[128:131], v[80:83], a[168:171]
    ds_read_b64_tr_b16 v[128:129], v4 offset:256
    ds_read_b64_tr_b16 v[130:131], v4 offset:4352
    v_mfma_f32_16x16x32_bf16 a[172:175], v[132:135], v[80:83], a[172:175]
    ds_read_b64_tr_b16 v[132:133], v5 offset:256
    ds_read_b64_tr_b16 v[134:135], v5 offset:4352
    v_mfma_f32_16x16x32_bf16 a[176:179], v[136:139], v[80:83], a[176:179]
    ds_read_b64_tr_b16 v[136:137], v4 offset:512
    ds_read_b64_tr_b16 v[138:139], v4 offset:4608
    v_mfma_f32_16x16x32_bf16 a[180:183], v[140:143], v[80:83], a[180:183]
    ds_read_b64_tr_b16 v[140:141], v5 offset:512
    ds_read_b64_tr_b16 v[142:143], v5 offset:4608
    v_mfma_f32_16x16x32_bf16 a[184:187], v[144:147], v[80:83], a[184:187]
    ds_read_b64_tr_b16 v[144:145], v4 offset:768
    ds_read_b64_tr_b16 v[146:147], v4 offset:4864
    v_mfma_f32_16x16x32_bf16 a[188:191], v[148:151], v[80:83], a[188:191]
    ds_read_b64_tr_b16 v[148:149], v5 offset:768
    ds_read_b64_tr_b16 v[150:151], v5 offset:4864
    v_mfma_f32_16x16x32_bf16 a[212:215], a[216:219], v[80:83], a[212:215]
    s_add_u32 m0, s58, 106496
    v_mfma_f32_16x16x32_bf16 v[64:67], v[88:91], v[200:203], v[28:31]
    s_waitcnt vmcnt(3)
    buffer_load_dwordx4 v1, s[4:7], s65 offen offset:0 nt lds
    v_mfma_f32_16x16x32_bf16 v[64:67], v[92:95], v[204:207], v[64:67]
    v_exp_f32 v45, v45
    v_mfma_f32_16x16x32_bf16 v[64:67], v[96:99], v[208:211], v[64:67]
    v_exp_f32 v46, v46
    v_mfma_f32_16x16x32_bf16 v[64:67], v[100:103], v[212:215], v[64:67]
    v_exp_f32 v47, v47
    v_mfma_f32_16x16x32_bf16 v[68:71], v[104:107], v[200:203], v[28:31]
    v_cvt_pk_bf16_f32 v42, v44, v45
    v_cvt_pk_bf16_f32 v43, v46, v47
    v_mfma_f32_16x16x32_bf16 v[68:71], v[108:111], v[204:207], v[68:71]
    v_exp_f32 v48, v48
    v_mfma_f32_16x16x32_bf16 v[68:71], v[112:115], v[208:211], v[68:71]
    v_exp_f32 v49, v49
    v_mfma_f32_16x16x32_bf16 v[68:71], v[116:119], v[212:215], v[68:71]
    s_waitcnt lgkmcnt(0)
    v_mfma_f32_16x16x32_bf16 a[0:3], v[120:123], v[40:43], a[0:3]
    v_exp_f32 v50, v50
    v_mfma_f32_16x16x32_bf16 a[4:7], v[124:127], v[40:43], a[4:7]
    s_waitcnt vmcnt(3)
    buffer_load_dwordx4 v2, s[4:7], s65 offen offset:1024 nt lds
    v_mfma_f32_16x16x32_bf16 a[8:11], v[128:131], v[40:43], a[8:11]
    v_exp_f32 v51, v51
    v_mfma_f32_16x16x32_bf16 a[12:15], v[132:135], v[40:43], a[12:15]
    v_cvt_pk_bf16_f32 v48, v48, v49
    v_cvt_pk_bf16_f32 v49, v50, v51
    v_mfma_f32_16x16x32_bf16 a[16:19], v[136:139], v[40:43], a[16:19]
    v_exp_f32 v52, v52
    v_mfma_f32_16x16x32_bf16 a[20:23], v[140:143], v[40:43], a[20:23]
    v_exp_f32 v53, v53
    v_mfma_f32_16x16x32_bf16 a[24:27], v[144:147], v[40:43], a[24:27]
    v_exp_f32 v54, v54
    v_mfma_f32_16x16x32_bf16 a[28:31], v[148:151], v[40:43], a[28:31]
    v_max3_f32 v6, v56, v57, v58
    v_max3_f32 v9, v64, v65, v66
    v_mfma_f32_16x16x32_bf16 a[192:195], a[216:219], v[40:43], a[192:195]
    v_max3_f32 v6, v6, v59, v60
    v_max3_f32 v9, v9, v67, v68
    v_mfma_f32_16x16x32_bf16 v[72:75], v[88:91], v[216:219], v[32:35]
    v_max3_f32 v6, v6, v61, v62
    v_max3_f32 v9, v9, v69, v70
    v_mfma_f32_16x16x32_bf16 v[72:75], v[92:95], v[220:223], v[72:75]
    v_max3_f32 v6, v6, v63, v71
    v_max_f32 v6, v6, v9
    v_mfma_f32_16x16x32_bf16 v[72:75], v[96:99], v[224:227], v[72:75]
    v_cmp_lt_f32 vcc, s61, v6
    v_mfma_f32_16x16x32_bf16 v[72:75], v[100:103], v[228:231], v[72:75]
    v_exp_f32 v55, v55
    v_mfma_f32_16x16x32_bf16 v[76:79], v[104:107], v[216:219], v[32:35]
    v_cvt_pk_bf16_f32 v50, v52, v53
    v_cvt_pk_bf16_f32 v51, v54, v55
    v_mfma_f32_16x16x32_bf16 v[76:79], v[108:111], v[220:223], v[76:79]
    s_cbranch_vccnz L_stub2_25
L_back2_25:
    v_mfma_f32_16x16x32_bf16 v[76:79], v[112:115], v[224:227], v[76:79]
    s_waitcnt vmcnt(3)
    buffer_load_dwordx4 v1, s[4:7], s65 offen offset:2048 nt lds
    v_mfma_f32_16x16x32_bf16 v[76:79], v[116:119], v[228:231], v[76:79]
    v_exp_f32 v56, v56
    v_mfma_f32_16x16x32_bf16 a[32:35], v[120:123], v[48:51], a[32:35]
    v_exp_f32 v57, v57
    v_mfma_f32_16x16x32_bf16 a[36:39], v[124:127], v[48:51], a[36:39]
    v_exp_f32 v58, v58
    v_mfma_f32_16x16x32_bf16 a[40:43], v[128:131], v[48:51], a[40:43]
    v_exp_f32 v59, v59
    v_mfma_f32_16x16x32_bf16 a[44:47], v[132:135], v[48:51], a[44:47]
    v_cvt_pk_bf16_f32 v56, v56, v57
    v_cvt_pk_bf16_f32 v57, v58, v59
    v_mfma_f32_16x16x32_bf16 a[48:51], v[136:139], v[48:51], a[48:51]
    v_exp_f32 v60, v60
    v_mfma_f32_16x16x32_bf16 a[52:55], v[140:143], v[48:51], a[52:55]
    v_exp_f32 v61, v61
    v_mfma_f32_16x16x32_bf16 a[56:59], v[144:147], v[48:51], a[56:59]
    v_exp_f32 v62, v62
    v_mfma_f32_16x16x32_bf16 a[60:63], v[148:151], v[48:51], a[60:63]
    v_exp_f32 v63, v63
    v_mfma_f32_16x16x32_bf16 a[196:199], a[216:219], v[48:51], a[196:199]
    v_cvt_pk_bf16_f32 v58, v60, v61
    v_cvt_pk_bf16_f32 v59, v62, v63
    s_barrier
    v_mfma_f32_16x16x32_bf16 v[80:83], v[88:91], v[232:235], v[36:39]
    v_exp_f32 v64, v64
    v_mfma_f32_16x16x32_bf16 v[80:83], v[92:95], v[236:239], v[80:83]
    ds_read_b128 v[88:91], v3 offset:32768
    ds_read_b128 v[92:95], v3 offset:33024
    v_mfma_f32_16x16x32_bf16 v[80:83], v[96:99], v[240:243], v[80:83]
    s_waitcnt vmcnt(3)
    buffer_load_dwordx4 v2, s[4:7], s65 offen offset:3072 nt lds
    v_mfma_f32_16x16x32_bf16 v[80:83], v[100:103], v[244:247], v[80:83]
    ds_read_b128 v[96:99], v3 offset:33280
    ds_read_b128 v[100:103], v3 offset:33536
    v_mfma_f32_16x16x32_bf16 v[84:87], v[104:107], v[232:235], v[36:39]
    v_exp_f32 v65, v65
    v_mfma_f32_16x16x32_bf16 v[84:87], v[108:111], v[236:239], v[84:87]
    ds_read_b128 v[104:107], v3 offset:36864
    ds_read_b128 v[108:111], v3 offset:37120
    v_mfma_f32_16x16x32_bf16 v[84:87], v[112:115], v[240:243], v[84:87]
    v_exp_f32 v66, v66
    v_mfma_f32_16x16x32_bf16 v[84:87], v[116:119], v[244:247], v[84:87]
    ds_read_b128 v[112:115], v3 offset:37376
    ds_read_b128 v[116:119], v3 offset:37632
    v_mfma_f32_16x16x32_bf16 a[64:67], v[120:123], v[56:59], a[64:67]
    v_exp_f32 v67, v67
    v_mfma_f32_16x16x32_bf16 a[68:71], v[124:127], v[56:59], a[68:71]
    v_cvt_pk_bf16_f32 v64, v64, v65
    v_cvt_pk_bf16_f32 v65, v66, v67
    v_mfma_f32_16x16x32_bf16 a[72:75], v[128:131], v[56:59], a[72:75]
    v_exp_f32 v68, v68
    v_mfma_f32_16x16x32_bf16 a[76:79], v[132:135], v[56:59], a[76:79]
    v_exp_f32 v69, v69
    v_mfma_f32_16x16x32_bf16 a[80:83], v[136:139], v[56:59], a[80:83]
    v_exp_f32 v70, v70
    v_mfma_f32_16x16x32_bf16 a[84:87], v[140:143], v[56:59], a[84:87]
    v_max3_f32 v6, v72, v73, v74
    v_max3_f32 v9, v80, v81, v82
    v_mfma_f32_16x16x32_bf16 a[88:91], v[144:147], v[56:59], a[88:91]
    v_max3_f32 v6, v6, v75, v76
    v_max3_f32 v9, v9, v83, v84
    v_mfma_f32_16x16x32_bf16 a[92:95], v[148:151], v[56:59], a[92:95]
    s_add_u32 m0, s58, 131072
    s_mov_b32 s65, 237568
    v_mfma_f32_16x16x32_bf16 a[200:203], a[216:219], v[56:59], a[200:203]
    s_waitcnt lgkmcnt(0)
    v_mfma_f32_16x16x32_bf16 v[40:43], v[88:91], v[152:155], v[16:19]
    s_waitcnt vmcnt(3)
    buffer_load_dwordx4 v1, s[28:31], s65 offen offset:0 nt lds
    v_mfma_f32_16x16x32_bf16 v[40:43], v[92:95], v[156:159], v[40:43]
    v_max3_f32 v6, v6, v77, v78
    v_max3_f32 v9, v9, v85, v86
    v_mfma_f32_16x16x32_bf16 v[40:43], v[96:99], v[160:163], v[40:43]
    v_max3_f32 v6, v6, v79, v87
    v_max_f32 v6, v6, v9
    v_mfma_f32_16x16x32_bf16 v[40:43], v[100:103], v[164:167], v[40:43]
    v_cmp_lt_f32 vcc, s61, v6
    v_mfma_f32_16x16x32_bf16 v[44:47], v[104:107], v[152:155], v[16:19]
    v_exp_f32 v71, v71
    v_mfma_f32_16x16x32_bf16 v[44:47], v[108:111], v[156:159], v[44:47]
    v_cvt_pk_bf16_f32 v66, v68, v69
    v_cvt_pk_bf16_f32 v67, v70, v71
    v_mfma_f32_16x16x32_bf16 v[44:47], v[112:115], v[160:163], v[44:47]
    s_cbranch_vccnz L_stub4_26
L_back4_26:
    v_mfma_f32_16x16x32_bf16 v[44:47], v[116:119], v[164:167], v[44:47]
    v_exp_f32 v72, v72
    v_mfma_f32_16x16x32_bf16 a[96:99], v[120:123], v[64:67], a[96:99]
    v_exp_f32 v73, v73
    v_mfma_f32_16x16x32_bf16 a[100:103], v[124:127], v[64:67], a[100:103]
    v_exp_f32 v74, v74
    v_mfma_f32_16x16x32_bf16 a[104:107], v[128:131], v[64:67], a[104:107]
    v_exp_f32 v75, v75
    v_mfma_f32_16x16x32_bf16 a[108:111], v[132:135], v[64:67], a[108:111]
    v_cvt_pk_bf16_f32 v72, v72, v73
    v_cvt_pk_bf16_f32 v73, v74, v75
    v_mfma_f32_16x16x32_bf16 a[112:115], v[136:139], v[64:67], a[112:115]
    s_waitcnt vmcnt(3)
    buffer_load_dwordx4 v2, s[28:31], s65 offen offset:1024 nt lds
    v_mfma_f32_16x16x32_bf16 a[116:119], v[140:143], v[64:67], a[116:119]
    v_exp_f32 v76, v76
    v_mfma_f32_16x16x32_bf16 a[120:123], v[144:147], v[64:67], a[120:123]
    v_exp_f32 v77, v77
    v_mfma_f32_16x16x32_bf16 a[124:127], v[148:151], v[64:67], a[124:127]
    v_exp_f32 v78, v78
    v_mfma_f32_16x16x32_bf16 a[204:207], a[216:219], v[64:67], a[204:207]
    v_exp_f32 v79, v79
    v_mfma_f32_16x16x32_bf16 v[48:51], v[88:91], v[168:171], v[20:23]
    v_cvt_pk_bf16_f32 v74, v76, v77
    v_cvt_pk_bf16_f32 v75, v78, v79
    v_mfma_f32_16x16x32_bf16 v[48:51], v[92:95], v[172:175], v[48:51]
    v_exp_f32 v80, v80
    v_mfma_f32_16x16x32_bf16 v[48:51], v[96:99], v[176:179], v[48:51]
    v_exp_f32 v81, v81
    v_mfma_f32_16x16x32_bf16 v[48:51], v[100:103], v[180:183], v[48:51]
    v_exp_f32 v82, v82
    v_mfma_f32_16x16x32_bf16 v[52:55], v[104:107], v[168:171], v[20:23]
    v_exp_f32 v83, v83
    v_mfma_f32_16x16x32_bf16 v[52:55], v[108:111], v[172:175], v[52:55]
    v_cvt_pk_bf16_f32 v80, v80, v81
    v_cvt_pk_bf16_f32 v81, v82, v83
    v_mfma_f32_16x16x32_bf16 v[52:55], v[112:115], v[176:179], v[52:55]
    v_exp_f32 v84, v84
    v_mfma_f32_16x16x32_bf16 v[52:55], v[116:119], v[180:183], v[52:55]
    v_exp_f32 v85, v85
    v_mfma_f32_16x16x32_bf16 a[128:131], v[120:123], v[72:75], a[128:131]
    s_waitcnt vmcnt(3)
    buffer_load_dwordx4 v1, s[28:31], s65 offen offset:2048 nt lds
    v_mfma_f32_16x16x32_bf16 a[132:135], v[124:127], v[72:75], a[132:135]
    v_exp_f32 v86, v86
    v_mfma_f32_16x16x32_bf16 a[136:139], v[128:131], v[72:75], a[136:139]
    v_max3_f32 v6, v40, v41, v42
    v_max3_f32 v9, v48, v49, v50
    v_mfma_f32_16x16x32_bf16 a[140:143], v[132:135], v[72:75], a[140:143]
    v_max3_f32 v6, v6, v43, v44
    v_max3_f32 v9, v9, v51, v52
    v_mfma_f32_16x16x32_bf16 a[144:147], v[136:139], v[72:75], a[144:147]
    v_max3_f32 v6, v6, v45, v46
    v_max3_f32 v9, v9, v53, v54
    v_mfma_f32_16x16x32_bf16 a[148:151], v[140:143], v[72:75], a[148:151]
    v_max3_f32 v6, v6, v47, v55
    v_max_f32 v6, v6, v9
    v_mfma_f32_16x16x32_bf16 a[152:155], v[144:147], v[72:75], a[152:155]
    v_cmp_lt_f32 vcc, s61, v6
    v_mfma_f32_16x16x32_bf16 a[156:159], v[148:151], v[72:75], a[156:159]
    v_exp_f32 v87, v87
    v_mfma_f32_16x16x32_bf16 a[208:211], a[216:219], v[72:75], a[208:211]
    v_cvt_pk_bf16_f32 v82, v84, v85
    v_cvt_pk_bf16_f32 v83, v86, v87
    v_mfma_f32_16x16x32_bf16 v[56:59], v[88:91], v[184:187], v[24:27]
    s_cbranch_vccnz L_stub0_26
L_back0_26:
    v_mfma_f32_16x16x32_bf16 v[56:59], v[92:95], v[188:191], v[56:59]
    v_exp_f32 v40, v40
    v_mfma_f32_16x16x32_bf16 v[56:59], v[96:99], v[192:195], v[56:59]
    v_exp_f32 v41, v41
    v_mfma_f32_16x16x32_bf16 v[56:59], v[100:103], v[196:199], v[56:59]
    v_exp_f32 v42, v42
    v_mfma_f32_16x16x32_bf16 v[60:63], v[104:107], v[184:187], v[24:27]
    s_waitcnt vmcnt(3)
    buffer_load_dwordx4 v2, s[28:31], s65 offen offset:3072 nt lds
    v_mfma_f32_16x16x32_bf16 v[60:63], v[108:111], v[188:191], v[60:63]
    v_exp_f32 v43, v43
    v_mfma_f32_16x16x32_bf16 v[60:63], v[112:115], v[192:195], v[60:63]
    v_cvt_pk_bf16_f32 v40, v40, v41
    v_cvt_pk_bf16_f32 v41, v42, v43
    v_mfma_f32_16x16x32_bf16 v[60:63], v[116:119], v[196:199], v[60:63]
    v_exp_f32 v44, v44
    v_mfma_f32_16x16x32_bf16 a[160:163], v[120:123], v[80:83], a[160:163]
    ds_read_b64_tr_b16 v[120:121], v4 offset:32768
    ds_read_b64_tr_b16 v[122:123], v4 offset:36864
    v_mfma_f32_16x16x32_bf16 a[164:167], v[124:127], v[80:83], a[164:167]
    ds_read_b64_tr_b16 v[124:125], v5 offset:32768
    ds_read_b64_tr_b16 v[126:127], v5 offset:36864
    v_mfma_f32_16x16x32_bf16 a[168:171], v[128:131], v[80:83], a[168:171]
    ds_read_b64_tr_b16 v[128:129], v4 offset:33024
    ds_read_b64_tr_b16 v[130:131], v4 offset:37120
    v_mfma_f32_16x16x32_bf16 a[172:175], v[132:135], v[80:83], a[172:175]
    ds_read_b64_tr_b16 v[132:133], v5 offset:33024
    ds_read_b64_tr_b16 v[134:135], v5 offset:37120
    v_mfma_f32_16x16x32_bf16 a[176:179], v[136:139], v[80:83], a[176:179]
    ds_read_b64_tr_b16 v[136:137], v4 offset:33280
    ds_read_b64_tr_b16 v[138:139], v4 offset:37376
    v_mfma_f32_16x16x32_bf16 a[180:183], v[140:143], v[80:83], a[180:183]
    ds_read_b64_tr_b16 v[140:141], v5 offset:33280
    ds_read_b64_tr_b16 v[142:143], v5 offset:37376
    v_mfma_f32_16x16x32_bf16 a[184:187], v[144:147], v[80:83], a[184:187]
    ds_read_b64_tr_b16 v[144:145], v4 offset:33536
    ds_read_b64_tr_b16 v[146:147], v4 offset:37632
    v_mfma_f32_16x16x32_bf16 a[188:191], v[148:151], v[80:83], a[188:191]
    ds_read_b64_tr_b16 v[148:149], v5 offset:33536
    ds_read_b64_tr_b16 v[150:151], v5 offset:37632
    v_mfma_f32_16x16x32_bf16 a[212:215], a[216:219], v[80:83], a[212:215]
    v_exp_f32 v45, v45
    v_mfma_f32_16x16x32_bf16 v[64:67], v[88:91], v[200:203], v[28:31]
    v_exp_f32 v46, v46
    v_mfma_f32_16x16x32_bf16 v[64:67], v[92:95], v[204:207], v[64:67]
    s_add_u32 m0, s58, 139264
    v_mfma_f32_16x16x32_bf16 v[64:67], v[96:99], v[208:211], v[64:67]
    s_waitcnt vmcnt(3)
    buffer_load_dwordx4 v1, s[4:7], s65 offen offset:0 nt lds
    v_mfma_f32_16x16x32_bf16 v[64:67], v[100:103], v[212:215], v[64:67]
    v_exp_f32 v47, v47
    v_mfma_f32_16x16x32_bf16 v[68:71], v[104:107], v[200:203], v[28:31]
    v_cvt_pk_bf16_f32 v42, v44, v45
    v_cvt_pk_bf16_f32 v43, v46, v47
    v_mfma_f32_16x16x32_bf16 v[68:71], v[108:111], v[204:207], v[68:71]
    v_exp_f32 v48, v48
    v_mfma_f32_16x16x32_bf16 v[68:71], v[112:115], v[208:211], v[68:71]
    v_exp_f32 v49, v49
    v_mfma_f32_16x16x32_bf16 v[68:71], v[116:119], v[212:215], v[68:71]
    s_waitcnt lgkmcnt(0)
    v_mfma_f32_16x16x32_bf16 a[0:3], v[120:123], v[40:43], a[0:3]
    v_exp_f32 v50, v50
    v_mfma_f32_16x16x32_bf16 a[4:7], v[124:127], v[40:43], a[4:7]
    v_exp_f32 v51, v51
    v_mfma_f32_16x16x32_bf16 a[8:11], v[128:131], v[40:43], a[8:11]
    v_cvt_pk_bf16_f32 v48, v48, v49
    v_cvt_pk_bf16_f32 v49, v50, v51
    v_mfma_f32_16x16x32_bf16 a[12:15], v[132:135], v[40:43], a[12:15]
    v_exp_f32 v52, v52
    v_mfma_f32_16x16x32_bf16 a[16:19], v[136:139], v[40:43], a[16:19]
    v_exp_f32 v53, v53
    v_mfma_f32_16x16x32_bf16 a[20:23], v[140:143], v[40:43], a[20:23]
    v_exp_f32 v54, v54
    v_mfma_f32_16x16x32_bf16 a[24:27], v[144:147], v[40:43], a[24:27]
    s_waitcnt vmcnt(3)
    buffer_load_dwordx4 v2, s[4:7], s65 offen offset:1024 nt lds
    v_mfma_f32_16x16x32_bf16 a[28:31], v[148:151], v[40:43], a[28:31]
    v_max3_f32 v6, v56, v57, v58
    v_max3_f32 v9, v64, v65, v66
    v_mfma_f32_16x16x32_bf16 a[192:195], a[216:219], v[40:43], a[192:195]
    v_max3_f32 v6, v6, v59, v60
    v_max3_f32 v9, v9, v67, v68
    v_mfma_f32_16x16x32_bf16 v[72:75], v[88:91], v[216:219], v[32:35]
    v_max3_f32 v6, v6, v61, v62
    v_max3_f32 v9, v9, v69, v70
    v_mfma_f32_16x16x32_bf16 v[72:75], v[92:95], v[220:223], v[72:75]
    v_max3_f32 v6, v6, v63, v71
    v_max_f32 v6, v6, v9
    v_mfma_f32_16x16x32_bf16 v[72:75], v[96:99], v[224:227], v[72:75]
    v_cmp_lt_f32 vcc, s61, v6
    v_mfma_f32_16x16x32_bf16 v[72:75], v[100:103], v[228:231], v[72:75]
    v_exp_f32 v55, v55
    v_mfma_f32_16x16x32_bf16 v[76:79], v[104:107], v[216:219], v[32:35]
    v_cvt_pk_bf16_f32 v50, v52, v53
    v_cvt_pk_bf16_f32 v51, v54, v55
    v_mfma_f32_16x16x32_bf16 v[76:79], v[108:111], v[220:223], v[76:79]
    s_cbranch_vccnz L_stub2_26
L_back2_26:
    v_mfma_f32_16x16x32_bf16 v[76:79], v[112:115], v[224:227], v[76:79]
    v_exp_f32 v56, v56
    v_mfma_f32_16x16x32_bf16 v[76:79], v[116:119], v[228:231], v[76:79]
    v_exp_f32 v57, v57
    v_mfma_f32_16x16x32_bf16 a[32:35], v[120:123], v[48:51], a[32:35]
    v_exp_f32 v58, v58
    v_mfma_f32_16x16x32_bf16 a[36:39], v[124:127], v[48:51], a[36:39]
    v_exp_f32 v59, v59
    v_mfma_f32_16x16x32_bf16 a[40:43], v[128:131], v[48:51], a[40:43]
    v_cvt_pk_bf16_f32 v56, v56, v57
    v_cvt_pk_bf16_f32 v57, v58, v59
    v_mfma_f32_16x16x32_bf16 a[44:47], v[132:135], v[48:51], a[44:47]
    s_waitcnt vmcnt(3)
    buffer_load_dwordx4 v1, s[4:7], s65 offen offset:2048 nt lds
    v_mfma_f32_16x16x32_bf16 a[48:51], v[136:139], v[48:51], a[48:51]
    v_exp_f32 v60, v60
    v_mfma_f32_16x16x32_bf16 a[52:55], v[140:143], v[48:51], a[52:55]
    v_exp_f32 v61, v61
    v_mfma_f32_16x16x32_bf16 a[56:59], v[144:147], v[48:51], a[56:59]
    v_exp_f32 v62, v62
    v_mfma_f32_16x16x32_bf16 a[60:63], v[148:151], v[48:51], a[60:63]
    v_exp_f32 v63, v63
    v_mfma_f32_16x16x32_bf16 a[196:199], a[216:219], v[48:51], a[196:199]
    v_cvt_pk_bf16_f32 v58, v60, v61
    v_cvt_pk_bf16_f32 v59, v62, v63
    s_barrier
    v_mfma_f32_16x16x32_bf16 v[80:83], v[88:91], v[232:235], v[36:39]
    v_exp_f32 v64, v64
    v_mfma_f32_16x16x32_bf16 v[80:83], v[92:95], v[236:239], v[80:83]
    ds_read_b128 v[88:91], v248 offset:0
    ds_read_b128 v[92:95], v248 offset:256
    v_mfma_f32_16x16x32_bf16 v[80:83], v[96:99], v[240:243], v[80:83]
    v_exp_f32 v65, v65
    v_mfma_f32_16x16x32_bf16 v[80:83], v[100:103], v[244:247], v[80:83]
    ds_read_b128 v[96:99], v248 offset:512
    ds_read_b128 v[100:103], v248 offset:768
    v_mfma_f32_16x16x32_bf16 v[84:87], v[104:107], v[232:235], v[36:39]
    v_exp_f32 v66, v66
    v_mfma_f32_16x16x32_bf16 v[84:87], v[108:111], v[236:239], v[84:87]
    ds_read_b128 v[104:107], v248 offset:4096
    ds_read_b128 v[108:111], v248 offset:4352
    v_mfma_f32_16x16x32_bf16 v[84:87], v[112:115], v[240:243], v[84:87]
    v_exp_f32 v67, v67
    v_mfma_f32_16x16x32_bf16 v[84:87], v[116:119], v[244:247], v[84:87]
    ds_read_b128 v[112:115], v248 offset:4608
    ds_read_b128 v[116:119], v248 offset:4864
    v_mfma_f32_16x16x32_bf16 a[64:67], v[120:123], v[56:59], a[64:67]
    s_waitcnt vmcnt(3)
    buffer_load_dwordx4 v2, s[4:7], s65 offen offset:3072 nt lds
    v_mfma_f32_16x16x32_bf16 a[68:71], v[124:127], v[56:59], a[68:71]
    v_cvt_pk_bf16_f32 v64, v64, v65
    v_cvt_pk_bf16_f32 v65, v66, v67
    v_mfma_f32_16x16x32_bf16 a[72:75], v[128:131], v[56:59], a[72:75]
    v_exp_f32 v68, v68
    v_mfma_f32_16x16x32_bf16 a[76:79], v[132:135], v[56:59], a[76:79]
    v_exp_f32 v69, v69
    v_mfma_f32_16x16x32_bf16 a[80:83], v[136:139], v[56:59], a[80:83]
    v_exp_f32 v70, v70
    v_mfma_f32_16x16x32_bf16 a[84:87], v[140:143], v[56:59], a[84:87]
    v_max3_f32 v6, v72, v73, v74
    v_max3_f32 v9, v80, v81, v82
    v_mfma_f32_16x16x32_bf16 a[88:91], v[144:147], v[56:59], a[88:91]
    v_max3_f32 v6, v6, v75, v76
    v_max3_f32 v9, v9, v83, v84
    v_mfma_f32_16x16x32_bf16 a[92:95], v[148:151], v[56:59], a[92:95]
    v_max3_f32 v6, v6, v77, v78
    v_max3_f32 v9, v9, v85, v86
    v_mfma_f32_16x16x32_bf16 a[200:203], a[216:219], v[56:59], a[200:203]
    s_waitcnt lgkmcnt(0)
    v_mfma_f32_16x16x32_bf16 v[40:43], v[88:91], v[152:155], v[16:19]
    v_max3_f32 v6, v6, v79, v87
    v_max_f32 v6, v6, v9
    v_mfma_f32_16x16x32_bf16 v[40:43], v[92:95], v[156:159], v[40:43]
    v_cmp_lt_f32 vcc, s61, v6
    v_mfma_f32_16x16x32_bf16 v[40:43], v[96:99], v[160:163], v[40:43]
    v_exp_f32 v71, v71
    v_mfma_f32_16x16x32_bf16 v[40:43], v[100:103], v[164:167], v[40:43]
    s_add_u32 m0, s58, 0
    s_mov_b32 s65, 245760
    v_mfma_f32_16x16x32_bf16 v[44:47], v[104:107], v[152:155], v[16:19]
    s_waitcnt vmcnt(3)
    buffer_load_dwordx4 v1, s[28:31], s65 offen offset:0 nt lds
    v_mfma_f32_16x16x32_bf16 v[44:47], v[108:111], v[156:159], v[44:47]
    v_cvt_pk_bf16_f32 v66, v68, v69
    v_cvt_pk_bf16_f32 v67, v70, v71
    v_mfma_f32_16x16x32_bf16 v[44:47], v[112:115], v[160:163], v[44:47]
    s_cbranch_vccnz L_stub4_27
L_back4_27:
    v_mfma_f32_16x16x32_bf16 v[44:47], v[116:119], v[164:167], v[44:47]
    v_exp_f32 v72, v72
    v_mfma_f32_16x16x32_bf16 a[96:99], v[120:123], v[64:67], a[96:99]
    v_exp_f32 v73, v73
    v_mfma_f32_16x16x32_bf16 a[100:103], v[124:127], v[64:67], a[100:103]
    v_exp_f32 v74, v74
    v_mfma_f32_16x16x32_bf16 a[104:107], v[128:131], v[64:67], a[104:107]
    v_exp_f32 v75, v75
    v_mfma_f32_16x16x32_bf16 a[108:111], v[132:135], v[64:67], a[108:111]
    v_cvt_pk_bf16_f32 v72, v72, v73
    v_cvt_pk_bf16_f32 v73, v74, v75
    v_mfma_f32_16x16x32_bf16 a[112:115], v[136:139], v[64:67], a[112:115]
    v_exp_f32 v76, v76
    v_mfma_f32_16x16x32_bf16 a[116:119], v[140:143], v[64:67], a[116:119]
    v_exp_f32 v77, v77
    v_mfma_f32_16x16x32_bf16 a[120:123], v[144:147], v[64:67], a[120:123]
    v_exp_f32 v78, v78
    v_mfma_f32_16x16x32_bf16 a[124:127], v[148:151], v[64:67], a[124:127]
    v_exp_f32 v79, v79
    v_mfma_f32_16x16x32_bf16 a[204:207], a[216:219], v[64:67], a[204:207]
    v_cvt_pk_bf16_f32 v74, v76, v77
    v_cvt_pk_bf16_f32 v75, v78, v79
    v_mfma_f32_16x16x32_bf16 v[48:51], v[88:91], v[168:171], v[20:23]
    s_waitcnt vmcnt(3)
    buffer_load_dwordx4 v2, s[28:31], s65 offen offset:1024 nt lds
    v_mfma_f32_16x16x32_bf16 v[48:51], v[92:95], v[172:175], v[48:51]
    v_exp_f32 v80, v80
    v_mfma_f32_16x16x32_bf16 v[48:51], v[96:99], v[176:179], v[48:51]
    v_exp_f32 v81, v81
    v_mfma_f32_16x16x32_bf16 v[48:51], v[100:103], v[180:183], v[48:51]
    v_exp_f32 v82, v82
    v_mfma_f32_16x16x32_bf16 v[52:55], v[104:107], v[168:171], v[20:23]
    v_exp_f32 v83, v83
    v_mfma_f32_16x16x32_bf16 v[52:55], v[108:111], v[172:175], v[52:55]
    v_cvt_pk_bf16_f32 v80, v80, v81
    v_cvt_pk_bf16_f32 v81, v82, v83
    v_mfma_f32_16x16x32_bf16 v[52:55], v[112:115], v[176:179], v[52:55]
    v_exp_f32 v84, v84
    v_mfma_f32_16x16x32_bf16 v[52:55], v[116:119], v[180:183], v[52:55]
    v_exp_f32 v85, v85
    v_mfma_f32_16x16x32_bf16 a[128:131], v[120:123], v[72:75], a[128:131]
    v_exp_f32 v86, v86
    v_mfma_f32_16x16x32_bf16 a[132:135], v[124:127], v[72:75], a[132:135]
    v_mfma_f32_16x16x32_bf16 a[136:139], v[128:131], v[72:75], a[136:139]
    v_max3_f32 v6, v40, v41, v42
    v_max3_f32 v9, v48, v49, v50
    v_mfma_f32_16x16x32_bf16 a[140:143], v[132:135], v[72:75], a[140:143]
    v_max3_f32 v6, v6, v43, v44
    v_max3_f32 v9, v9, v51, v52
    v_mfma_f32_16x16x32_bf16 a[144:147], v[136:139], v[72:75], a[144:147]
    v_max3_f32 v6, v6, v45, v46
    v_max3_f32 v9, v9, v53, v54
    v_mfma_f32_16x16x32_bf16 a[148:151], v[140:143], v[72:75], a[148:151]
    s_waitcnt vmcnt(3)
    buffer_load_dwordx4 v1, s[28:31], s65 offen offset:2048 nt lds
    v_mfma_f32_16x16x32_bf16 a[152:155], v[144:147], v[72:75], a[152:155]
    v_max3_f32 v6, v6, v47, v55
    v_max_f32 v6, v6, v9
    v_mfma_f32_16x16x32_bf16 a[156:159], v[148:151], v[72:75], a[156:159]
    v_cmp_lt_f32 vcc, s61, v6
    v_mfma_f32_16x16x32_bf16 a[208:211], a[216:219], v[72:75], a[208:211]
    v_exp_f32 v87, v87
    v_mfma_f32_16x16x32_bf16 v[56:59], v[88:91], v[184:187], v[24:27]
    v_cvt_pk_bf16_f32 v82, v84, v85
    v_cvt_pk_bf16_f32 v83, v86, v87
    v_mfma_f32_16x16x32_bf16 v[56:59], v[92:95], v[188:191], v[56:59]
    s_cbranch_vccnz L_stub0_27
L_back0_27:
    v_mfma_f32_16x16x32_bf16 v[56:59], v[96:99], v[192:195], v[56:59]
    v_exp_f32 v40, v40
    v_mfma_f32_16x16x32_bf16 v[56:59], v[100:103], v[196:199], v[56:59]
    v_exp_f32 v41, v41
    v_mfma_f32_16x16x32_bf16 v[60:63], v[104:107], v[184:187], v[24:27]
    v_exp_f32 v42, v42
    v_mfma_f32_16x16x32_bf16 v[60:63], v[108:111], v[188:191], v[60:63]
    v_exp_f32 v43, v43
    v_mfma_f32_16x16x32_bf16 v[60:63], v[112:115], v[192:195], v[60:63]
    v_cvt_pk_bf16_f32 v40, v40, v41
    v_cvt_pk_bf16_f32 v41, v42, v43
    v_mfma_f32_16x16x32_bf16 v[60:63], v[116:119], v[196:199], v[60:63]
    v_exp_f32 v44, v44
    v_mfma_f32_16x16x32_bf16 a[160:163], v[120:123], v[80:83], a[160:163]
    ds_read_b64_tr_b16 v[120:121], v249 offset:0
    ds_read_b64_tr_b16 v[122:123], v249 offset:4096
    v_mfma_f32_16x16x32_bf16 a[164:167], v[124:127], v[80:83], a[164:167]
    ds_read_b64_tr_b16 v[124:125], v250 offset:0
    ds_read_b64_tr_b16 v[126:127], v250 offset:4096
    v_mfma_f32_16x16x32_bf16 a[168:171], v[128:131], v[80:83], a[168:171]
    ds_read_b64_tr_b16 v[128:129], v249 offset:256
    ds_read_b64_tr_b16 v[130:131], v249 offset:4352
    v_mfma_f32_16x16x32_bf16 a[172:175], v[132:135], v[80:83], a[172:175]
    ds_read_b64_tr_b16 v[132:133], v250 offset:256
    ds_read_b64_tr_b16 v[134:135], v250 offset:4352
    v_mfma_f32_16x16x32_bf16 a[176:179], v[136:139], v[80:83], a[176:179]
    ds_read_b64_tr_b16 v[136:137], v249 offset:512
    ds_read_b64_tr_b16 v[138:139], v249 offset:4608
    v_mfma_f32_16x16x32_bf16 a[180:183], v[140:143], v[80:83], a[180:183]
    ds_read_b64_tr_b16 v[140:141], v250 offset:512
    ds_read_b64_tr_b16 v[142:143], v250 offset:4608
    v_mfma_f32_16x16x32_bf16 a[184:187], v[144:147], v[80:83], a[184:187]
    ds_read_b64_tr_b16 v[144:145], v249 offset:768
    ds_read_b64_tr_b16 v[146:147], v249 offset:4864
    v_mfma_f32_16x16x32_bf16 a[188:191], v[148:151], v[80:83], a[188:191]
    ds_read_b64_tr_b16 v[148:149], v250 offset:768
    ds_read_b64_tr_b16 v[150:151], v250 offset:4864
    v_mfma_f32_16x16x32_bf16 a[212:215], a[216:219], v[80:83], a[212:215]
    s_waitcnt vmcnt(3)
    buffer_load_dwordx4 v2, s[28:31], s65 offen offset:3072 nt lds
    v_mfma_f32_16x16x32_bf16 v[64:67], v[88:91], v[200:203], v[28:31]
    v_exp_f32 v45, v45
    v_mfma_f32_16x16x32_bf16 v[64:67], v[92:95], v[204:207], v[64:67]
    v_exp_f32 v46, v46
    v_mfma_f32_16x16x32_bf16 v[64:67], v[96:99], v[208:211], v[64:67]
    v_exp_f32 v47, v47
    v_mfma_f32_16x16x32_bf16 v[64:67], v[100:103], v[212:215], v[64:67]
    v_cvt_pk_bf16_f32 v42, v44, v45
    v_cvt_pk_bf16_f32 v43, v46, v47
    v_mfma_f32_16x16x32_bf16 v[68:71], v[104:107], v[200:203], v[28:31]
    v_exp_f32 v48, v48
    v_mfma_f32_16x16x32_bf16 v[68:71], v[108:111], v[204:207], v[68:71]
    v_exp_f32 v49, v49
    v_mfma_f32_16x16x32_bf16 v[68:71], v[112:115], v[208:211], v[68:71]
    s_add_u32 m0, s58, 8192
    v_mfma_f32_16x16x32_bf16 v[68:71], v[116:119], v[212:215], v[68:71]
    s_waitcnt lgkmcnt(0)
    v_mfma_f32_16x16x32_bf16 a[0:3], v[120:123], v[40:43], a[0:3]
    s_waitcnt vmcnt(3)
    buffer_load_dwordx4 v1, s[4:7], s65 offen offset:0 nt lds
    v_mfma_f32_16x16x32_bf16 a[4:7], v[124:127], v[40:43], a[4:7]
    v_exp_f32 v50, v50
    v_mfma_f32_16x16x32_bf16 a[8:11], v[128:131], v[40:43], a[8:11]
    v_exp_f32 v51, v51
    v_mfma_f32_16x16x32_bf16 a[12:15], v[132:135], v[40:43], a[12:15]
    v_cvt_pk_bf16_f32 v48, v48, v49
    v_cvt_pk_bf16_f32 v49, v50, v51
    v_mfma_f32_16x16x32_bf16 a[16:19], v[136:139], v[40:43], a[16:19]
    v_exp_f32 v52, v52
    v_mfma_f32_16x16x32_bf16 a[20:23], v[140:143], v[40:43], a[20:23]
    v_exp_f32 v53, v53
    v_mfma_f32_16x16x32_bf16 a[24:27], v[144:147], v[40:43], a[24:27]
    v_exp_f32 v54, v54
    v_mfma_f32_16x16x32_bf16 a[28:31], v[148:151], v[40:43], a[28:31]
    v_max3_f32 v6, v56, v57, v58
    v_max3_f32 v9, v64, v65, v66
    v_mfma_f32_16x16x32_bf16 a[192:195], a[216:219], v[40:43], a[192:195]
    v_max3_f32 v6, v6, v59, v60
    v_max3_f32 v9, v9, v67, v68
    v_mfma_f32_16x16x32_bf16 v[72:75], v[88:91], v[216:219], v[32:35]
    v_max3_f32 v6, v6, v61, v62
    v_max3_f32 v9, v9, v69, v70
    v_mfma_f32_16x16x32_bf16 v[72:75], v[92:95], v[220:223], v[72:75]
    v_max3_f32 v6, v6, v63, v71
    v_max_f32 v6, v6, v9
    v_mfma_f32_16x16x32_bf16 v[72:75], v[96:99], v[224:227], v[72:75]
    s_waitcnt vmcnt(3)
    buffer_load_dwordx4 v2, s[4:7], s65 offen offset:1024 nt lds
    v_mfma_f32_16x16x32_bf16 v[72:75], v[100:103], v[228:231], v[72:75]
    v_cmp_lt_f32 vcc, s61, v6
    v_mfma_f32_16x16x32_bf16 v[76:79], v[104:107], v[216:219], v[32:35]
    v_exp_f32 v55, v55
    v_mfma_f32_16x16x32_bf16 v[76:79], v[108:111], v[220:223], v[76:79]
    v_cvt_pk_bf16_f32 v50, v52, v53
    v_cvt_pk_bf16_f32 v51, v54, v55
    v_mfma_f32_16x16x32_bf16 v[76:79], v[112:115], v[224:227], v[76:79]
    s_cbranch_vccnz L_stub2_27
L_back2_27:
    v_mfma_f32_16x16x32_bf16 v[76:79], v[116:119], v[228:231], v[76:79]
    v_exp_f32 v56, v56
    v_mfma_f32_16x16x32_bf16 a[32:35], v[120:123], v[48:51], a[32:35]
    v_exp_f32 v57, v57
    v_mfma_f32_16x16x32_bf16 a[36:39], v[124:127], v[48:51], a[36:39]
    v_exp_f32 v58, v58
    v_mfma_f32_16x16x32_bf16 a[40:43], v[128:131], v[48:51], a[40:43]
    v_exp_f32 v59, v59
    v_mfma_f32_16x16x32_bf16 a[44:47], v[132:135], v[48:51], a[44:47]
    v_cvt_pk_bf16_f32 v56, v56, v57
    v_cvt_pk_bf16_f32 v57, v58, v59
    v_mfma_f32_16x16x32_bf16 a[48:51], v[136:139], v[48:51], a[48:51]
    v_exp_f32 v60, v60
    v_mfma_f32_16x16x32_bf16 a[52:55], v[140:143], v[48:51], a[52:55]
    v_exp_f32 v61, v61
    v_mfma_f32_16x16x32_bf16 a[56:59], v[144:147], v[48:51], a[56:59]
    v_exp_f32 v62, v62
    v_mfma_f32_16x16x32_bf16 a[60:63], v[148:151], v[48:51], a[60:63]
    s_waitcnt vmcnt(3)
    buffer_load_dwordx4 v1, s[4:7], s65 offen offset:2048 nt lds
    v_mfma_f32_16x16x32_bf16 a[196:199], a[216:219], v[48:51], a[196:199]
    v_exp_f32 v63, v63
    v_cvt_pk_bf16_f32 v58, v60, v61
    v_cvt_pk_bf16_f32 v59, v62, v63
    s_barrier
    v_mfma_f32_16x16x32_bf16 v[80:83], v[88:91], v[232:235], v[36:39]
    v_exp_f32 v64, v64
    v_mfma_f32_16x16x32_bf16 v[80:83], v[92:95], v[236:239], v[80:83]
    ds_read_b128 v[88:91], v248 offset:32768
    ds_read_b128 v[92:95], v248 offset:33024
    v_mfma_f32_16x16x32_bf16 v[80:83], v[96:99], v[240:243], v[80:83]
    v_exp_f32 v65, v65
    v_mfma_f32_16x16x32_bf16 v[80:83], v[100:103], v[244:247], v[80:83]
    ds_read_b128 v[96:99], v248 offset:33280
    ds_read_b128 v[100:103], v248 offset:33536
    v_mfma_f32_16x16x32_bf16 v[84:87], v[104:107], v[232:235], v[36:39]
    v_exp_f32 v66, v66
    v_mfma_f32_16x16x32_bf16 v[84:87], v[108:111], v[236:239], v[84:87]
    ds_read_b128 v[104:107], v248 offset:36864
    ds_read_b128 v[108:111], v248 offset:37120
    v_mfma_f32_16x16x32_bf16 v[84:87], v[112:115], v[240:243], v[84:87]
    v_exp_f32 v67, v67
    v_mfma_f32_16x16x32_bf16 v[84:87], v[116:119], v[244:247], v[84:87]
    ds_read_b128 v[112:115], v248 offset:37376
    ds_read_b128 v[116:119], v248 offset:37632
    v_mfma_f32_16x16x32_bf16 a[64:67], v[120:123], v[56:59], a[64:67]
    v_cvt_pk_bf16_f32 v64, v64, v65
    v_cvt_pk_bf16_f32 v65, v66, v67
    v_mfma_f32_16x16x32_bf16 a[68:71], v[124:127], v[56:59], a[68:71]
    v_exp_f32 v68, v68
    v_mfma_f32_16x16x32_bf16 a[72:75], v[128:131], v[56:59], a[72:75]
    v_exp_f32 v69, v69
    v_mfma_f32_16x16x32_bf16 a[76:79], v[132:135], v[56:59], a[76:79]
    v_exp_f32 v70, v70
    v_mfma_f32_16x16x32_bf16 a[80:83], v[136:139], v[56:59], a[80:83]
    s_waitcnt vmcnt(3)
    buffer_load_dwordx4 v2, s[4:7], s65 offen offset:3072 nt lds
    v_mfma_f32_16x16x32_bf16 a[84:87], v[140:143], v[56:59], a[84:87]
    v_max3_f32 v6, v72, v73, v74
    v_max3_f32 v9, v80, v81, v82
    v_mfma_f32_16x16x32_bf16 a[88:91], v[144:147], v[56:59], a[88:91]
    v_max3_f32 v6, v6, v75, v76
    v_max3_f32 v9, v9, v83, v84
    v_mfma_f32_16x16x32_bf16 a[92:95], v[148:151], v[56:59], a[92:95]
    v_max3_f32 v6, v6, v77, v78
    v_max3_f32 v9, v9, v85, v86
    v_mfma_f32_16x16x32_bf16 a[200:203], a[216:219], v[56:59], a[200:203]
    s_waitcnt lgkmcnt(0)
    v_mfma_f32_16x16x32_bf16 v[40:43], v[88:91], v[152:155], v[16:19]
    v_max3_f32 v6, v6, v79, v87
    v_max_f32 v6, v6, v9
    v_mfma_f32_16x16x32_bf16 v[40:43], v[92:95], v[156:159], v[40:43]
    v_cmp_lt_f32 vcc, s61, v6
    v_mfma_f32_16x16x32_bf16 v[40:43], v[96:99], v[160:163], v[40:43]
    v_exp_f32 v71, v71
    v_mfma_f32_16x16x32_bf16 v[40:43], v[100:103], v[164:167], v[40:43]
    v_cvt_pk_bf16_f32 v66, v68, v69
    v_cvt_pk_bf16_f32 v67, v70, v71
    v_mfma_f32_16x16x32_bf16 v[44:47], v[104:107], v[152:155], v[16:19]
    s_cbranch_vccnz L_stub4_28
L_back4_28:
    v_mfma_f32_16x16x32_bf16 v[44:47], v[108:111], v[156:159], v[44:47]
    v_exp_f32 v72, v72
    v_mfma_f32_16x16x32_bf16 v[44:47], v[112:115], v[160:163], v[44:47]
    v_exp_f32 v73, v73
    v_mfma_f32_16x16x32_bf16 v[44:47], v[116:119], v[164:167], v[44:47]
    v_exp_f32 v74, v74
    v_mfma_f32_16x16x32_bf16 a[96:99], v[120:123], v[64:67], a[96:99]
    s_add_u32 m0, s58, 32768
    s_mov_b32 s65, 253952
    v_mfma_f32_16x16x32_bf16 a[100:103], v[124:127], v[64:67], a[100:103]
    s_waitcnt vmcnt(3)
    buffer_load_dwordx4 v1, s[28:31], s65 offen offset:0 nt lds
    v_mfma_f32_16x16x32_bf16 a[104:107], v[128:131], v[64:67], a[104:107]
    v_exp_f32 v75, v75
    v_mfma_f32_16x16x32_bf16 a[108:111], v[132:135], v[64:67], a[108:111]
    v_cvt_pk_bf16_f32 v72, v72, v73
    v_cvt_pk_bf16_f32 v73, v74, v75
    v_mfma_f32_16x16x32_bf16 a[112:115], v[136:139], v[64:67], a[112:115]
    v_exp_f32 v76, v76
    v_mfma_f32_16x16x32_bf16 a[116:119], v[140:143], v[64:67], a[116:119]
    v_exp_f32 v77, v77
    v_mfma_f32_16x16x32_bf16 a[120:123], v[144:147], v[64:67], a[120:123]
    v_exp_f32 v78, v78
    v_mfma_f32_16x16x32_bf16 a[124:127], v[148:151], v[64:67], a[124:127]
    v_exp_f32 v79, v79
    v_mfma_f32_16x16x32_bf16 a[204:207], a[216:219], v[64:67], a[204:207]
    v_cvt_pk_bf16_f32 v74, v76, v77
    v_cvt_pk_bf16_f32 v75, v78, v79
    v_mfma_f32_16x16x32_bf16 v[48:51], v[88:91], v[168:171], v[20:23]
    v_exp_f32 v80, v80
    v_mfma_f32_16x16x32_bf16 v[48:51], v[92:95], v[172:175], v[48:51]
    v_exp_f32 v81, v81
    v_mfma_f32_16x16x32_bf16 v[48:51], v[96:99], v[176:179], v[48:51]
    v_exp_f32 v82, v82
    v_mfma_f32_16x16x32_bf16 v[48:51], v[100:103], v[180:183], v[48:51]
    v_exp_f32 v83, v83
    v_mfma_f32_16x16x32_bf16 v[52:55], v[104:107], v[168:171], v[20:23]
    v_cvt_pk_bf16_f32 v80, v80, v81
    v_cvt_pk_bf16_f32 v81, v82, v83
    v_mfma_f32_16x16x32_bf16 v[52:55], v[108:111], v[172:175], v[52:55]
    s_waitcnt vmcnt(3)
    buffer_load_dwordx4 v2, s[28:31], s65 offen offset:1024 nt lds
    v_mfma_f32_16x16x32_bf16 v[52:55], v[112:115], v[176:179], v[52:55]
    v_exp_f32 v84, v84
    v_mfma_f32_16x16x32_bf16 v[52:55], v[116:119], v[180:183], v[52:55]
    v_exp_f32 v85, v85
    v_mfma_f32_16x16x32_bf16 a[128:131], v[120:123], v[72:75], a[128:131]
    v_exp_f32 v86, v86
    v_mfma_f32_16x16x32_bf16 a[132:135], v[124:127], v[72:75], a[132:135]
    v_mfma_f32_16x16x32_bf16 a[136:139], v[128:131], v[72:75], a[136:139]
    v_max3_f32 v6, v40, v41, v42
    v_max3_f32 v9, v48, v49, v50
    v_mfma_f32_16x16x32_bf16 a[140:143], v[132:135], v[72:75], a[140:143]
    v_max3_f32 v6, v6, v43, v44
    v_max3_f32 v9, v9, v51, v52
    v_mfma_f32_16x16x32_bf16 a[144:147], v[136:139], v[72:75], a[144:147]
    v_max3_f32 v6, v6, v45, v46
    v_max3_f32 v9, v9, v53, v54
    v_mfma_f32_16x16x32_bf16 a[148:151], v[140:143], v[72:75], a[148:151]
    v_max3_f32 v6, v6, v47, v55
    v_max_f32 v6, v6, v9
    v_mfma_f32_16x16x32_bf16 a[152:155], v[144:147], v[72:75], a[152:155]
    v_cmp_lt_f32 vcc, s61, v6
    v_mfma_f32_16x16x32_bf16 a[156:159], v[148:151], v[72:75], a[156:159]
    v_exp_f32 v87, v87
    v_mfma_f32_16x16x32_bf16 a[208:211], a[216:219], v[72:75], a[208:211]
    v_cvt_pk_bf16_f32 v82, v84, v85
    v_cvt_pk_bf16_f32 v83, v86, v87
    v_mfma_f32_16x16x32_bf16 v[56:59], v[88:91], v[184:187], v[24:27]
    s_cbranch_vccnz L_stub0_28
L_back0_28:
    v_mfma_f32_16x16x32_bf16 v[56:59], v[92:95], v[188:191], v[56:59]
    s_waitcnt vmcnt(3)
    buffer_load_dwordx4 v1, s[28:31], s65 offen offset:2048 nt lds
    v_mfma_f32_16x16x32_bf16 v[56:59], v[96:99], v[192:195], v[56:59]
    v_exp_f32 v40, v40
    v_mfma_f32_16x16x32_bf16 v[56:59], v[100:103], v[196:199], v[56:59]
    v_exp_f32 v41, v41
    v_mfma_f32_16x16x32_bf16 v[60:63], v[104:107], v[184:187], v[24:27]
    v_exp_f32 v42, v42
    v_mfma_f32_16x16x32_bf16 v[60:63], v[108:111], v[188:191], v[60:63]
    v_exp_f32 v43, v43
    v_mfma_f32_16x16x32_bf16 v[60:63], v[112:115], v[192:195], v[60:63]
    v_cvt_pk_bf16_f32 v40, v40, v41
    v_cvt_pk_bf16_f32 v41, v42, v43
    v_mfma_f32_16x16x32_bf16 v[60:63], v[116:119], v[196:199], v[60:63]
    v_exp_f32 v44, v44
    v_mfma_f32_16x16x32_bf16 a[160:163], v[120:123], v[80:83], a[160:163]
    ds_read_b64_tr_b16 v[120:121], v249 offset:32768
    ds_read_b64_tr_b16 v[122:123], v249 offset:36864
    v_mfma_f32_16x16x32_bf16 a[164:167], v[124:127], v[80:83], a[164:167]
    ds_read_b64_tr_b16 v[124:125], v250 offset:32768
    ds_read_b64_tr_b16 v[126:127], v250 offset:36864
    v_mfma_f32_16x16x32_bf16 a[168:171], v[128:131], v[80:83], a[168:171]
    ds_read_b64_tr_b16 v[128:129], v249 offset:33024
    ds_read_b64_tr_b16 v[130:131], v249 offset:37120
    v_mfma_f32_16x16x32_bf16 a[172:175], v[132:135], v[80:83], a[172:175]
    ds_read_b64_tr_b16 v[132:133], v250 offset:33024
    ds_read_b64_tr_b16 v[134:135], v250 offset:37120
    v_mfma_f32_16x16x32_bf16 a[176:179], v[136:139], v[80:83], a[176:179]
    ds_read_b64_tr_b16 v[136:137], v249 offset:33280
    ds_read_b64_tr_b16 v[138:139], v249 offset:37376
    v_mfma_f32_16x16x32_bf16 a[180:183], v[140:143], v[80:83], a[180:183]
    ds_read_b64_tr_b16 v[140:141], v250 offset:33280
    ds_read_b64_tr_b16 v[142:143], v250 offset:37376
    v_mfma_f32_16x16x32_bf16 a[184:187], v[144:147], v[80:83], a[184:187]
    ds_read_b64_tr_b16 v[144:145], v249 offset:33536
    ds_read_b64_tr_b16 v[146:147], v249 offset:37632
    v_mfma_f32_16x16x32_bf16 a[188:191], v[148:151], v[80:83], a[188:191]
    ds_read_b64_tr_b16 v[148:149], v250 offset:33536
    ds_read_b64_tr_b16 v[150:151], v250 offset:37632
    v_mfma_f32_16x16x32_bf16 a[212:215], a[216:219], v[80:83], a[212:215]
    s_waitcnt vmcnt(3)
    buffer_load_dwordx4 v2, s[28:31], s65 offen offset:3072 nt lds
    v_mfma_f32_16x16x32_bf16 v[64:67], v[88:91], v[200:203], v[28:31]
    v_exp_f32 v45, v45
    v_mfma_f32_16x16x32_bf16 v[64:67], v[92:95], v[204:207], v[64:67]
    v_exp_f32 v46, v46
    v_mfma_f32_16x16x32_bf16 v[64:67], v[96:99], v[208:211], v[64:67]
    v_exp_f32 v47, v47
    v_mfma_f32_16x16x32_bf16 v[64:67], v[100:103], v[212:215], v[64:67]
    v_cvt_pk_bf16_f32 v42, v44, v45
    v_cvt_pk_bf16_f32 v43, v46, v47
    v_mfma_f32_16x16x32_bf16 v[68:71], v[104:107], v[200:203], v[28:31]
    v_exp_f32 v48, v48
    v_mfma_f32_16x16x32_bf16 v[68:71], v[108:111], v[204:207], v[68:71]
    v_exp_f32 v49, v49
    v_mfma_f32_16x16x32_bf16 v[68:71], v[112:115], v[208:211], v[68:71]
    v_exp_f32 v50, v50
    v_mfma_f32_16x16x32_bf16 v[68:71], v[116:119], v[212:215], v[68:71]
    s_waitcnt lgkmcnt(0)
    v_mfma_f32_16x16x32_bf16 a[0:3], v[120:123], v[40:43], a[0:3]
    v_exp_f32 v51, v51
    v_mfma_f32_16x16x32_bf16 a[4:7], v[124:127], v[40:43], a[4:7]
    v_cvt_pk_bf16_f32 v48, v48, v49
    v_cvt_pk_bf16_f32 v49, v50, v51
    v_mfma_f32_16x16x32_bf16 a[8:11], v[128:131], v[40:43], a[8:11]
    v_exp_f32 v52, v52
    v_mfma_f32_16x16x32_bf16 a[12:15], v[132:135], v[40:43], a[12:15]
    s_add_u32 m0, s58, 40960
    v_mfma_f32_16x16x32_bf16 a[16:19], v[136:139], v[40:43], a[16:19]
    s_waitcnt vmcnt(3)
    buffer_load_dwordx4 v1, s[4:7], s65 offen offset:0 nt lds
    v_mfma_f32_16x16x32_bf16 a[20:23], v[140:143], v[40:43], a[20:23]
    v_exp_f32 v53, v53
    v_mfma_f32_16x16x32_bf16 a[24:27], v[144:147], v[40:43], a[24:27]
    v_exp_f32 v54, v54
    v_mfma_f32_16x16x32_bf16 a[28:31], v[148:151], v[40:43], a[28:31]
    v_max3_f32 v6, v56, v57, v58
    v_max3_f32 v9, v64, v65, v66
    v_mfma_f32_16x16x32_bf16 a[192:195], a[216:219], v[40:43], a[192:195]
    v_max3_f32 v6, v6, v59, v60
    v_max3_f32 v9, v9, v67, v68
    v_mfma_f32_16x16x32_bf16 v[72:75], v[88:91], v[216:219], v[32:35]
    v_max3_f32 v6, v6, v61, v62
    v_max3_f32 v9, v9, v69, v70
    v_mfma_f32_16x16x32_bf16 v[72:75], v[92:95], v[220:223], v[72:75]
    v_max3_f32 v6, v6, v63, v71
    v_max_f32 v6, v6, v9
    v_mfma_f32_16x16x32_bf16 v[72:75], v[96:99], v[224:227], v[72:75]
    v_cmp_lt_f32 vcc, s61, v6
    v_mfma_f32_16x16x32_bf16 v[72:75], v[100:103], v[228:231], v[72:75]
    v_exp_f32 v55, v55
    v_mfma_f32_16x16x32_bf16 v[76:79], v[104:107], v[216:219], v[32:35]
    v_cvt_pk_bf16_f32 v50, v52, v53
    v_cvt_pk_bf16_f32 v51, v54, v55
    v_mfma_f32_16x16x32_bf16 v[76:79], v[108:111], v[220:223], v[76:79]
    s_cbranch_vccnz L_stub2_28
L_back2_28:
    v_mfma_f32_16x16x32_bf16 v[76:79], v[112:115], v[224:227], v[76:79]
    v_exp_f32 v56, v56
    v_mfma_f32_16x16x32_bf16 v[76:79], v[116:119], v[228:231], v[76:79]
    s_waitcnt vmcnt(3)
    buffer_load_dwordx4 v2, s[4:7], s65 offen offset:1024 nt lds
    v_mfma_f32_16x16x32_bf16 a[32:35], v[120:123], v[48:51], a[32:35]
    v_exp_f32 v57, v57
    v_mfma_f32_16x16x32_bf16 a[36:39], v[124:127], v[48:51], a[36:39]
    v_exp_f32 v58, v58
    v_mfma_f32_16x16x32_bf16 a[40:43], v[128:131], v[48:51], a[40:43]
    v_exp_f32 v59, v59
    v_mfma_f32_16x16x32_bf16 a[44:47], v[132:135], v[48:51], a[44:47]
    v_cvt_pk_bf16_f32 v56, v56, v57
    v_cvt_pk_bf16_f32 v57, v58, v59
    v_mfma_f32_16x16x32_bf16 a[48:51], v[136:139], v[48:51], a[48:51]
    v_exp_f32 v60, v60
    v_mfma_f32_16x16x32_bf16 a[52:55], v[140:143], v[48:51], a[52:55]
    v_exp_f32 v61, v61
    v_mfma_f32_16x16x32_bf16 a[56:59], v[144:147], v[48:51], a[56:59]
    global_load_dword v13, v[10:11], off
    v_mfma_f32_16x16x32_bf16 a[60:63], v[148:151], v[48:51], a[60:63]
    v_exp_f32 v62, v62
    v_mfma_f32_16x16x32_bf16 a[196:199], a[216:219], v[48:51], a[196:199]
    v_exp_f32 v63, v63
    v_cvt_pk_bf16_f32 v58, v60, v61
    v_cvt_pk_bf16_f32 v59, v62, v63
    s_barrier
    v_mfma_f32_16x16x32_bf16 v[80:83], v[88:91], v[232:235], v[36:39]
    v_exp_f32 v64, v64
    v_mfma_f32_16x16x32_bf16 v[80:83], v[92:95], v[236:239], v[80:83]
    ds_read_b128 v[88:91], v251 offset:0
    ds_read_b128 v[92:95], v251 offset:256
    v_mfma_f32_16x16x32_bf16 v[80:83], v[96:99], v[240:243], v[80:83]
    v_exp_f32 v65, v65
    v_mfma_f32_16x16x32_bf16 v[80:83], v[100:103], v[244:247], v[80:83]
    ds_read_b128 v[96:99], v251 offset:512
    ds_read_b128 v[100:103], v251 offset:768
    v_mfma_f32_16x16x32_bf16 v[84:87], v[104:107], v[232:235], v[36:39]
    s_waitcnt vmcnt(4)
    buffer_load_dwordx4 v1, s[4:7], s65 offen offset:2048 nt lds
    v_mfma_f32_16x16x32_bf16 v[84:87], v[108:111], v[236:239], v[84:87]
    ds_read_b128 v[104:107], v251 offset:4096
    ds_read_b128 v[108:111], v251 offset:4352
    v_mfma_f32_16x16x32_bf16 v[84:87], v[112:115], v[240:243], v[84:87]
    v_exp_f32 v66, v66
    v_mfma_f32_16x16x32_bf16 v[84:87], v[116:119], v[244:247], v[84:87]
    ds_read_b128 v[112:115], v251 offset:4608
    ds_read_b128 v[116:119], v251 offset:4864
    v_mfma_f32_16x16x32_bf16 a[64:67], v[120:123], v[56:59], a[64:67]
    v_exp_f32 v67, v67
    v_mfma_f32_16x16x32_bf16 a[68:71], v[124:127], v[56:59], a[68:71]
    v_cvt_pk_bf16_f32 v64, v64, v65
    v_cvt_pk_bf16_f32 v65, v66, v67
    v_mfma_f32_16x16x32_bf16 a[72:75], v[128:131], v[56:59], a[72:75]
    v_exp_f32 v68, v68
    v_mfma_f32_16x16x32_bf16 a[76:79], v[132:135], v[56:59], a[76:79]
    v_exp_f32 v69, v69
    v_mfma_f32_16x16x32_bf16 a[80:83], v[136:139], v[56:59], a[80:83]
    v_exp_f32 v70, v70
    v_mfma_f32_16x16x32_bf16 a[84:87], v[140:143], v[56:59], a[84:87]
    v_max3_f32 v6, v72, v73, v74
    v_max3_f32 v9, v80, v81, v82
    v_mfma_f32_16x16x32_bf16 a[88:91], v[144:147], v[56:59], a[88:91]
    v_max3_f32 v6, v6, v75, v76
    v_max3_f32 v9, v9, v83, v84
    v_mfma_f32_16x16x32_bf16 a[92:95], v[148:151], v[56:59], a[92:95]
    v_max3_f32 v6, v6, v77, v78
    v_max3_f32 v9, v9, v85, v86
    v_mfma_f32_16x16x32_bf16 a[200:203], a[216:219], v[56:59], a[200:203]
    s_waitcnt lgkmcnt(0)
    v_mfma_f32_16x16x32_bf16 v[40:43], v[88:91], v[152:155], v[16:19]
    s_waitcnt vmcnt(4)
    buffer_load_dwordx4 v2, s[4:7], s65 offen offset:3072 nt lds
    v_mfma_f32_16x16x32_bf16 v[40:43], v[92:95], v[156:159], v[40:43]
    v_max3_f32 v6, v6, v79, v87
    v_max_f32 v6, v6, v9
    v_mfma_f32_16x16x32_bf16 v[40:43], v[96:99], v[160:163], v[40:43]
    v_cmp_lt_f32 vcc, s61, v6
    v_mfma_f32_16x16x32_bf16 v[40:43], v[100:103], v[164:167], v[40:43]
    v_exp_f32 v71, v71
    v_mfma_f32_16x16x32_bf16 v[44:47], v[104:107], v[152:155], v[16:19]
    v_cvt_pk_bf16_f32 v66, v68, v69
    v_cvt_pk_bf16_f32 v67, v70, v71
    v_mfma_f32_16x16x32_bf16 v[44:47], v[108:111], v[156:159], v[44:47]
    s_cbranch_vccnz L_stub4_29
L_back4_29:
    v_mfma_f32_16x16x32_bf16 v[44:47], v[112:115], v[160:163], v[44:47]
    v_exp_f32 v72, v72
    v_mfma_f32_16x16x32_bf16 v[44:47], v[116:119], v[164:167], v[44:47]
    v_exp_f32 v73, v73
    v_mfma_f32_16x16x32_bf16 a[96:99], v[120:123], v[64:67], a[96:99]
    v_exp_f32 v74, v74
    v_mfma_f32_16x16x32_bf16 a[100:103], v[124:127], v[64:67], a[100:103]
    v_exp_f32 v75, v75
    v_mfma_f32_16x16x32_bf16 a[104:107], v[128:131], v[64:67], a[104:107]
    v_cvt_pk_bf16_f32 v72, v72, v73
    v_cvt_pk_bf16_f32 v73, v74, v75
    v_mfma_f32_16x16x32_bf16 a[108:111], v[132:135], v[64:67], a[108:111]
    v_exp_f32 v76, v76
    v_mfma_f32_16x16x32_bf16 a[112:115], v[136:139], v[64:67], a[112:115]
    v_exp_f32 v77, v77
    v_mfma_f32_16x16x32_bf16 a[116:119], v[140:143], v[64:67], a[116:119]
    s_mov_b32 s75, 0
    buffer_load_dword v13, v255, s[36:39], s75 offen
    v_mfma_f32_16x16x32_bf16 a[120:123], v[144:147], v[64:67], a[120:123]
    v_exp_f32 v78, v78
    v_mfma_f32_16x16x32_bf16 a[124:127], v[148:151], v[64:67], a[124:127]
    v_exp_f32 v79, v79
    v_mfma_f32_16x16x32_bf16 a[204:207], a[216:219], v[64:67], a[204:207]
    v_cvt_pk_bf16_f32 v74, v76, v77
    v_cvt_pk_bf16_f32 v75, v78, v79
    v_mfma_f32_16x16x32_bf16 v[48:51], v[88:91], v[168:171], v[20:23]
    v_exp_f32 v80, v80
    v_mfma_f32_16x16x32_bf16 v[48:51], v[92:95], v[172:175], v[48:51]
    v_exp_f32 v81, v81
    v_mfma_f32_16x16x32_bf16 v[48:51], v[96:99], v[176:179], v[48:51]
    v_exp_f32 v82, v82
    v_mfma_f32_16x16x32_bf16 v[48:51], v[100:103], v[180:183], v[48:51]
    v_exp_f32 v83, v83
    v_mfma_f32_16x16x32_bf16 v[52:55], v[104:107], v[168:171], v[20:23]
    v_cvt_pk_bf16_f32 v80, v80, v81
    v_cvt_pk_bf16_f32 v81, v82, v83
    v_mfma_f32_16x16x32_bf16 v[52:55], v[108:111], v[172:175], v[52:55]
    s_mov_b32 s75, 2048
    buffer_load_dword v13, v255, s[36:39], s75 offen
    v_mfma_f32_16x16x32_bf16 v[52:55], v[112:115], v[176:179], v[52:55]
    v_exp_f32 v84, v84
    v_mfma_f32_16x16x32_bf16 v[52:55], v[116:119], v[180:183], v[52:55]
    v_exp_f32 v85, v85
    v_mfma_f32_16x16x32_bf16 a[128:131], v[120:123], v[72:75], a[128:131]
    v_exp_f32 v86, v86
    v_mfma_f32_16x16x32_bf16 a[132:135], v[124:127], v[72:75], a[132:135]
    v_mfma_f32_16x16x32_bf16 a[136:139], v[128:131], v[72:75], a[136:139]
    v_max3_f32 v6, v40, v41, v42
    v_max3_f32 v9, v48, v49, v50
    v_mfma_f32_16x16x32_bf16 a[140:143], v[132:135], v[72:75], a[140:143]
    v_max3_f32 v6, v6, v43, v44
    v_max3_f32 v9, v9, v51, v52
    v_mfma_f32_16x16x32_bf16 a[144:147], v[136:139], v[72:75], a[144:147]
    v_max3_f32 v6, v6, v45, v46
    v_max3_f32 v9, v9, v53, v54
    v_mfma_f32_16x16x32_bf16 a[148:151], v[140:143], v[72:75], a[148:151]
    v_max3_f32 v6, v6, v47, v55
    v_max_f32 v6, v6, v9
    v_mfma_f32_16x16x32_bf16 a[152:155], v[144:147], v[72:75], a[152:155]
    s_mov_b32 s75, 4096
    buffer_load_dword v13, v255, s[36:39], s75 offen
    v_mfma_f32_16x16x32_bf16 a[156:159], v[148:151], v[72:75], a[156:159]
    v_cmp_lt_f32 vcc, s61, v6
    v_mfma_f32_16x16x32_bf16 a[208:211], a[216:219], v[72:75], a[208:211]
    v_exp_f32 v87, v87
    v_mfma_f32_16x16x32_bf16 v[56:59], v[88:91], v[184:187], v[24:27]
    v_cvt_pk_bf16_f32 v82, v84, v85
    v_cvt_pk_bf16_f32 v83, v86, v87
    v_mfma_f32_16x16x32_bf16 v[56:59], v[92:95], v[188:191], v[56:59]
    s_cbranch_vccnz L_stub0_29
L_back0_29:
    v_mfma_f32_16x16x32_bf16 v[56:59], v[96:99], v[192:195], v[56:59]
    v_exp_f32 v40, v40
    v_mfma_f32_16x16x32_bf16 v[56:59], v[100:103], v[196:199], v[56:59]
    v_exp_f32 v41, v41
    v_mfma_f32_16x16x32_bf16 v[60:63], v[104:107], v[184:187], v[24:27]
    v_exp_f32 v42, v42
    v_mfma_f32_16x16x32_bf16 v[60:63], v[108:111], v[188:191], v[60:63]
    v_exp_f32 v43, v43
    v_mfma_f32_16x16x32_bf16 v[60:63], v[112:115], v[192:195], v[60:63]
    v_cvt_pk_bf16_f32 v40, v40, v41
    v_cvt_pk_bf16_f32 v41, v42, v43
    v_mfma_f32_16x16x32_bf16 v[60:63], v[116:119], v[196:199], v[60:63]
    s_mov_b32 s75, 6144
    buffer_load_dword v13, v255, s[36:39], s75 offen
    v_mfma_f32_16x16x32_bf16 a[160:163], v[120:123], v[80:83], a[160:163]
    ds_read_b64_tr_b16 v[120:121], v252 offset:0
    ds_read_b64_tr_b16 v[122:123], v252 offset:4096
    v_mfma_f32_16x16x32_bf16 a[164:167], v[124:127], v[80:83], a[164:167]
    ds_read_b64_tr_b16 v[124:125], v253 offset:0
    ds_read_b64_tr_b16 v[126:127], v253 offset:4096
    v_mfma_f32_16x16x32_bf16 a[168:171], v[128:131], v[80:83], a[168:171]
    ds_read_b64_tr_b16 v[128:129], v252 offset:256
    ds_read_b64_tr_b16 v[130:131], v252 offset:4352
    v_mfma_f32_16x16x32_bf16 a[172:175], v[132:135], v[80:83], a[172:175]
    ds_read_b64_tr_b16 v[132:133], v253 offset:256
    ds_read_b64_tr_b16 v[134:135], v253 offset:4352
    v_mfma_f32_16x16x32_bf16 a[176:179], v[136:139], v[80:83], a[176:179]
    ds_read_b64_tr_b16 v[136:137], v252 offset:512
    ds_read_b64_tr_b16 v[138:139], v252 offset:4608
    v_mfma_f32_16x16x32_bf16 a[180:183], v[140:143], v[80:83], a[180:183]
    ds_read_b64_tr_b16 v[140:141], v253 offset:512
    ds_read_b64_tr_b16 v[142:143], v253 offset:4608
    v_mfma_f32_16x16x32_bf16 a[184:187], v[144:147], v[80:83], a[184:187]
    ds_read_b64_tr_b16 v[144:145], v252 offset:768
    ds_read_b64_tr_b16 v[146:147], v252 offset:4864
    v_mfma_f32_16x16x32_bf16 a[188:191], v[148:151], v[80:83], a[188:191]
    ds_read_b64_tr_b16 v[148:149], v253 offset:768
    ds_read_b64_tr_b16 v[150:151], v253 offset:4864
    v_mfma_f32_16x16x32_bf16 a[212:215], a[216:219], v[80:83], a[212:215]
    s_mov_b32 s75, 7168
    buffer_load_dword v13, v255, s[36:39], s75 offen
    v_mfma_f32_16x16x32_bf16 v[64:67], v[88:91], v[200:203], v[28:31]
    v_exp_f32 v44, v44
    v_mfma_f32_16x16x32_bf16 v[64:67], v[92:95], v[204:207], v[64:67]
    v_exp_f32 v45, v45
    v_mfma_f32_16x16x32_bf16 v[64:67], v[96:99], v[208:211], v[64:67]
    v_exp_f32 v46, v46
    v_mfma_f32_16x16x32_bf16 v[64:67], v[100:103], v[212:215], v[64:67]
    v_exp_f32 v47, v47
    v_mfma_f32_16x16x32_bf16 v[68:71], v[104:107], v[200:203], v[28:31]
    v_cvt_pk_bf16_f32 v42, v44, v45
    v_cvt_pk_bf16_f32 v43, v46, v47
    v_mfma_f32_16x16x32_bf16 v[68:71], v[108:111], v[204:207], v[68:71]
    v_exp_f32 v48, v48
    v_mfma_f32_16x16x32_bf16 v[68:71], v[112:115], v[208:211], v[68:71]
    v_exp_f32 v49, v49
    v_mfma_f32_16x16x32_bf16 v[68:71], v[116:119], v[212:215], v[68:71]
    s_waitcnt lgkmcnt(0)
    v_mfma_f32_16x16x32_bf16 a[0:3], v[120:123], v[40:43], a[0:3]
    s_add_u32 m0, s64, 65536
    s_add_u32 s65, s66, 0
    buffer_load_dwordx4 v12, s[36:39], s65 offen offset:0 lds
    v_mfma_f32_16x16x32_bf16 a[4:7], v[124:127], v[40:43], a[4:7]
    v_exp_f32 v50, v50
    v_mfma_f32_16x16x32_bf16 a[8:11], v[128:131], v[40:43], a[8:11]
    v_exp_f32 v51, v51
    v_mfma_f32_16x16x32_bf16 a[12:15], v[132:135], v[40:43], a[12:15]
    v_cvt_pk_bf16_f32 v48, v48, v49
    v_cvt_pk_bf16_f32 v49, v50, v51
    v_mfma_f32_16x16x32_bf16 a[16:19], v[136:139], v[40:43], a[16:19]
    v_exp_f32 v52, v52
    v_mfma_f32_16x16x32_bf16 a[20:23], v[140:143], v[40:43], a[20:23]
    v_exp_f32 v53, v53
    v_mfma_f32_16x16x32_bf16 a[24:27], v[144:147], v[40:43], a[24:27]
    v_exp_f32 v54, v54
    v_mfma_f32_16x16x32_bf16 a[28:31], v[148:151], v[40:43], a[28:31]
    v_max3_f32 v6, v56, v57, v58
    v_max3_f32 v9, v64, v65, v66
    v_mfma_f32_16x16x32_bf16 a[192:195], a[216:219], v[40:43], a[192:195]
    v_max3_f32 v6, v6, v59, v60
    v_max3_f32 v9, v9, v67, v68
    v_mfma_f32_16x16x32_bf16 v[72:75], v[88:91], v[216:219], v[32:35]
    s_add_u32 m0, s64, 69504
    s_nop 0
    buffer_load_dwordx4 v12, s[36:39], s65 offen offset:128 lds
    v_mfma_f32_16x16x32_bf16 v[72:75], v[92:95], v[220:223], v[72:75]
    v_max3_f32 v6, v6, v61, v62
    v_max3_f32 v9, v9, v69, v70
    v_mfma_f32_16x16x32_bf16 v[72:75], v[96:99], v[224:227], v[72:75]
    v_max3_f32 v6, v6, v63, v71
    v_max_f32 v6, v6, v9
    v_mfma_f32_16x16x32_bf16 v[72:75], v[100:103], v[228:231], v[72:75]
    v_cmp_lt_f32 vcc, s61, v6
    v_mfma_f32_16x16x32_bf16 v[76:79], v[104:107], v[216:219], v[32:35]
    v_exp_f32 v55, v55
    v_mfma_f32_16x16x32_bf16 v[76:79], v[108:111], v[220:223], v[76:79]
    v_cvt_pk_bf16_f32 v50, v52, v53
    v_cvt_pk_bf16_f32 v51, v54, v55
    v_mfma_f32_16x16x32_bf16 v[76:79], v[112:115], v[224:227], v[76:79]
    s_cbranch_vccnz L_stub2_29
L_back2_29:
    v_mfma_f32_16x16x32_bf16 v[76:79], v[116:119], v[228:231], v[76:79]
    v_exp_f32 v56, v56
    v_mfma_f32_16x16x32_bf16 a[32:35], v[120:123], v[48:51], a[32:35]
    v_exp_f32 v57, v57
    v_mfma_f32_16x16x32_bf16 a[36:39], v[124:127], v[48:51], a[36:39]
    s_add_u32 m0, s64, 73472
    s_nop 0
    buffer_load_dwordx4 v12, s[36:39], s65 offen offset:256 lds
    v_mfma_f32_16x16x32_bf16 a[40:43], v[128:131], v[48:51], a[40:43]
    v_exp_f32 v58, v58
    v_mfma_f32_16x16x32_bf16 a[44:47], v[132:135], v[48:51], a[44:47]
    v_exp_f32 v59, v59
    v_mfma_f32_16x16x32_bf16 a[48:51], v[136:139], v[48:51], a[48:51]
    v_cvt_pk_bf16_f32 v56, v56, v57
    v_cvt_pk_bf16_f32 v57, v58, v59
    v_mfma_f32_16x16x32_bf16 a[52:55], v[140:143], v[48:51], a[52:55]
    v_exp_f32 v60, v60
    v_mfma_f32_16x16x32_bf16 a[56:59], v[144:147], v[48:51], a[56:59]
    v_exp_f32 v61, v61
    v_mfma_f32_16x16x32_bf16 a[60:63], v[148:151], v[48:51], a[60:63]
    v_exp_f32 v62, v62
    v_mfma_f32_16x16x32_bf16 a[196:199], a[216:219], v[48:51], a[196:199]
    v_exp_f32 v63, v63
    v_cvt_pk_bf16_f32 v58, v60, v61
    v_cvt_pk_bf16_f32 v59, v62, v63
    s_barrier
    v_mfma_f32_16x16x32_bf16 v[80:83], v[88:91], v[232:235], v[36:39]
    v_exp_f32 v64, v64
    v_mfma_f32_16x16x32_bf16 v[80:83], v[92:95], v[236:239], v[80:83]
    ds_read_b128 v[88:91], v3 offset:0
    ds_read_b128 v[92:95], v3 offset:256
    v_mfma_f32_16x16x32_bf16 v[80:83], v[96:99], v[240:243], v[80:83]
    s_add_u32 m0, s64, 66560
    s_add_u32 s65, s66, 9216
    buffer_load_dwordx4 v12, s[36:39], s65 offen offset:0 lds
    v_mfma_f32_16x16x32_bf16 v[80:83], v[100:103], v[244:247], v[80:83]
    ds_read_b128 v[96:99], v3 offset:512
    ds_read_b128 v[100:103], v3 offset:768
    v_mfma_f32_16x16x32_bf16 v[84:87], v[104:107], v[232:235], v[36:39]
    v_exp_f32 v65, v65
    v_mfma_f32_16x16x32_bf16 v[84:87], v[108:111], v[236:239], v[84:87]
    ds_read_b128 v[104:107], v3 offset:4096
    ds_read_b128 v[108:111], v3 offset:4352
    v_mfma_f32_16x16x32_bf16 v[84:87], v[112:115], v[240:243], v[84:87]
    v_exp_f32 v66, v66
    v_mfma_f32_16x16x32_bf16 v[84:87], v[116:119], v[244:247], v[84:87]
    ds_read_b128 v[112:115], v3 offset:4608
    ds_read_b128 v[116:119], v3 offset:4864
    v_mfma_f32_16x16x32_bf16 a[64:67], v[120:123], v[56:59], a[64:67]
    v_exp_f32 v67, v67
    v_mfma_f32_16x16x32_bf16 a[68:71], v[124:127], v[56:59], a[68:71]
    v_cvt_pk_bf16_f32 v64, v64, v65
    v_cvt_pk_bf16_f32 v65, v66, v67
    v_mfma_f32_16x16x32_bf16 a[72:75], v[128:131], v[56:59], a[72:75]
    s_add_u32 m0, s64, 70528
    s_nop 0
    buffer_load_dwordx4 v12, s[36:39], s65 offen offset:128 lds
    v_mfma_f32_16x16x32_bf16 a[76:79], v[132:135], v[56:59], a[76:79]
    v_exp_f32 v68, v68
    v_mfma_f32_16x16x32_bf16 a[80:83], v[136:139], v[56:59], a[80:83]
    v_exp_f32 v69, v69
    v_mfma_f32_16x16x32_bf16 a[84:87], v[140:143], v[56:59], a[84:87]
    v_exp_f32 v70, v70
    v_mfma_f32_16x16x32_bf16 a[88:91], v[144:147], v[56:59], a[88:91]
    v_max3_f32 v6, v72, v73, v74
    v_max3_f32 v9, v80, v81, v82
    v_mfma_f32_16x16x32_bf16 a[92:95], v[148:151], v[56:59], a[92:95]
    v_max3_f32 v6, v6, v75, v76
    v_max3_f32 v9, v9, v83, v84
    v_mfma_f32_16x16x32_bf16 a[200:203], a[216:219], v[56:59], a[200:203]
    s_waitcnt lgkmcnt(0)
    v_mfma_f32_16x16x32_bf16 v[40:43], v[88:91], v[152:155], v[16:19]
    v_max3_f32 v6, v6, v77, v78
    v_max3_f32 v9, v9, v85, v86
    v_mfma_f32_16x16x32_bf16 v[40:43], v[92:95], v[156:159], v[40:43]
    v_max3_f32 v6, v6, v79, v87
    v_max_f32 v6, v6, v9
    v_mfma_f32_16x16x32_bf16 v[40:43], v[96:99], v[160:163], v[40:43]
    v_cmp_lt_f32 vcc, s61, v6
    v_mfma_f32_16x16x32_bf16 v[40:43], v[100:103], v[164:167], v[40:43]
    s_add_u32 m0, s64, 74496
    s_nop 0
    buffer_load_dwordx4 v12, s[36:39], s65 offen offset:256 lds
    v_mfma_f32_16x16x32_bf16 v[44:47], v[104:107], v[152:155], v[16:19]
    v_exp_f32 v71, v71
    v_mfma_f32_16x16x32_bf16 v[44:47], v[108:111], v[156:159], v[44:47]
    v_cvt_pk_bf16_f32 v66, v68, v69
    v_cvt_pk_bf16_f32 v67, v70, v71
    v_mfma_f32_16x16x32_bf16 v[44:47], v[112:115], v[160:163], v[44:47]
    s_cbranch_vccnz L_stub4_30
L_back4_30:
    v_mfma_f32_16x16x32_bf16 v[44:47], v[116:119], v[164:167], v[44:47]
    v_exp_f32 v72, v72
    v_mfma_f32_16x16x32_bf16 a[96:99], v[120:123], v[64:67], a[96:99]
    v_exp_f32 v73, v73
    v_mfma_f32_16x16x32_bf16 a[100:103], v[124:127], v[64:67], a[100:103]
    v_exp_f32 v74, v74
    v_mfma_f32_16x16x32_bf16 a[104:107], v[128:131], v[64:67], a[104:107]
    v_exp_f32 v75, v75
    v_mfma_f32_16x16x32_bf16 a[108:111], v[132:135], v[64:67], a[108:111]
    v_cvt_pk_bf16_f32 v72, v72, v73
    v_cvt_pk_bf16_f32 v73, v74, v75
    v_mfma_f32_16x16x32_bf16 a[112:115], v[136:139], v[64:67], a[112:115]
    s_add_u32 m0, s64, 98304
    s_add_u32 s65, s66, 36864
    buffer_load_dwordx4 v12, s[36:39], s65 offen offset:0 lds
    v_mfma_f32_16x16x32_bf16 a[116:119], v[140:143], v[64:67], a[116:119]
    v_exp_f32 v76, v76
    v_mfma_f32_16x16x32_bf16 a[120:123], v[144:147], v[64:67], a[120:123]
    v_exp_f32 v77, v77
    v_mfma_f32_16x16x32_bf16 a[124:127], v[148:151], v[64:67], a[124:127]
    v_exp_f32 v78, v78
    v_mfma_f32_16x16x32_bf16 a[204:207], a[216:219], v[64:67], a[204:207]
    v_exp_f32 v79, v79
    v_mfma_f32_16x16x32_bf16 v[48:51], v[88:91], v[168:171], v[20:23]
    v_cvt_pk_bf16_f32 v74, v76, v77
    v_cvt_pk_bf16_f32 v75, v78, v79
    v_mfma_f32_16x16x32_bf16 v[48:51], v[92:95], v[172:175], v[48:51]
    v_exp_f32 v80, v80
    v_mfma_f32_16x16x32_bf16 v[48:51], v[96:99], v[176:179], v[48:51]
    v_exp_f32 v81, v81
    v_mfma_f32_16x16x32_bf16 v[48:51], v[100:103], v[180:183], v[48:51]
    v_exp_f32 v82, v82
    v_mfma_f32_16x16x32_bf16 v[52:55], v[104:107], v[168:171], v[20:23]
    s_add_u32 m0, s64, 102272
    s_nop 0
    buffer_load_dwordx4 v12, s[36:39], s65 offen offset:128 lds
    v_mfma_f32_16x16x32_bf16 v[52:55], v[108:111], v[172:175], v[52:55]
    v_exp_f32 v83, v83
    v_mfma_f32_16x16x32_bf16 v[52:55], v[112:115], v[176:179], v[52:55]
    v_cvt_pk_bf16_f32 v80, v80, v81
    v_cvt_pk_bf16_f32 v81, v82, v83
    v_mfma_f32_16x16x32_bf16 v[52:55], v[116:119], v[180:183], v[52:55]
    v_exp_f32 v84, v84
    v_mfma_f32_16x16x32_bf16 a[128:131], v[120:123], v[72:75], a[128:131]
    v_exp_f32 v85, v85
    v_mfma_f32_16x16x32_bf16 a[132:135], v[124:127], v[72:75], a[132:135]
    v_exp_f32 v86, v86
    v_mfma_f32_16x16x32_bf16 a[136:139], v[128:131], v[72:75], a[136:139]
    v_max3_f32 v6, v40, v41, v42
    v_max3_f32 v9, v48, v49, v50
    v_mfma_f32_16x16x32_bf16 a[140:143], v[132:135], v[72:75], a[140:143]
    v_max3_f32 v6, v6, v43, v44
    v_max3_f32 v9, v9, v51, v52
    v_mfma_f32_16x16x32_bf16 a[144:147], v[136:139], v[72:75], a[144:147]
    v_max3_f32 v6, v6, v45, v46
    v_max3_f32 v9, v9, v53, v54
    v_mfma_f32_16x16x32_bf16 a[148:151], v[140:143], v[72:75], a[148:151]
    s_add_u32 m0, s64, 106240
    s_nop 0
    buffer_load_dwordx4 v12, s[36:39], s65 offen offset:256 lds
    v_mfma_f32_16x16x32_bf16 a[152:155], v[144:147], v[72:75], a[152:155]
    v_max3_f32 v6, v6, v47, v55
    v_max_f32 v6, v6, v9
    v_mfma_f32_16x16x32_bf16 a[156:159], v[148:151], v[72:75], a[156:159]
    v_cmp_lt_f32 vcc, s61, v6
    v_mfma_f32_16x16x32_bf16 a[208:211], a[216:219], v[72:75], a[208:211]
    v_exp_f32 v87, v87
    v_mfma_f32_16x16x32_bf16 v[56:59], v[88:91], v[184:187], v[24:27]
    v_cvt_pk_bf16_f32 v82, v84, v85
    v_cvt_pk_bf16_f32 v83, v86, v87
    v_mfma_f32_16x16x32_bf16 v[56:59], v[92:95], v[188:191], v[56:59]
    s_cbranch_vccnz L_stub0_30
L_back0_30:
    v_mfma_f32_16x16x32_bf16 v[56:59], v[96:99], v[192:195], v[56:59]
    v_exp_f32 v40, v40
    v_mfma_f32_16x16x32_bf16 v[56:59], v[100:103], v[196:199], v[56:59]
    v_exp_f32 v41, v41
    v_mfma_f32_16x16x32_bf16 v[60:63], v[104:107], v[184:187], v[24:27]
    v_exp_f32 v42, v42
    v_mfma_f32_16x16x32_bf16 v[60:63], v[108:111], v[188:191], v[60:63]
    s_add_u32 m0, s64, 99328
    s_add_u32 s65, s66, 46080
    buffer_load_dwordx4 v12, s[36:39], s65 offen offset:0 lds
    v_mfma_f32_16x16x32_bf16 v[60:63], v[112:115], v[192:195], v[60:63]
    v_exp_f32 v43, v43
    v_mfma_f32_16x16x32_bf16 v[60:63], v[116:119], v[196:199], v[60:63]
    v_cvt_pk_bf16_f32 v40, v40, v41
    v_cvt_pk_bf16_f32 v41, v42, v43
    v_mfma_f32_16x16x32_bf16 a[160:163], v[120:123], v[80:83], a[160:163]
    ds_read_b64_tr_b16 v[120:121], v4 offset:0
    ds_read_b64_tr_b16 v[122:123], v4 offset:4096
    v_mfma_f32_16x16x32_bf16 a[164:167], v[124:127], v[80:83], a[164:167]
    ds_read_b64_tr_b16 v[124:125], v5 offset:0
    ds_read_b64_tr_b16 v[126:127], v5 offset:4096
    v_mfma_f32_16x16x32_bf16 a[168:171], v[128:131], v[80:83], a[168:171]
    ds_read_b64_tr_b16 v[128:129], v4 offset:256
    ds_read_b64_tr_b16 v[130:131], v4 offset:4352
    v_mfma_f32_16x16x32_bf16 a[172:175], v[132:135], v[80:83], a[172:175]
    ds_read_b64_tr_b16 v[132:133], v5 offset:256
    ds_read_b64_tr_b16 v[134:135], v5 offset:4352
    v_mfma_f32_16x16x32_bf16 a[176:179], v[136:139], v[80:83], a[176:179]
    ds_read_b64_tr_b16 v[136:137], v4 offset:512
    ds_read_b64_tr_b16 v[138:139], v4 offset:4608
    v_mfma_f32_16x16x32_bf16 a[180:183], v[140:143], v[80:83], a[180:183]
    ds_read_b64_tr_b16 v[140:141], v5 offset:512
    ds_read_b64_tr_b16 v[142:143], v5 offset:4608
    v_mfma_f32_16x16x32_bf16 a[184:187], v[144:147], v[80:83], a[184:187]
    ds_read_b64_tr_b16 v[144:145], v4 offset:768
    ds_read_b64_tr_b16 v[146:147], v4 offset:4864
    v_mfma_f32_16x16x32_bf16 a[188:191], v[148:151], v[80:83], a[188:191]
    ds_read_b64_tr_b16 v[148:149], v5 offset:768
    ds_read_b64_tr_b16 v[150:151], v5 offset:4864
    v_mfma_f32_16x16x32_bf16 a[212:215], a[216:219], v[80:83], a[212:215]
    s_add_u32 m0, s64, 103296
    s_nop 0
    buffer_load_dwordx4 v12, s[36:39], s65 offen offset:128 lds
    v_mfma_f32_16x16x32_bf16 v[64:67], v[88:91], v[200:203], v[28:31]
    v_exp_f32 v44, v44
    v_mfma_f32_16x16x32_bf16 v[64:67], v[92:95], v[204:207], v[64:67]
    v_exp_f32 v45, v45
    v_mfma_f32_16x16x32_bf16 v[64:67], v[96:99], v[208:211], v[64:67]
    v_exp_f32 v46, v46
    v_mfma_f32_16x16x32_bf16 v[64:67], v[100:103], v[212:215], v[64:67]
    v_exp_f32 v47, v47
    v_mfma_f32_16x16x32_bf16 v[68:71], v[104:107], v[200:203], v[28:31]
    v_cvt_pk_bf16_f32 v42, v44, v45
    v_cvt_pk_bf16_f32 v43, v46, v47
    v_mfma_f32_16x16x32_bf16 v[68:71], v[108:111], v[204:207], v[68:71]
    v_exp_f32 v48, v48
    v_mfma_f32_16x16x32_bf16 v[68:71], v[112:115], v[208:211], v[68:71]
    s_add_u32 m0, s64, 107264
    s_nop 0
    buffer_load_dwordx4 v12, s[36:39], s65 offen offset:256 lds
    v_mfma_f32_16x16x32_bf16 v[68:71], v[116:119], v[212:215], v[68:71]
    s_waitcnt lgkmcnt(0)
    v_mfma_f32_16x16x32_bf16 a[0:3], v[120:123], v[40:43], a[0:3]
    v_exp_f32 v49, v49
    v_mfma_f32_16x16x32_bf16 a[4:7], v[124:127], v[40:43], a[4:7]
    v_exp_f32 v50, v50
    v_mfma_f32_16x16x32_bf16 a[8:11], v[128:131], v[40:43], a[8:11]
    v_exp_f32 v51, v51
    v_mfma_f32_16x16x32_bf16 a[12:15], v[132:135], v[40:43], a[12:15]
    v_cvt_pk_bf16_f32 v48, v48, v49
    v_cvt_pk_bf16_f32 v49, v50, v51
    v_mfma_f32_16x16x32_bf16 a[16:19], v[136:139], v[40:43], a[16:19]
    v_exp_f32 v52, v52
    v_mfma_f32_16x16x32_bf16 a[20:23], v[140:143], v[40:43], a[20:23]
    v_exp_f32 v53, v53
    v_mfma_f32_16x16x32_bf16 a[24:27], v[144:147], v[40:43], a[24:27]
    v_exp_f32 v54, v54
    v_mfma_f32_16x16x32_bf16 a[28:31], v[148:151], v[40:43], a[28:31]
    v_max3_f32 v6, v56, v57, v58
    v_max3_f32 v9, v64, v65, v66
    v_mfma_f32_16x16x32_bf16 a[192:195], a[216:219], v[40:43], a[192:195]
    s_add_u32 m0, s64, 131072
    s_add_u32 s65, s66, 73728
    buffer_load_dwordx4 v12, s[36:39], s65 offen offset:0 lds
    v_mfma_f32_16x16x32_bf16 v[72:75], v[88:91], v[216:219], v[32:35]
    v_max3_f32 v6, v6, v59, v60
    v_max3_f32 v9, v9, v67, v68
    v_mfma_f32_16x16x32_bf16 v[72:75], v[92:95], v[220:223], v[72:75]
    v_max3_f32 v6, v6, v61, v62
    v_max3_f32 v9, v9, v69, v70
    v_mfma_f32_16x16x32_bf16 v[72:75], v[96:99], v[224:227], v[72:75]
    v_max3_f32 v6, v6, v63, v71
    v_max_f32 v6, v6, v9
    v_mfma_f32_16x16x32_bf16 v[72:75], v[100:103], v[228:231], v[72:75]
    v_cmp_lt_f32 vcc, s61, v6
    v_mfma_f32_16x16x32_bf16 v[76:79], v[104:107], v[216:219], v[32:35]
    v_exp_f32 v55, v55
    v_mfma_f32_16x16x32_bf16 v[76:79], v[108:111], v[220:223], v[76:79]
    v_cvt_pk_bf16_f32 v50, v52, v53
    v_cvt_pk_bf16_f32 v51, v54, v55
    v_mfma_f32_16x16x32_bf16 v[76:79], v[112:115], v[224:227], v[76:79]
    s_cbranch_vccnz L_stub2_30
L_back2_30:
    v_mfma_f32_16x16x32_bf16 v[76:79], v[116:119], v[228:231], v[76:79]
    v_exp_f32 v56, v56
    v_mfma_f32_16x16x32_bf16 a[32:35], v[120:123], v[48:51], a[32:35]
    s_add_u32 m0, s64, 135040
    s_nop 0
    buffer_load_dwordx4 v12, s[36:39], s65 offen offset:128 lds
    v_mfma_f32_16x16x32_bf16 a[36:39], v[124:127], v[48:51], a[36:39]
    v_exp_f32 v57, v57
    v_mfma_f32_16x16x32_bf16 a[40:43], v[128:131], v[48:51], a[40:43]
    v_exp_f32 v58, v58
    v_mfma_f32_16x16x32_bf16 a[44:47], v[132:135], v[48:51], a[44:47]
    v_exp_f32 v59, v59
    v_mfma_f32_16x16x32_bf16 a[48:51], v[136:139], v[48:51], a[48:51]
    v_cvt_pk_bf16_f32 v56, v56, v57
    v_cvt_pk_bf16_f32 v57, v58, v59
    v_mfma_f32_16x16x32_bf16 a[52:55], v[140:143], v[48:51], a[52:55]
    v_exp_f32 v60, v60
    v_mfma_f32_16x16x32_bf16 a[56:59], v[144:147], v[48:51], a[56:59]
    v_exp_f32 v61, v61
    v_mfma_f32_16x16x32_bf16 a[60:63], v[148:151], v[48:51], a[60:63]
    v_exp_f32 v62, v62
    v_mfma_f32_16x16x32_bf16 a[196:199], a[216:219], v[48:51], a[196:199]
    v_exp_f32 v63, v63
    v_cvt_pk_bf16_f32 v58, v60, v61
    v_cvt_pk_bf16_f32 v59, v62, v63
    s_waitcnt vmcnt(19)
    s_barrier
    v_mfma_f32_16x16x32_bf16 v[80:83], v[88:91], v[232:235], v[36:39]
    s_add_u32 m0, s64, 139008
    s_nop 0
    buffer_load_dwordx4 v12, s[36:39], s65 offen offset:256 lds
    v_mfma_f32_16x16x32_bf16 v[80:83], v[92:95], v[236:239], v[80:83]
    ds_read_b128 v[88:91], v3 offset:32768
    ds_read_b128 v[92:95], v3 offset:33024
    v_mfma_f32_16x16x32_bf16 v[80:83], v[96:99], v[240:243], v[80:83]
    v_exp_f32 v64, v64
    v_mfma_f32_16x16x32_bf16 v[80:83], v[100:103], v[244:247], v[80:83]
    ds_read_b128 v[96:99], v3 offset:33280
    ds_read_b128 v[100:103], v3 offset:33536
    v_mfma_f32_16x16x32_bf16 v[84:87], v[104:107], v[232:235], v[36:39]
    v_exp_f32 v65, v65
    v_mfma_f32_16x16x32_bf16 v[84:87], v[108:111], v[236:239], v[84:87]
    ds_read_b128 v[104:107], v3 offset:36864
    ds_read_b128 v[108:111], v3 offset:37120
    v_mfma_f32_16x16x32_bf16 v[84:87], v[112:115], v[240:243], v[84:87]
    v_exp_f32 v66, v66
    v_mfma_f32_16x16x32_bf16 v[84:87], v[116:119], v[244:247], v[84:87]
    ds_read_b128 v[112:115], v3 offset:37376
    ds_read_b128 v[116:119], v3 offset:37632
    v_mfma_f32_16x16x32_bf16 a[64:67], v[120:123], v[56:59], a[64:67]
    v_exp_f32 v67, v67
    v_mfma_f32_16x16x32_bf16 a[68:71], v[124:127], v[56:59], a[68:71]
    s_add_u32 m0, s64, 132096
    s_add_u32 s65, s66, 82944
    buffer_load_dwordx4 v12, s[36:39], s65 offen offset:0 lds
    v_mfma_f32_16x16x32_bf16 a[72:75], v[128:131], v[56:59], a[72:75]
    v_cvt_pk_bf16_f32 v64, v64, v65
    v_cvt_pk_bf16_f32 v65, v66, v67
    v_mfma_f32_16x16x32_bf16 a[76:79], v[132:135], v[56:59], a[76:79]
    v_exp_f32 v68, v68
    v_mfma_f32_16x16x32_bf16 a[80:83], v[136:139], v[56:59], a[80:83]
    v_exp_f32 v69, v69
    v_mfma_f32_16x16x32_bf16 a[84:87], v[140:143], v[56:59], a[84:87]
    v_exp_f32 v70, v70
    v_mfma_f32_16x16x32_bf16 a[88:91], v[144:147], v[56:59], a[88:91]
    v_max3_f32 v6, v72, v73, v74
    v_max3_f32 v9, v80, v81, v82
    v_mfma_f32_16x16x32_bf16 a[92:95], v[148:151], v[56:59], a[92:95]
    v_max3_f32 v6, v6, v75, v76
    v_max3_f32 v9, v9, v83, v84
    v_mfma_f32_16x16x32_bf16 a[200:203], a[216:219], v[56:59], a[200:203]
    s_waitcnt lgkmcnt(0)
    v_mfma_f32_16x16x32_bf16 v[40:43], v[88:91], v[152:155], v[16:19]
    v_max3_f32 v6, v6, v77, v78
    v_max3_f32 v9, v9, v85, v86
    v_mfma_f32_16x16x32_bf16 v[40:43], v[92:95], v[156:159], v[40:43]
    s_add_u32 m0, s64, 136064
    s_nop 0
    buffer_load_dwordx4 v12, s[36:39], s65 offen offset:128 lds
    v_mfma_f32_16x16x32_bf16 v[40:43], v[96:99], v[160:163], v[40:43]
    v_max3_f32 v6, v6, v79, v87
    v_max_f32 v6, v6, v9
    v_mfma_f32_16x16x32_bf16 v[40:43], v[100:103], v[164:167], v[40:43]
    v_cmp_lt_f32 vcc, s61, v6
    v_mfma_f32_16x16x32_bf16 v[44:47], v[104:107], v[152:155], v[16:19]
    v_exp_f32 v71, v71
    v_mfma_f32_16x16x32_bf16 v[44:47], v[108:111], v[156:159], v[44:47]
    v_cvt_pk_bf16_f32 v66, v68, v69
    v_cvt_pk_bf16_f32 v67, v70, v71
    v_mfma_f32_16x16x32_bf16 v[44:47], v[112:115], v[160:163], v[44:47]
    s_cbranch_vccnz L_stub4_31
L_back4_31:
    v_mfma_f32_16x16x32_bf16 v[44:47], v[116:119], v[164:167], v[44:47]
    v_exp_f32 v72, v72
    v_mfma_f32_16x16x32_bf16 a[96:99], v[120:123], v[64:67], a[96:99]
    v_exp_f32 v73, v73
    v_mfma_f32_16x16x32_bf16 a[100:103], v[124:127], v[64:67], a[100:103]
    v_exp_f32 v74, v74
    v_mfma_f32_16x16x32_bf16 a[104:107], v[128:131], v[64:67], a[104:107]
    s_add_u32 m0, s64, 140032
    s_nop 0
    buffer_load_dwordx4 v12, s[36:39], s65 offen offset:256 lds
    v_mfma_f32_16x16x32_bf16 a[108:111], v[132:135], v[64:67], a[108:111]
    v_exp_f32 v75, v75
    v_mfma_f32_16x16x32_bf16 a[112:115], v[136:139], v[64:67], a[112:115]
    v_cvt_pk_bf16_f32 v72, v72, v73
    v_cvt_pk_bf16_f32 v73, v74, v75
    v_mfma_f32_16x16x32_bf16 a[116:119], v[140:143], v[64:67], a[116:119]
    v_exp_f32 v76, v76
    v_mfma_f32_16x16x32_bf16 a[120:123], v[144:147], v[64:67], a[120:123]
    v_exp_f32 v77, v77
    v_mfma_f32_16x16x32_bf16 a[124:127], v[148:151], v[64:67], a[124:127]
    v_exp_f32 v78, v78
    v_mfma_f32_16x16x32_bf16 a[204:207], a[216:219], v[64:67], a[204:207]
    v_exp_f32 v79, v79
    v_mfma_f32_16x16x32_bf16 v[48:51], v[88:91], v[168:171], v[20:23]
    v_cvt_pk_bf16_f32 v74, v76, v77
    v_cvt_pk_bf16_f32 v75, v78, v79
    v_mfma_f32_16x16x32_bf16 v[48:51], v[92:95], v[172:175], v[48:51]
    v_exp_f32 v80, v80
    v_mfma_f32_16x16x32_bf16 v[48:51], v[96:99], v[176:179], v[48:51]
    s_add_u32 m0, s64, 0
    s_add_u32 s65, s66, 110592
    buffer_load_dwordx4 v12, s[36:39], s65 offen offset:0 lds
    v_mfma_f32_16x16x32_bf16 v[48:51], v[100:103], v[180:183], v[48:51]
    v_exp_f32 v81, v81
    v_mfma_f32_16x16x32_bf16 v[52:55], v[104:107], v[168:171], v[20:23]
    v_exp_f32 v82, v82
    v_mfma_f32_16x16x32_bf16 v[52:55], v[108:111], v[172:175], v[52:55]
    v_exp_f32 v83, v83
    v_mfma_f32_16x16x32_bf16 v[52:55], v[112:115], v[176:179], v[52:55]
    v_cvt_pk_bf16_f32 v80, v80, v81
    v_cvt_pk_bf16_f32 v81, v82, v83
    v_mfma_f32_16x16x32_bf16 v[52:55], v[116:119], v[180:183], v[52:55]
    v_exp_f32 v84, v84
    v_mfma_f32_16x16x32_bf16 a[128:131], v[120:123], v[72:75], a[128:131]
    v_exp_f32 v85, v85
    v_mfma_f32_16x16x32_bf16 a[132:135], v[124:127], v[72:75], a[132:135]
    v_exp_f32 v86, v86
    v_mfma_f32_16x16x32_bf16 a[136:139], v[128:131], v[72:75], a[136:139]
    v_max3_f32 v6, v40, v41, v42
    v_max3_f32 v9, v48, v49, v50
    v_mfma_f32_16x16x32_bf16 a[140:143], v[132:135], v[72:75], a[140:143]
    v_max3_f32 v6, v6, v43, v44
    v_max3_f32 v9, v9, v51, v52
    v_mfma_f32_16x16x32_bf16 a[144:147], v[136:139], v[72:75], a[144:147]
    s_add_u32 m0, s64, 3968
    s_nop 0
    buffer_load_dwordx4 v12, s[36:39], s65 offen offset:128 lds
    v_mfma_f32_16x16x32_bf16 a[148:151], v[140:143], v[72:75], a[148:151]
    v_max3_f32 v6, v6, v45, v46
    v_max3_f32 v9, v9, v53, v54
    v_mfma_f32_16x16x32_bf16 a[152:155], v[144:147], v[72:75], a[152:155]
    v_max3_f32 v6, v6, v47, v55
    v_max_f32 v6, v6, v9
    v_mfma_f32_16x16x32_bf16 a[156:159], v[148:151], v[72:75], a[156:159]
    v_cmp_lt_f32 vcc, s61, v6
    v_mfma_f32_16x16x32_bf16 a[208:211], a[216:219], v[72:75], a[208:211]
    v_exp_f32 v87, v87
    v_mfma_f32_16x16x32_bf16 v[56:59], v[88:91], v[184:187], v[24:27]
    v_cvt_pk_bf16_f32 v82, v84, v85
    v_cvt_pk_bf16_f32 v83, v86, v87
    v_mfma_f32_16x16x32_bf16 v[56:59], v[92:95], v[188:191], v[56:59]
    s_cbranch_vccnz L_stub0_31
L_back0_31:
    v_mfma_f32_16x16x32_bf16 v[56:59], v[96:99], v[192:195], v[56:59]
    v_exp_f32 v40, v40
    v_mfma_f32_16x16x32_bf16 v[56:59], v[100:103], v[196:199], v[56:59]
    v_exp_f32 v41, v41
    v_mfma_f32_16x16x32_bf16 v[60:63], v[104:107], v[184:187], v[24:27]
    s_add_u32 m0, s64, 7936
    s_nop 0
    buffer_load_dwordx4 v12, s[36:39], s65 offen offset:256 lds
    v_mfma_f32_16x16x32_bf16 v[60:63], v[108:111], v[188:191], v[60:63]
    v_exp_f32 v42, v42
    v_mfma_f32_16x16x32_bf16 v[60:63], v[112:115], v[192:195], v[60:63]
    v_exp_f32 v43, v43
    v_mfma_f32_16x16x32_bf16 v[60:63], v[116:119], v[196:199], v[60:63]
    v_cvt_pk_bf16_f32 v40, v40, v41
    v_cvt_pk_bf16_f32 v41, v42, v43
    v_mfma_f32_16x16x32_bf16 a[160:163], v[120:123], v[80:83], a[160:163]
    ds_read_b64_tr_b16 v[120:121], v4 offset:32768
    ds_read_b64_tr_b16 v[122:123], v4 offset:36864
    v_mfma_f32_16x16x32_bf16 a[164:167], v[124:127], v[80:83], a[164:167]
    ds_read_b64_tr_b16 v[124:125], v5 offset:32768
    ds_read_b64_tr_b16 v[126:127], v5 offset:36864
    v_mfma_f32_16x16x32_bf16 a[168:171], v[128:131], v[80:83], a[168:171]
    ds_read_b64_tr_b16 v[128:129], v4 offset:33024
    ds_read_b64_tr_b16 v[130:131], v4 offset:37120
    v_mfma_f32_16x16x32_bf16 a[172:175], v[132:135], v[80:83], a[172:175]
    ds_read_b64_tr_b16 v[132:133], v5 offset:33024
    ds_read_b64_tr_b16 v[134:135], v5 offset:37120
    v_mfma_f32_16x16x32_bf16 a[176:179], v[136:139], v[80:83], a[176:179]
    ds_read_b64_tr_b16 v[136:137], v4 offset:33280
    ds_read_b64_tr_b16 v[138:139], v4 offset:37376
    v_mfma_f32_16x16x32_bf16 a[180:183], v[140:143], v[80:83], a[180:183]
    ds_read_b64_tr_b16 v[140:141], v5 offset:33280
    ds_read_b64_tr_b16 v[142:143], v5 offset:37376
    v_mfma_f32_16x16x32_bf16 a[184:187], v[144:147], v[80:83], a[184:187]
    ds_read_b64_tr_b16 v[144:145], v4 offset:33536
    ds_read_b64_tr_b16 v[146:147], v4 offset:37632
    v_mfma_f32_16x16x32_bf16 a[188:191], v[148:151], v[80:83], a[188:191]
    ds_read_b64_tr_b16 v[148:149], v5 offset:33536
    ds_read_b64_tr_b16 v[150:151], v5 offset:37632
    v_mfma_f32_16x16x32_bf16 a[212:215], a[216:219], v[80:83], a[212:215]
    s_add_u32 m0, s64, 1024
    s_add_u32 s65, s66, 119808
    buffer_load_dwordx4 v12, s[36:39], s65 offen offset:0 lds
    v_mfma_f32_16x16x32_bf16 v[64:67], v[88:91], v[200:203], v[28:31]
    v_exp_f32 v44, v44
    v_mfma_f32_16x16x32_bf16 v[64:67], v[92:95], v[204:207], v[64:67]
    v_exp_f32 v45, v45
    v_mfma_f32_16x16x32_bf16 v[64:67], v[96:99], v[208:211], v[64:67]
    v_exp_f32 v46, v46
    v_mfma_f32_16x16x32_bf16 v[64:67], v[100:103], v[212:215], v[64:67]
    v_exp_f32 v47, v47
    v_mfma_f32_16x16x32_bf16 v[68:71], v[104:107], v[200:203], v[28:31]
    v_cvt_pk_bf16_f32 v42, v44, v45
    v_cvt_pk_bf16_f32 v43, v46, v47
    v_mfma_f32_16x16x32_bf16 v[68:71], v[108:111], v[204:207], v[68:71]
    s_add_u32 m0, s64, 4992
    s_nop 0
    buffer_load_dwordx4 v12, s[36:39], s65 offen offset:128 lds
    v_mfma_f32_16x16x32_bf16 v[68:71], v[112:115], v[208:211], v[68:71]
    v_exp_f32 v48, v48
    v_mfma_f32_16x16x32_bf16 v[68:71], v[116:119], v[212:215], v[68:71]
    s_waitcnt lgkmcnt(0)
    v_mfma_f32_16x16x32_bf16 a[0:3], v[120:123], v[40:43], a[0:3]
    v_exp_f32 v49, v49
    v_mfma_f32_16x16x32_bf16 a[4:7], v[124:127], v[40:43], a[4:7]
    v_exp_f32 v50, v50
    v_mfma_f32_16x16x32_bf16 a[8:11], v[128:131], v[40:43], a[8:11]
    v_exp_f32 v51, v51
    v_mfma_f32_16x16x32_bf16 a[12:15], v[132:135], v[40:43], a[12:15]
    v_cvt_pk_bf16_f32 v48, v48, v49
    v_cvt_pk_bf16_f32 v49, v50, v51
    v_mfma_f32_16x16x32_bf16 a[16:19], v[136:139], v[40:43], a[16:19]
    v_exp_f32 v52, v52
    v_mfma_f32_16x16x32_bf16 a[20:23], v[140:143], v[40:43], a[20:23]
    v_exp_f32 v53, v53
    v_mfma_f32_16x16x32_bf16 a[24:27], v[144:147], v[40:43], a[24:27]
    s_add_u32 m0, s64, 8960
    s_nop 0
    buffer_load_dwordx4 v12, s[36:39], s65 offen offset:256 lds
    v_mfma_f32_16x16x32_bf16 a[28:31], v[148:151], v[40:43], a[28:31]
    v_exp_f32 v54, v54
    v_mfma_f32_16x16x32_bf16 a[192:195], a[216:219], v[40:43], a[192:195]
    v_max3_f32 v6, v56, v57, v58
    v_max3_f32 v9, v64, v65, v66
    v_mfma_f32_16x16x32_bf16 v[72:75], v[88:91], v[216:219], v[32:35]
    v_max3_f32 v6, v6, v59, v60
    v_max3_f32 v9, v9, v67, v68
    v_mfma_f32_16x16x32_bf16 v[72:75], v[92:95], v[220:223], v[72:75]
    v_max3_f32 v6, v6, v61, v62
    v_max3_f32 v9, v9, v69, v70
    v_mfma_f32_16x16x32_bf16 v[72:75], v[96:99], v[224:227], v[72:75]
    v_max3_f32 v6, v6, v63, v71
    v_max_f32 v6, v6, v9
    v_mfma_f32_16x16x32_bf16 v[72:75], v[100:103], v[228:231], v[72:75]
    v_cmp_lt_f32 vcc, s61, v6
    v_mfma_f32_16x16x32_bf16 v[76:79], v[104:107], v[216:219], v[32:35]
    v_exp_f32 v55, v55
    v_mfma_f32_16x16x32_bf16 v[76:79], v[108:111], v[220:223], v[76:79]
    v_cvt_pk_bf16_f32 v50, v52, v53
    v_cvt_pk_bf16_f32 v51, v54, v55
    v_mfma_f32_16x16x32_bf16 v[76:79], v[112:115], v[224:227], v[76:79]
    s_cbranch_vccnz L_stub2_31
L_back2_31:
    v_mfma_f32_16x16x32_bf16 v[76:79], v[116:119], v[228:231], v[76:79]
    v_exp_f32 v56, v56
    v_mfma_f32_16x16x32_bf16 a[32:35], v[120:123], v[48:51], a[32:35]
    v_exp_f32 v57, v57
    v_mfma_f32_16x16x32_bf16 a[36:39], v[124:127], v[48:51], a[36:39]
    v_exp_f32 v58, v58
    v_mfma_f32_16x16x32_bf16 a[40:43], v[128:131], v[48:51], a[40:43]
    v_exp_f32 v59, v59
    v_mfma_f32_16x16x32_bf16 a[44:47], v[132:135], v[48:51], a[44:47]
    v_cvt_pk_bf16_f32 v56, v56, v57
    v_cvt_pk_bf16_f32 v57, v58, v59
    v_mfma_f32_16x16x32_bf16 a[48:51], v[136:139], v[48:51], a[48:51]
    v_exp_f32 v60, v60
    v_mfma_f32_16x16x32_bf16 a[52:55], v[140:143], v[48:51], a[52:55]
    v_exp_f32 v61, v61
    v_mfma_f32_16x16x32_bf16 a[56:59], v[144:147], v[48:51], a[56:59]
    v_exp_f32 v62, v62
    v_mfma_f32_16x16x32_bf16 a[60:63], v[148:151], v[48:51], a[60:63]
    v_exp_f32 v63, v63
    v_mfma_f32_16x16x32_bf16 a[196:199], a[216:219], v[48:51], a[196:199]
    v_cvt_pk_bf16_f32 v58, v60, v61
    v_cvt_pk_bf16_f32 v59, v62, v63
    v_mfma_f32_16x16x32_bf16 v[80:83], v[88:91], v[232:235], v[36:39]
    v_exp_f32 v64, v64
    s_lshl_b32 s72, s49, 4
    v_mov_b32 v5, 0
    buffer_load_dwordx4 v[248:251], v5, s[44:47], s72 offen sc1
    v_accvgpr_read_b32 v16, a192
    v_rcp_f32 v16, v16
    v_mfma_f32_16x16x32_bf16 v[80:83], v[92:95], v[236:239], v[80:83]
    v_exp_f32 v65, v65
    v_accvgpr_read_b32 v40, a0
    v_accvgpr_read_b32 v41, a1
    v_accvgpr_read_b32 v42, a2
    v_accvgpr_read_b32 v43, a3
    v_accvgpr_read_b32 v44, a4
    v_accvgpr_read_b32 v45, a5
    v_mfma_f32_16x16x32_bf16 v[80:83], v[96:99], v[240:243], v[80:83]
    v_exp_f32 v66, v66
    v_accvgpr_read_b32 v46, a6
    v_accvgpr_read_b32 v47, a7
    v_pk_mul_f32 v[40:41], v[40:41], v[16:17] op_sel_hi:[1,0]
    v_pk_mul_f32 v[42:43], v[42:43], v[16:17] op_sel_hi:[1,0]
    v_pk_mul_f32 v[44:45], v[44:45], v[16:17] op_sel_hi:[1,0]
    v_pk_mul_f32 v[46:47], v[46:47], v[16:17] op_sel_hi:[1,0]
    v_mfma_f32_16x16x32_bf16 v[80:83], v[100:103], v[244:247], v[80:83]
    v_exp_f32 v67, v67
    v_cvt_pk_bf16_f32 v152, v40, v41
    v_cvt_pk_bf16_f32 v153, v42, v43
    v_cvt_pk_bf16_f32 v154, v44, v45
    v_cvt_pk_bf16_f32 v155, v46, v47
    s_add_u32 s72, s62, 0
    buffer_store_dwordx4 v[152:155], v14, s[32:35], s72 offen offset:0 sc1
    v_mfma_f32_16x16x32_bf16 v[84:87], v[104:107], v[232:235], v[36:39]
    v_cvt_pk_bf16_f32 v64, v64, v65
    v_cvt_pk_bf16_f32 v65, v66, v67
    v_accvgpr_read_b32 v48, a8
    v_accvgpr_read_b32 v49, a9
    v_accvgpr_read_b32 v50, a10
    v_accvgpr_read_b32 v51, a11
    v_accvgpr_read_b32 v52, a12
    v_accvgpr_read_b32 v53, a13
    v_mfma_f32_16x16x32_bf16 v[84:87], v[108:111], v[236:239], v[84:87]
    v_exp_f32 v68, v68
    v_accvgpr_read_b32 v54, a14
    v_accvgpr_read_b32 v55, a15
    v_pk_mul_f32 v[48:49], v[48:49], v[16:17] op_sel_hi:[1,0]
    v_pk_mul_f32 v[50:51], v[50:51], v[16:17] op_sel_hi:[1,0]
    v_pk_mul_f32 v[52:53], v[52:53], v[16:17] op_sel_hi:[1,0]
    v_pk_mul_f32 v[54:55], v[54:55], v[16:17] op_sel_hi:[1,0]
    v_mfma_f32_16x16x32_bf16 v[84:87], v[112:115], v[240:243], v[84:87]
    v_exp_f32 v69, v69
    v_cvt_pk_bf16_f32 v156, v48, v49
    v_cvt_pk_bf16_f32 v157, v50, v51
    v_cvt_pk_bf16_f32 v158, v52, v53
    v_cvt_pk_bf16_f32 v159, v54, v55
    s_add_u32 s72, s62, 3072
    buffer_store_dwordx4 v[156:159], v14, s[32:35], s72 offen offset:0 sc1
    v_mfma_f32_16x16x32_bf16 v[84:87], v[116:119], v[244:247], v[84:87]
    v_exp_f32 v70, v70
    v_accvgpr_read_b32 v40, a16
    v_accvgpr_read_b32 v41, a17
    v_accvgpr_read_b32 v42, a18
    v_accvgpr_read_b32 v43, a19
    v_accvgpr_read_b32 v44, a20
    v_accvgpr_read_b32 v45, a21
    v_mfma_f32_16x16x32_bf16 a[64:67], v[120:123], v[56:59], a[64:67]
    v_accvgpr_read_b32 v46, a22
    v_accvgpr_read_b32 v47, a23
    v_pk_mul_f32 v[40:41], v[40:41], v[16:17] op_sel_hi:[1,0]
    v_pk_mul_f32 v[42:43], v[42:43], v[16:17] op_sel_hi:[1,0]
    v_pk_mul_f32 v[44:45], v[44:45], v[16:17] op_sel_hi:[1,0]
    v_pk_mul_f32 v[46:47], v[46:47], v[16:17] op_sel_hi:[1,0]
    v_cvt_pk_bf16_f32 v160, v40, v41
    v_cvt_pk_bf16_f32 v161, v42, v43
    v_mfma_f32_16x16x32_bf16 a[68:71], v[124:127], v[56:59], a[68:71]
    v_cvt_pk_bf16_f32 v162, v44, v45
    v_cvt_pk_bf16_f32 v163, v46, v47
    s_add_u32 s72, s62, 6144
    buffer_store_dwordx4 v[160:163], v14, s[32:35], s72 offen offset:0 sc1
    v_accvgpr_read_b32 v48, a24
    v_accvgpr_read_b32 v49, a25
    v_accvgpr_read_b32 v50, a26
    v_accvgpr_read_b32 v51, a27
    v_mfma_f32_16x16x32_bf16 a[72:75], v[128:131], v[56:59], a[72:75]
    v_max3_f32 v6, v72, v73, v74
    v_max3_f32 v9, v80, v81, v82
    v_accvgpr_read_b32 v52, a28
    v_accvgpr_read_b32 v53, a29
    v_accvgpr_read_b32 v54, a30
    v_accvgpr_read_b32 v55, a31
    v_pk_mul_f32 v[48:49], v[48:49], v[16:17] op_sel_hi:[1,0]
    v_pk_mul_f32 v[50:51], v[50:51], v[16:17] op_sel_hi:[1,0]
    v_mfma_f32_16x16x32_bf16 a[76:79], v[132:135], v[56:59], a[76:79]
    v_max3_f32 v6, v6, v75, v76
    v_max3_f32 v9, v9, v83, v84
    v_pk_mul_f32 v[52:53], v[52:53], v[16:17] op_sel_hi:[1,0]
    v_pk_mul_f32 v[54:55], v[54:55], v[16:17] op_sel_hi:[1,0]
    v_cvt_pk_bf16_f32 v164, v48, v49
    v_cvt_pk_bf16_f32 v165, v50, v51
    v_cvt_pk_bf16_f32 v166, v52, v53
    v_cvt_pk_bf16_f32 v167, v54, v55
    v_mfma_f32_16x16x32_bf16 a[80:83], v[136:139], v[56:59], a[80:83]
    v_max3_f32 v6, v6, v77, v78
    v_max3_f32 v9, v9, v85, v86
    s_add_u32 s72, s62, 9216
    buffer_store_dwordx4 v[164:167], v14, s[32:35], s72 offen offset:0 sc1
    v_accvgpr_read_b32 v18, a196
    v_rcp_f32 v18, v18
    v_accvgpr_read_b32 v40, a32
    v_accvgpr_read_b32 v41, a33
    v_mfma_f32_16x16x32_bf16 a[84:87], v[140:143], v[56:59], a[84:87]
    v_max3_f32 v6, v6, v79, v87
    v_max_f32 v6, v6, v9
    v_accvgpr_read_b32 v42, a34
    v_accvgpr_read_b32 v43, a35
    v_accvgpr_read_b32 v44, a36
    v_accvgpr_read_b32 v45, a37
    v_accvgpr_read_b32 v46, a38
    v_accvgpr_read_b32 v47, a39
    v_mfma_f32_16x16x32_bf16 a[88:91], v[144:147], v[56:59], a[88:91]
    v_cmp_lt_f32 vcc, s61, v6
    v_pk_mul_f32 v[40:41], v[40:41], v[18:19] op_sel_hi:[1,0]
    v_pk_mul_f32 v[42:43], v[42:43], v[18:19] op_sel_hi:[1,0]
    v_pk_mul_f32 v[44:45], v[44:45], v[18:19] op_sel_hi:[1,0]
    v_pk_mul_f32 v[46:47], v[46:47], v[18:19] op_sel_hi:[1,0]
    v_cvt_pk_bf16_f32 v168, v40, v41
    v_cvt_pk_bf16_f32 v169, v42, v43
    v_mfma_f32_16x16x32_bf16 a[92:95], v[148:151], v[56:59], a[92:95]
    v_exp_f32 v71, v71
    v_cvt_pk_bf16_f32 v170, v44, v45
    v_cvt_pk_bf16_f32 v171, v46, v47
    s_add_u32 s72, s62, 0
    buffer_store_dwordx4 v[168:171], v14, s[32:35], s72 offen offset:1024 sc1
    v_accvgpr_read_b32 v48, a40
    v_accvgpr_read_b32 v49, a41
    v_mfma_f32_16x16x32_bf16 a[200:203], a[216:219], v[56:59], a[200:203]
    v_cvt_pk_bf16_f32 v66, v68, v69
    v_cvt_pk_bf16_f32 v67, v70, v71
    v_accvgpr_read_b32 v50, a42
    v_accvgpr_read_b32 v51, a43
    v_accvgpr_read_b32 v52, a44
    v_accvgpr_read_b32 v53, a45
    v_accvgpr_read_b32 v54, a46
    v_accvgpr_read_b32 v55, a47
    v_mfma_f32_16x16x32_bf16 a[96:99], v[120:123], v[64:67], a[96:99]
    s_cbranch_vccnz L_stub4_32
L_back4_32:
    v_pk_mul_f32 v[48:49], v[48:49], v[18:19] op_sel_hi:[1,0]
    v_pk_mul_f32 v[50:51], v[50:51], v[18:19] op_sel_hi:[1,0]
    v_pk_mul_f32 v[52:53], v[52:53], v[18:19] op_sel_hi:[1,0]
    v_pk_mul_f32 v[54:55], v[54:55], v[18:19] op_sel_hi:[1,0]
    v_cvt_pk_bf16_f32 v172, v48, v49
    v_cvt_pk_bf16_f32 v173, v50, v51
    v_mfma_f32_16x16x32_bf16 a[100:103], v[124:127], v[64:67], a[100:103]
    v_exp_f32 v72, v72
    v_cvt_pk_bf16_f32 v174, v52, v53
    v_cvt_pk_bf16_f32 v175, v54, v55
    s_add_u32 s72, s62, 3072
    buffer_store_dwordx4 v[172:175], v14, s[32:35], s72 offen offset:1024 sc1
    v_accvgpr_read_b32 v40, a48
    v_accvgpr_read_b32 v41, a49
    v_mfma_f32_16x16x32_bf16 a[104:107], v[128:131], v[64:67], a[104:107]
    v_exp_f32 v73, v73
    v_accvgpr_read_b32 v42, a50
    v_accvgpr_read_b32 v43, a51
    v_accvgpr_read_b32 v44, a52
    v_accvgpr_read_b32 v45, a53
    v_accvgpr_read_b32 v46, a54
    v_accvgpr_read_b32 v47, a55
    v_mfma_f32_16x16x32_bf16 a[108:111], v[132:135], v[64:67], a[108:111]
    v_exp_f32 v74, v74
    v_pk_mul_f32 v[40:41], v[40:41], v[18:19] op_sel_hi:[1,0]
    v_pk_mul_f32 v[42:43], v[42:43], v[18:19] op_sel_hi:[1,0]
    v_pk_mul_f32 v[44:45], v[44:45], v[18:19] op_sel_hi:[1,0]
    v_pk_mul_f32 v[46:47], v[46:47], v[18:19] op_sel_hi:[1,0]
    v_cvt_pk_bf16_f32 v176, v40, v41
    v_cvt_pk_bf16_f32 v177, v42, v43
    v_mfma_f32_16x16x32_bf16 a[112:115], v[136:139], v[64:67], a[112:115]
    v_exp_f32 v75, v75
    v_cvt_pk_bf16_f32 v178, v44, v45
    v_cvt_pk_bf16_f32 v179, v46, v47
    s_add_u32 s72, s62, 6144
    buffer_store_dwordx4 v[176:179], v14, s[32:35], s72 offen offset:1024 sc1
    v_accvgpr_read_b32 v48, a56
    v_accvgpr_read_b32 v49, a57
    v_mfma_f32_16x16x32_bf16 a[116:119], v[140:143], v[64:67], a[116:119]
    v_cvt_pk_bf16_f32 v72, v72, v73
    v_cvt_pk_bf16_f32 v73, v74, v75
    v_accvgpr_read_b32 v50, a58
    v_accvgpr_read_b32 v51, a59
    v_accvgpr_read_b32 v52, a60
    v_accvgpr_read_b32 v53, a61
    v_accvgpr_read_b32 v54, a62
    v_accvgpr_read_b32 v55, a63
    v_mfma_f32_16x16x32_bf16 a[120:123], v[144:147], v[64:67], a[120:123]
    v_exp_f32 v76, v76
    v_pk_mul_f32 v[48:49], v[48:49], v[18:19] op_sel_hi:[1,0]
    v_pk_mul_f32 v[50:51], v[50:51], v[18:19] op_sel_hi:[1,0]
    v_pk_mul_f32 v[52:53], v[52:53], v[18:19] op_sel_hi:[1,0]
    v_pk_mul_f32 v[54:55], v[54:55], v[18:19] op_sel_hi:[1,0]
    v_cvt_pk_bf16_f32 v180, v48, v49
    v_cvt_pk_bf16_f32 v181, v50, v51
    v_mfma_f32_16x16x32_bf16 a[124:127], v[148:151], v[64:67], a[124:127]
    v_exp_f32 v77, v77
    v_cvt_pk_bf16_f32 v182, v52, v53
    v_cvt_pk_bf16_f32 v183, v54, v55
    s_add_u32 s72, s62, 9216
    buffer_store_dwordx4 v[180:183], v14, s[32:35], s72 offen offset:1024 sc1
    v_lshrrev_b32 v11, 2, v0
    v_lshlrev_b32 v11, 7, v11
    v_mfma_f32_16x16x32_bf16 a[204:207], a[216:219], v[64:67], a[204:207]
    v_exp_f32 v78, v78
    v_and_b32 v15, 3, v0
    v_lshl_add_u32 v11, v15, 3, v11
    v_bfe_u32 v15, v0, 3, 2
    s_add_u32 s74, s55, 0
    s_and_b32 s75, s74, 3
    s_lshr_b32 s74, s74, 2
    s_lshl_b32 s74, s74, 12
    v_xor_b32 v1, s75, v15
    v_lshl_add_u32 v1, v1, 5, v11
    v_add_u32 v1, s74, v1
    v_exp_f32 v79, v79
    v_cvt_pk_bf16_f32 v74, v76, v77
    v_cvt_pk_bf16_f32 v75, v78, v79
    s_nop 1
    v_mfma_f32_16x16x32_bf16 a[128:131], v[120:123], v[72:75], a[128:131]
    v_exp_f32 v80, v80
    s_add_u32 s74, s55, 1
    s_and_b32 s75, s74, 3
    s_lshr_b32 s74, s74, 2
    s_lshl_b32 s74, s74, 12
    v_xor_b32 v2, s75, v15
    v_lshl_add_u32 v2, v2, 5, v11
    v_add_u32 v2, s74, v2
    s_add_u32 s74, s55, 2
    s_and_b32 s75, s74, 3
    s_lshr_b32 s74, s74, 2
    s_lshl_b32 s74, s74, 12
    v_mfma_f32_16x16x32_bf16 a[132:135], v[124:127], v[72:75], a[132:135]
    v_exp_f32 v81, v81
    v_xor_b32 v3, s75, v15
    v_lshl_add_u32 v3, v3, 5, v11
    v_add_u32 v3, s74, v3
    s_add_u32 s74, s55, 3
    s_and_b32 s75, s74, 3
    s_lshr_b32 s74, s74, 2
    s_lshl_b32 s74, s74, 12
    v_xor_b32 v4, s75, v15
    v_lshl_add_u32 v4, v4, 5, v11
    v_add_u32 v4, s74, v4
    v_mfma_f32_16x16x32_bf16 a[136:139], v[128:131], v[72:75], a[136:139]
    v_exp_f32 v82, v82
    s_lshl_b32 s74, s48, 13
    s_add_u32 s74, s74, 32768
    v_add_u32 v5, s74, v14
    s_lshr_b32 s74, s48, 1
    s_mul_i32 s74, s74, 32768
    s_and_b32 s75, s48, 1
    s_lshl_b32 s75, s75, 12
    s_add_u32 s74, s74, s75
    s_add_u32 s74, s74, 90112
    v_add_u32 v11, s74, v14
    v_mfma_f32_16x16x32_bf16 a[140:143], v[132:135], v[72:75], a[140:143]
    v_exp_f32 v83, v83
    s_add_u32 s74, s60, 65536
    v_add_u32 v252, s74, v1
    v_add_u32 v253, s74, v2
    v_add_u32 v254, s74, v3
    v_add_u32 v255, s74, v4
    v_mfma_f32_16x16x32_bf16 a[144:147], v[136:139], v[72:75], a[144:147]
    v_cvt_pk_bf16_f32 v80, v80, v81
    v_cvt_pk_bf16_f32 v81, v82, v83
    s_waitcnt vmcnt(9)
    s_barrier
    ds_read_b64_tr_b16 a[220:221], v252 offset:0
    ds_read_b64_tr_b16 a[222:223], v252 offset:2048
    ds_read_b64_tr_b16 a[224:225], v253 offset:0
    ds_read_b64_tr_b16 a[226:227], v253 offset:2048
    v_mfma_f32_16x16x32_bf16 a[148:151], v[140:143], v[72:75], a[148:151]
    v_exp_f32 v84, v84
    ds_read_b64_tr_b16 a[228:229], v254 offset:0
    ds_read_b64_tr_b16 a[230:231], v254 offset:2048
    ds_read_b64_tr_b16 a[232:233], v255 offset:0
    ds_read_b64_tr_b16 a[234:235], v255 offset:2048
    ds_read_b64_tr_b16 a[236:237], v252 offset:4096
    ds_read_b64_tr_b16 a[238:239], v252 offset:6144
    v_mfma_f32_16x16x32_bf16 a[152:155], v[144:147], v[72:75], a[152:155]
    v_exp_f32 v85, v85
    ds_read_b64_tr_b16 a[240:241], v253 offset:4096
    ds_read_b64_tr_b16 a[242:243], v253 offset:6144
    ds_read_b64_tr_b16 a[244:245], v254 offset:4096
    ds_read_b64_tr_b16 a[246:247], v254 offset:6144
    ds_read_b64_tr_b16 a[248:249], v255 offset:4096
    ds_read_b64_tr_b16 a[250:251], v255 offset:6144
    v_mfma_f32_16x16x32_bf16 a[156:159], v[148:151], v[72:75], a[156:159]
    v_exp_f32 v86, v86
    ds_read_b64_tr_b16 a[252:253], v252 offset:8192
    ds_read_b64_tr_b16 a[254:255], v252 offset:10240
    v_accvgpr_read_b32 v20, a200
    v_rcp_f32 v20, v20
    v_accvgpr_read_b32 v40, a64
    v_accvgpr_read_b32 v41, a65
    v_mfma_f32_16x16x32_bf16 a[208:211], a[216:219], v[72:75], a[208:211]
    v_exp_f32 v87, v87
    v_accvgpr_read_b32 v42, a66
    v_accvgpr_read_b32 v43, a67
    v_accvgpr_read_b32 v44, a68
    v_accvgpr_read_b32 v45, a69
    v_accvgpr_read_b32 v46, a70
    v_accvgpr_read_b32 v47, a71
    v_cvt_pk_bf16_f32 v82, v84, v85
    v_cvt_pk_bf16_f32 v83, v86, v87
    s_nop 1
    v_mfma_f32_16x16x32_bf16 a[160:163], v[120:123], v[80:83], a[160:163]
    v_pk_mul_f32 v[40:41], v[40:41], v[20:21] op_sel_hi:[1,0]
    v_pk_mul_f32 v[42:43], v[42:43], v[20:21] op_sel_hi:[1,0]
    v_pk_mul_f32 v[44:45], v[44:45], v[20:21] op_sel_hi:[1,0]
    v_pk_mul_f32 v[46:47], v[46:47], v[20:21] op_sel_hi:[1,0]
    v_cvt_pk_bf16_f32 v184, v40, v41
    v_cvt_pk_bf16_f32 v185, v42, v43
    v_cvt_pk_bf16_f32 v186, v44, v45
    v_cvt_pk_bf16_f32 v187, v46, v47
    v_mfma_f32_16x16x32_bf16 a[164:167], v[124:127], v[80:83], a[164:167]
    s_add_u32 s72, s62, 0
    buffer_store_dwordx4 v[184:187], v14, s[32:35], s72 offen offset:2048 sc1
    v_accvgpr_read_b32 v48, a72
    v_accvgpr_read_b32 v49, a73
    v_accvgpr_read_b32 v50, a74
    v_accvgpr_read_b32 v51, a75
    v_accvgpr_read_b32 v52, a76
    v_accvgpr_read_b32 v53, a77
    v_mfma_f32_16x16x32_bf16 a[168:171], v[128:131], v[80:83], a[168:171]
    v_accvgpr_read_b32 v54, a78
    v_accvgpr_read_b32 v55, a79
    v_pk_mul_f32 v[48:49], v[48:49], v[20:21] op_sel_hi:[1,0]
    v_pk_mul_f32 v[50:51], v[50:51], v[20:21] op_sel_hi:[1,0]
    v_pk_mul_f32 v[52:53], v[52:53], v[20:21] op_sel_hi:[1,0]
    v_pk_mul_f32 v[54:55], v[54:55], v[20:21] op_sel_hi:[1,0]
    v_cvt_pk_bf16_f32 v188, v48, v49
    v_cvt_pk_bf16_f32 v189, v50, v51
    v_mfma_f32_16x16x32_bf16 a[172:175], v[132:135], v[80:83], a[172:175]
    v_cvt_pk_bf16_f32 v190, v52, v53
    v_cvt_pk_bf16_f32 v191, v54, v55
    s_add_u32 s72, s62, 3072
    buffer_store_dwordx4 v[188:191], v14, s[32:35], s72 offen offset:2048 sc1
    v_accvgpr_read_b32 v40, a80
    v_accvgpr_read_b32 v41, a81
    v_accvgpr_read_b32 v42, a82
    v_accvgpr_read_b32 v43, a83
    v_mfma_f32_16x16x32_bf16 a[176:179], v[136:139], v[80:83], a[176:179]
    v_accvgpr_read_b32 v44, a84
    v_accvgpr_read_b32 v45, a85
    v_accvgpr_read_b32 v46, a86
    v_accvgpr_read_b32 v47, a87
    v_pk_mul_f32 v[40:41], v[40:41], v[20:21] op_sel_hi:[1,0]
    v_pk_mul_f32 v[42:43], v[42:43], v[20:21] op_sel_hi:[1,0]
    v_pk_mul_f32 v[44:45], v[44:45], v[20:21] op_sel_hi:[1,0]
    v_pk_mul_f32 v[46:47], v[46:47], v[20:21] op_sel_hi:[1,0]
    v_mfma_f32_16x16x32_bf16 a[180:183], v[140:143], v[80:83], a[180:183]
    v_cvt_pk_bf16_f32 v192, v40, v41
    v_cvt_pk_bf16_f32 v193, v42, v43
    v_cvt_pk_bf16_f32 v194, v44, v45
    v_cvt_pk_bf16_f32 v195, v46, v47
    s_add_u32 s72, s62, 6144
    buffer_store_dwordx4 v[192:195], v14, s[32:35], s72 offen offset:2048 sc1
    v_accvgpr_read_b32 v48, a88
    v_accvgpr_read_b32 v49, a89
    v_mfma_f32_16x16x32_bf16 a[184:187], v[144:147], v[80:83], a[184:187]
    v_accvgpr_read_b32 v50, a90
    v_accvgpr_read_b32 v51, a91
    v_accvgpr_read_b32 v52, a92
    v_accvgpr_read_b32 v53, a93
    v_accvgpr_read_b32 v54, a94
    v_accvgpr_read_b32 v55, a95
    v_pk_mul_f32 v[48:49], v[48:49], v[20:21] op_sel_hi:[1,0]
    v_pk_mul_f32 v[50:51], v[50:51], v[20:21] op_sel_hi:[1,0]
    v_mfma_f32_16x16x32_bf16 a[188:191], v[148:151], v[80:83], a[188:191]
    v_pk_mul_f32 v[52:53], v[52:53], v[20:21] op_sel_hi:[1,0]
    v_pk_mul_f32 v[54:55], v[54:55], v[20:21] op_sel_hi:[1,0]
    v_cvt_pk_bf16_f32 v196, v48, v49
    v_cvt_pk_bf16_f32 v197, v50, v51
    v_cvt_pk_bf16_f32 v198, v52, v53
    v_cvt_pk_bf16_f32 v199, v54, v55
    s_add_u32 s72, s62, 9216
    buffer_store_dwordx4 v[196:199], v14, s[32:35], s72 offen offset:2048 sc1
    v_mfma_f32_16x16x32_bf16 a[212:215], a[216:219], v[80:83], a[212:215]
    s_lshl_b32 s74, s50, 13
    s_add_u32 s74, s74, 32768
    v_add_u32 v8, s74, v14
    s_lshr_b32 s74, s50, 1
    s_mul_i32 s74, s74, 32768
    s_and_b32 s75, s50, 1
    s_lshl_b32 s75, s75, 12
    s_add_u32 s74, s74, s75
    s_add_u32 s74, s74, 90112
    v_add_u32 v9, s74, v14
L_tail:
    s_waitcnt vmcnt(12)
    v_and_b32 v248, v248, v249
    v_and_b32 v250, v250, v251
    v_and_b32 v248, v248, v250
    v_cmp_eq_u32 vcc, 0x01010101, v248
    s_nop 1
    s_cmp_eq_u64 vcc, exec
    s_cbranch_scc1 L_goC
    s_lshl_b32 s72, s49, 4
    v_mov_b32 v136, 0
    s_mov_b32 s75, 0x200000
L_spinC:
    buffer_load_dwordx4 v[248:251], v136, s[44:47], s72 offen sc1
    s_waitcnt vmcnt(0)
    v_and_b32 v248, v248, v249
    v_and_b32 v250, v250, v251
    v_and_b32 v248, v248, v250
    v_cmp_eq_u32 vcc, 0x01010101, v248
    s_nop 1
    s_cmp_eq_u64 vcc, exec
    s_cbranch_scc1 L_goC
    s_sub_u32 s75, s75, 1
    s_cmp_lg_u32 s75, 0
    s_cbranch_scc1 L_spinC
L_goC:
    v_or_b32 v248, s48, v0
    v_min_u32 v248, 1, v248
    v_lshlrev_b32 v248, 30, v248
    v_mov_b32 v249, 1
    v_and_b32 v250, 3, v0
    v_lshlrev_b32 v251, 9, v250
    v_lshlrev_b32 v250, 7, v250
    s_and_b32 s58, s57, 0xfc
    s_lshl_b32 s58, s58, 7
    s_add_u32 s58, s58, 50331648
    s_waitcnt lgkmcnt(15)
    v_mfma_f32_16x16x32_bf16 v[16:19], a[220:223], v[152:155], 0
    s_add_u32 s74, s60, 98304
    v_add_u32 v252, s74, v1
    v_add_u32 v253, s74, v2
    v_add_u32 v254, s74, v3
    v_mfma_f32_16x16x32_bf16 v[52:55], a[220:223], v[168:171], 0
    v_add_u32 v255, s74, v4
    v_accvgpr_read_b32 v124, a204
    v_rcp_f32 v124, v124
    v_mfma_f32_16x16x32_bf16 v[88:91], a[220:223], v[184:187], 0
    ds_read_b64_tr_b16 a[220:221], v252 offset:0
    ds_read_b64_tr_b16 a[222:223], v252 offset:2048
    v_accvgpr_read_b32 v136, a96
    v_accvgpr_read_b32 v137, a97
    s_waitcnt lgkmcnt(15)
    v_mfma_f32_16x16x32_bf16 v[20:23], a[224:227], v[152:155], 0
    v_accvgpr_read_b32 v138, a98
    v_accvgpr_read_b32 v139, a99
    v_accvgpr_read_b32 v140, a100
    v_accvgpr_read_b32 v141, a101
    v_mfma_f32_16x16x32_bf16 v[56:59], a[224:227], v[168:171], 0
    v_accvgpr_read_b32 v142, a102
    v_accvgpr_read_b32 v143, a103
    v_pk_mul_f32 v[136:137], v[136:137], v[124:125] op_sel_hi:[1,0]
    v_pk_mul_f32 v[138:139], v[138:139], v[124:125] op_sel_hi:[1,0]
    v_mfma_f32_16x16x32_bf16 v[92:95], a[224:227], v[184:187], 0
    ds_read_b64_tr_b16 a[224:225], v253 offset:0
    ds_read_b64_tr_b16 a[226:227], v253 offset:2048
    v_pk_mul_f32 v[140:141], v[140:141], v[124:125] op_sel_hi:[1,0]
    v_pk_mul_f32 v[142:143], v[142:143], v[124:125] op_sel_hi:[1,0]
    s_waitcnt lgkmcnt(15)
    v_mfma_f32_16x16x32_bf16 v[24:27], a[228:231], v[152:155], 0
    v_cvt_pk_bf16_f32 v200, v136, v137
    v_cvt_pk_bf16_f32 v201, v138, v139
    v_cvt_pk_bf16_f32 v202, v140, v141
    v_cvt_pk_bf16_f32 v203, v142, v143
    v_mfma_f32_16x16x32_bf16 v[60:63], a[228:231], v[168:171], 0
    s_add_u32 s72, s63, 0
    buffer_store_dwordx4 v[200:203], v14, s[32:35], s72 offen offset:0 sc1
    ds_write_b128 v5, v[200:203] offset:0
    v_accvgpr_read_b32 v144, a104
    v_accvgpr_read_b32 v145, a105
    v_mfma_f32_16x16x32_bf16 v[96:99], a[228:231], v[184:187], 0
    ds_read_b64_tr_b16 a[228:229], v254 offset:0
    ds_read_b64_tr_b16 a[230:231], v254 offset:2048
    v_accvgpr_read_b32 v146, a106
    v_accvgpr_read_b32 v147, a107
    s_waitcnt lgkmcnt(15)
    v_mfma_f32_16x16x32_bf16 v[28:31], a[232:235], v[152:155], 0
    v_accvgpr_read_b32 v148, a108
    v_accvgpr_read_b32 v149, a109
    v_accvgpr_read_b32 v150, a110
    v_accvgpr_read_b32 v151, a111
    v_mfma_f32_16x16x32_bf16 v[64:67], a[232:235], v[168:171], 0
    v_pk_mul_f32 v[144:145], v[144:145], v[124:125] op_sel_hi:[1,0]
    v_pk_mul_f32 v[146:147], v[146:147], v[124:125] op_sel_hi:[1,0]
    v_pk_mul_f32 v[148:149], v[148:149], v[124:125] op_sel_hi:[1,0]
    v_pk_mul_f32 v[150:151], v[150:151], v[124:125] op_sel_hi:[1,0]
    v_mfma_f32_16x16x32_bf16 v[100:103], a[232:235], v[184:187], 0
    ds_read_b64_tr_b16 a[232:233], v255 offset:0
    ds_read_b64_tr_b16 a[234:235], v255 offset:2048
    v_cvt_pk_bf16_f32 v204, v144, v145
    v_cvt_pk_bf16_f32 v205, v146, v147
    v_mfma_f32_16x16x32_bf16 v[32:35], a[236:239], v[152:155], 0
    v_cvt_pk_bf16_f32 v206, v148, v149
    v_cvt_pk_bf16_f32 v207, v150, v151
    s_add_u32 s72, s63, 3072
    buffer_store_dwordx4 v[204:207], v14, s[32:35], s72 offen offset:0 sc1
    ds_write_b128 v5, v[204:207] offset:3072
    v_mfma_f32_16x16x32_bf16 v[68:71], a[236:239], v[168:171], 0
    v_accvgpr_read_b32 v136, a112
    v_accvgpr_read_b32 v137, a113
    v_accvgpr_read_b32 v138, a114
    v_accvgpr_read_b32 v139, a115
    v_mfma_f32_16x16x32_bf16 v[104:107], a[236:239], v[184:187], 0
    ds_read_b64_tr_b16 a[236:237], v252 offset:4096
    ds_read_b64_tr_b16 a[238:239], v252 offset:6144
    v_accvgpr_read_b32 v140, a116
    v_accvgpr_read_b32 v141, a117
    s_waitcnt lgkmcnt(15)
    v_mfma_f32_16x16x32_bf16 v[36:39], a[240:243], v[152:155], 0
    v_accvgpr_read_b32 v142, a118
    v_accvgpr_read_b32 v143, a119
    v_pk_mul_f32 v[136:137], v[136:137], v[124:125] op_sel_hi:[1,0]
    v_pk_mul_f32 v[138:139], v[138:139], v[124:125] op_sel_hi:[1,0]
    v_mfma_f32_16x16x32_bf16 v[72:75], a[240:243], v[168:171], 0
    v_pk_mul_f32 v[140:141], v[140:141], v[124:125] op_sel_hi:[1,0]
    v_pk_mul_f32 v[142:143], v[142:143], v[124:125] op_sel_hi:[1,0]
    v_cvt_pk_bf16_f32 v208, v136, v137
    v_cvt_pk_bf16_f32 v209, v138, v139
    v_mfma_f32_16x16x32_bf16 v[108:111], a[240:243], v[184:187], 0
    ds_read_b64_tr_b16 a[240:241], v253 offset:4096
    ds_read_b64_tr_b16 a[242:243], v253 offset:6144
    v_cvt_pk_bf16_f32 v210, v140, v141
    v_cvt_pk_bf16_f32 v211, v142, v143
    v_mfma_f32_16x16x32_bf16 v[40:43], a[244:247], v[152:155], 0
    s_add_u32 s72, s63, 6144
    buffer_store_dwordx4 v[208:211], v14, s[32:35], s72 offen offset:0 sc1
    ds_write_b128 v5, v[208:211] offset:6144
    v_accvgpr_read_b32 v144, a120
    v_accvgpr_read_b32 v145, a121
    v_mfma_f32_16x16x32_bf16 v[76:79], a[244:247], v[168:171], 0
    v_accvgpr_read_b32 v146, a122
    v_accvgpr_read_b32 v147, a123
    v_accvgpr_read_b32 v148, a124
    v_accvgpr_read_b32 v149, a125
    v_mfma_f32_16x16x32_bf16 v[112:115], a[244:247], v[184:187], 0
    ds_read_b64_tr_b16 a[244:245], v254 offset:4096
    ds_read_b64_tr_b16 a[246:247], v254 offset:6144
    v_accvgpr_read_b32 v150, a126
    v_accvgpr_read_b32 v151, a127
    s_waitcnt lgkmcnt(15)
    v_mfma_f32_16x16x32_bf16 v[44:47], a[248:251], v[152:155], 0
    v_pk_mul_f32 v[144:145], v[144:145], v[124:125] op_sel_hi:[1,0]
    v_pk_mul_f32 v[146:147], v[146:147], v[124:125] op_sel_hi:[1,0]
    v_pk_mul_f32 v[148:149], v[148:149], v[124:125] op_sel_hi:[1,0]
    v_pk_mul_f32 v[150:151], v[150:151], v[124:125] op_sel_hi:[1,0]
    v_mfma_f32_16x16x32_bf16 v[80:83], a[248:251], v[168:171], 0
    v_cvt_pk_bf16_f32 v212, v144, v145
    v_cvt_pk_bf16_f32 v213, v146, v147
    v_cvt_pk_bf16_f32 v214, v148, v149
    v_cvt_pk_bf16_f32 v215, v150, v151
    v_mfma_f32_16x16x32_bf16 v[116:119], a[248:251], v[184:187], 0
    ds_read_b64_tr_b16 a[248:249], v255 offset:4096
    ds_read_b64_tr_b16 a[250:251], v255 offset:6144
    s_add_u32 s72, s63, 9216
    buffer_store_dwordx4 v[212:215], v14, s[32:35], s72 offen offset:0 sc1
    ds_write_b128 v11, v[212:215] offset:1024
    v_mfma_f32_16x16x32_bf16 v[48:51], a[252:255], v[152:155], 0
    v_accvgpr_read_b32 v126, a208
    v_rcp_f32 v126, v126
    v_accvgpr_read_b32 v136, a128
    v_accvgpr_read_b32 v137, a129
    v_mfma_f32_16x16x32_bf16 v[84:87], a[252:255], v[168:171], 0
    v_accvgpr_read_b32 v138, a130
    v_accvgpr_read_b32 v139, a131
    v_mfma_f32_16x16x32_bf16 v[120:123], a[252:255], v[184:187], 0
    ds_read_b64_tr_b16 a[252:253], v252 offset:8192
    ds_read_b64_tr_b16 a[254:255], v252 offset:10240
    v_mfma_f32_16x16x32_bf16 v[16:19], a[220:223], v[156:159], v[16:19]
    s_add_u32 s74, s60, 131072
    v_add_u32 v252, s74, v1
    v_add_u32 v253, s74, v2
    v_add_u32 v254, s74, v3
    v_mfma_f32_16x16x32_bf16 v[52:55], a[220:223], v[172:175], v[52:55]
    v_add_u32 v255, s74, v4
    v_accvgpr_read_b32 v140, a132
    v_accvgpr_read_b32 v141, a133
    v_mfma_f32_16x16x32_bf16 v[88:91], a[220:223], v[188:191], v[88:91]
    ds_read_b64_tr_b16 a[220:221], v252 offset:0
    ds_read_b64_tr_b16 a[222:223], v252 offset:2048
    v_accvgpr_read_b32 v142, a134
    v_accvgpr_read_b32 v143, a135
    s_waitcnt lgkmcnt(15)
    v_mfma_f32_16x16x32_bf16 v[20:23], a[224:227], v[156:159], v[20:23]
    v_pk_mul_f32 v[136:137], v[136:137], v[126:127] op_sel_hi:[1,0]
    v_pk_mul_f32 v[138:139], v[138:139], v[126:127] op_sel_hi:[1,0]
    v_pk_mul_f32 v[140:141], v[140:141], v[126:127] op_sel_hi:[1,0]
    v_pk_mul_f32 v[142:143], v[142:143], v[126:127] op_sel_hi:[1,0]
    v_mfma_f32_16x16x32_bf16 v[56:59], a[224:227], v[172:175], v[56:59]
    v_cvt_pk_bf16_f32 v216, v136, v137
    v_cvt_pk_bf16_f32 v217, v138, v139
    v_cvt_pk_bf16_f32 v218, v140, v141
    v_cvt_pk_bf16_f32 v219, v142, v143
    v_mfma_f32_16x16x32_bf16 v[92:95], a[224:227], v[188:191], v[92:95]
    ds_read_b64_tr_b16 a[224:225], v253 offset:0
    ds_read_b64_tr_b16 a[226:227], v253 offset:2048
    s_add_u32 s72, s63, 0
    buffer_store_dwordx4 v[216:219], v14, s[32:35], s72 offen offset:1024 sc1
    ds_write_b128 v5, v[216:219] offset:1024
    v_mfma_f32_16x16x32_bf16 v[24:27], a[228:231], v[156:159], v[24:27]
    v_accvgpr_read_b32 v144, a136
    v_accvgpr_read_b32 v145, a137
    v_accvgpr_read_b32 v146, a138
    v_accvgpr_read_b32 v147, a139
    v_mfma_f32_16x16x32_bf16 v[60:63], a[228:231], v[172:175], v[60:63]
    v_accvgpr_read_b32 v148, a140
    v_accvgpr_read_b32 v149, a141
    v_accvgpr_read_b32 v150, a142
    v_accvgpr_read_b32 v151, a143
    v_mfma_f32_16x16x32_bf16 v[96:99], a[228:231], v[188:191], v[96:99]
    ds_read_b64_tr_b16 a[228:229], v254 offset:0
    ds_read_b64_tr_b16 a[230:231], v254 offset:2048
    v_pk_mul_f32 v[144:145], v[144:145], v[126:127] op_sel_hi:[1,0]
    v_pk_mul_f32 v[146:147], v[146:147], v[126:127] op_sel_hi:[1,0]
    v_mfma_f32_16x16x32_bf16 v[28:31], a[232:235], v[156:159], v[28:31]
    v_pk_mul_f32 v[148:149], v[148:149], v[126:127] op_sel_hi:[1,0]
    v_pk_mul_f32 v[150:151], v[150:151], v[126:127] op_sel_hi:[1,0]
    v_cvt_pk_bf16_f32 v220, v144, v145
    v_cvt_pk_bf16_f32 v221, v146, v147
    v_mfma_f32_16x16x32_bf16 v[64:67], a[232:235], v[172:175], v[64:67]
    v_cvt_pk_bf16_f32 v222, v148, v149
    v_cvt_pk_bf16_f32 v223, v150, v151
    s_add_u32 s72, s63, 3072
    buffer_store_dwordx4 v[220:223], v14, s[32:35], s72 offen offset:1024 sc1
    ds_write_b128 v5, v[220:223] offset:4096
    v_mfma_f32_16x16x32_bf16 v[100:103], a[232:235], v[188:191], v[100:103]
    ds_read_b64_tr_b16 a[232:233], v255 offset:0
    ds_read_b64_tr_b16 a[234:235], v255 offset:2048
    v_accvgpr_read_b32 v136, a144
    v_accvgpr_read_b32 v137, a145
    s_waitcnt lgkmcnt(15)
    v_mfma_f32_16x16x32_bf16 v[32:35], a[236:239], v[156:159], v[32:35]
    v_accvgpr_read_b32 v138, a146
    v_accvgpr_read_b32 v139, a147
    v_accvgpr_read_b32 v140, a148
    v_accvgpr_read_b32 v141, a149
    v_mfma_f32_16x16x32_bf16 v[68:71], a[236:239], v[172:175], v[68:71]
    v_accvgpr_read_b32 v142, a150
    v_accvgpr_read_b32 v143, a151
    v_pk_mul_f32 v[136:137], v[136:137], v[126:127] op_sel_hi:[1,0]
    v_pk_mul_f32 v[138:139], v[138:139], v[126:127] op_sel_hi:[1,0]
    v_mfma_f32_16x16x32_bf16 v[104:107], a[236:239], v[188:191], v[104:107]
    ds_read_b64_tr_b16 a[236:237], v252 offset:4096
    ds_read_b64_tr_b16 a[238:239], v252 offset:6144
    v_pk_mul_f32 v[140:141], v[140:141], v[126:127] op_sel_hi:[1,0]
    v_pk_mul_f32 v[142:143], v[142:143], v[126:127] op_sel_hi:[1,0]
    v_mfma_f32_16x16x32_bf16 v[36:39], a[240:243], v[156:159], v[36:39]
    v_cvt_pk_bf16_f32 v224, v136, v137
    v_cvt_pk_bf16_f32 v225, v138, v139
    v_cvt_pk_bf16_f32 v226, v140, v141
    v_cvt_pk_bf16_f32 v227, v142, v143
    v_mfma_f32_16x16x32_bf16 v[72:75], a[240:243], v[172:175], v[72:75]
    s_add_u32 s72, s63, 6144
    buffer_store_dwordx4 v[224:227], v14, s[32:35], s72 offen offset:1024 sc1
    ds_write_b128 v5, v[224:227] offset:7168
    v_accvgpr_read_b32 v144, a152
    v_accvgpr_read_b32 v145, a153
    v_mfma_f32_16x16x32_bf16 v[108:111], a[240:243], v[188:191], v[108:111]
    ds_read_b64_tr_b16 a[240:241], v253 offset:4096
    ds_read_b64_tr_b16 a[242:243], v253 offset:6144
    v_accvgpr_read_b32 v146, a154
    v_accvgpr_read_b32 v147, a155
    v_mfma_f32_16x16x32_bf16 v[40:43], a[244:247], v[156:159], v[40:43]
    v_accvgpr_read_b32 v148, a156
    v_accvgpr_read_b32 v149, a157
    v_accvgpr_read_b32 v150, a158
    v_accvgpr_read_b32 v151, a159
    v_mfma_f32_16x16x32_bf16 v[76:79], a[244:247], v[172:175], v[76:79]
    v_pk_mul_f32 v[144:145], v[144:145], v[126:127] op_sel_hi:[1,0]
    v_pk_mul_f32 v[146:147], v[146:147], v[126:127] op_sel_hi:[1,0]
    v_pk_mul_f32 v[148:149], v[148:149], v[126:127] op_sel_hi:[1,0]
    v_pk_mul_f32 v[150:151], v[150:151], v[126:127] op_sel_hi:[1,0]
    v_mfma_f32_16x16x32_bf16 v[112:115], a[244:247], v[188:191], v[112:115]
    ds_read_b64_tr_b16 a[244:245], v254 offset:4096
    ds_read_b64_tr_b16 a[246:247], v254 offset:6144
    v_cvt_pk_bf16_f32 v228, v144, v145
    v_cvt_pk_bf16_f32 v229, v146, v147
    s_waitcnt lgkmcnt(15)
    v_mfma_f32_16x16x32_bf16 v[44:47], a[248:251], v[156:159], v[44:47]
    v_cvt_pk_bf16_f32 v230, v148, v149
    v_cvt_pk_bf16_f32 v231, v150, v151
    s_add_u32 s72, s63, 9216
    buffer_store_dwordx4 v[228:231], v14, s[32:35], s72 offen offset:1024 sc1
    ds_write_b128 v11, v[228:231] offset:2048
    v_mfma_f32_16x16x32_bf16 v[80:83], a[248:251], v[172:175], v[80:83]
    v_accvgpr_read_b32 v128, a212
    v_rcp_f32 v128, v128
    v_accvgpr_read_b32 v136, a160
    v_accvgpr_read_b32 v137, a161
    v_mfma_f32_16x16x32_bf16 v[116:119], a[248:251], v[188:191], v[116:119]
    ds_read_b64_tr_b16 a[248:249], v255 offset:4096
    ds_read_b64_tr_b16 a[250:251], v255 offset:6144
    v_accvgpr_read_b32 v138, a162
    v_accvgpr_read_b32 v139, a163
    v_mfma_f32_16x16x32_bf16 v[48:51], a[252:255], v[156:159], v[48:51]
    v_accvgpr_read_b32 v140, a164
    v_accvgpr_read_b32 v141, a165
    v_accvgpr_read_b32 v142, a166
    v_accvgpr_read_b32 v143, a167
    v_mfma_f32_16x16x32_bf16 v[84:87], a[252:255], v[172:175], v[84:87]
    v_pk_mul_f32 v[136:137], v[136:137], v[128:129] op_sel_hi:[1,0]
    v_pk_mul_f32 v[138:139], v[138:139], v[128:129] op_sel_hi:[1,0]
    v_mfma_f32_16x16x32_bf16 v[120:123], a[252:255], v[188:191], v[120:123]
    ds_read_b64_tr_b16 a[252:253], v252 offset:8192
    ds_read_b64_tr_b16 a[254:255], v252 offset:10240
    s_waitcnt vmcnt(8)
    s_barrier
    s_lshl_b32 s75, s57, 7
    s_add_u32 s75, s75, 50331648
    buffer_store_dword v249, v248, s[32:35], s75 offen sc1
    v_mfma_f32_16x16x32_bf16 v[16:19], a[220:223], v[160:163], v[16:19]
    s_add_u32 s74, s60, 0
    v_add_u32 v252, s74, v1
    v_add_u32 v253, s74, v2
    v_add_u32 v254, s74, v3
    v_mfma_f32_16x16x32_bf16 v[52:55], a[220:223], v[176:179], v[52:55]
    v_add_u32 v255, s74, v4
    v_pk_mul_f32 v[140:141], v[140:141], v[128:129] op_sel_hi:[1,0]
    v_pk_mul_f32 v[142:143], v[142:143], v[128:129] op_sel_hi:[1,0]
    v_mfma_f32_16x16x32_bf16 v[88:91], a[220:223], v[192:195], v[88:91]
    ds_read_b64_tr_b16 a[220:221], v252 offset:0
    ds_read_b64_tr_b16 a[222:223], v252 offset:2048
    v_cvt_pk_bf16_f32 v232, v136, v137
    v_cvt_pk_bf16_f32 v233, v138, v139
    s_waitcnt lgkmcnt(15)
    v_mfma_f32_16x16x32_bf16 v[20:23], a[224:227], v[160:163], v[20:23]
    v_cvt_pk_bf16_f32 v234, v140, v141
    v_cvt_pk_bf16_f32 v235, v142, v143
    s_add_u32 s72, s63, 0
    buffer_store_dwordx4 v[232:235], v14, s[32:35], s72 offen offset:2048 sc1
    ds_write_b128 v5, v[232:235] offset:2048
    v_mfma_f32_16x16x32_bf16 v[56:59], a[224:227], v[176:179], v[56:59]
    v_accvgpr_read_b32 v144, a168
    v_accvgpr_read_b32 v145, a169
    v_accvgpr_read_b32 v146, a170
    v_accvgpr_read_b32 v147, a171
    v_mfma_f32_16x16x32_bf16 v[92:95], a[224:227], v[192:195], v[92:95]
    ds_read_b64_tr_b16 a[224:225], v253 offset:0
    ds_read_b64_tr_b16 a[226:227], v253 offset:2048
    v_accvgpr_read_b32 v148, a172
    v_accvgpr_read_b32 v149, a173
    v_mfma_f32_16x16x32_bf16 v[24:27], a[228:231], v[160:163], v[24:27]
    v_accvgpr_read_b32 v150, a174
    v_accvgpr_read_b32 v151, a175
    v_pk_mul_f32 v[144:145], v[144:145], v[128:129] op_sel_hi:[1,0]
    v_pk_mul_f32 v[146:147], v[146:147], v[128:129] op_sel_hi:[1,0]
    v_mfma_f32_16x16x32_bf16 v[60:63], a[228:231], v[176:179], v[60:63]
    v_pk_mul_f32 v[148:149], v[148:149], v[128:129] op_sel_hi:[1,0]
    v_pk_mul_f32 v[150:151], v[150:151], v[128:129] op_sel_hi:[1,0]
    v_cvt_pk_bf16_f32 v236, v144, v145
    v_cvt_pk_bf16_f32 v237, v146, v147
    v_mfma_f32_16x16x32_bf16 v[96:99], a[228:231], v[192:195], v[96:99]
    ds_read_b64_tr_b16 a[228:229], v254 offset:0
    ds_read_b64_tr_b16 a[230:231], v254 offset:2048
    v_cvt_pk_bf16_f32 v238, v148, v149
    v_cvt_pk_bf16_f32 v239, v150, v151
    s_waitcnt lgkmcnt(15)
    v_mfma_f32_16x16x32_bf16 v[28:31], a[232:235], v[160:163], v[28:31]
    s_add_u32 s72, s63, 3072
    buffer_store_dwordx4 v[236:239], v14, s[32:35], s72 offen offset:2048 sc1
    ds_write_b128 v5, v[236:239] offset:5120
    v_accvgpr_read_b32 v136, a176
    v_accvgpr_read_b32 v137, a177
    v_mfma_f32_16x16x32_bf16 v[64:67], a[232:235], v[176:179], v[64:67]
    v_accvgpr_read_b32 v138, a178
    v_accvgpr_read_b32 v139, a179
    v_accvgpr_read_b32 v140, a180
    v_accvgpr_read_b32 v141, a181
    v_mfma_f32_16x16x32_bf16 v[100:103], a[232:235], v[192:195], v[100:103]
    ds_read_b64_tr_b16 a[232:233], v255 offset:0
    ds_read_b64_tr_b16 a[234:235], v255 offset:2048
    v_accvgpr_read_b32 v142, a182
    v_accvgpr_read_b32 v143, a183
    v_mfma_f32_16x16x32_bf16 v[32:35], a[236:239], v[160:163], v[32:35]
    v_pk_mul_f32 v[136:137], v[136:137], v[128:129] op_sel_hi:[1,0]
    v_pk_mul_f32 v[138:139], v[138:139], v[128:129] op_sel_hi:[1,0]
    v_pk_mul_f32 v[140:141], v[140:141], v[128:129] op_sel_hi:[1,0]
    v_pk_mul_f32 v[142:143], v[142:143], v[128:129] op_sel_hi:[1,0]
    v_mfma_f32_16x16x32_bf16 v[68:71], a[236:239], v[176:179], v[68:71]
    v_cvt_pk_bf16_f32 v240, v136, v137
    v_cvt_pk_bf16_f32 v241, v138, v139
    v_cvt_pk_bf16_f32 v242, v140, v141
    v_cvt_pk_bf16_f32 v243, v142, v143
    v_mfma_f32_16x16x32_bf16 v[104:107], a[236:239], v[192:195], v[104:107]
    ds_read_b64_tr_b16 a[236:237], v252 offset:4096
    ds_read_b64_tr_b16 a[238:239], v252 offset:6144
    s_add_u32 s72, s63, 6144
    buffer_store_dwordx4 v[240:243], v14, s[32:35], s72 offen offset:2048 sc1
    ds_write_b128 v11, v[240:243] offset:0
    s_waitcnt lgkmcnt(15)
    v_mfma_f32_16x16x32_bf16 v[36:39], a[240:243], v[160:163], v[36:39]
    v_accvgpr_read_b32 v144, a184
    v_accvgpr_read_b32 v145, a185
    v_accvgpr_read_b32 v146, a186
    v_accvgpr_read_b32 v147, a187
    v_mfma_f32_16x16x32_bf16 v[72:75], a[240:243], v[176:179], v[72:75]
    v_accvgpr_read_b32 v148, a188
    v_accvgpr_read_b32 v149, a189
    v_accvgpr_read_b32 v150, a190
    v_accvgpr_read_b32 v151, a191
    v_mfma_f32_16x16x32_bf16 v[108:111], a[240:243], v[192:195], v[108:111]
    ds_read_b64_tr_b16 a[240:241], v253 offset:4096
    ds_read_b64_tr_b16 a[242:243], v253 offset:6144
    v_pk_mul_f32 v[144:145], v[144:145], v[128:129] op_sel_hi:[1,0]
    v_pk_mul_f32 v[146:147], v[146:147], v[128:129] op_sel_hi:[1,0]
    v_mfma_f32_16x16x32_bf16 v[40:43], a[244:247], v[160:163], v[40:43]
    v_pk_mul_f32 v[148:149], v[148:149], v[128:129] op_sel_hi:[1,0]
    v_pk_mul_f32 v[150:151], v[150:151], v[128:129] op_sel_hi:[1,0]
    v_cvt_pk_bf16_f32 v244, v144, v145
    v_cvt_pk_bf16_f32 v245, v146, v147
    v_mfma_f32_16x16x32_bf16 v[76:79], a[244:247], v[176:179], v[76:79]
    v_cvt_pk_bf16_f32 v246, v148, v149
    v_cvt_pk_bf16_f32 v247, v150, v151
    s_add_u32 s72, s63, 9216
    buffer_store_dwordx4 v[244:247], v14, s[32:35], s72 offen offset:2048 sc1
    ds_write_b128 v11, v[244:247] offset:3072
    v_mfma_f32_16x16x32_bf16 v[112:115], a[244:247], v[192:195], v[112:115]
    ds_read_b64_tr_b16 a[244:245], v254 offset:4096
    ds_read_b64_tr_b16 a[246:247], v254 offset:6144
    v_mfma_f32_16x16x32_bf16 v[44:47], a[248:251], v[160:163], v[44:47]
    v_mfma_f32_16x16x32_bf16 v[80:83], a[248:251], v[176:179], v[80:83]
    v_mfma_f32_16x16x32_bf16 v[116:119], a[248:251], v[192:195], v[116:119]
    ds_read_b64_tr_b16 a[248:249], v255 offset:4096
    ds_read_b64_tr_b16 a[250:251], v255 offset:6144
    s_waitcnt lgkmcnt(15)
    v_mfma_f32_16x16x32_bf16 v[48:51], a[252:255], v[160:163], v[48:51]
    v_mfma_f32_16x16x32_bf16 v[84:87], a[252:255], v[176:179], v[84:87]
    v_mfma_f32_16x16x32_bf16 v[120:123], a[252:255], v[192:195], v[120:123]
    ds_read_b64_tr_b16 a[252:253], v252 offset:8192
    ds_read_b64_tr_b16 a[254:255], v252 offset:10240
    s_waitcnt lgkmcnt(4)
    v_mfma_f32_16x16x32_bf16 v[16:19], a[220:223], v[164:167], v[16:19]
    s_add_u32 s74, s59, 65536
    v_add_u32 v252, s74, v1
    v_mfma_f32_16x16x32_bf16 v[52:55], a[220:223], v[180:183], v[52:55]
    v_add_u32 v253, s74, v2
    v_add_u32 v254, s74, v3
    v_add_u32 v255, s74, v4
    v_mfma_f32_16x16x32_bf16 v[88:91], a[220:223], v[196:199], v[88:91]
    ds_read_b64_tr_b16 a[220:221], v252 offset:0
    ds_read_b64_tr_b16 a[222:223], v252 offset:2048
    v_mfma_f32_16x16x32_bf16 v[20:23], a[224:227], v[164:167], v[20:23]
    v_mfma_f32_16x16x32_bf16 v[56:59], a[224:227], v[180:183], v[56:59]
    v_mfma_f32_16x16x32_bf16 v[92:95], a[224:227], v[196:199], v[92:95]
    ds_read_b64_tr_b16 a[224:225], v253 offset:0
    ds_read_b64_tr_b16 a[226:227], v253 offset:2048
    v_mfma_f32_16x16x32_bf16 v[24:27], a[228:231], v[164:167], v[24:27]
    v_mfma_f32_16x16x32_bf16 v[60:63], a[228:231], v[180:183], v[60:63]
    v_mfma_f32_16x16x32_bf16 v[96:99], a[228:231], v[196:199], v[96:99]
    ds_read_b64_tr_b16 a[228:229], v254 offset:0
    ds_read_b64_tr_b16 a[230:231], v254 offset:2048
    v_mfma_f32_16x16x32_bf16 v[28:31], a[232:235], v[164:167], v[28:31]
    v_mfma_f32_16x16x32_bf16 v[64:67], a[232:235], v[180:183], v[64:67]
    v_mfma_f32_16x16x32_bf16 v[100:103], a[232:235], v[196:199], v[100:103]
    ds_read_b64_tr_b16 a[232:233], v255 offset:0
    ds_read_b64_tr_b16 a[234:235], v255 offset:2048
    v_mfma_f32_16x16x32_bf16 v[32:35], a[236:239], v[164:167], v[32:35]
    v_mfma_f32_16x16x32_bf16 v[68:71], a[236:239], v[180:183], v[68:71]
    v_mfma_f32_16x16x32_bf16 v[104:107], a[236:239], v[196:199], v[104:107]
    ds_read_b64_tr_b16 a[236:237], v252 offset:4096
    ds_read_b64_tr_b16 a[238:239], v252 offset:6144
    v_mfma_f32_16x16x32_bf16 v[36:39], a[240:243], v[164:167], v[36:39]
    v_mfma_f32_16x16x32_bf16 v[72:75], a[240:243], v[180:183], v[72:75]
    v_mfma_f32_16x16x32_bf16 v[108:111], a[240:243], v[196:199], v[108:111]
    ds_read_b64_tr_b16 a[240:241], v253 offset:4096
    ds_read_b64_tr_b16 a[242:243], v253 offset:6144
    v_mfma_f32_16x16x32_bf16 v[40:43], a[244:247], v[164:167], v[40:43]
    v_mfma_f32_16x16x32_bf16 v[76:79], a[244:247], v[180:183], v[76:79]
    v_mfma_f32_16x16x32_bf16 v[112:115], a[244:247], v[196:199], v[112:115]
    ds_read_b64_tr_b16 a[244:245], v254 offset:4096
    ds_read_b64_tr_b16 a[246:247], v254 offset:6144
    s_waitcnt lgkmcnt(15)
    v_mfma_f32_16x16x32_bf16 v[44:47], a[248:251], v[164:167], v[44:47]
    v_mfma_f32_16x16x32_bf16 v[80:83], a[248:251], v[180:183], v[80:83]
    v_mfma_f32_16x16x32_bf16 v[116:119], a[248:251], v[196:199], v[116:119]
    ds_read_b64_tr_b16 a[248:249], v255 offset:4096
    ds_read_b64_tr_b16 a[250:251], v255 offset:6144
    s_waitcnt lgkmcnt(15)
    v_mfma_f32_16x16x32_bf16 v[48:51], a[252:255], v[164:167], v[48:51]
    v_mfma_f32_16x16x32_bf16 v[84:87], a[252:255], v[180:183], v[84:87]
    v_mfma_f32_16x16x32_bf16 v[120:123], a[252:255], v[196:199], v[120:123]
    ds_read_b64_tr_b16 a[252:253], v252 offset:8192
    ds_read_b64_tr_b16 a[254:255], v252 offset:10240
    s_waitcnt lgkmcnt(0)
    s_barrier
    ds_read_b128 v[200:203], v8 offset:0
    ds_read_b128 v[216:219], v8 offset:1024
    ds_read_b128 v[232:235], v8 offset:2048
    ds_read_b128 v[204:207], v8 offset:3072
    ds_read_b128 v[220:223], v8 offset:4096
    ds_read_b128 v[236:239], v8 offset:5120
    ds_read_b128 v[208:211], v8 offset:6144
    ds_read_b128 v[224:227], v8 offset:7168
    ds_read_b128 v[240:243], v9 offset:0
    ds_read_b128 v[212:215], v9 offset:1024
    ds_read_b128 v[228:231], v9 offset:2048
    ds_read_b128 v[244:247], v9 offset:3072
    s_waitcnt lgkmcnt(11)
    v_mfma_f32_16x16x32_bf16 v[16:19], a[220:223], v[200:203], v[16:19]
    s_add_u32 s74, s59, 98304
    v_add_u32 v252, s74, v1
    s_waitcnt lgkmcnt(10)
    v_mfma_f32_16x16x32_bf16 v[52:55], a[220:223], v[216:219], v[52:55]
    v_add_u32 v253, s74, v2
    v_add_u32 v254, s74, v3
    v_add_u32 v255, s74, v4
    s_waitcnt lgkmcnt(9)
    v_mfma_f32_16x16x32_bf16 v[88:91], a[220:223], v[232:235], v[88:91]
    ds_read_b64_tr_b16 a[220:221], v252 offset:0
    ds_read_b64_tr_b16 a[222:223], v252 offset:2048
    v_mfma_f32_16x16x32_bf16 v[20:23], a[224:227], v[200:203], v[20:23]
    buffer_load_dword v132, v250, s[32:35], s58 offen offset:0 sc1
    v_mfma_f32_16x16x32_bf16 v[56:59], a[224:227], v[216:219], v[56:59]
    v_mfma_f32_16x16x32_bf16 v[92:95], a[224:227], v[232:235], v[92:95]
    ds_read_b64_tr_b16 a[224:225], v253 offset:0
    ds_read_b64_tr_b16 a[226:227], v253 offset:2048
    v_mfma_f32_16x16x32_bf16 v[24:27], a[228:231], v[200:203], v[24:27]
    v_mfma_f32_16x16x32_bf16 v[60:63], a[228:231], v[216:219], v[60:63]
    v_mfma_f32_16x16x32_bf16 v[96:99], a[228:231], v[232:235], v[96:99]
    ds_read_b64_tr_b16 a[228:229], v254 offset:0
    ds_read_b64_tr_b16 a[230:231], v254 offset:2048
    v_mfma_f32_16x16x32_bf16 v[28:31], a[232:235], v[200:203], v[28:31]
    v_mfma_f32_16x16x32_bf16 v[64:67], a[232:235], v[216:219], v[64:67]
    v_mfma_f32_16x16x32_bf16 v[100:103], a[232:235], v[232:235], v[100:103]
    ds_read_b64_tr_b16 a[232:233], v255 offset:0
    ds_read_b64_tr_b16 a[234:235], v255 offset:2048
    v_mfma_f32_16x16x32_bf16 v[32:35], a[236:239], v[200:203], v[32:35]
    v_mfma_f32_16x16x32_bf16 v[68:71], a[236:239], v[216:219], v[68:71]
    v_mfma_f32_16x16x32_bf16 v[104:107], a[236:239], v[232:235], v[104:107]
    ds_read_b64_tr_b16 a[236:237], v252 offset:4096
    ds_read_b64_tr_b16 a[238:239], v252 offset:6144
    v_mfma_f32_16x16x32_bf16 v[36:39], a[240:243], v[200:203], v[36:39]
    v_mfma_f32_16x16x32_bf16 v[72:75], a[240:243], v[216:219], v[72:75]
    v_mfma_f32_16x16x32_bf16 v[108:111], a[240:243], v[232:235], v[108:111]
    ds_read_b64_tr_b16 a[240:241], v253 offset:4096
    ds_read_b64_tr_b16 a[242:243], v253 offset:6144
    v_mfma_f32_16x16x32_bf16 v[40:43], a[244:247], v[200:203], v[40:43]
    v_mfma_f32_16x16x32_bf16 v[76:79], a[244:247], v[216:219], v[76:79]
    v_mfma_f32_16x16x32_bf16 v[112:115], a[244:247], v[232:235], v[112:115]
    ds_read_b64_tr_b16 a[244:245], v254 offset:4096
    ds_read_b64_tr_b16 a[246:247], v254 offset:6144
    v_mfma_f32_16x16x32_bf16 v[44:47], a[248:251], v[200:203], v[44:47]
    v_mfma_f32_16x16x32_bf16 v[80:83], a[248:251], v[216:219], v[80:83]
    v_mfma_f32_16x16x32_bf16 v[116:119], a[248:251], v[232:235], v[116:119]
    ds_read_b64_tr_b16 a[248:249], v255 offset:4096
    ds_read_b64_tr_b16 a[250:251], v255 offset:6144
    v_mfma_f32_16x16x32_bf16 v[48:51], a[252:255], v[200:203], v[48:51]
    v_mfma_f32_16x16x32_bf16 v[84:87], a[252:255], v[216:219], v[84:87]
    v_mfma_f32_16x16x32_bf16 v[120:123], a[252:255], v[232:235], v[120:123]
    ds_read_b64_tr_b16 a[252:253], v252 offset:8192
    ds_read_b64_tr_b16 a[254:255], v252 offset:10240
    s_waitcnt lgkmcnt(0)
    s_barrier
    s_waitcnt lgkmcnt(4)
    v_mfma_f32_16x16x32_bf16 v[16:19], a[220:223], v[204:207], v[16:19]
    s_add_u32 s74, s59, 131072
    v_add_u32 v252, s74, v1
    v_mfma_f32_16x16x32_bf16 v[52:55], a[220:223], v[220:223], v[52:55]
    v_add_u32 v253, s74, v2
    v_add_u32 v254, s74, v3
    v_add_u32 v255, s74, v4
    v_mfma_f32_16x16x32_bf16 v[88:91], a[220:223], v[236:239], v[88:91]
    ds_read_b64_tr_b16 a[220:221], v252 offset:0
    ds_read_b64_tr_b16 a[222:223], v252 offset:2048
    v_mfma_f32_16x16x32_bf16 v[20:23], a[224:227], v[204:207], v[20:23]
    s_add_u32 m0, s64, 32768
    s_add_u32 s65, s67, 0
    buffer_load_dwordx4 v12, s[36:39], s65 offen offset:0 lds
    v_mfma_f32_16x16x32_bf16 v[56:59], a[224:227], v[220:223], v[56:59]
    v_mfma_f32_16x16x32_bf16 v[92:95], a[224:227], v[236:239], v[92:95]
    ds_read_b64_tr_b16 a[224:225], v253 offset:0
    ds_read_b64_tr_b16 a[226:227], v253 offset:2048
    v_mfma_f32_16x16x32_bf16 v[24:27], a[228:231], v[204:207], v[24:27]
    s_add_u32 m0, s64, 36736
    s_nop 0
    buffer_load_dwordx4 v12, s[36:39], s65 offen offset:128 lds
    v_mfma_f32_16x16x32_bf16 v[60:63], a[228:231], v[220:223], v[60:63]
    v_mfma_f32_16x16x32_bf16 v[96:99], a[228:231], v[236:239], v[96:99]
    ds_read_b64_tr_b16 a[228:229], v254 offset:0
    ds_read_b64_tr_b16 a[230:231], v254 offset:2048
    v_mfma_f32_16x16x32_bf16 v[28:31], a[232:235], v[204:207], v[28:31]
    v_mfma_f32_16x16x32_bf16 v[64:67], a[232:235], v[220:223], v[64:67]
    s_add_u32 m0, s64, 40704
    s_nop 0
    buffer_load_dwordx4 v12, s[36:39], s65 offen offset:256 lds
    v_mfma_f32_16x16x32_bf16 v[100:103], a[232:235], v[236:239], v[100:103]
    ds_read_b64_tr_b16 a[232:233], v255 offset:0
    ds_read_b64_tr_b16 a[234:235], v255 offset:2048
    v_mfma_f32_16x16x32_bf16 v[32:35], a[236:239], v[204:207], v[32:35]
    v_mfma_f32_16x16x32_bf16 v[68:71], a[236:239], v[220:223], v[68:71]
    v_mfma_f32_16x16x32_bf16 v[104:107], a[236:239], v[236:239], v[104:107]
    ds_read_b64_tr_b16 a[236:237], v252 offset:4096
    ds_read_b64_tr_b16 a[238:239], v252 offset:6144
    v_mfma_f32_16x16x32_bf16 v[36:39], a[240:243], v[204:207], v[36:39]
    s_add_u32 m0, s64, 33792
    s_add_u32 s65, s67, 9216
    buffer_load_dwordx4 v12, s[36:39], s65 offen offset:0 lds
    v_mfma_f32_16x16x32_bf16 v[72:75], a[240:243], v[220:223], v[72:75]
    v_mfma_f32_16x16x32_bf16 v[108:111], a[240:243], v[236:239], v[108:111]
    ds_read_b64_tr_b16 a[240:241], v253 offset:4096
    ds_read_b64_tr_b16 a[242:243], v253 offset:6144
    v_mfma_f32_16x16x32_bf16 v[40:43], a[244:247], v[204:207], v[40:43]
    s_add_u32 m0, s64, 37760
    s_nop 0
    buffer_load_dwordx4 v12, s[36:39], s65 offen offset:128 lds
    v_mfma_f32_16x16x32_bf16 v[76:79], a[244:247], v[220:223], v[76:79]
    v_mfma_f32_16x16x32_bf16 v[112:115], a[244:247], v[236:239], v[112:115]
    ds_read_b64_tr_b16 a[244:245], v254 offset:4096
    ds_read_b64_tr_b16 a[246:247], v254 offset:6144
    v_mfma_f32_16x16x32_bf16 v[44:47], a[248:251], v[204:207], v[44:47]
    v_mfma_f32_16x16x32_bf16 v[80:83], a[248:251], v[220:223], v[80:83]
    s_add_u32 m0, s64, 41728
    s_nop 0
    buffer_load_dwordx4 v12, s[36:39], s65 offen offset:256 lds
    v_mfma_f32_16x16x32_bf16 v[116:119], a[248:251], v[236:239], v[116:119]
    ds_read_b64_tr_b16 a[248:249], v255 offset:4096
    ds_read_b64_tr_b16 a[250:251], v255 offset:6144
    v_mfma_f32_16x16x32_bf16 v[48:51], a[252:255], v[204:207], v[48:51]
    v_mfma_f32_16x16x32_bf16 v[84:87], a[252:255], v[220:223], v[84:87]
    v_mfma_f32_16x16x32_bf16 v[120:123], a[252:255], v[236:239], v[120:123]
    ds_read_b64_tr_b16 a[252:253], v252 offset:8192
    ds_read_b64_tr_b16 a[254:255], v252 offset:10240
    s_waitcnt vmcnt(7)
    s_barrier
    s_lshl_b32 s75, s57, 7
    s_add_u32 s75, s75, 50331656
    buffer_store_dword v249, v248, s[32:35], s75 offen sc1
    s_waitcnt vmcnt(7)
    v_cmp_eq_u32 vcc, 1, v132
    s_nop 1
    s_cmp_eq_u64 vcc, exec
    s_cbranch_scc1 L_goA
    s_mov_b32 s75, 0x200000
L_spinA:
    buffer_load_dword v132, v250, s[32:35], s58 offen offset:0 sc1
    s_waitcnt vmcnt(0)
    v_cmp_eq_u32 vcc, 1, v132
    s_nop 1
    s_cmp_eq_u64 vcc, exec
    s_cbranch_scc1 L_goA
    s_sub_u32 s75, s75, 1
    s_cmp_lg_u32 s75, 0
    s_cbranch_scc1 L_spinA
L_goA:
    s_waitcnt lgkmcnt(4)
    v_mfma_f32_16x16x32_bf16 v[16:19], a[220:223], v[208:211], v[16:19]
    s_add_u32 s74, s59, 0
    v_add_u32 v252, s74, v1
    v_mfma_f32_16x16x32_bf16 v[52:55], a[220:223], v[224:227], v[52:55]
    v_add_u32 v253, s74, v2
    v_add_u32 v254, s74, v3
    v_add_u32 v255, s74, v4
    v_mfma_f32_16x16x32_bf16 v[88:91], a[220:223], v[240:243], v[88:91]
    ds_read_b64_tr_b16 a[220:221], v252 offset:0
    ds_read_b64_tr_b16 a[222:223], v252 offset:2048
    v_mfma_f32_16x16x32_bf16 v[20:23], a[224:227], v[208:211], v[20:23]
    s_add_u32 m0, s64, 65536
    s_add_u32 s65, s68, 0
    buffer_load_dwordx4 v12, s[36:39], s65 offen offset:0 lds
    v_mfma_f32_16x16x32_bf16 v[56:59], a[224:227], v[224:227], v[56:59]
    s_add_u32 m0, s64, 69504
    s_nop 0
    buffer_load_dwordx4 v12, s[36:39], s65 offen offset:128 lds
    v_mfma_f32_16x16x32_bf16 v[92:95], a[224:227], v[240:243], v[92:95]
    ds_read_b64_tr_b16 a[224:225], v253 offset:0
    ds_read_b64_tr_b16 a[226:227], v253 offset:2048
    v_mfma_f32_16x16x32_bf16 v[24:27], a[228:231], v[208:211], v[24:27]
    s_add_u32 m0, s64, 73472
    s_nop 0
    buffer_load_dwordx4 v12, s[36:39], s65 offen offset:256 lds
    v_mfma_f32_16x16x32_bf16 v[60:63], a[228:231], v[224:227], v[60:63]
    v_mfma_f32_16x16x32_bf16 v[96:99], a[228:231], v[240:243], v[96:99]
    ds_read_b64_tr_b16 a[228:229], v254 offset:0
    ds_read_b64_tr_b16 a[230:231], v254 offset:2048
    v_mfma_f32_16x16x32_bf16 v[28:31], a[232:235], v[208:211], v[28:31]
    s_add_u32 m0, s64, 66560
    s_add_u32 s65, s68, 9216
    buffer_load_dwordx4 v12, s[36:39], s65 offen offset:0 lds
    v_mfma_f32_16x16x32_bf16 v[64:67], a[232:235], v[224:227], v[64:67]
    s_add_u32 m0, s64, 70528
    s_nop 0
    buffer_load_dwordx4 v12, s[36:39], s65 offen offset:128 lds
    v_mfma_f32_16x16x32_bf16 v[100:103], a[232:235], v[240:243], v[100:103]
    ds_read_b64_tr_b16 a[232:233], v255 offset:0
    ds_read_b64_tr_b16 a[234:235], v255 offset:2048
    v_mfma_f32_16x16x32_bf16 v[32:35], a[236:239], v[208:211], v[32:35]
    s_add_u32 m0, s64, 74496
    s_nop 0
    buffer_load_dwordx4 v12, s[36:39], s65 offen offset:256 lds
    v_mfma_f32_16x16x32_bf16 v[68:71], a[236:239], v[224:227], v[68:71]
    v_mfma_f32_16x16x32_bf16 v[104:107], a[236:239], v[240:243], v[104:107]
    ds_read_b64_tr_b16 a[236:237], v252 offset:4096
    ds_read_b64_tr_b16 a[238:239], v252 offset:6144
    v_mfma_f32_16x16x32_bf16 v[36:39], a[240:243], v[208:211], v[36:39]
    s_add_u32 s72, s11, 0
    buffer_load_dwordx4 a[0:3], v14, s[32:35], s72 offen offset:0 sc1
    v_mfma_f32_16x16x32_bf16 v[72:75], a[240:243], v[224:227], v[72:75]
    buffer_load_dwordx4 a[16:19], v14, s[32:35], s72 offen offset:1024 sc1
    v_mfma_f32_16x16x32_bf16 v[108:111], a[240:243], v[240:243], v[108:111]
    ds_read_b64_tr_b16 a[240:241], v253 offset:4096
    ds_read_b64_tr_b16 a[242:243], v253 offset:6144
    v_mfma_f32_16x16x32_bf16 v[40:43], a[244:247], v[208:211], v[40:43]
    buffer_load_dwordx4 a[32:35], v14, s[32:35], s72 offen offset:2048 sc1
    v_mfma_f32_16x16x32_bf16 v[76:79], a[244:247], v[224:227], v[76:79]
    v_mfma_f32_16x16x32_bf16 v[112:115], a[244:247], v[240:243], v[112:115]
    ds_read_b64_tr_b16 a[244:245], v254 offset:4096
    ds_read_b64_tr_b16 a[246:247], v254 offset:6144
    s_waitcnt lgkmcnt(15)
    v_mfma_f32_16x16x32_bf16 v[44:47], a[248:251], v[208:211], v[44:47]
    s_add_u32 s72, s12, 0
    buffer_load_dwordx4 a[96:99], v14, s[32:35], s72 offen offset:0 sc1
    v_mfma_f32_16x16x32_bf16 v[80:83], a[248:251], v[224:227], v[80:83]
    buffer_load_dwordx4 a[112:115], v14, s[32:35], s72 offen offset:1024 sc1
    v_mfma_f32_16x16x32_bf16 v[116:119], a[248:251], v[240:243], v[116:119]
    ds_read_b64_tr_b16 a[248:249], v255 offset:4096
    ds_read_b64_tr_b16 a[250:251], v255 offset:6144
    s_waitcnt lgkmcnt(15)
    v_mfma_f32_16x16x32_bf16 v[48:51], a[252:255], v[208:211], v[48:51]
    buffer_load_dwordx4 a[128:131], v14, s[32:35], s72 offen offset:2048 sc1
    v_mfma_f32_16x16x32_bf16 v[84:87], a[252:255], v[224:227], v[84:87]
    v_mfma_f32_16x16x32_bf16 v[120:123], a[252:255], v[240:243], v[120:123]
    ds_read_b64_tr_b16 a[252:253], v252 offset:8192
    ds_read_b64_tr_b16 a[254:255], v252 offset:10240
    s_waitcnt vmcnt(13)
    s_barrier
    s_waitcnt lgkmcnt(4)
    v_mfma_f32_16x16x32_bf16 v[16:19], a[220:223], v[212:215], v[16:19]
    s_add_u32 s74, s60, 32768
    v_add_u32 v252, s74, v1
    v_mfma_f32_16x16x32_bf16 v[52:55], a[220:223], v[228:231], v[52:55]
    v_add_u32 v253, s74, v2
    v_add_u32 v254, s74, v3
    v_add_u32 v255, s74, v4
    v_mfma_f32_16x16x32_bf16 v[88:91], a[220:223], v[244:247], v[88:91]
    ds_read_b64_tr_b16 a[220:221], v252 offset:0
    ds_read_b64_tr_b16 a[222:223], v252 offset:2048
    v_mfma_f32_16x16x32_bf16 v[20:23], a[224:227], v[212:215], v[20:23]
    buffer_load_dword v132, v250, s[32:35], s58 offen offset:8 sc1
    v_mfma_f32_16x16x32_bf16 v[56:59], a[224:227], v[228:231], v[56:59]
    v_mfma_f32_16x16x32_bf16 v[92:95], a[224:227], v[244:247], v[92:95]
    ds_read_b64_tr_b16 a[224:225], v253 offset:0
    ds_read_b64_tr_b16 a[226:227], v253 offset:2048
    v_mfma_f32_16x16x32_bf16 v[24:27], a[228:231], v[212:215], v[24:27]
    s_add_u32 m0, s64, 98304
    s_add_u32 s65, s69, 0
    buffer_load_dwordx4 v12, s[36:39], s65 offen offset:0 lds
    v_mfma_f32_16x16x32_bf16 v[60:63], a[228:231], v[228:231], v[60:63]
    s_add_u32 m0, s64, 102272
    s_nop 0
    buffer_load_dwordx4 v12, s[36:39], s65 offen offset:128 lds
    v_mfma_f32_16x16x32_bf16 v[96:99], a[228:231], v[244:247], v[96:99]
    ds_read_b64_tr_b16 a[228:229], v254 offset:0
    ds_read_b64_tr_b16 a[230:231], v254 offset:2048
    v_mfma_f32_16x16x32_bf16 v[28:31], a[232:235], v[212:215], v[28:31]
    s_add_u32 m0, s64, 106240
    s_nop 0
    buffer_load_dwordx4 v12, s[36:39], s65 offen offset:256 lds
    v_mfma_f32_16x16x32_bf16 v[64:67], a[232:235], v[228:231], v[64:67]
    v_mfma_f32_16x16x32_bf16 v[100:103], a[232:235], v[244:247], v[100:103]
    ds_read_b64_tr_b16 a[232:233], v255 offset:0
    ds_read_b64_tr_b16 a[234:235], v255 offset:2048
    v_mfma_f32_16x16x32_bf16 v[32:35], a[236:239], v[212:215], v[32:35]
    s_add_u32 m0, s64, 99328
    s_add_u32 s65, s69, 9216
    buffer_load_dwordx4 v12, s[36:39], s65 offen offset:0 lds
    v_mfma_f32_16x16x32_bf16 v[68:71], a[236:239], v[228:231], v[68:71]
    v_mfma_f32_16x16x32_bf16 v[104:107], a[236:239], v[244:247], v[104:107]
    ds_read_b64_tr_b16 a[236:237], v252 offset:4096
    ds_read_b64_tr_b16 a[238:239], v252 offset:6144
    v_mfma_f32_16x16x32_bf16 v[36:39], a[240:243], v[212:215], v[36:39]
    s_add_u32 m0, s64, 103296
    s_nop 0
    buffer_load_dwordx4 v12, s[36:39], s65 offen offset:128 lds
    v_mfma_f32_16x16x32_bf16 v[72:75], a[240:243], v[228:231], v[72:75]
    s_add_u32 m0, s64, 107264
    s_nop 0
    buffer_load_dwordx4 v12, s[36:39], s65 offen offset:256 lds
    v_mfma_f32_16x16x32_bf16 v[108:111], a[240:243], v[244:247], v[108:111]
    ds_read_b64_tr_b16 a[240:241], v253 offset:4096
    ds_read_b64_tr_b16 a[242:243], v253 offset:6144
    v_mfma_f32_16x16x32_bf16 v[40:43], a[244:247], v[212:215], v[40:43]
    v_mfma_f32_16x16x32_bf16 v[76:79], a[244:247], v[228:231], v[76:79]
    s_add_u32 s72, s13, 0
    buffer_load_dwordx4 v[152:155], v14, s[32:35], s72 offen offset:0 sc1
    v_mfma_f32_16x16x32_bf16 v[112:115], a[244:247], v[244:247], v[112:115]
    ds_read_b64_tr_b16 a[244:245], v254 offset:4096
    ds_read_b64_tr_b16 a[246:247], v254 offset:6144
    s_waitcnt lgkmcnt(15)
    v_mfma_f32_16x16x32_bf16 v[44:47], a[248:251], v[212:215], v[44:47]
    buffer_load_dwordx4 v[168:171], v14, s[32:35], s72 offen offset:1024 sc1
    v_mfma_f32_16x16x32_bf16 v[80:83], a[248:251], v[228:231], v[80:83]
    v_mfma_f32_16x16x32_bf16 v[116:119], a[248:251], v[244:247], v[116:119]
    ds_read_b64_tr_b16 a[248:249], v255 offset:4096
    ds_read_b64_tr_b16 a[250:251], v255 offset:6144
    s_waitcnt lgkmcnt(15)
    v_mfma_f32_16x16x32_bf16 v[48:51], a[252:255], v[212:215], v[48:51]
    buffer_load_dwordx4 v[184:187], v14, s[32:35], s72 offen offset:2048 sc1
    v_mfma_f32_16x16x32_bf16 v[84:87], a[252:255], v[228:231], v[84:87]
    v_mfma_f32_16x16x32_bf16 v[120:123], a[252:255], v[244:247], v[120:123]
    ds_read_b64_tr_b16 a[252:253], v252 offset:8192
    ds_read_b64_tr_b16 a[254:255], v252 offset:10240
    s_waitcnt vmcnt(16)
    s_barrier
    s_waitcnt lgkmcnt(4)
    s_waitcnt vmcnt(15)
    v_mfma_f32_16x16x32_bf16 v[16:19], a[220:223], a[0:3], v[16:19]
    s_add_u32 s74, s60, 65536
    v_add_u32 v252, s74, v1
    s_waitcnt vmcnt(14)
    v_mfma_f32_16x16x32_bf16 v[52:55], a[220:223], a[16:19], v[52:55]
    v_add_u32 v253, s74, v2
    v_add_u32 v254, s74, v3
    v_add_u32 v255, s74, v4
    s_waitcnt vmcnt(13)
    v_mfma_f32_16x16x32_bf16 v[88:91], a[220:223], a[32:35], v[88:91]
    ds_read_b64_tr_b16 a[220:221], v252 offset:0
    ds_read_b64_tr_b16 a[222:223], v252 offset:2048
    v_mfma_f32_16x16x32_bf16 v[20:23], a[224:227], a[0:3], v[20:23]
    s_add_u32 m0, s64, 131072
    s_add_u32 s65, s67, 36864
    buffer_load_dwordx4 v12, s[36:39], s65 offen offset:0 lds
    v_mfma_f32_16x16x32_bf16 v[56:59], a[224:227], a[16:19], v[56:59]
    v_mfma_f32_16x16x32_bf16 v[92:95], a[224:227], a[32:35], v[92:95]
    ds_read_b64_tr_b16 a[224:225], v253 offset:0
    ds_read_b64_tr_b16 a[226:227], v253 offset:2048
    v_mfma_f32_16x16x32_bf16 v[24:27], a[228:231], a[0:3], v[24:27]
    s_add_u32 m0, s64, 135040
    s_nop 0
    buffer_load_dwordx4 v12, s[36:39], s65 offen offset:128 lds
    v_mfma_f32_16x16x32_bf16 v[60:63], a[228:231], a[16:19], v[60:63]
    v_mfma_f32_16x16x32_bf16 v[96:99], a[228:231], a[32:35], v[96:99]
    ds_read_b64_tr_b16 a[228:229], v254 offset:0
    ds_read_b64_tr_b16 a[230:231], v254 offset:2048
    v_mfma_f32_16x16x32_bf16 v[28:31], a[232:235], a[0:3], v[28:31]
    v_mfma_f32_16x16x32_bf16 v[64:67], a[232:235], a[16:19], v[64:67]
    s_add_u32 m0, s64, 139008
    s_nop 0
    buffer_load_dwordx4 v12, s[36:39], s65 offen offset:256 lds
    v_mfma_f32_16x16x32_bf16 v[100:103], a[232:235], a[32:35], v[100:103]
    ds_read_b64_tr_b16 a[232:233], v255 offset:0
    ds_read_b64_tr_b16 a[234:235], v255 offset:2048
    v_mfma_f32_16x16x32_bf16 v[32:35], a[236:239], a[0:3], v[32:35]
    v_mfma_f32_16x16x32_bf16 v[68:71], a[236:239], a[16:19], v[68:71]
    v_mfma_f32_16x16x32_bf16 v[104:107], a[236:239], a[32:35], v[104:107]
    ds_read_b64_tr_b16 a[236:237], v252 offset:4096
    ds_read_b64_tr_b16 a[238:239], v252 offset:6144
    v_mfma_f32_16x16x32_bf16 v[36:39], a[240:243], a[0:3], v[36:39]
    s_add_u32 m0, s64, 132096
    s_add_u32 s65, s67, 46080
    buffer_load_dwordx4 v12, s[36:39], s65 offen offset:0 lds
    v_mfma_f32_16x16x32_bf16 v[72:75], a[240:243], a[16:19], v[72:75]
    v_mfma_f32_16x16x32_bf16 v[108:111], a[240:243], a[32:35], v[108:111]
    ds_read_b64_tr_b16 a[240:241], v253 offset:4096
    ds_read_b64_tr_b16 a[242:243], v253 offset:6144
    v_mfma_f32_16x16x32_bf16 v[40:43], a[244:247], a[0:3], v[40:43]
    s_add_u32 m0, s64, 136064
    s_nop 0
    buffer_load_dwordx4 v12, s[36:39], s65 offen offset:128 lds
    v_mfma_f32_16x16x32_bf16 v[76:79], a[244:247], a[16:19], v[76:79]
    v_mfma_f32_16x16x32_bf16 v[112:115], a[244:247], a[32:35], v[112:115]
    ds_read_b64_tr_b16 a[244:245], v254 offset:4096
    ds_read_b64_tr_b16 a[246:247], v254 offset:6144
    s_waitcnt lgkmcnt(15)
    v_mfma_f32_16x16x32_bf16 v[44:47], a[248:251], a[0:3], v[44:47]
    v_mfma_f32_16x16x32_bf16 v[80:83], a[248:251], a[16:19], v[80:83]
    s_add_u32 m0, s64, 140032
    s_nop 0
    buffer_load_dwordx4 v12, s[36:39], s65 offen offset:256 lds
    v_mfma_f32_16x16x32_bf16 v[116:119], a[248:251], a[32:35], v[116:119]
    ds_read_b64_tr_b16 a[248:249], v255 offset:4096
    ds_read_b64_tr_b16 a[250:251], v255 offset:6144
    s_waitcnt lgkmcnt(15)
    v_mfma_f32_16x16x32_bf16 v[48:51], a[252:255], a[0:3], v[48:51]
    v_mfma_f32_16x16x32_bf16 v[84:87], a[252:255], a[16:19], v[84:87]
    v_mfma_f32_16x16x32_bf16 v[120:123], a[252:255], a[32:35], v[120:123]
    ds_read_b64_tr_b16 a[252:253], v252 offset:8192
    ds_read_b64_tr_b16 a[254:255], v252 offset:10240
    s_waitcnt vmcnt(9)
    s_barrier
    v_cmp_eq_u32 vcc, 1, v132
    s_nop 1
    s_cmp_eq_u64 vcc, exec
    s_cbranch_scc1 L_goB
    s_mov_b32 s75, 0x200000
L_spinB:
    buffer_load_dword v132, v250, s[32:35], s58 offen offset:8 sc1
    s_waitcnt vmcnt(0)
    v_cmp_eq_u32 vcc, 1, v132
    s_nop 1
    s_cmp_eq_u64 vcc, exec
    s_cbranch_scc1 L_goB
    s_sub_u32 s75, s75, 1
    s_cmp_lg_u32 s75, 0
    s_cbranch_scc1 L_spinB
L_goB:
    s_waitcnt lgkmcnt(4)
    v_mfma_f32_16x16x32_bf16 v[16:19], a[220:223], a[96:99], v[16:19]
    s_add_u32 s74, s60, 98304
    v_add_u32 v252, s74, v1
    v_mfma_f32_16x16x32_bf16 v[52:55], a[220:223], a[112:115], v[52:55]
    v_add_u32 v253, s74, v2
    v_add_u32 v254, s74, v3
    v_add_u32 v255, s74, v4
    v_mfma_f32_16x16x32_bf16 v[88:91], a[220:223], a[128:131], v[88:91]
    ds_read_b64_tr_b16 a[220:221], v252 offset:0
    ds_read_b64_tr_b16 a[222:223], v252 offset:2048
    v_mfma_f32_16x16x32_bf16 v[20:23], a[224:227], a[96:99], v[20:23]
    s_add_u32 m0, s64, 0
    s_add_u32 s65, s68, 36864
    buffer_load_dwordx4 v12, s[36:39], s65 offen offset:0 lds
    v_mfma_f32_16x16x32_bf16 v[56:59], a[224:227], a[112:115], v[56:59]
    s_add_u32 m0, s64, 3968
    s_nop 0
    buffer_load_dwordx4 v12, s[36:39], s65 offen offset:128 lds
    v_mfma_f32_16x16x32_bf16 v[92:95], a[224:227], a[128:131], v[92:95]
    ds_read_b64_tr_b16 a[224:225], v253 offset:0
    ds_read_b64_tr_b16 a[226:227], v253 offset:2048
    v_mfma_f32_16x16x32_bf16 v[24:27], a[228:231], a[96:99], v[24:27]
    s_add_u32 m0, s64, 7936
    s_nop 0
    buffer_load_dwordx4 v12, s[36:39], s65 offen offset:256 lds
    v_mfma_f32_16x16x32_bf16 v[60:63], a[228:231], a[112:115], v[60:63]
    v_mfma_f32_16x16x32_bf16 v[96:99], a[228:231], a[128:131], v[96:99]
    ds_read_b64_tr_b16 a[228:229], v254 offset:0
    ds_read_b64_tr_b16 a[230:231], v254 offset:2048
    v_mfma_f32_16x16x32_bf16 v[28:31], a[232:235], a[96:99], v[28:31]
    s_add_u32 m0, s64, 1024
    s_add_u32 s65, s68, 46080
    buffer_load_dwordx4 v12, s[36:39], s65 offen offset:0 lds
    v_mfma_f32_16x16x32_bf16 v[64:67], a[232:235], a[112:115], v[64:67]
    s_add_u32 m0, s64, 4992
    s_nop 0
    buffer_load_dwordx4 v12, s[36:39], s65 offen offset:128 lds
    v_mfma_f32_16x16x32_bf16 v[100:103], a[232:235], a[128:131], v[100:103]
    ds_read_b64_tr_b16 a[232:233], v255 offset:0
    ds_read_b64_tr_b16 a[234:235], v255 offset:2048
    v_mfma_f32_16x16x32_bf16 v[32:35], a[236:239], a[96:99], v[32:35]
    s_add_u32 m0, s64, 8960
    s_nop 0
    buffer_load_dwordx4 v12, s[36:39], s65 offen offset:256 lds
    v_mfma_f32_16x16x32_bf16 v[68:71], a[236:239], a[112:115], v[68:71]
    v_mfma_f32_16x16x32_bf16 v[104:107], a[236:239], a[128:131], v[104:107]
    ds_read_b64_tr_b16 a[236:237], v252 offset:4096
    ds_read_b64_tr_b16 a[238:239], v252 offset:6144
    v_mfma_f32_16x16x32_bf16 v[36:39], a[240:243], a[96:99], v[36:39]
    s_add_u32 s72, s14, 0
    buffer_load_dwordx4 a[48:51], v14, s[32:35], s72 offen offset:0 sc1
    v_mfma_f32_16x16x32_bf16 v[72:75], a[240:243], a[112:115], v[72:75]
    buffer_load_dwordx4 a[64:67], v14, s[32:35], s72 offen offset:1024 sc1
    v_mfma_f32_16x16x32_bf16 v[108:111], a[240:243], a[128:131], v[108:111]
    ds_read_b64_tr_b16 a[240:241], v253 offset:4096
    ds_read_b64_tr_b16 a[242:243], v253 offset:6144
    v_mfma_f32_16x16x32_bf16 v[40:43], a[244:247], a[96:99], v[40:43]
    buffer_load_dwordx4 a[80:83], v14, s[32:35], s72 offen offset:2048 sc1
    v_mfma_f32_16x16x32_bf16 v[76:79], a[244:247], a[112:115], v[76:79]
    v_mfma_f32_16x16x32_bf16 v[112:115], a[244:247], a[128:131], v[112:115]
    ds_read_b64_tr_b16 a[244:245], v254 offset:4096
    ds_read_b64_tr_b16 a[246:247], v254 offset:6144
    s_waitcnt lgkmcnt(15)
    v_mfma_f32_16x16x32_bf16 v[44:47], a[248:251], a[96:99], v[44:47]
    s_add_u32 s72, s15, 0
    buffer_load_dwordx4 a[144:147], v14, s[32:35], s72 offen offset:0 sc1
    v_mfma_f32_16x16x32_bf16 v[80:83], a[248:251], a[112:115], v[80:83]
    buffer_load_dwordx4 a[160:163], v14, s[32:35], s72 offen offset:1024 sc1
    v_mfma_f32_16x16x32_bf16 v[116:119], a[248:251], a[128:131], v[116:119]
    ds_read_b64_tr_b16 a[248:249], v255 offset:4096
    ds_read_b64_tr_b16 a[250:251], v255 offset:6144
    s_waitcnt lgkmcnt(15)
    v_mfma_f32_16x16x32_bf16 v[48:51], a[252:255], a[96:99], v[48:51]
    buffer_load_dwordx4 a[176:179], v14, s[32:35], s72 offen offset:2048 sc1
    v_mfma_f32_16x16x32_bf16 v[84:87], a[252:255], a[112:115], v[84:87]
    v_mfma_f32_16x16x32_bf16 v[120:123], a[252:255], a[128:131], v[120:123]
    ds_read_b64_tr_b16 a[252:253], v252 offset:8192
    ds_read_b64_tr_b16 a[254:255], v252 offset:10240
    s_waitcnt lgkmcnt(4)
    s_waitcnt vmcnt(20)
    v_mfma_f32_16x16x32_bf16 v[16:19], a[220:223], v[152:155], v[16:19]
    s_add_u32 s74, s59, 32768
    v_add_u32 v252, s74, v1
    s_waitcnt vmcnt(19)
    v_mfma_f32_16x16x32_bf16 v[52:55], a[220:223], v[168:171], v[52:55]
    v_add_u32 v253, s74, v2
    v_add_u32 v254, s74, v3
    v_add_u32 v255, s74, v4
    s_waitcnt vmcnt(18)
    v_mfma_f32_16x16x32_bf16 v[88:91], a[220:223], v[184:187], v[88:91]
    ds_read_b64_tr_b16 a[220:221], v252 offset:0
    ds_read_b64_tr_b16 a[222:223], v252 offset:2048
    v_mfma_f32_16x16x32_bf16 v[20:23], a[224:227], v[152:155], v[20:23]
    s_add_u32 s72, s16, 0
    buffer_load_dwordx4 v[200:203], v14, s[32:35], s72 offen offset:0 sc1
    v_mfma_f32_16x16x32_bf16 v[56:59], a[224:227], v[168:171], v[56:59]
    v_mfma_f32_16x16x32_bf16 v[92:95], a[224:227], v[184:187], v[92:95]
    ds_read_b64_tr_b16 a[224:225], v253 offset:0
    ds_read_b64_tr_b16 a[226:227], v253 offset:2048
    v_mfma_f32_16x16x32_bf16 v[24:27], a[228:231], v[152:155], v[24:27]
    buffer_load_dwordx4 v[216:219], v14, s[32:35], s72 offen offset:1024 sc1
    v_mfma_f32_16x16x32_bf16 v[60:63], a[228:231], v[168:171], v[60:63]
    v_mfma_f32_16x16x32_bf16 v[96:99], a[228:231], v[184:187], v[96:99]
    ds_read_b64_tr_b16 a[228:229], v254 offset:0
    ds_read_b64_tr_b16 a[230:231], v254 offset:2048
    v_mfma_f32_16x16x32_bf16 v[28:31], a[232:235], v[152:155], v[28:31]
    v_mfma_f32_16x16x32_bf16 v[64:67], a[232:235], v[168:171], v[64:67]
    buffer_load_dwordx4 v[232:235], v14, s[32:35], s72 offen offset:2048 sc1
    v_mfma_f32_16x16x32_bf16 v[100:103], a[232:235], v[184:187], v[100:103]
    ds_read_b64_tr_b16 a[232:233], v255 offset:0
    ds_read_b64_tr_b16 a[234:235], v255 offset:2048
    v_mfma_f32_16x16x32_bf16 v[32:35], a[236:239], v[152:155], v[32:35]
    v_mfma_f32_16x16x32_bf16 v[68:71], a[236:239], v[168:171], v[68:71]
    v_mfma_f32_16x16x32_bf16 v[104:107], a[236:239], v[184:187], v[104:107]
    ds_read_b64_tr_b16 a[236:237], v252 offset:4096
    ds_read_b64_tr_b16 a[238:239], v252 offset:6144
    v_mfma_f32_16x16x32_bf16 v[36:39], a[240:243], v[152:155], v[36:39]
    s_add_u32 s72, s11, 3072
    buffer_load_dwordx4 a[4:7], v14, s[32:35], s72 offen offset:0 sc1
    v_mfma_f32_16x16x32_bf16 v[72:75], a[240:243], v[168:171], v[72:75]
    v_mfma_f32_16x16x32_bf16 v[108:111], a[240:243], v[184:187], v[108:111]
    ds_read_b64_tr_b16 a[240:241], v253 offset:4096
    ds_read_b64_tr_b16 a[242:243], v253 offset:6144
    v_mfma_f32_16x16x32_bf16 v[40:43], a[244:247], v[152:155], v[40:43]
    buffer_load_dwordx4 a[20:23], v14, s[32:35], s72 offen offset:1024 sc1
    v_mfma_f32_16x16x32_bf16 v[76:79], a[244:247], v[168:171], v[76:79]
    v_mfma_f32_16x16x32_bf16 v[112:115], a[244:247], v[184:187], v[112:115]
    ds_read_b64_tr_b16 a[244:245], v254 offset:4096
    ds_read_b64_tr_b16 a[246:247], v254 offset:6144
    s_waitcnt lgkmcnt(15)
    v_mfma_f32_16x16x32_bf16 v[44:47], a[248:251], v[152:155], v[44:47]
    v_mfma_f32_16x16x32_bf16 v[80:83], a[248:251], v[168:171], v[80:83]
    buffer_load_dwordx4 a[36:39], v14, s[32:35], s72 offen offset:2048 sc1
    v_mfma_f32_16x16x32_bf16 v[116:119], a[248:251], v[184:187], v[116:119]
    ds_read_b64_tr_b16 a[248:249], v255 offset:4096
    ds_read_b64_tr_b16 a[250:251], v255 offset:6144
    s_waitcnt lgkmcnt(15)
    v_mfma_f32_16x16x32_bf16 v[48:51], a[252:255], v[152:155], v[48:51]
    v_mfma_f32_16x16x32_bf16 v[84:87], a[252:255], v[168:171], v[84:87]
    v_mfma_f32_16x16x32_bf16 v[120:123], a[252:255], v[184:187], v[120:123]
    ds_read_b64_tr_b16 a[252:253], v252 offset:8192
    ds_read_b64_tr_b16 a[254:255], v252 offset:10240
    s_waitcnt lgkmcnt(4)
    s_waitcnt vmcnt(11)
    v_mfma_f32_16x16x32_bf16 v[16:19], a[220:223], a[48:51], v[16:19]
    s_add_u32 s74, s59, 65536
    v_add_u32 v252, s74, v1
    s_waitcnt vmcnt(10)
    v_mfma_f32_16x16x32_bf16 v[52:55], a[220:223], a[64:67], v[52:55]
    v_add_u32 v253, s74, v2
    v_add_u32 v254, s74, v3
    v_add_u32 v255, s74, v4
    s_waitcnt vmcnt(9)
    v_mfma_f32_16x16x32_bf16 v[88:91], a[220:223], a[80:83], v[88:91]
    ds_read_b64_tr_b16 a[220:221], v252 offset:0
    ds_read_b64_tr_b16 a[222:223], v252 offset:2048
    v_mfma_f32_16x16x32_bf16 v[20:23], a[224:227], a[48:51], v[20:23]
    s_add_u32 s72, s14, 3072
    buffer_load_dwordx4 a[52:55], v14, s[32:35], s72 offen offset:0 sc1
    v_mfma_f32_16x16x32_bf16 v[56:59], a[224:227], a[64:67], v[56:59]
    v_mfma_f32_16x16x32_bf16 v[92:95], a[224:227], a[80:83], v[92:95]
    ds_read_b64_tr_b16 a[224:225], v253 offset:0
    ds_read_b64_tr_b16 a[226:227], v253 offset:2048
    v_mfma_f32_16x16x32_bf16 v[24:27], a[228:231], a[48:51], v[24:27]
    v_mfma_f32_16x16x32_bf16 v[60:63], a[228:231], a[64:67], v[60:63]
    v_mfma_f32_16x16x32_bf16 v[96:99], a[228:231], a[80:83], v[96:99]
    ds_read_b64_tr_b16 a[228:229], v254 offset:0
    ds_read_b64_tr_b16 a[230:231], v254 offset:2048
    v_mfma_f32_16x16x32_bf16 v[28:31], a[232:235], a[48:51], v[28:31]
    v_mfma_f32_16x16x32_bf16 v[64:67], a[232:235], a[64:67], v[64:67]
    buffer_load_dwordx4 a[68:71], v14, s[32:35], s72 offen offset:1024 sc1
    v_mfma_f32_16x16x32_bf16 v[100:103], a[232:235], a[80:83], v[100:103]
    ds_read_b64_tr_b16 a[232:233], v255 offset:0
    ds_read_b64_tr_b16 a[234:235], v255 offset:2048
    v_mfma_f32_16x16x32_bf16 v[32:35], a[236:239], a[48:51], v[32:35]
    v_mfma_f32_16x16x32_bf16 v[68:71], a[236:239], a[64:67], v[68:71]
    v_mfma_f32_16x16x32_bf16 v[104:107], a[236:239], a[80:83], v[104:107]
    ds_read_b64_tr_b16 a[236:237], v252 offset:4096
    ds_read_b64_tr_b16 a[238:239], v252 offset:6144
    v_mfma_f32_16x16x32_bf16 v[36:39], a[240:243], a[48:51], v[36:39]
    v_mfma_f32_16x16x32_bf16 v[72:75], a[240:243], a[64:67], v[72:75]
    v_mfma_f32_16x16x32_bf16 v[108:111], a[240:243], a[80:83], v[108:111]
    ds_read_b64_tr_b16 a[240:241], v253 offset:4096
    ds_read_b64_tr_b16 a[242:243], v253 offset:6144
    v_mfma_f32_16x16x32_bf16 v[40:43], a[244:247], a[48:51], v[40:43]
    buffer_load_dwordx4 a[84:87], v14, s[32:35], s72 offen offset:2048 sc1
    v_mfma_f32_16x16x32_bf16 v[76:79], a[244:247], a[64:67], v[76:79]
    v_mfma_f32_16x16x32_bf16 v[112:115], a[244:247], a[80:83], v[112:115]
    ds_read_b64_tr_b16 a[244:245], v254 offset:4096
    ds_read_b64_tr_b16 a[246:247], v254 offset:6144
    s_waitcnt lgkmcnt(15)
    v_mfma_f32_16x16x32_bf16 v[44:47], a[248:251], a[48:51], v[44:47]
    v_mfma_f32_16x16x32_bf16 v[80:83], a[248:251], a[64:67], v[80:83]
    v_mfma_f32_16x16x32_bf16 v[116:119], a[248:251], a[80:83], v[116:119]
    ds_read_b64_tr_b16 a[248:249], v255 offset:4096
    ds_read_b64_tr_b16 a[250:251], v255 offset:6144
    s_waitcnt lgkmcnt(15)
    v_mfma_f32_16x16x32_bf16 v[48:51], a[252:255], a[48:51], v[48:51]
    v_mfma_f32_16x16x32_bf16 v[84:87], a[252:255], a[64:67], v[84:87]
    v_mfma_f32_16x16x32_bf16 v[120:123], a[252:255], a[80:83], v[120:123]
    ds_read_b64_tr_b16 a[252:253], v252 offset:8192
    ds_read_b64_tr_b16 a[254:255], v252 offset:10240
    s_barrier
    s_waitcnt lgkmcnt(4)
    s_waitcnt vmcnt(11)
    v_mfma_f32_16x16x32_bf16 v[16:19], a[220:223], a[144:147], v[16:19]
    s_add_u32 s74, s59, 98304
    v_add_u32 v252, s74, v1
    s_waitcnt vmcnt(10)
    v_mfma_f32_16x16x32_bf16 v[52:55], a[220:223], a[160:163], v[52:55]
    v_add_u32 v253, s74, v2
    v_add_u32 v254, s74, v3
    v_add_u32 v255, s74, v4
    s_waitcnt vmcnt(9)
    v_mfma_f32_16x16x32_bf16 v[88:91], a[220:223], a[176:179], v[88:91]
    ds_read_b64_tr_b16 a[220:221], v252 offset:0
    ds_read_b64_tr_b16 a[222:223], v252 offset:2048
    v_mfma_f32_16x16x32_bf16 v[20:23], a[224:227], a[144:147], v[20:23]
    s_add_u32 m0, s64, 32768
    s_add_u32 s65, s69, 36864
    buffer_load_dwordx4 v12, s[36:39], s65 offen offset:0 lds
    v_mfma_f32_16x16x32_bf16 v[56:59], a[224:227], a[160:163], v[56:59]
    v_mfma_f32_16x16x32_bf16 v[92:95], a[224:227], a[176:179], v[92:95]
    ds_read_b64_tr_b16 a[224:225], v253 offset:0
    ds_read_b64_tr_b16 a[226:227], v253 offset:2048
    v_mfma_f32_16x16x32_bf16 v[24:27], a[228:231], a[144:147], v[24:27]
    s_add_u32 m0, s64, 36736
    s_nop 0
    buffer_load_dwordx4 v12, s[36:39], s65 offen offset:128 lds
    v_mfma_f32_16x16x32_bf16 v[60:63], a[228:231], a[160:163], v[60:63]
    v_mfma_f32_16x16x32_bf16 v[96:99], a[228:231], a[176:179], v[96:99]
    ds_read_b64_tr_b16 a[228:229], v254 offset:0
    ds_read_b64_tr_b16 a[230:231], v254 offset:2048
    v_mfma_f32_16x16x32_bf16 v[28:31], a[232:235], a[144:147], v[28:31]
    s_add_u32 m0, s64, 40704
    s_nop 0
    buffer_load_dwordx4 v12, s[36:39], s65 offen offset:256 lds
    v_mfma_f32_16x16x32_bf16 v[64:67], a[232:235], a[160:163], v[64:67]
    s_add_u32 m0, s64, 33792
    s_add_u32 s65, s69, 46080
    buffer_load_dwordx4 v12, s[36:39], s65 offen offset:0 lds
    v_mfma_f32_16x16x32_bf16 v[100:103], a[232:235], a[176:179], v[100:103]
    ds_read_b64_tr_b16 a[232:233], v255 offset:0
    ds_read_b64_tr_b16 a[234:235], v255 offset:2048
    v_mfma_f32_16x16x32_bf16 v[32:35], a[236:239], a[144:147], v[32:35]
    v_mfma_f32_16x16x32_bf16 v[68:71], a[236:239], a[160:163], v[68:71]
    s_add_u32 m0, s64, 37760
    s_nop 0
    buffer_load_dwordx4 v12, s[36:39], s65 offen offset:128 lds
    v_mfma_f32_16x16x32_bf16 v[104:107], a[236:239], a[176:179], v[104:107]
    ds_read_b64_tr_b16 a[236:237], v252 offset:4096
    ds_read_b64_tr_b16 a[238:239], v252 offset:6144
    v_mfma_f32_16x16x32_bf16 v[36:39], a[240:243], a[144:147], v[36:39]
    s_add_u32 m0, s64, 41728
    s_nop 0
    buffer_load_dwordx4 v12, s[36:39], s65 offen offset:256 lds
    v_mfma_f32_16x16x32_bf16 v[72:75], a[240:243], a[160:163], v[72:75]
    v_mfma_f32_16x16x32_bf16 v[108:111], a[240:243], a[176:179], v[108:111]
    ds_read_b64_tr_b16 a[240:241], v253 offset:4096
    ds_read_b64_tr_b16 a[242:243], v253 offset:6144
    v_mfma_f32_16x16x32_bf16 v[40:43], a[244:247], a[144:147], v[40:43]
    s_add_u32 s72, s12, 3072
    buffer_load_dwordx4 a[100:103], v14, s[32:35], s72 offen offset:0 sc1
    v_mfma_f32_16x16x32_bf16 v[76:79], a[244:247], a[160:163], v[76:79]
    v_mfma_f32_16x16x32_bf16 v[112:115], a[244:247], a[176:179], v[112:115]
    ds_read_b64_tr_b16 a[244:245], v254 offset:4096
    ds_read_b64_tr_b16 a[246:247], v254 offset:6144
    s_waitcnt lgkmcnt(15)
    v_mfma_f32_16x16x32_bf16 v[44:47], a[248:251], a[144:147], v[44:47]
    buffer_load_dwordx4 a[116:119], v14, s[32:35], s72 offen offset:1024 sc1
    v_mfma_f32_16x16x32_bf16 v[80:83], a[248:251], a[160:163], v[80:83]
    v_mfma_f32_16x16x32_bf16 v[116:119], a[248:251], a[176:179], v[116:119]
    ds_read_b64_tr_b16 a[248:249], v255 offset:4096
    ds_read_b64_tr_b16 a[250:251], v255 offset:6144
    s_waitcnt lgkmcnt(15)
    v_mfma_f32_16x16x32_bf16 v[48:51], a[252:255], a[144:147], v[48:51]
    buffer_load_dwordx4 a[132:135], v14, s[32:35], s72 offen offset:2048 sc1
    v_mfma_f32_16x16x32_bf16 v[84:87], a[252:255], a[160:163], v[84:87]
    v_mfma_f32_16x16x32_bf16 v[120:123], a[252:255], a[176:179], v[120:123]
    ds_read_b64_tr_b16 a[252:253], v252 offset:8192
    ds_read_b64_tr_b16 a[254:255], v252 offset:10240
    s_barrier
    s_waitcnt lgkmcnt(4)
    s_waitcnt vmcnt(17)
    v_mfma_f32_16x16x32_bf16 v[16:19], a[220:223], v[200:203], v[16:19]
    s_add_u32 s74, s60, 131072
    v_add_u32 v252, s74, v1
    s_waitcnt vmcnt(16)
    v_mfma_f32_16x16x32_bf16 v[52:55], a[220:223], v[216:219], v[52:55]
    v_add_u32 v253, s74, v2
    v_add_u32 v254, s74, v3
    v_add_u32 v255, s74, v4
    s_waitcnt vmcnt(15)
    v_mfma_f32_16x16x32_bf16 v[88:91], a[220:223], v[232:235], v[88:91]
    ds_read_b64_tr_b16 a[220:221], v252 offset:0
    ds_read_b64_tr_b16 a[222:223], v252 offset:2048
    v_mfma_f32_16x16x32_bf16 v[20:23], a[224:227], v[200:203], v[20:23]
    s_add_u32 m0, s64, 65536
    s_add_u32 s65, s67, 73728
    buffer_load_dwordx4 v12, s[36:39], s65 offen offset:0 lds
    v_mfma_f32_16x16x32_bf16 v[56:59], a[224:227], v[216:219], v[56:59]
    v_mfma_f32_16x16x32_bf16 v[92:95], a[224:227], v[232:235], v[92:95]
    ds_read_b64_tr_b16 a[224:225], v253 offset:0
    ds_read_b64_tr_b16 a[226:227], v253 offset:2048
    v_mfma_f32_16x16x32_bf16 v[24:27], a[228:231], v[200:203], v[24:27]
    s_add_u32 m0, s64, 69504
    s_nop 0
    buffer_load_dwordx4 v12, s[36:39], s65 offen offset:128 lds
    v_mfma_f32_16x16x32_bf16 v[60:63], a[228:231], v[216:219], v[60:63]
    v_mfma_f32_16x16x32_bf16 v[96:99], a[228:231], v[232:235], v[96:99]
    ds_read_b64_tr_b16 a[228:229], v254 offset:0
    ds_read_b64_tr_b16 a[230:231], v254 offset:2048
    v_mfma_f32_16x16x32_bf16 v[28:31], a[232:235], v[200:203], v[28:31]
    s_add_u32 m0, s64, 73472
    s_nop 0
    buffer_load_dwordx4 v12, s[36:39], s65 offen offset:256 lds
    v_mfma_f32_16x16x32_bf16 v[64:67], a[232:235], v[216:219], v[64:67]
    s_add_u32 m0, s64, 66560
    s_add_u32 s65, s67, 82944
    buffer_load_dwordx4 v12, s[36:39], s65 offen offset:0 lds
    v_mfma_f32_16x16x32_bf16 v[100:103], a[232:235], v[232:235], v[100:103]
    ds_read_b64_tr_b16 a[232:233], v255 offset:0
    ds_read_b64_tr_b16 a[234:235], v255 offset:2048
    v_mfma_f32_16x16x32_bf16 v[32:35], a[236:239], v[200:203], v[32:35]
    v_mfma_f32_16x16x32_bf16 v[68:71], a[236:239], v[216:219], v[68:71]
    s_add_u32 m0, s64, 70528
    s_nop 0
    buffer_load_dwordx4 v12, s[36:39], s65 offen offset:128 lds
    v_mfma_f32_16x16x32_bf16 v[104:107], a[236:239], v[232:235], v[104:107]
    ds_read_b64_tr_b16 a[236:237], v252 offset:4096
    ds_read_b64_tr_b16 a[238:239], v252 offset:6144
    v_mfma_f32_16x16x32_bf16 v[36:39], a[240:243], v[200:203], v[36:39]
    s_add_u32 m0, s64, 74496
    s_nop 0
    buffer_load_dwordx4 v12, s[36:39], s65 offen offset:256 lds
    v_mfma_f32_16x16x32_bf16 v[72:75], a[240:243], v[216:219], v[72:75]
    v_mfma_f32_16x16x32_bf16 v[108:111], a[240:243], v[232:235], v[108:111]
    ds_read_b64_tr_b16 a[240:241], v253 offset:4096
    ds_read_b64_tr_b16 a[242:243], v253 offset:6144
    v_mfma_f32_16x16x32_bf16 v[40:43], a[244:247], v[200:203], v[40:43]
    s_add_u32 s72, s15, 3072
    buffer_load_dwordx4 a[148:151], v14, s[32:35], s72 offen offset:0 sc1
    v_mfma_f32_16x16x32_bf16 v[76:79], a[244:247], v[216:219], v[76:79]
    v_mfma_f32_16x16x32_bf16 v[112:115], a[244:247], v[232:235], v[112:115]
    ds_read_b64_tr_b16 a[244:245], v254 offset:4096
    ds_read_b64_tr_b16 a[246:247], v254 offset:6144
    s_waitcnt lgkmcnt(15)
    v_mfma_f32_16x16x32_bf16 v[44:47], a[248:251], v[200:203], v[44:47]
    buffer_load_dwordx4 a[164:167], v14, s[32:35], s72 offen offset:1024 sc1
    v_mfma_f32_16x16x32_bf16 v[80:83], a[248:251], v[216:219], v[80:83]
    v_mfma_f32_16x16x32_bf16 v[116:119], a[248:251], v[232:235], v[116:119]
    ds_read_b64_tr_b16 a[248:249], v255 offset:4096
    ds_read_b64_tr_b16 a[250:251], v255 offset:6144
    s_waitcnt lgkmcnt(15)
    v_mfma_f32_16x16x32_bf16 v[48:51], a[252:255], v[200:203], v[48:51]
    buffer_load_dwordx4 a[180:183], v14, s[32:35], s72 offen offset:2048 sc1
    v_mfma_f32_16x16x32_bf16 v[84:87], a[252:255], v[216:219], v[84:87]
    v_mfma_f32_16x16x32_bf16 v[120:123], a[252:255], v[232:235], v[120:123]
    ds_read_b64_tr_b16 a[252:253], v252 offset:8192
    ds_read_b64_tr_b16 a[254:255], v252 offset:10240
    s_barrier
    s_waitcnt lgkmcnt(4)
    s_waitcnt vmcnt(23)
    v_mfma_f32_16x16x32_bf16 v[16:19], a[220:223], a[4:7], v[16:19]
    s_add_u32 s74, s59, 131072
    v_add_u32 v252, s74, v1
    s_waitcnt vmcnt(22)
    v_mfma_f32_16x16x32_bf16 v[52:55], a[220:223], a[20:23], v[52:55]
    v_add_u32 v253, s74, v2
    v_add_u32 v254, s74, v3
    v_add_u32 v255, s74, v4
    s_waitcnt vmcnt(21)
    v_mfma_f32_16x16x32_bf16 v[88:91], a[220:223], a[36:39], v[88:91]
    ds_read_b64_tr_b16 a[220:221], v252 offset:0
    ds_read_b64_tr_b16 a[222:223], v252 offset:2048
    v_mfma_f32_16x16x32_bf16 v[20:23], a[224:227], a[4:7], v[20:23]
    s_add_u32 m0, s64, 98304
    s_add_u32 s65, s68, 73728
    buffer_load_dwordx4 v12, s[36:39], s65 offen offset:0 lds
    v_mfma_f32_16x16x32_bf16 v[56:59], a[224:227], a[20:23], v[56:59]
    v_mfma_f32_16x16x32_bf16 v[92:95], a[224:227], a[36:39], v[92:95]
    ds_read_b64_tr_b16 a[224:225], v253 offset:0
    ds_read_b64_tr_b16 a[226:227], v253 offset:2048
    v_mfma_f32_16x16x32_bf16 v[24:27], a[228:231], a[4:7], v[24:27]
    s_add_u32 m0, s64, 102272
    s_nop 0
    buffer_load_dwordx4 v12, s[36:39], s65 offen offset:128 lds
    v_mfma_f32_16x16x32_bf16 v[60:63], a[228:231], a[20:23], v[60:63]
    v_mfma_f32_16x16x32_bf16 v[96:99], a[228:231], a[36:39], v[96:99]
    ds_read_b64_tr_b16 a[228:229], v254 offset:0
    ds_read_b64_tr_b16 a[230:231], v254 offset:2048
    v_mfma_f32_16x16x32_bf16 v[28:31], a[232:235], a[4:7], v[28:31]
    s_add_u32 m0, s64, 106240
    s_nop 0
    buffer_load_dwordx4 v12, s[36:39], s65 offen offset:256 lds
    v_mfma_f32_16x16x32_bf16 v[64:67], a[232:235], a[20:23], v[64:67]
    s_add_u32 m0, s64, 99328
    s_add_u32 s65, s68, 82944
    buffer_load_dwordx4 v12, s[36:39], s65 offen offset:0 lds
    v_mfma_f32_16x16x32_bf16 v[100:103], a[232:235], a[36:39], v[100:103]
    ds_read_b64_tr_b16 a[232:233], v255 offset:0
    ds_read_b64_tr_b16 a[234:235], v255 offset:2048
    v_mfma_f32_16x16x32_bf16 v[32:35], a[236:239], a[4:7], v[32:35]
    v_mfma_f32_16x16x32_bf16 v[68:71], a[236:239], a[20:23], v[68:71]
    s_add_u32 m0, s64, 103296
    s_nop 0
    buffer_load_dwordx4 v12, s[36:39], s65 offen offset:128 lds
    v_mfma_f32_16x16x32_bf16 v[104:107], a[236:239], a[36:39], v[104:107]
    ds_read_b64_tr_b16 a[236:237], v252 offset:4096
    ds_read_b64_tr_b16 a[238:239], v252 offset:6144
    v_mfma_f32_16x16x32_bf16 v[36:39], a[240:243], a[4:7], v[36:39]
    s_add_u32 m0, s64, 107264
    s_nop 0
    buffer_load_dwordx4 v12, s[36:39], s65 offen offset:256 lds
    v_mfma_f32_16x16x32_bf16 v[72:75], a[240:243], a[20:23], v[72:75]
    v_mfma_f32_16x16x32_bf16 v[108:111], a[240:243], a[36:39], v[108:111]
    ds_read_b64_tr_b16 a[240:241], v253 offset:4096
    ds_read_b64_tr_b16 a[242:243], v253 offset:6144
    v_mfma_f32_16x16x32_bf16 v[40:43], a[244:247], a[4:7], v[40:43]
    s_add_u32 s72, s13, 3072
    buffer_load_dwordx4 v[156:159], v14, s[32:35], s72 offen offset:0 sc1
    v_mfma_f32_16x16x32_bf16 v[76:79], a[244:247], a[20:23], v[76:79]
    v_mfma_f32_16x16x32_bf16 v[112:115], a[244:247], a[36:39], v[112:115]
    ds_read_b64_tr_b16 a[244:245], v254 offset:4096
    ds_read_b64_tr_b16 a[246:247], v254 offset:6144
    s_waitcnt lgkmcnt(15)
    v_mfma_f32_16x16x32_bf16 v[44:47], a[248:251], a[4:7], v[44:47]
    buffer_load_dwordx4 v[172:175], v14, s[32:35], s72 offen offset:1024 sc1
    v_mfma_f32_16x16x32_bf16 v[80:83], a[248:251], a[20:23], v[80:83]
    v_mfma_f32_16x16x32_bf16 v[116:119], a[248:251], a[36:39], v[116:119]
    ds_read_b64_tr_b16 a[248:249], v255 offset:4096
    ds_read_b64_tr_b16 a[250:251], v255 offset:6144
    s_waitcnt lgkmcnt(15)
    v_mfma_f32_16x16x32_bf16 v[48:51], a[252:255], a[4:7], v[48:51]
    buffer_load_dwordx4 v[188:191], v14, s[32:35], s72 offen offset:2048 sc1
    v_mfma_f32_16x16x32_bf16 v[84:87], a[252:255], a[20:23], v[84:87]
    v_mfma_f32_16x16x32_bf16 v[120:123], a[252:255], a[36:39], v[120:123]
    ds_read_b64_tr_b16 a[252:253], v252 offset:8192
    ds_read_b64_tr_b16 a[254:255], v252 offset:10240
    s_barrier
    s_waitcnt lgkmcnt(4)
    s_waitcnt vmcnt(29)
    v_mfma_f32_16x16x32_bf16 v[16:19], a[220:223], a[52:55], v[16:19]
    s_add_u32 s74, s60, 0
    v_add_u32 v252, s74, v1
    s_waitcnt vmcnt(28)
    v_mfma_f32_16x16x32_bf16 v[52:55], a[220:223], a[68:71], v[52:55]
    v_add_u32 v253, s74, v2
    v_add_u32 v254, s74, v3
    v_add_u32 v255, s74, v4
    s_waitcnt vmcnt(27)
    v_mfma_f32_16x16x32_bf16 v[88:91], a[220:223], a[84:87], v[88:91]
    ds_read_b64_tr_b16 a[220:221], v252 offset:0
    ds_read_b64_tr_b16 a[222:223], v252 offset:2048
    v_mfma_f32_16x16x32_bf16 v[20:23], a[224:227], a[52:55], v[20:23]
    s_add_u32 s72, s16, 3072
    buffer_load_dwordx4 v[204:207], v14, s[32:35], s72 offen offset:0 sc1
    v_mfma_f32_16x16x32_bf16 v[56:59], a[224:227], a[68:71], v[56:59]
    v_mfma_f32_16x16x32_bf16 v[92:95], a[224:227], a[84:87], v[92:95]
    ds_read_b64_tr_b16 a[224:225], v253 offset:0
    ds_read_b64_tr_b16 a[226:227], v253 offset:2048
    v_mfma_f32_16x16x32_bf16 v[24:27], a[228:231], a[52:55], v[24:27]
    v_mfma_f32_16x16x32_bf16 v[60:63], a[228:231], a[68:71], v[60:63]
    v_mfma_f32_16x16x32_bf16 v[96:99], a[228:231], a[84:87], v[96:99]
    ds_read_b64_tr_b16 a[228:229], v254 offset:0
    ds_read_b64_tr_b16 a[230:231], v254 offset:2048
    v_mfma_f32_16x16x32_bf16 v[28:31], a[232:235], a[52:55], v[28:31]
    v_mfma_f32_16x16x32_bf16 v[64:67], a[232:235], a[68:71], v[64:67]
    buffer_load_dwordx4 v[220:223], v14, s[32:35], s72 offen offset:1024 sc1
    v_mfma_f32_16x16x32_bf16 v[100:103], a[232:235], a[84:87], v[100:103]
    ds_read_b64_tr_b16 a[232:233], v255 offset:0
    ds_read_b64_tr_b16 a[234:235], v255 offset:2048
    v_mfma_f32_16x16x32_bf16 v[32:35], a[236:239], a[52:55], v[32:35]
    v_mfma_f32_16x16x32_bf16 v[68:71], a[236:239], a[68:71], v[68:71]
    v_mfma_f32_16x16x32_bf16 v[104:107], a[236:239], a[84:87], v[104:107]
    ds_read_b64_tr_b16 a[236:237], v252 offset:4096
    ds_read_b64_tr_b16 a[238:239], v252 offset:6144
    v_mfma_f32_16x16x32_bf16 v[36:39], a[240:243], a[52:55], v[36:39]
    v_mfma_f32_16x16x32_bf16 v[72:75], a[240:243], a[68:71], v[72:75]
    v_mfma_f32_16x16x32_bf16 v[108:111], a[240:243], a[84:87], v[108:111]
    ds_read_b64_tr_b16 a[240:241], v253 offset:4096
    ds_read_b64_tr_b16 a[242:243], v253 offset:6144
    v_mfma_f32_16x16x32_bf16 v[40:43], a[244:247], a[52:55], v[40:43]
    buffer_load_dwordx4 v[236:239], v14, s[32:35], s72 offen offset:2048 sc1
    v_mfma_f32_16x16x32_bf16 v[76:79], a[244:247], a[68:71], v[76:79]
    v_mfma_f32_16x16x32_bf16 v[112:115], a[244:247], a[84:87], v[112:115]
    ds_read_b64_tr_b16 a[244:245], v254 offset:4096
    ds_read_b64_tr_b16 a[246:247], v254 offset:6144
    s_waitcnt lgkmcnt(15)
    v_mfma_f32_16x16x32_bf16 v[44:47], a[248:251], a[52:55], v[44:47]
    v_mfma_f32_16x16x32_bf16 v[80:83], a[248:251], a[68:71], v[80:83]
    v_mfma_f32_16x16x32_bf16 v[116:119], a[248:251], a[84:87], v[116:119]
    ds_read_b64_tr_b16 a[248:249], v255 offset:4096
    ds_read_b64_tr_b16 a[250:251], v255 offset:6144
    s_waitcnt lgkmcnt(15)
    v_mfma_f32_16x16x32_bf16 v[48:51], a[252:255], a[52:55], v[48:51]
    v_mfma_f32_16x16x32_bf16 v[84:87], a[252:255], a[68:71], v[84:87]
    v_mfma_f32_16x16x32_bf16 v[120:123], a[252:255], a[84:87], v[120:123]
    ds_read_b64_tr_b16 a[252:253], v252 offset:8192
    ds_read_b64_tr_b16 a[254:255], v252 offset:10240
    s_waitcnt lgkmcnt(4)
    s_waitcnt vmcnt(23)
    v_mfma_f32_16x16x32_bf16 v[16:19], a[220:223], a[100:103], v[16:19]
    s_add_u32 s74, s59, 0
    v_add_u32 v252, s74, v1
    s_waitcnt vmcnt(22)
    v_mfma_f32_16x16x32_bf16 v[52:55], a[220:223], a[116:119], v[52:55]
    v_add_u32 v253, s74, v2
    v_add_u32 v254, s74, v3
    v_add_u32 v255, s74, v4
    s_waitcnt vmcnt(21)
    v_mfma_f32_16x16x32_bf16 v[88:91], a[220:223], a[132:135], v[88:91]
    ds_read_b64_tr_b16 a[220:221], v252 offset:0
    ds_read_b64_tr_b16 a[222:223], v252 offset:2048
    v_mfma_f32_16x16x32_bf16 v[20:23], a[224:227], a[100:103], v[20:23]
    s_add_u32 s72, s11, 6144
    buffer_load_dwordx4 a[8:11], v14, s[32:35], s72 offen offset:0 sc1
    v_mfma_f32_16x16x32_bf16 v[56:59], a[224:227], a[116:119], v[56:59]
    v_mfma_f32_16x16x32_bf16 v[92:95], a[224:227], a[132:135], v[92:95]
    ds_read_b64_tr_b16 a[224:225], v253 offset:0
    ds_read_b64_tr_b16 a[226:227], v253 offset:2048
    v_mfma_f32_16x16x32_bf16 v[24:27], a[228:231], a[100:103], v[24:27]
    v_mfma_f32_16x16x32_bf16 v[60:63], a[228:231], a[116:119], v[60:63]
    v_mfma_f32_16x16x32_bf16 v[96:99], a[228:231], a[132:135], v[96:99]
    ds_read_b64_tr_b16 a[228:229], v254 offset:0
    ds_read_b64_tr_b16 a[230:231], v254 offset:2048
    v_mfma_f32_16x16x32_bf16 v[28:31], a[232:235], a[100:103], v[28:31]
    v_mfma_f32_16x16x32_bf16 v[64:67], a[232:235], a[116:119], v[64:67]
    buffer_load_dwordx4 a[24:27], v14, s[32:35], s72 offen offset:1024 sc1
    v_mfma_f32_16x16x32_bf16 v[100:103], a[232:235], a[132:135], v[100:103]
    ds_read_b64_tr_b16 a[232:233], v255 offset:0
    ds_read_b64_tr_b16 a[234:235], v255 offset:2048
    v_mfma_f32_16x16x32_bf16 v[32:35], a[236:239], a[100:103], v[32:35]
    v_mfma_f32_16x16x32_bf16 v[68:71], a[236:239], a[116:119], v[68:71]
    v_mfma_f32_16x16x32_bf16 v[104:107], a[236:239], a[132:135], v[104:107]
    ds_read_b64_tr_b16 a[236:237], v252 offset:4096
    ds_read_b64_tr_b16 a[238:239], v252 offset:6144
    v_mfma_f32_16x16x32_bf16 v[36:39], a[240:243], a[100:103], v[36:39]
    v_mfma_f32_16x16x32_bf16 v[72:75], a[240:243], a[116:119], v[72:75]
    v_mfma_f32_16x16x32_bf16 v[108:111], a[240:243], a[132:135], v[108:111]
    ds_read_b64_tr_b16 a[240:241], v253 offset:4096
    ds_read_b64_tr_b16 a[242:243], v253 offset:6144
    v_mfma_f32_16x16x32_bf16 v[40:43], a[244:247], a[100:103], v[40:43]
    buffer_load_dwordx4 a[40:43], v14, s[32:35], s72 offen offset:2048 sc1
    v_mfma_f32_16x16x32_bf16 v[76:79], a[244:247], a[116:119], v[76:79]
    v_mfma_f32_16x16x32_bf16 v[112:115], a[244:247], a[132:135], v[112:115]
    ds_read_b64_tr_b16 a[244:245], v254 offset:4096
    ds_read_b64_tr_b16 a[246:247], v254 offset:6144
    s_waitcnt lgkmcnt(15)
    v_mfma_f32_16x16x32_bf16 v[44:47], a[248:251], a[100:103], v[44:47]
    v_mfma_f32_16x16x32_bf16 v[80:83], a[248:251], a[116:119], v[80:83]
    v_mfma_f32_16x16x32_bf16 v[116:119], a[248:251], a[132:135], v[116:119]
    ds_read_b64_tr_b16 a[248:249], v255 offset:4096
    ds_read_b64_tr_b16 a[250:251], v255 offset:6144
    s_waitcnt lgkmcnt(15)
    v_mfma_f32_16x16x32_bf16 v[48:51], a[252:255], a[100:103], v[48:51]
    v_mfma_f32_16x16x32_bf16 v[84:87], a[252:255], a[116:119], v[84:87]
    v_mfma_f32_16x16x32_bf16 v[120:123], a[252:255], a[132:135], v[120:123]
    ds_read_b64_tr_b16 a[252:253], v252 offset:8192
    ds_read_b64_tr_b16 a[254:255], v252 offset:10240
    s_barrier
    s_waitcnt lgkmcnt(4)
    s_waitcnt vmcnt(17)
    v_mfma_f32_16x16x32_bf16 v[16:19], a[220:223], a[148:151], v[16:19]
    s_add_u32 s74, s60, 32768
    v_add_u32 v252, s74, v1
    s_waitcnt vmcnt(16)
    v_mfma_f32_16x16x32_bf16 v[52:55], a[220:223], a[164:167], v[52:55]
    v_add_u32 v253, s74, v2
    v_add_u32 v254, s74, v3
    v_add_u32 v255, s74, v4
    s_waitcnt vmcnt(15)
    v_mfma_f32_16x16x32_bf16 v[88:91], a[220:223], a[180:183], v[88:91]
    ds_read_b64_tr_b16 a[220:221], v252 offset:0
    ds_read_b64_tr_b16 a[222:223], v252 offset:2048
    v_mfma_f32_16x16x32_bf16 v[20:23], a[224:227], a[148:151], v[20:23]
    s_add_u32 m0, s64, 131072
    s_add_u32 s65, s69, 73728
    buffer_load_dwordx4 v12, s[36:39], s65 offen offset:0 lds
    v_mfma_f32_16x16x32_bf16 v[56:59], a[224:227], a[164:167], v[56:59]
    v_mfma_f32_16x16x32_bf16 v[92:95], a[224:227], a[180:183], v[92:95]
    ds_read_b64_tr_b16 a[224:225], v253 offset:0
    ds_read_b64_tr_b16 a[226:227], v253 offset:2048
    v_mfma_f32_16x16x32_bf16 v[24:27], a[228:231], a[148:151], v[24:27]
    s_add_u32 m0, s64, 135040
    s_nop 0
    buffer_load_dwordx4 v12, s[36:39], s65 offen offset:128 lds
    v_mfma_f32_16x16x32_bf16 v[60:63], a[228:231], a[164:167], v[60:63]
    v_mfma_f32_16x16x32_bf16 v[96:99], a[228:231], a[180:183], v[96:99]
    ds_read_b64_tr_b16 a[228:229], v254 offset:0
    ds_read_b64_tr_b16 a[230:231], v254 offset:2048
    v_mfma_f32_16x16x32_bf16 v[28:31], a[232:235], a[148:151], v[28:31]
    v_mfma_f32_16x16x32_bf16 v[64:67], a[232:235], a[164:167], v[64:67]
    s_add_u32 m0, s64, 139008
    s_nop 0
    buffer_load_dwordx4 v12, s[36:39], s65 offen offset:256 lds
    v_mfma_f32_16x16x32_bf16 v[100:103], a[232:235], a[180:183], v[100:103]
    ds_read_b64_tr_b16 a[232:233], v255 offset:0
    ds_read_b64_tr_b16 a[234:235], v255 offset:2048
    v_mfma_f32_16x16x32_bf16 v[32:35], a[236:239], a[148:151], v[32:35]
    v_mfma_f32_16x16x32_bf16 v[68:71], a[236:239], a[164:167], v[68:71]
    v_mfma_f32_16x16x32_bf16 v[104:107], a[236:239], a[180:183], v[104:107]
    ds_read_b64_tr_b16 a[236:237], v252 offset:4096
    ds_read_b64_tr_b16 a[238:239], v252 offset:6144
    v_mfma_f32_16x16x32_bf16 v[36:39], a[240:243], a[148:151], v[36:39]
    s_add_u32 s72, s14, 6144
    buffer_load_dwordx4 a[56:59], v14, s[32:35], s72 offen offset:0 sc1
    v_mfma_f32_16x16x32_bf16 v[72:75], a[240:243], a[164:167], v[72:75]
    v_mfma_f32_16x16x32_bf16 v[108:111], a[240:243], a[180:183], v[108:111]
    ds_read_b64_tr_b16 a[240:241], v253 offset:4096
    ds_read_b64_tr_b16 a[242:243], v253 offset:6144
    v_mfma_f32_16x16x32_bf16 v[40:43], a[244:247], a[148:151], v[40:43]
    buffer_load_dwordx4 a[72:75], v14, s[32:35], s72 offen offset:1024 sc1
    v_mfma_f32_16x16x32_bf16 v[76:79], a[244:247], a[164:167], v[76:79]
    v_mfma_f32_16x16x32_bf16 v[112:115], a[244:247], a[180:183], v[112:115]
    ds_read_b64_tr_b16 a[244:245], v254 offset:4096
    ds_read_b64_tr_b16 a[246:247], v254 offset:6144
    s_waitcnt lgkmcnt(15)
    v_mfma_f32_16x16x32_bf16 v[44:47], a[248:251], a[148:151], v[44:47]
    v_mfma_f32_16x16x32_bf16 v[80:83], a[248:251], a[164:167], v[80:83]
    buffer_load_dwordx4 a[88:91], v14, s[32:35], s72 offen offset:2048 sc1
    v_mfma_f32_16x16x32_bf16 v[116:119], a[248:251], a[180:183], v[116:119]
    ds_read_b64_tr_b16 a[248:249], v255 offset:4096
    ds_read_b64_tr_b16 a[250:251], v255 offset:6144
    s_waitcnt lgkmcnt(15)
    v_mfma_f32_16x16x32_bf16 v[48:51], a[252:255], a[148:151], v[48:51]
    v_mfma_f32_16x16x32_bf16 v[84:87], a[252:255], a[164:167], v[84:87]
    v_mfma_f32_16x16x32_bf16 v[120:123], a[252:255], a[180:183], v[120:123]
    ds_read_b64_tr_b16 a[252:253], v252 offset:8192
    ds_read_b64_tr_b16 a[254:255], v252 offset:10240
    s_waitcnt lgkmcnt(4)
    s_waitcnt vmcnt(14)
    v_mfma_f32_16x16x32_bf16 v[16:19], a[220:223], v[156:159], v[16:19]
    s_add_u32 s74, s59, 32768
    v_add_u32 v252, s74, v1
    s_waitcnt vmcnt(13)
    v_mfma_f32_16x16x32_bf16 v[52:55], a[220:223], v[172:175], v[52:55]
    v_add_u32 v253, s74, v2
    v_add_u32 v254, s74, v3
    v_add_u32 v255, s74, v4
    s_waitcnt vmcnt(12)
    v_mfma_f32_16x16x32_bf16 v[88:91], a[220:223], v[188:191], v[88:91]
    ds_read_b64_tr_b16 a[220:221], v252 offset:0
    ds_read_b64_tr_b16 a[222:223], v252 offset:2048
    v_mfma_f32_16x16x32_bf16 v[20:23], a[224:227], v[156:159], v[20:23]
    s_add_u32 m0, s64, 132096
    s_add_u32 s65, s69, 82944
    buffer_load_dwordx4 v12, s[36:39], s65 offen offset:0 lds
    v_mfma_f32_16x16x32_bf16 v[56:59], a[224:227], v[172:175], v[56:59]
    v_mfma_f32_16x16x32_bf16 v[92:95], a[224:227], v[188:191], v[92:95]
    ds_read_b64_tr_b16 a[224:225], v253 offset:0
    ds_read_b64_tr_b16 a[226:227], v253 offset:2048
    v_mfma_f32_16x16x32_bf16 v[24:27], a[228:231], v[156:159], v[24:27]
    s_add_u32 m0, s64, 136064
    s_nop 0
    buffer_load_dwordx4 v12, s[36:39], s65 offen offset:128 lds
    v_mfma_f32_16x16x32_bf16 v[60:63], a[228:231], v[172:175], v[60:63]
    v_mfma_f32_16x16x32_bf16 v[96:99], a[228:231], v[188:191], v[96:99]
    ds_read_b64_tr_b16 a[228:229], v254 offset:0
    ds_read_b64_tr_b16 a[230:231], v254 offset:2048
    v_mfma_f32_16x16x32_bf16 v[28:31], a[232:235], v[156:159], v[28:31]
    v_mfma_f32_16x16x32_bf16 v[64:67], a[232:235], v[172:175], v[64:67]
    s_add_u32 m0, s64, 140032
    s_nop 0
    buffer_load_dwordx4 v12, s[36:39], s65 offen offset:256 lds
    v_mfma_f32_16x16x32_bf16 v[100:103], a[232:235], v[188:191], v[100:103]
    ds_read_b64_tr_b16 a[232:233], v255 offset:0
    ds_read_b64_tr_b16 a[234:235], v255 offset:2048
    v_mfma_f32_16x16x32_bf16 v[32:35], a[236:239], v[156:159], v[32:35]
    v_mfma_f32_16x16x32_bf16 v[68:71], a[236:239], v[172:175], v[68:71]
    v_mfma_f32_16x16x32_bf16 v[104:107], a[236:239], v[188:191], v[104:107]
    ds_read_b64_tr_b16 a[236:237], v252 offset:4096
    ds_read_b64_tr_b16 a[238:239], v252 offset:6144
    v_mfma_f32_16x16x32_bf16 v[36:39], a[240:243], v[156:159], v[36:39]
    s_add_u32 s72, s12, 6144
    buffer_load_dwordx4 a[104:107], v14, s[32:35], s72 offen offset:0 sc1
    v_mfma_f32_16x16x32_bf16 v[72:75], a[240:243], v[172:175], v[72:75]
    v_mfma_f32_16x16x32_bf16 v[108:111], a[240:243], v[188:191], v[108:111]
    ds_read_b64_tr_b16 a[240:241], v253 offset:4096
    ds_read_b64_tr_b16 a[242:243], v253 offset:6144
    v_mfma_f32_16x16x32_bf16 v[40:43], a[244:247], v[156:159], v[40:43]
    buffer_load_dwordx4 a[120:123], v14, s[32:35], s72 offen offset:1024 sc1
    v_mfma_f32_16x16x32_bf16 v[76:79], a[244:247], v[172:175], v[76:79]
    v_mfma_f32_16x16x32_bf16 v[112:115], a[244:247], v[188:191], v[112:115]
    ds_read_b64_tr_b16 a[244:245], v254 offset:4096
    ds_read_b64_tr_b16 a[246:247], v254 offset:6144
    s_waitcnt lgkmcnt(15)
    v_mfma_f32_16x16x32_bf16 v[44:47], a[248:251], v[156:159], v[44:47]
    v_mfma_f32_16x16x32_bf16 v[80:83], a[248:251], v[172:175], v[80:83]
    buffer_load_dwordx4 a[136:139], v14, s[32:35], s72 offen offset:2048 sc1
    v_mfma_f32_16x16x32_bf16 v[116:119], a[248:251], v[188:191], v[116:119]
    ds_read_b64_tr_b16 a[248:249], v255 offset:4096
    ds_read_b64_tr_b16 a[250:251], v255 offset:6144
    s_waitcnt lgkmcnt(15)
    v_mfma_f32_16x16x32_bf16 v[48:51], a[252:255], v[156:159], v[48:51]
    v_mfma_f32_16x16x32_bf16 v[84:87], a[252:255], v[172:175], v[84:87]
    v_mfma_f32_16x16x32_bf16 v[120:123], a[252:255], v[188:191], v[120:123]
    ds_read_b64_tr_b16 a[252:253], v252 offset:8192
    ds_read_b64_tr_b16 a[254:255], v252 offset:10240
    s_barrier
    s_waitcnt lgkmcnt(4)
    s_waitcnt vmcnt(17)
    v_mfma_f32_16x16x32_bf16 v[16:19], a[220:223], v[204:207], v[16:19]
    s_add_u32 s74, s60, 65536
    v_add_u32 v252, s74, v1
    s_waitcnt vmcnt(16)
    v_mfma_f32_16x16x32_bf16 v[52:55], a[220:223], v[220:223], v[52:55]
    v_add_u32 v253, s74, v2
    v_add_u32 v254, s74, v3
    v_add_u32 v255, s74, v4
    s_waitcnt vmcnt(15)
    v_mfma_f32_16x16x32_bf16 v[88:91], a[220:223], v[236:239], v[88:91]
    ds_read_b64_tr_b16 a[220:221], v252 offset:0
    ds_read_b64_tr_b16 a[222:223], v252 offset:2048
    v_mfma_f32_16x16x32_bf16 v[20:23], a[224:227], v[204:207], v[20:23]
    s_add_u32 m0, s64, 0
    s_add_u32 s65, s67, 110592
    buffer_load_dwordx4 v12, s[36:39], s65 offen offset:0 lds
    v_mfma_f32_16x16x32_bf16 v[56:59], a[224:227], v[220:223], v[56:59]
    v_mfma_f32_16x16x32_bf16 v[92:95], a[224:227], v[236:239], v[92:95]
    ds_read_b64_tr_b16 a[224:225], v253 offset:0
    ds_read_b64_tr_b16 a[226:227], v253 offset:2048
    v_mfma_f32_16x16x32_bf16 v[24:27], a[228:231], v[204:207], v[24:27]
    s_add_u32 m0, s64, 3968
    s_nop 0
    buffer_load_dwordx4 v12, s[36:39], s65 offen offset:128 lds
    v_mfma_f32_16x16x32_bf16 v[60:63], a[228:231], v[220:223], v[60:63]
    v_mfma_f32_16x16x32_bf16 v[96:99], a[228:231], v[236:239], v[96:99]
    ds_read_b64_tr_b16 a[228:229], v254 offset:0
    ds_read_b64_tr_b16 a[230:231], v254 offset:2048
    v_mfma_f32_16x16x32_bf16 v[28:31], a[232:235], v[204:207], v[28:31]
    v_mfma_f32_16x16x32_bf16 v[64:67], a[232:235], v[220:223], v[64:67]
    s_add_u32 m0, s64, 7936
    s_nop 0
    buffer_load_dwordx4 v12, s[36:39], s65 offen offset:256 lds
    v_mfma_f32_16x16x32_bf16 v[100:103], a[232:235], v[236:239], v[100:103]
    ds_read_b64_tr_b16 a[232:233], v255 offset:0
    ds_read_b64_tr_b16 a[234:235], v255 offset:2048
    v_mfma_f32_16x16x32_bf16 v[32:35], a[236:239], v[204:207], v[32:35]
    v_mfma_f32_16x16x32_bf16 v[68:71], a[236:239], v[220:223], v[68:71]
    v_mfma_f32_16x16x32_bf16 v[104:107], a[236:239], v[236:239], v[104:107]
    ds_read_b64_tr_b16 a[236:237], v252 offset:4096
    ds_read_b64_tr_b16 a[238:239], v252 offset:6144
    v_mfma_f32_16x16x32_bf16 v[36:39], a[240:243], v[204:207], v[36:39]
    s_add_u32 s72, s15, 6144
    buffer_load_dwordx4 a[152:155], v14, s[32:35], s72 offen offset:0 sc1
    v_mfma_f32_16x16x32_bf16 v[72:75], a[240:243], v[220:223], v[72:75]
    v_mfma_f32_16x16x32_bf16 v[108:111], a[240:243], v[236:239], v[108:111]
    ds_read_b64_tr_b16 a[240:241], v253 offset:4096
    ds_read_b64_tr_b16 a[242:243], v253 offset:6144
    v_mfma_f32_16x16x32_bf16 v[40:43], a[244:247], v[204:207], v[40:43]
    buffer_load_dwordx4 a[168:171], v14, s[32:35], s72 offen offset:1024 sc1
    v_mfma_f32_16x16x32_bf16 v[76:79], a[244:247], v[220:223], v[76:79]
    v_mfma_f32_16x16x32_bf16 v[112:115], a[244:247], v[236:239], v[112:115]
    ds_read_b64_tr_b16 a[244:245], v254 offset:4096
    ds_read_b64_tr_b16 a[246:247], v254 offset:6144
    s_waitcnt lgkmcnt(15)
    v_mfma_f32_16x16x32_bf16 v[44:47], a[248:251], v[204:207], v[44:47]
    v_mfma_f32_16x16x32_bf16 v[80:83], a[248:251], v[220:223], v[80:83]
    buffer_load_dwordx4 a[184:187], v14, s[32:35], s72 offen offset:2048 sc1
    v_mfma_f32_16x16x32_bf16 v[116:119], a[248:251], v[236:239], v[116:119]
    ds_read_b64_tr_b16 a[248:249], v255 offset:4096
    ds_read_b64_tr_b16 a[250:251], v255 offset:6144
    s_waitcnt lgkmcnt(15)
    v_mfma_f32_16x16x32_bf16 v[48:51], a[252:255], v[204:207], v[48:51]
    v_mfma_f32_16x16x32_bf16 v[84:87], a[252:255], v[220:223], v[84:87]
    v_mfma_f32_16x16x32_bf16 v[120:123], a[252:255], v[236:239], v[120:123]
    ds_read_b64_tr_b16 a[252:253], v252 offset:8192
    ds_read_b64_tr_b16 a[254:255], v252 offset:10240
    s_waitcnt lgkmcnt(4)
    s_waitcnt vmcnt(20)
    v_mfma_f32_16x16x32_bf16 v[16:19], a[220:223], a[8:11], v[16:19]
    s_add_u32 s74, s59, 65536
    v_add_u32 v252, s74, v1
    s_waitcnt vmcnt(19)
    v_mfma_f32_16x16x32_bf16 v[52:55], a[220:223], a[24:27], v[52:55]
    v_add_u32 v253, s74, v2
    v_add_u32 v254, s74, v3
    v_add_u32 v255, s74, v4
    s_waitcnt vmcnt(18)
    v_mfma_f32_16x16x32_bf16 v[88:91], a[220:223], a[40:43], v[88:91]
    ds_read_b64_tr_b16 a[220:221], v252 offset:0
    ds_read_b64_tr_b16 a[222:223], v252 offset:2048
    v_mfma_f32_16x16x32_bf16 v[20:23], a[224:227], a[8:11], v[20:23]
    s_add_u32 m0, s64, 1024
    s_add_u32 s65, s67, 119808
    buffer_load_dwordx4 v12, s[36:39], s65 offen offset:0 lds
    v_mfma_f32_16x16x32_bf16 v[56:59], a[224:227], a[24:27], v[56:59]
    v_mfma_f32_16x16x32_bf16 v[92:95], a[224:227], a[40:43], v[92:95]
    ds_read_b64_tr_b16 a[224:225], v253 offset:0
    ds_read_b64_tr_b16 a[226:227], v253 offset:2048
    v_mfma_f32_16x16x32_bf16 v[24:27], a[228:231], a[8:11], v[24:27]
    s_add_u32 m0, s64, 4992
    s_nop 0
    buffer_load_dwordx4 v12, s[36:39], s65 offen offset:128 lds
    v_mfma_f32_16x16x32_bf16 v[60:63], a[228:231], a[24:27], v[60:63]
    v_mfma_f32_16x16x32_bf16 v[96:99], a[228:231], a[40:43], v[96:99]
    ds_read_b64_tr_b16 a[228:229], v254 offset:0
    ds_read_b64_tr_b16 a[230:231], v254 offset:2048
    v_mfma_f32_16x16x32_bf16 v[28:31], a[232:235], a[8:11], v[28:31]
    v_mfma_f32_16x16x32_bf16 v[64:67], a[232:235], a[24:27], v[64:67]
    s_add_u32 m0, s64, 8960
    s_nop 0
    buffer_load_dwordx4 v12, s[36:39], s65 offen offset:256 lds
    v_mfma_f32_16x16x32_bf16 v[100:103], a[232:235], a[40:43], v[100:103]
    ds_read_b64_tr_b16 a[232:233], v255 offset:0
    ds_read_b64_tr_b16 a[234:235], v255 offset:2048
    v_mfma_f32_16x16x32_bf16 v[32:35], a[236:239], a[8:11], v[32:35]
    v_mfma_f32_16x16x32_bf16 v[68:71], a[236:239], a[24:27], v[68:71]
    v_mfma_f32_16x16x32_bf16 v[104:107], a[236:239], a[40:43], v[104:107]
    ds_read_b64_tr_b16 a[236:237], v252 offset:4096
    ds_read_b64_tr_b16 a[238:239], v252 offset:6144
    v_mfma_f32_16x16x32_bf16 v[36:39], a[240:243], a[8:11], v[36:39]
    s_add_u32 s72, s13, 6144
    buffer_load_dwordx4 v[160:163], v14, s[32:35], s72 offen offset:0 sc1
    v_mfma_f32_16x16x32_bf16 v[72:75], a[240:243], a[24:27], v[72:75]
    v_mfma_f32_16x16x32_bf16 v[108:111], a[240:243], a[40:43], v[108:111]
    ds_read_b64_tr_b16 a[240:241], v253 offset:4096
    ds_read_b64_tr_b16 a[242:243], v253 offset:6144
    v_mfma_f32_16x16x32_bf16 v[40:43], a[244:247], a[8:11], v[40:43]
    buffer_load_dwordx4 v[176:179], v14, s[32:35], s72 offen offset:1024 sc1
    v_mfma_f32_16x16x32_bf16 v[76:79], a[244:247], a[24:27], v[76:79]
    v_mfma_f32_16x16x32_bf16 v[112:115], a[244:247], a[40:43], v[112:115]
    ds_read_b64_tr_b16 a[244:245], v254 offset:4096
    ds_read_b64_tr_b16 a[246:247], v254 offset:6144
    s_waitcnt lgkmcnt(15)
    v_mfma_f32_16x16x32_bf16 v[44:47], a[248:251], a[8:11], v[44:47]
    v_mfma_f32_16x16x32_bf16 v[80:83], a[248:251], a[24:27], v[80:83]
    buffer_load_dwordx4 v[192:195], v14, s[32:35], s72 offen offset:2048 sc1
    v_mfma_f32_16x16x32_bf16 v[116:119], a[248:251], a[40:43], v[116:119]
    ds_read_b64_tr_b16 a[248:249], v255 offset:4096
    ds_read_b64_tr_b16 a[250:251], v255 offset:6144
    s_waitcnt lgkmcnt(15)
    v_mfma_f32_16x16x32_bf16 v[48:51], a[252:255], a[8:11], v[48:51]
    v_mfma_f32_16x16x32_bf16 v[84:87], a[252:255], a[24:27], v[84:87]
    v_mfma_f32_16x16x32_bf16 v[120:123], a[252:255], a[40:43], v[120:123]
    ds_read_b64_tr_b16 a[252:253], v252 offset:8192
    ds_read_b64_tr_b16 a[254:255], v252 offset:10240
    s_barrier
    s_waitcnt lgkmcnt(4)
    s_waitcnt vmcnt(20)
    v_mfma_f32_16x16x32_bf16 v[16:19], a[220:223], a[56:59], v[16:19]
    s_add_u32 s74, s60, 98304
    v_add_u32 v252, s74, v1
    s_waitcnt vmcnt(19)
    v_mfma_f32_16x16x32_bf16 v[52:55], a[220:223], a[72:75], v[52:55]
    v_add_u32 v253, s74, v2
    v_add_u32 v254, s74, v3
    v_add_u32 v255, s74, v4
    s_waitcnt vmcnt(18)
    v_mfma_f32_16x16x32_bf16 v[88:91], a[220:223], a[88:91], v[88:91]
    ds_read_b64_tr_b16 a[220:221], v252 offset:0
    ds_read_b64_tr_b16 a[222:223], v252 offset:2048
    v_mfma_f32_16x16x32_bf16 v[20:23], a[224:227], a[56:59], v[20:23]
    s_add_u32 m0, s64, 32768
    s_add_u32 s65, s68, 110592
    buffer_load_dwordx4 v12, s[36:39], s65 offen offset:0 lds
    v_mfma_f32_16x16x32_bf16 v[56:59], a[224:227], a[72:75], v[56:59]
    v_mfma_f32_16x16x32_bf16 v[92:95], a[224:227], a[88:91], v[92:95]
    ds_read_b64_tr_b16 a[224:225], v253 offset:0
    ds_read_b64_tr_b16 a[226:227], v253 offset:2048
    v_mfma_f32_16x16x32_bf16 v[24:27], a[228:231], a[56:59], v[24:27]
    s_add_u32 m0, s64, 36736
    s_nop 0
    buffer_load_dwordx4 v12, s[36:39], s65 offen offset:128 lds
    v_mfma_f32_16x16x32_bf16 v[60:63], a[228:231], a[72:75], v[60:63]
    v_mfma_f32_16x16x32_bf16 v[96:99], a[228:231], a[88:91], v[96:99]
    ds_read_b64_tr_b16 a[228:229], v254 offset:0
    ds_read_b64_tr_b16 a[230:231], v254 offset:2048
    v_mfma_f32_16x16x32_bf16 v[28:31], a[232:235], a[56:59], v[28:31]
    v_mfma_f32_16x16x32_bf16 v[64:67], a[232:235], a[72:75], v[64:67]
    s_add_u32 m0, s64, 40704
    s_nop 0
    buffer_load_dwordx4 v12, s[36:39], s65 offen offset:256 lds
    v_mfma_f32_16x16x32_bf16 v[100:103], a[232:235], a[88:91], v[100:103]
    ds_read_b64_tr_b16 a[232:233], v255 offset:0
    ds_read_b64_tr_b16 a[234:235], v255 offset:2048
    v_mfma_f32_16x16x32_bf16 v[32:35], a[236:239], a[56:59], v[32:35]
    v_mfma_f32_16x16x32_bf16 v[68:71], a[236:239], a[72:75], v[68:71]
    v_mfma_f32_16x16x32_bf16 v[104:107], a[236:239], a[88:91], v[104:107]
    ds_read_b64_tr_b16 a[236:237], v252 offset:4096
    ds_read_b64_tr_b16 a[238:239], v252 offset:6144
    v_mfma_f32_16x16x32_bf16 v[36:39], a[240:243], a[56:59], v[36:39]
    s_add_u32 s72, s16, 6144
    buffer_load_dwordx4 v[208:211], v14, s[32:35], s72 offen offset:0 sc1
    v_mfma_f32_16x16x32_bf16 v[72:75], a[240:243], a[72:75], v[72:75]
    v_mfma_f32_16x16x32_bf16 v[108:111], a[240:243], a[88:91], v[108:111]
    ds_read_b64_tr_b16 a[240:241], v253 offset:4096
    ds_read_b64_tr_b16 a[242:243], v253 offset:6144
    v_mfma_f32_16x16x32_bf16 v[40:43], a[244:247], a[56:59], v[40:43]
    buffer_load_dwordx4 v[224:227], v14, s[32:35], s72 offen offset:1024 sc1
    v_mfma_f32_16x16x32_bf16 v[76:79], a[244:247], a[72:75], v[76:79]
    v_mfma_f32_16x16x32_bf16 v[112:115], a[244:247], a[88:91], v[112:115]
    ds_read_b64_tr_b16 a[244:245], v254 offset:4096
    ds_read_b64_tr_b16 a[246:247], v254 offset:6144
    s_waitcnt lgkmcnt(15)
    v_mfma_f32_16x16x32_bf16 v[44:47], a[248:251], a[56:59], v[44:47]
    v_mfma_f32_16x16x32_bf16 v[80:83], a[248:251], a[72:75], v[80:83]
    buffer_load_dwordx4 v[240:243], v14, s[32:35], s72 offen offset:2048 sc1
    v_mfma_f32_16x16x32_bf16 v[116:119], a[248:251], a[88:91], v[116:119]
    ds_read_b64_tr_b16 a[248:249], v255 offset:4096
    ds_read_b64_tr_b16 a[250:251], v255 offset:6144
    s_waitcnt lgkmcnt(15)
    v_mfma_f32_16x16x32_bf16 v[48:51], a[252:255], a[56:59], v[48:51]
    v_mfma_f32_16x16x32_bf16 v[84:87], a[252:255], a[72:75], v[84:87]
    v_mfma_f32_16x16x32_bf16 v[120:123], a[252:255], a[88:91], v[120:123]
    ds_read_b64_tr_b16 a[252:253], v252 offset:8192
    ds_read_b64_tr_b16 a[254:255], v252 offset:10240
    s_waitcnt lgkmcnt(4)
    s_waitcnt vmcnt(20)
    v_mfma_f32_16x16x32_bf16 v[16:19], a[220:223], a[104:107], v[16:19]
    s_add_u32 s74, s59, 98304
    v_add_u32 v252, s74, v1
    s_waitcnt vmcnt(19)
    v_mfma_f32_16x16x32_bf16 v[52:55], a[220:223], a[120:123], v[52:55]
    v_add_u32 v253, s74, v2
    v_add_u32 v254, s74, v3
    v_add_u32 v255, s74, v4
    s_waitcnt vmcnt(18)
    v_mfma_f32_16x16x32_bf16 v[88:91], a[220:223], a[136:139], v[88:91]
    ds_read_b64_tr_b16 a[220:221], v252 offset:0
    ds_read_b64_tr_b16 a[222:223], v252 offset:2048
    v_mfma_f32_16x16x32_bf16 v[20:23], a[224:227], a[104:107], v[20:23]
    s_add_u32 m0, s64, 33792
    s_add_u32 s65, s68, 119808
    buffer_load_dwordx4 v12, s[36:39], s65 offen offset:0 lds
    v_mfma_f32_16x16x32_bf16 v[56:59], a[224:227], a[120:123], v[56:59]
    v_mfma_f32_16x16x32_bf16 v[92:95], a[224:227], a[136:139], v[92:95]
    ds_read_b64_tr_b16 a[224:225], v253 offset:0
    ds_read_b64_tr_b16 a[226:227], v253 offset:2048
    v_mfma_f32_16x16x32_bf16 v[24:27], a[228:231], a[104:107], v[24:27]
    s_add_u32 m0, s64, 37760
    s_nop 0
    buffer_load_dwordx4 v12, s[36:39], s65 offen offset:128 lds
    v_mfma_f32_16x16x32_bf16 v[60:63], a[228:231], a[120:123], v[60:63]
    v_mfma_f32_16x16x32_bf16 v[96:99], a[228:231], a[136:139], v[96:99]
    ds_read_b64_tr_b16 a[228:229], v254 offset:0
    ds_read_b64_tr_b16 a[230:231], v254 offset:2048
    v_mfma_f32_16x16x32_bf16 v[28:31], a[232:235], a[104:107], v[28:31]
    v_mfma_f32_16x16x32_bf16 v[64:67], a[232:235], a[120:123], v[64:67]
    s_add_u32 m0, s64, 41728
    s_nop 0
    buffer_load_dwordx4 v12, s[36:39], s65 offen offset:256 lds
    v_mfma_f32_16x16x32_bf16 v[100:103], a[232:235], a[136:139], v[100:103]
    ds_read_b64_tr_b16 a[232:233], v255 offset:0
    ds_read_b64_tr_b16 a[234:235], v255 offset:2048
    v_mfma_f32_16x16x32_bf16 v[32:35], a[236:239], a[104:107], v[32:35]
    v_mfma_f32_16x16x32_bf16 v[68:71], a[236:239], a[120:123], v[68:71]
    v_mfma_f32_16x16x32_bf16 v[104:107], a[236:239], a[136:139], v[104:107]
    ds_read_b64_tr_b16 a[236:237], v252 offset:4096
    ds_read_b64_tr_b16 a[238:239], v252 offset:6144
    v_mfma_f32_16x16x32_bf16 v[36:39], a[240:243], a[104:107], v[36:39]
    s_add_u32 s72, s11, 9216
    buffer_load_dwordx4 a[12:15], v14, s[32:35], s72 offen offset:0 sc1
    v_mfma_f32_16x16x32_bf16 v[72:75], a[240:243], a[120:123], v[72:75]
    v_mfma_f32_16x16x32_bf16 v[108:111], a[240:243], a[136:139], v[108:111]
    ds_read_b64_tr_b16 a[240:241], v253 offset:4096
    ds_read_b64_tr_b16 a[242:243], v253 offset:6144
    v_mfma_f32_16x16x32_bf16 v[40:43], a[244:247], a[104:107], v[40:43]
    buffer_load_dwordx4 a[28:31], v14, s[32:35], s72 offen offset:1024 sc1
    v_mfma_f32_16x16x32_bf16 v[76:79], a[244:247], a[120:123], v[76:79]
    v_mfma_f32_16x16x32_bf16 v[112:115], a[244:247], a[136:139], v[112:115]
    ds_read_b64_tr_b16 a[244:245], v254 offset:4096
    ds_read_b64_tr_b16 a[246:247], v254 offset:6144
    s_waitcnt lgkmcnt(15)
    v_mfma_f32_16x16x32_bf16 v[44:47], a[248:251], a[104:107], v[44:47]
    v_mfma_f32_16x16x32_bf16 v[80:83], a[248:251], a[120:123], v[80:83]
    buffer_load_dwordx4 a[44:47], v14, s[32:35], s72 offen offset:2048 sc1
    v_mfma_f32_16x16x32_bf16 v[116:119], a[248:251], a[136:139], v[116:119]
    ds_read_b64_tr_b16 a[248:249], v255 offset:4096
    ds_read_b64_tr_b16 a[250:251], v255 offset:6144
    s_waitcnt lgkmcnt(15)
    v_mfma_f32_16x16x32_bf16 v[48:51], a[252:255], a[104:107], v[48:51]
    v_mfma_f32_16x16x32_bf16 v[84:87], a[252:255], a[120:123], v[84:87]
    v_mfma_f32_16x16x32_bf16 v[120:123], a[252:255], a[136:139], v[120:123]
    ds_read_b64_tr_b16 a[252:253], v252 offset:8192
    ds_read_b64_tr_b16 a[254:255], v252 offset:10240
    s_barrier
    s_waitcnt lgkmcnt(4)
    s_waitcnt vmcnt(20)
    v_mfma_f32_16x16x32_bf16 v[16:19], a[220:223], a[152:155], v[16:19]
    s_add_u32 s74, s60, 131072
    v_add_u32 v252, s74, v1
    s_waitcnt vmcnt(19)
    v_mfma_f32_16x16x32_bf16 v[52:55], a[220:223], a[168:171], v[52:55]
    v_add_u32 v253, s74, v2
    v_add_u32 v254, s74, v3
    v_add_u32 v255, s74, v4
    s_waitcnt vmcnt(18)
    v_mfma_f32_16x16x32_bf16 v[88:91], a[220:223], a[184:187], v[88:91]
    ds_read_b64_tr_b16 a[220:221], v252 offset:0
    ds_read_b64_tr_b16 a[222:223], v252 offset:2048
    v_mfma_f32_16x16x32_bf16 v[20:23], a[224:227], a[152:155], v[20:23]
    s_add_u32 m0, s64, 65536
    s_add_u32 s65, s69, 110592
    buffer_load_dwordx4 v12, s[36:39], s65 offen offset:0 lds
    v_mfma_f32_16x16x32_bf16 v[56:59], a[224:227], a[168:171], v[56:59]
    v_mfma_f32_16x16x32_bf16 v[92:95], a[224:227], a[184:187], v[92:95]
    ds_read_b64_tr_b16 a[224:225], v253 offset:0
    ds_read_b64_tr_b16 a[226:227], v253 offset:2048
    v_mfma_f32_16x16x32_bf16 v[24:27], a[228:231], a[152:155], v[24:27]
    s_add_u32 m0, s64, 69504
    s_nop 0
    buffer_load_dwordx4 v12, s[36:39], s65 offen offset:128 lds
    v_mfma_f32_16x16x32_bf16 v[60:63], a[228:231], a[168:171], v[60:63]
    v_mfma_f32_16x16x32_bf16 v[96:99], a[228:231], a[184:187], v[96:99]
    ds_read_b64_tr_b16 a[228:229], v254 offset:0
    ds_read_b64_tr_b16 a[230:231], v254 offset:2048
    v_mfma_f32_16x16x32_bf16 v[28:31], a[232:235], a[152:155], v[28:31]
    v_mfma_f32_16x16x32_bf16 v[64:67], a[232:235], a[168:171], v[64:67]
    s_add_u32 m0, s64, 73472
    s_nop 0
    buffer_load_dwordx4 v12, s[36:39], s65 offen offset:256 lds
    v_mfma_f32_16x16x32_bf16 v[100:103], a[232:235], a[184:187], v[100:103]
    ds_read_b64_tr_b16 a[232:233], v255 offset:0
    ds_read_b64_tr_b16 a[234:235], v255 offset:2048
    v_mfma_f32_16x16x32_bf16 v[32:35], a[236:239], a[152:155], v[32:35]
    v_mfma_f32_16x16x32_bf16 v[68:71], a[236:239], a[168:171], v[68:71]
    v_mfma_f32_16x16x32_bf16 v[104:107], a[236:239], a[184:187], v[104:107]
    ds_read_b64_tr_b16 a[236:237], v252 offset:4096
    ds_read_b64_tr_b16 a[238:239], v252 offset:6144
    v_mfma_f32_16x16x32_bf16 v[36:39], a[240:243], a[152:155], v[36:39]
    s_add_u32 s72, s14, 9216
    buffer_load_dwordx4 a[60:63], v14, s[32:35], s72 offen offset:0 sc1
    v_mfma_f32_16x16x32_bf16 v[72:75], a[240:243], a[168:171], v[72:75]
    v_mfma_f32_16x16x32_bf16 v[108:111], a[240:243], a[184:187], v[108:111]
    ds_read_b64_tr_b16 a[240:241], v253 offset:4096
    ds_read_b64_tr_b16 a[242:243], v253 offset:6144
    v_mfma_f32_16x16x32_bf16 v[40:43], a[244:247], a[152:155], v[40:43]
    buffer_load_dwordx4 a[76:79], v14, s[32:35], s72 offen offset:1024 sc1
    v_mfma_f32_16x16x32_bf16 v[76:79], a[244:247], a[168:171], v[76:79]
    v_mfma_f32_16x16x32_bf16 v[112:115], a[244:247], a[184:187], v[112:115]
    ds_read_b64_tr_b16 a[244:245], v254 offset:4096
    ds_read_b64_tr_b16 a[246:247], v254 offset:6144
    s_waitcnt lgkmcnt(15)
    v_mfma_f32_16x16x32_bf16 v[44:47], a[248:251], a[152:155], v[44:47]
    v_mfma_f32_16x16x32_bf16 v[80:83], a[248:251], a[168:171], v[80:83]
    buffer_load_dwordx4 a[92:95], v14, s[32:35], s72 offen offset:2048 sc1
    v_mfma_f32_16x16x32_bf16 v[116:119], a[248:251], a[184:187], v[116:119]
    ds_read_b64_tr_b16 a[248:249], v255 offset:4096
    ds_read_b64_tr_b16 a[250:251], v255 offset:6144
    s_waitcnt lgkmcnt(15)
    v_mfma_f32_16x16x32_bf16 v[48:51], a[252:255], a[152:155], v[48:51]
    v_mfma_f32_16x16x32_bf16 v[84:87], a[252:255], a[168:171], v[84:87]
    v_mfma_f32_16x16x32_bf16 v[120:123], a[252:255], a[184:187], v[120:123]
    ds_read_b64_tr_b16 a[252:253], v252 offset:8192
    ds_read_b64_tr_b16 a[254:255], v252 offset:10240
    s_waitcnt lgkmcnt(4)
    s_waitcnt vmcnt(20)
    v_mfma_f32_16x16x32_bf16 v[16:19], a[220:223], v[160:163], v[16:19]
    s_add_u32 s74, s59, 131072
    v_add_u32 v252, s74, v1
    s_waitcnt vmcnt(19)
    v_mfma_f32_16x16x32_bf16 v[52:55], a[220:223], v[176:179], v[52:55]
    v_add_u32 v253, s74, v2
    v_add_u32 v254, s74, v3
    v_add_u32 v255, s74, v4
    s_waitcnt vmcnt(18)
    v_mfma_f32_16x16x32_bf16 v[88:91], a[220:223], v[192:195], v[88:91]
    ds_read_b64_tr_b16 a[220:221], v252 offset:0
    ds_read_b64_tr_b16 a[222:223], v252 offset:2048
    v_mfma_f32_16x16x32_bf16 v[20:23], a[224:227], v[160:163], v[20:23]
    s_add_u32 m0, s64, 66560
    s_add_u32 s65, s69, 119808
    buffer_load_dwordx4 v12, s[36:39], s65 offen offset:0 lds
    v_mfma_f32_16x16x32_bf16 v[56:59], a[224:227], v[176:179], v[56:59]
    v_mfma_f32_16x16x32_bf16 v[92:95], a[224:227], v[192:195], v[92:95]
    ds_read_b64_tr_b16 a[224:225], v253 offset:0
    ds_read_b64_tr_b16 a[226:227], v253 offset:2048
    v_mfma_f32_16x16x32_bf16 v[24:27], a[228:231], v[160:163], v[24:27]
    s_add_u32 m0, s64, 70528
    s_nop 0
    buffer_load_dwordx4 v12, s[36:39], s65 offen offset:128 lds
    v_mfma_f32_16x16x32_bf16 v[60:63], a[228:231], v[176:179], v[60:63]
    v_mfma_f32_16x16x32_bf16 v[96:99], a[228:231], v[192:195], v[96:99]
    ds_read_b64_tr_b16 a[228:229], v254 offset:0
    ds_read_b64_tr_b16 a[230:231], v254 offset:2048
    v_mfma_f32_16x16x32_bf16 v[28:31], a[232:235], v[160:163], v[28:31]
    v_mfma_f32_16x16x32_bf16 v[64:67], a[232:235], v[176:179], v[64:67]
    s_add_u32 m0, s64, 74496
    s_nop 0
    buffer_load_dwordx4 v12, s[36:39], s65 offen offset:256 lds
    v_mfma_f32_16x16x32_bf16 v[100:103], a[232:235], v[192:195], v[100:103]
    ds_read_b64_tr_b16 a[232:233], v255 offset:0
    ds_read_b64_tr_b16 a[234:235], v255 offset:2048
    v_mfma_f32_16x16x32_bf16 v[32:35], a[236:239], v[160:163], v[32:35]
    v_mfma_f32_16x16x32_bf16 v[68:71], a[236:239], v[176:179], v[68:71]
    v_mfma_f32_16x16x32_bf16 v[104:107], a[236:239], v[192:195], v[104:107]
    ds_read_b64_tr_b16 a[236:237], v252 offset:4096
    ds_read_b64_tr_b16 a[238:239], v252 offset:6144
    v_mfma_f32_16x16x32_bf16 v[36:39], a[240:243], v[160:163], v[36:39]
    s_add_u32 s72, s12, 9216
    buffer_load_dwordx4 a[108:111], v14, s[32:35], s72 offen offset:0 sc1
    v_mfma_f32_16x16x32_bf16 v[72:75], a[240:243], v[176:179], v[72:75]
    v_mfma_f32_16x16x32_bf16 v[108:111], a[240:243], v[192:195], v[108:111]
    ds_read_b64_tr_b16 a[240:241], v253 offset:4096
    ds_read_b64_tr_b16 a[242:243], v253 offset:6144
    v_mfma_f32_16x16x32_bf16 v[40:43], a[244:247], v[160:163], v[40:43]
    buffer_load_dwordx4 a[124:127], v14, s[32:35], s72 offen offset:1024 sc1
    v_mfma_f32_16x16x32_bf16 v[76:79], a[244:247], v[176:179], v[76:79]
    v_mfma_f32_16x16x32_bf16 v[112:115], a[244:247], v[192:195], v[112:115]
    ds_read_b64_tr_b16 a[244:245], v254 offset:4096
    ds_read_b64_tr_b16 a[246:247], v254 offset:6144
    s_waitcnt lgkmcnt(15)
    v_mfma_f32_16x16x32_bf16 v[44:47], a[248:251], v[160:163], v[44:47]
    v_mfma_f32_16x16x32_bf16 v[80:83], a[248:251], v[176:179], v[80:83]
    buffer_load_dwordx4 a[140:143], v14, s[32:35], s72 offen offset:2048 sc1
    v_mfma_f32_16x16x32_bf16 v[116:119], a[248:251], v[192:195], v[116:119]
    ds_read_b64_tr_b16 a[248:249], v255 offset:4096
    ds_read_b64_tr_b16 a[250:251], v255 offset:6144
    s_waitcnt lgkmcnt(15)
    v_mfma_f32_16x16x32_bf16 v[48:51], a[252:255], v[160:163], v[48:51]
    v_mfma_f32_16x16x32_bf16 v[84:87], a[252:255], v[176:179], v[84:87]
    v_mfma_f32_16x16x32_bf16 v[120:123], a[252:255], v[192:195], v[120:123]
    ds_read_b64_tr_b16 a[252:253], v252 offset:8192
    ds_read_b64_tr_b16 a[254:255], v252 offset:10240
    s_barrier
    s_waitcnt lgkmcnt(4)
    s_waitcnt vmcnt(20)
    v_mfma_f32_16x16x32_bf16 v[16:19], a[220:223], v[208:211], v[16:19]
    s_add_u32 s74, s60, 0
    v_add_u32 v252, s74, v1
    s_waitcnt vmcnt(19)
    v_mfma_f32_16x16x32_bf16 v[52:55], a[220:223], v[224:227], v[52:55]
    v_add_u32 v253, s74, v2
    v_add_u32 v254, s74, v3
    v_add_u32 v255, s74, v4
    s_waitcnt vmcnt(18)
    v_mfma_f32_16x16x32_bf16 v[88:91], a[220:223], v[240:243], v[88:91]
    ds_read_b64_tr_b16 a[220:221], v252 offset:0
    ds_read_b64_tr_b16 a[222:223], v252 offset:2048
    v_mfma_f32_16x16x32_bf16 v[20:23], a[224:227], v[208:211], v[20:23]
    s_add_u32 s72, s15, 9216
    buffer_load_dwordx4 a[156:159], v14, s[32:35], s72 offen offset:0 sc1
    v_mfma_f32_16x16x32_bf16 v[56:59], a[224:227], v[224:227], v[56:59]
    v_mfma_f32_16x16x32_bf16 v[92:95], a[224:227], v[240:243], v[92:95]
    ds_read_b64_tr_b16 a[224:225], v253 offset:0
    ds_read_b64_tr_b16 a[226:227], v253 offset:2048
    v_mfma_f32_16x16x32_bf16 v[24:27], a[228:231], v[208:211], v[24:27]
    v_mfma_f32_16x16x32_bf16 v[60:63], a[228:231], v[224:227], v[60:63]
    v_mfma_f32_16x16x32_bf16 v[96:99], a[228:231], v[240:243], v[96:99]
    ds_read_b64_tr_b16 a[228:229], v254 offset:0
    ds_read_b64_tr_b16 a[230:231], v254 offset:2048
    v_mfma_f32_16x16x32_bf16 v[28:31], a[232:235], v[208:211], v[28:31]
    v_mfma_f32_16x16x32_bf16 v[64:67], a[232:235], v[224:227], v[64:67]
    buffer_load_dwordx4 a[172:175], v14, s[32:35], s72 offen offset:1024 sc1
    v_mfma_f32_16x16x32_bf16 v[100:103], a[232:235], v[240:243], v[100:103]
    ds_read_b64_tr_b16 a[232:233], v255 offset:0
    ds_read_b64_tr_b16 a[234:235], v255 offset:2048
    v_mfma_f32_16x16x32_bf16 v[32:35], a[236:239], v[208:211], v[32:35]
    v_mfma_f32_16x16x32_bf16 v[68:71], a[236:239], v[224:227], v[68:71]
    v_mfma_f32_16x16x32_bf16 v[104:107], a[236:239], v[240:243], v[104:107]
    ds_read_b64_tr_b16 a[236:237], v252 offset:4096
    ds_read_b64_tr_b16 a[238:239], v252 offset:6144
    v_mfma_f32_16x16x32_bf16 v[36:39], a[240:243], v[208:211], v[36:39]
    v_mfma_f32_16x16x32_bf16 v[72:75], a[240:243], v[224:227], v[72:75]
    v_mfma_f32_16x16x32_bf16 v[108:111], a[240:243], v[240:243], v[108:111]
    ds_read_b64_tr_b16 a[240:241], v253 offset:4096
    ds_read_b64_tr_b16 a[242:243], v253 offset:6144
    v_mfma_f32_16x16x32_bf16 v[40:43], a[244:247], v[208:211], v[40:43]
    buffer_load_dwordx4 a[188:191], v14, s[32:35], s72 offen offset:2048 sc1
    v_mfma_f32_16x16x32_bf16 v[76:79], a[244:247], v[224:227], v[76:79]
    v_mfma_f32_16x16x32_bf16 v[112:115], a[244:247], v[240:243], v[112:115]
    ds_read_b64_tr_b16 a[244:245], v254 offset:4096
    ds_read_b64_tr_b16 a[246:247], v254 offset:6144
    s_waitcnt lgkmcnt(15)
    v_mfma_f32_16x16x32_bf16 v[44:47], a[248:251], v[208:211], v[44:47]
    v_mfma_f32_16x16x32_bf16 v[80:83], a[248:251], v[224:227], v[80:83]
    v_mfma_f32_16x16x32_bf16 v[116:119], a[248:251], v[240:243], v[116:119]
    ds_read_b64_tr_b16 a[248:249], v255 offset:4096
    ds_read_b64_tr_b16 a[250:251], v255 offset:6144
    s_waitcnt lgkmcnt(15)
    v_mfma_f32_16x16x32_bf16 v[48:51], a[252:255], v[208:211], v[48:51]
    v_mfma_f32_16x16x32_bf16 v[84:87], a[252:255], v[224:227], v[84:87]
    v_mfma_f32_16x16x32_bf16 v[120:123], a[252:255], v[240:243], v[120:123]
    ds_read_b64_tr_b16 a[252:253], v252 offset:8192
    ds_read_b64_tr_b16 a[254:255], v252 offset:10240
    s_waitcnt lgkmcnt(4)
    s_waitcnt vmcnt(17)
    v_mfma_f32_16x16x32_bf16 v[16:19], a[220:223], a[12:15], v[16:19]
    s_add_u32 s74, s59, 0
    v_add_u32 v252, s74, v1
    s_waitcnt vmcnt(16)
    v_mfma_f32_16x16x32_bf16 v[52:55], a[220:223], a[28:31], v[52:55]
    v_add_u32 v253, s74, v2
    v_add_u32 v254, s74, v3
    v_add_u32 v255, s74, v4
    s_waitcnt vmcnt(15)
    v_mfma_f32_16x16x32_bf16 v[88:91], a[220:223], a[44:47], v[88:91]
    ds_read_b64_tr_b16 a[220:221], v252 offset:0
    ds_read_b64_tr_b16 a[222:223], v252 offset:2048
    v_mfma_f32_16x16x32_bf16 v[20:23], a[224:227], a[12:15], v[20:23]
    s_add_u32 s72, s13, 9216
    buffer_load_dwordx4 v[164:167], v14, s[32:35], s72 offen offset:0 sc1
    v_mfma_f32_16x16x32_bf16 v[56:59], a[224:227], a[28:31], v[56:59]
    v_mfma_f32_16x16x32_bf16 v[92:95], a[224:227], a[44:47], v[92:95]
    ds_read_b64_tr_b16 a[224:225], v253 offset:0
    ds_read_b64_tr_b16 a[226:227], v253 offset:2048
    v_mfma_f32_16x16x32_bf16 v[24:27], a[228:231], a[12:15], v[24:27]
    v_mfma_f32_16x16x32_bf16 v[60:63], a[228:231], a[28:31], v[60:63]
    v_mfma_f32_16x16x32_bf16 v[96:99], a[228:231], a[44:47], v[96:99]
    ds_read_b64_tr_b16 a[228:229], v254 offset:0
    ds_read_b64_tr_b16 a[230:231], v254 offset:2048
    v_mfma_f32_16x16x32_bf16 v[28:31], a[232:235], a[12:15], v[28:31]
    v_mfma_f32_16x16x32_bf16 v[64:67], a[232:235], a[28:31], v[64:67]
    buffer_load_dwordx4 v[180:183], v14, s[32:35], s72 offen offset:1024 sc1
    v_mfma_f32_16x16x32_bf16 v[100:103], a[232:235], a[44:47], v[100:103]
    ds_read_b64_tr_b16 a[232:233], v255 offset:0
    ds_read_b64_tr_b16 a[234:235], v255 offset:2048
    v_mfma_f32_16x16x32_bf16 v[32:35], a[236:239], a[12:15], v[32:35]
    v_mfma_f32_16x16x32_bf16 v[68:71], a[236:239], a[28:31], v[68:71]
    v_mfma_f32_16x16x32_bf16 v[104:107], a[236:239], a[44:47], v[104:107]
    ds_read_b64_tr_b16 a[236:237], v252 offset:4096
    ds_read_b64_tr_b16 a[238:239], v252 offset:6144
    v_mfma_f32_16x16x32_bf16 v[36:39], a[240:243], a[12:15], v[36:39]
    v_mfma_f32_16x16x32_bf16 v[72:75], a[240:243], a[28:31], v[72:75]
    v_mfma_f32_16x16x32_bf16 v[108:111], a[240:243], a[44:47], v[108:111]
    ds_read_b64_tr_b16 a[240:241], v253 offset:4096
    ds_read_b64_tr_b16 a[242:243], v253 offset:6144
    v_mfma_f32_16x16x32_bf16 v[40:43], a[244:247], a[12:15], v[40:43]
    buffer_load_dwordx4 v[196:199], v14, s[32:35], s72 offen offset:2048 sc1
    v_mfma_f32_16x16x32_bf16 v[76:79], a[244:247], a[28:31], v[76:79]
    v_mfma_f32_16x16x32_bf16 v[112:115], a[244:247], a[44:47], v[112:115]
    ds_read_b64_tr_b16 a[244:245], v254 offset:4096
    ds_read_b64_tr_b16 a[246:247], v254 offset:6144
    s_waitcnt lgkmcnt(15)
    v_mfma_f32_16x16x32_bf16 v[44:47], a[248:251], a[12:15], v[44:47]
    v_mfma_f32_16x16x32_bf16 v[80:83], a[248:251], a[28:31], v[80:83]
    v_mfma_f32_16x16x32_bf16 v[116:119], a[248:251], a[44:47], v[116:119]
    ds_read_b64_tr_b16 a[248:249], v255 offset:4096
    ds_read_b64_tr_b16 a[250:251], v255 offset:6144
    s_waitcnt lgkmcnt(15)
    v_mfma_f32_16x16x32_bf16 v[48:51], a[252:255], a[12:15], v[48:51]
    v_mfma_f32_16x16x32_bf16 v[84:87], a[252:255], a[28:31], v[84:87]
    v_mfma_f32_16x16x32_bf16 v[120:123], a[252:255], a[44:47], v[120:123]
    ds_read_b64_tr_b16 a[252:253], v252 offset:8192
    ds_read_b64_tr_b16 a[254:255], v252 offset:10240
    s_barrier
    s_waitcnt lgkmcnt(4)
    s_waitcnt vmcnt(14)
    v_mfma_f32_16x16x32_bf16 v[16:19], a[220:223], a[60:63], v[16:19]
    s_add_u32 s74, s60, 32768
    v_add_u32 v252, s74, v1
    s_waitcnt vmcnt(13)
    v_mfma_f32_16x16x32_bf16 v[52:55], a[220:223], a[76:79], v[52:55]
    v_add_u32 v253, s74, v2
    v_add_u32 v254, s74, v3
    v_add_u32 v255, s74, v4
    s_waitcnt vmcnt(12)
    v_mfma_f32_16x16x32_bf16 v[88:91], a[220:223], a[92:95], v[88:91]
    ds_read_b64_tr_b16 a[220:221], v252 offset:0
    ds_read_b64_tr_b16 a[222:223], v252 offset:2048
    v_mfma_f32_16x16x32_bf16 v[20:23], a[224:227], a[60:63], v[20:23]
    s_add_u32 s72, s16, 9216
    buffer_load_dwordx4 v[212:215], v14, s[32:35], s72 offen offset:0 sc1
    v_mfma_f32_16x16x32_bf16 v[56:59], a[224:227], a[76:79], v[56:59]
    v_mfma_f32_16x16x32_bf16 v[92:95], a[224:227], a[92:95], v[92:95]
    ds_read_b64_tr_b16 a[224:225], v253 offset:0
    ds_read_b64_tr_b16 a[226:227], v253 offset:2048
    v_mfma_f32_16x16x32_bf16 v[24:27], a[228:231], a[60:63], v[24:27]
    v_mfma_f32_16x16x32_bf16 v[60:63], a[228:231], a[76:79], v[60:63]
    v_mfma_f32_16x16x32_bf16 v[96:99], a[228:231], a[92:95], v[96:99]
    ds_read_b64_tr_b16 a[228:229], v254 offset:0
    ds_read_b64_tr_b16 a[230:231], v254 offset:2048
    v_mfma_f32_16x16x32_bf16 v[28:31], a[232:235], a[60:63], v[28:31]
    v_mfma_f32_16x16x32_bf16 v[64:67], a[232:235], a[76:79], v[64:67]
    buffer_load_dwordx4 v[228:231], v14, s[32:35], s72 offen offset:1024 sc1
    v_mfma_f32_16x16x32_bf16 v[100:103], a[232:235], a[92:95], v[100:103]
    ds_read_b64_tr_b16 a[232:233], v255 offset:0
    ds_read_b64_tr_b16 a[234:235], v255 offset:2048
    v_mfma_f32_16x16x32_bf16 v[32:35], a[236:239], a[60:63], v[32:35]
    v_mfma_f32_16x16x32_bf16 v[68:71], a[236:239], a[76:79], v[68:71]
    v_mfma_f32_16x16x32_bf16 v[104:107], a[236:239], a[92:95], v[104:107]
    ds_read_b64_tr_b16 a[236:237], v252 offset:4096
    ds_read_b64_tr_b16 a[238:239], v252 offset:6144
    v_mfma_f32_16x16x32_bf16 v[36:39], a[240:243], a[60:63], v[36:39]
    v_mfma_f32_16x16x32_bf16 v[72:75], a[240:243], a[76:79], v[72:75]
    v_mfma_f32_16x16x32_bf16 v[108:111], a[240:243], a[92:95], v[108:111]
    ds_read_b64_tr_b16 a[240:241], v253 offset:4096
    ds_read_b64_tr_b16 a[242:243], v253 offset:6144
    v_mfma_f32_16x16x32_bf16 v[40:43], a[244:247], a[60:63], v[40:43]
    buffer_load_dwordx4 v[244:247], v14, s[32:35], s72 offen offset:2048 sc1
    v_mfma_f32_16x16x32_bf16 v[76:79], a[244:247], a[76:79], v[76:79]
    v_mfma_f32_16x16x32_bf16 v[112:115], a[244:247], a[92:95], v[112:115]
    ds_read_b64_tr_b16 a[244:245], v254 offset:4096
    ds_read_b64_tr_b16 a[246:247], v254 offset:6144
    s_waitcnt lgkmcnt(15)
    v_mfma_f32_16x16x32_bf16 v[44:47], a[248:251], a[60:63], v[44:47]
    v_mfma_f32_16x16x32_bf16 v[80:83], a[248:251], a[76:79], v[80:83]
    v_mfma_f32_16x16x32_bf16 v[116:119], a[248:251], a[92:95], v[116:119]
    ds_read_b64_tr_b16 a[248:249], v255 offset:4096
    ds_read_b64_tr_b16 a[250:251], v255 offset:6144
    s_waitcnt lgkmcnt(15)
    v_mfma_f32_16x16x32_bf16 v[48:51], a[252:255], a[60:63], v[48:51]
    v_mfma_f32_16x16x32_bf16 v[84:87], a[252:255], a[76:79], v[84:87]
    v_mfma_f32_16x16x32_bf16 v[120:123], a[252:255], a[92:95], v[120:123]
    ds_read_b64_tr_b16 a[252:253], v252 offset:8192
    ds_read_b64_tr_b16 a[254:255], v252 offset:10240
    s_waitcnt lgkmcnt(4)
    s_waitcnt vmcnt(11)
    v_mfma_f32_16x16x32_bf16 v[16:19], a[220:223], a[108:111], v[16:19]
    s_add_u32 s74, s59, 32768
    v_add_u32 v252, s74, v1
    s_waitcnt vmcnt(10)
    v_mfma_f32_16x16x32_bf16 v[52:55], a[220:223], a[124:127], v[52:55]
    v_add_u32 v253, s74, v2
    v_add_u32 v254, s74, v3
    v_add_u32 v255, s74, v4
    s_waitcnt vmcnt(9)
    v_mfma_f32_16x16x32_bf16 v[88:91], a[220:223], a[140:143], v[88:91]
    ds_read_b64_tr_b16 a[220:221], v252 offset:0
    ds_read_b64_tr_b16 a[222:223], v252 offset:2048
    v_mfma_f32_16x16x32_bf16 v[20:23], a[224:227], a[108:111], v[20:23]
    v_mfma_f32_16x16x32_bf16 v[56:59], a[224:227], a[124:127], v[56:59]
    v_mfma_f32_16x16x32_bf16 v[92:95], a[224:227], a[140:143], v[92:95]
    ds_read_b64_tr_b16 a[224:225], v253 offset:0
    ds_read_b64_tr_b16 a[226:227], v253 offset:2048
    v_mfma_f32_16x16x32_bf16 v[24:27], a[228:231], a[108:111], v[24:27]
    v_mfma_f32_16x16x32_bf16 v[60:63], a[228:231], a[124:127], v[60:63]
    v_mfma_f32_16x16x32_bf16 v[96:99], a[228:231], a[140:143], v[96:99]
    ds_read_b64_tr_b16 a[228:229], v254 offset:0
    ds_read_b64_tr_b16 a[230:231], v254 offset:2048
    v_mfma_f32_16x16x32_bf16 v[28:31], a[232:235], a[108:111], v[28:31]
    v_mfma_f32_16x16x32_bf16 v[64:67], a[232:235], a[124:127], v[64:67]
    v_mfma_f32_16x16x32_bf16 v[100:103], a[232:235], a[140:143], v[100:103]
    ds_read_b64_tr_b16 a[232:233], v255 offset:0
    ds_read_b64_tr_b16 a[234:235], v255 offset:2048
    v_mfma_f32_16x16x32_bf16 v[32:35], a[236:239], a[108:111], v[32:35]
    v_mfma_f32_16x16x32_bf16 v[68:71], a[236:239], a[124:127], v[68:71]
    v_mfma_f32_16x16x32_bf16 v[104:107], a[236:239], a[140:143], v[104:107]
    ds_read_b64_tr_b16 a[236:237], v252 offset:4096
    ds_read_b64_tr_b16 a[238:239], v252 offset:6144
    v_mfma_f32_16x16x32_bf16 v[36:39], a[240:243], a[108:111], v[36:39]
    v_mfma_f32_16x16x32_bf16 v[72:75], a[240:243], a[124:127], v[72:75]
    v_mfma_f32_16x16x32_bf16 v[108:111], a[240:243], a[140:143], v[108:111]
    ds_read_b64_tr_b16 a[240:241], v253 offset:4096
    ds_read_b64_tr_b16 a[242:243], v253 offset:6144
    v_mfma_f32_16x16x32_bf16 v[40:43], a[244:247], a[108:111], v[40:43]
    v_mfma_f32_16x16x32_bf16 v[76:79], a[244:247], a[124:127], v[76:79]
    v_mfma_f32_16x16x32_bf16 v[112:115], a[244:247], a[140:143], v[112:115]
    ds_read_b64_tr_b16 a[244:245], v254 offset:4096
    ds_read_b64_tr_b16 a[246:247], v254 offset:6144
    s_waitcnt lgkmcnt(15)
    v_mfma_f32_16x16x32_bf16 v[44:47], a[248:251], a[108:111], v[44:47]
    v_mfma_f32_16x16x32_bf16 v[80:83], a[248:251], a[124:127], v[80:83]
    v_mfma_f32_16x16x32_bf16 v[116:119], a[248:251], a[140:143], v[116:119]
    ds_read_b64_tr_b16 a[248:249], v255 offset:4096
    ds_read_b64_tr_b16 a[250:251], v255 offset:6144
    s_waitcnt lgkmcnt(15)
    v_mfma_f32_16x16x32_bf16 v[48:51], a[252:255], a[108:111], v[48:51]
    v_mfma_f32_16x16x32_bf16 v[84:87], a[252:255], a[124:127], v[84:87]
    v_mfma_f32_16x16x32_bf16 v[120:123], a[252:255], a[140:143], v[120:123]
    ds_read_b64_tr_b16 a[252:253], v252 offset:8192
    ds_read_b64_tr_b16 a[254:255], v252 offset:10240
    s_barrier
    s_waitcnt lgkmcnt(4)
    s_waitcnt vmcnt(8)
    v_mfma_f32_16x16x32_bf16 v[16:19], a[220:223], a[156:159], v[16:19]
    s_add_u32 s74, s60, 65536
    v_add_u32 v252, s74, v1
    s_waitcnt vmcnt(7)
    v_mfma_f32_16x16x32_bf16 v[52:55], a[220:223], a[172:175], v[52:55]
    v_add_u32 v253, s74, v2
    v_add_u32 v254, s74, v3
    v_add_u32 v255, s74, v4
    s_waitcnt vmcnt(6)
    v_mfma_f32_16x16x32_bf16 v[88:91], a[220:223], a[188:191], v[88:91]
    ds_read_b64_tr_b16 a[220:221], v252 offset:0
    ds_read_b64_tr_b16 a[222:223], v252 offset:2048
    v_mfma_f32_16x16x32_bf16 v[20:23], a[224:227], a[156:159], v[20:23]
    v_mfma_f32_16x16x32_bf16 v[56:59], a[224:227], a[172:175], v[56:59]
    v_mfma_f32_16x16x32_bf16 v[92:95], a[224:227], a[188:191], v[92:95]
    ds_read_b64_tr_b16 a[224:225], v253 offset:0
    ds_read_b64_tr_b16 a[226:227], v253 offset:2048
    v_mfma_f32_16x16x32_bf16 v[24:27], a[228:231], a[156:159], v[24:27]
    v_mfma_f32_16x16x32_bf16 v[60:63], a[228:231], a[172:175], v[60:63]
    v_mfma_f32_16x16x32_bf16 v[96:99], a[228:231], a[188:191], v[96:99]
    ds_read_b64_tr_b16 a[228:229], v254 offset:0
    ds_read_b64_tr_b16 a[230:231], v254 offset:2048
    v_mfma_f32_16x16x32_bf16 v[28:31], a[232:235], a[156:159], v[28:31]
    v_mfma_f32_16x16x32_bf16 v[64:67], a[232:235], a[172:175], v[64:67]
    v_mfma_f32_16x16x32_bf16 v[100:103], a[232:235], a[188:191], v[100:103]
    ds_read_b64_tr_b16 a[232:233], v255 offset:0
    ds_read_b64_tr_b16 a[234:235], v255 offset:2048
    v_mfma_f32_16x16x32_bf16 v[32:35], a[236:239], a[156:159], v[32:35]
    v_mfma_f32_16x16x32_bf16 v[68:71], a[236:239], a[172:175], v[68:71]
    v_mfma_f32_16x16x32_bf16 v[104:107], a[236:239], a[188:191], v[104:107]
    ds_read_b64_tr_b16 a[236:237], v252 offset:4096
    ds_read_b64_tr_b16 a[238:239], v252 offset:6144
    v_mfma_f32_16x16x32_bf16 v[36:39], a[240:243], a[156:159], v[36:39]
    v_mfma_f32_16x16x32_bf16 v[72:75], a[240:243], a[172:175], v[72:75]
    v_mfma_f32_16x16x32_bf16 v[108:111], a[240:243], a[188:191], v[108:111]
    ds_read_b64_tr_b16 a[240:241], v253 offset:4096
    ds_read_b64_tr_b16 a[242:243], v253 offset:6144
    v_mfma_f32_16x16x32_bf16 v[40:43], a[244:247], a[156:159], v[40:43]
    v_mfma_f32_16x16x32_bf16 v[76:79], a[244:247], a[172:175], v[76:79]
    v_mfma_f32_16x16x32_bf16 v[112:115], a[244:247], a[188:191], v[112:115]
    ds_read_b64_tr_b16 a[244:245], v254 offset:4096
    ds_read_b64_tr_b16 a[246:247], v254 offset:6144
    s_waitcnt lgkmcnt(15)
    v_mfma_f32_16x16x32_bf16 v[44:47], a[248:251], a[156:159], v[44:47]
    v_mfma_f32_16x16x32_bf16 v[80:83], a[248:251], a[172:175], v[80:83]
    v_mfma_f32_16x16x32_bf16 v[116:119], a[248:251], a[188:191], v[116:119]
    ds_read_b64_tr_b16 a[248:249], v255 offset:4096
    ds_read_b64_tr_b16 a[250:251], v255 offset:6144
    s_waitcnt lgkmcnt(15)
    v_mfma_f32_16x16x32_bf16 v[48:51], a[252:255], a[156:159], v[48:51]
    v_mfma_f32_16x16x32_bf16 v[84:87], a[252:255], a[172:175], v[84:87]
    v_mfma_f32_16x16x32_bf16 v[120:123], a[252:255], a[188:191], v[120:123]
    ds_read_b64_tr_b16 a[252:253], v252 offset:8192
    ds_read_b64_tr_b16 a[254:255], v252 offset:10240
    s_waitcnt lgkmcnt(4)
    s_waitcnt vmcnt(5)
    v_mfma_f32_16x16x32_bf16 v[16:19], a[220:223], v[164:167], v[16:19]
    s_add_u32 s74, s59, 65536
    v_add_u32 v252, s74, v1
    s_waitcnt vmcnt(4)
    v_mfma_f32_16x16x32_bf16 v[52:55], a[220:223], v[180:183], v[52:55]
    v_add_u32 v253, s74, v2
    v_add_u32 v254, s74, v3
    v_add_u32 v255, s74, v4
    s_waitcnt vmcnt(3)
    v_mfma_f32_16x16x32_bf16 v[88:91], a[220:223], v[196:199], v[88:91]
    ds_read_b64_tr_b16 a[220:221], v252 offset:0
    ds_read_b64_tr_b16 a[222:223], v252 offset:2048
    v_mfma_f32_16x16x32_bf16 v[20:23], a[224:227], v[164:167], v[20:23]
    v_mfma_f32_16x16x32_bf16 v[56:59], a[224:227], v[180:183], v[56:59]
    v_mfma_f32_16x16x32_bf16 v[92:95], a[224:227], v[196:199], v[92:95]
    ds_read_b64_tr_b16 a[224:225], v253 offset:0
    ds_read_b64_tr_b16 a[226:227], v253 offset:2048
    v_mfma_f32_16x16x32_bf16 v[24:27], a[228:231], v[164:167], v[24:27]
    v_mfma_f32_16x16x32_bf16 v[60:63], a[228:231], v[180:183], v[60:63]
    v_mfma_f32_16x16x32_bf16 v[96:99], a[228:231], v[196:199], v[96:99]
    ds_read_b64_tr_b16 a[228:229], v254 offset:0
    ds_read_b64_tr_b16 a[230:231], v254 offset:2048
    v_mfma_f32_16x16x32_bf16 v[28:31], a[232:235], v[164:167], v[28:31]
    v_mfma_f32_16x16x32_bf16 v[64:67], a[232:235], v[180:183], v[64:67]
    v_mfma_f32_16x16x32_bf16 v[100:103], a[232:235], v[196:199], v[100:103]
    ds_read_b64_tr_b16 a[232:233], v255 offset:0
    ds_read_b64_tr_b16 a[234:235], v255 offset:2048
    v_mfma_f32_16x16x32_bf16 v[32:35], a[236:239], v[164:167], v[32:35]
    v_mfma_f32_16x16x32_bf16 v[68:71], a[236:239], v[180:183], v[68:71]
    v_mfma_f32_16x16x32_bf16 v[104:107], a[236:239], v[196:199], v[104:107]
    ds_read_b64_tr_b16 a[236:237], v252 offset:4096
    ds_read_b64_tr_b16 a[238:239], v252 offset:6144
    v_mfma_f32_16x16x32_bf16 v[36:39], a[240:243], v[164:167], v[36:39]
    v_mfma_f32_16x16x32_bf16 v[72:75], a[240:243], v[180:183], v[72:75]
    v_mfma_f32_16x16x32_bf16 v[108:111], a[240:243], v[196:199], v[108:111]
    ds_read_b64_tr_b16 a[240:241], v253 offset:4096
    ds_read_b64_tr_b16 a[242:243], v253 offset:6144
    v_mfma_f32_16x16x32_bf16 v[40:43], a[244:247], v[164:167], v[40:43]
    v_mfma_f32_16x16x32_bf16 v[76:79], a[244:247], v[180:183], v[76:79]
    v_mfma_f32_16x16x32_bf16 v[112:115], a[244:247], v[196:199], v[112:115]
    ds_read_b64_tr_b16 a[244:245], v254 offset:4096
    ds_read_b64_tr_b16 a[246:247], v254 offset:6144
    s_waitcnt lgkmcnt(15)
    v_mfma_f32_16x16x32_bf16 v[44:47], a[248:251], v[164:167], v[44:47]
    v_mfma_f32_16x16x32_bf16 v[80:83], a[248:251], v[180:183], v[80:83]
    v_mfma_f32_16x16x32_bf16 v[116:119], a[248:251], v[196:199], v[116:119]
    ds_read_b64_tr_b16 a[248:249], v255 offset:4096
    ds_read_b64_tr_b16 a[250:251], v255 offset:6144
    s_waitcnt lgkmcnt(15)
    v_mfma_f32_16x16x32_bf16 v[48:51], a[252:255], v[164:167], v[48:51]
    v_mfma_f32_16x16x32_bf16 v[84:87], a[252:255], v[180:183], v[84:87]
    v_mfma_f32_16x16x32_bf16 v[120:123], a[252:255], v[196:199], v[120:123]
    ds_read_b64_tr_b16 a[252:253], v252 offset:8192
    ds_read_b64_tr_b16 a[254:255], v252 offset:10240
    s_waitcnt lgkmcnt(4)
    s_waitcnt vmcnt(2)
    v_mfma_f32_16x16x32_bf16 v[16:19], a[220:223], v[212:215], v[16:19]
    s_waitcnt vmcnt(1)
    v_mfma_f32_16x16x32_bf16 v[52:55], a[220:223], v[228:231], v[52:55]
    s_waitcnt vmcnt(0)
    v_mfma_f32_16x16x32_bf16 v[88:91], a[220:223], v[244:247], v[88:91]
    v_mfma_f32_16x16x32_bf16 v[20:23], a[224:227], v[212:215], v[20:23]
    v_mfma_f32_16x16x32_bf16 v[56:59], a[224:227], v[228:231], v[56:59]
    v_mfma_f32_16x16x32_bf16 v[92:95], a[224:227], v[244:247], v[92:95]
    v_mfma_f32_16x16x32_bf16 v[24:27], a[228:231], v[212:215], v[24:27]
    v_mfma_f32_16x16x32_bf16 v[60:63], a[228:231], v[228:231], v[60:63]
    v_mfma_f32_16x16x32_bf16 v[96:99], a[228:231], v[244:247], v[96:99]
    v_mfma_f32_16x16x32_bf16 v[28:31], a[232:235], v[212:215], v[28:31]
    v_mfma_f32_16x16x32_bf16 v[64:67], a[232:235], v[228:231], v[64:67]
    v_mfma_f32_16x16x32_bf16 v[100:103], a[232:235], v[244:247], v[100:103]
    v_mfma_f32_16x16x32_bf16 v[32:35], a[236:239], v[212:215], v[32:35]
    v_mfma_f32_16x16x32_bf16 v[68:71], a[236:239], v[228:231], v[68:71]
    v_mfma_f32_16x16x32_bf16 v[104:107], a[236:239], v[244:247], v[104:107]
    v_mfma_f32_16x16x32_bf16 v[36:39], a[240:243], v[212:215], v[36:39]
    v_mfma_f32_16x16x32_bf16 v[72:75], a[240:243], v[228:231], v[72:75]
    v_mfma_f32_16x16x32_bf16 v[108:111], a[240:243], v[244:247], v[108:111]
    v_mfma_f32_16x16x32_bf16 v[40:43], a[244:247], v[212:215], v[40:43]
    v_mfma_f32_16x16x32_bf16 v[76:79], a[244:247], v[228:231], v[76:79]
    v_mfma_f32_16x16x32_bf16 v[112:115], a[244:247], v[244:247], v[112:115]
    s_waitcnt lgkmcnt(2)
    v_mfma_f32_16x16x32_bf16 v[44:47], a[248:251], v[212:215], v[44:47]
    v_mfma_f32_16x16x32_bf16 v[80:83], a[248:251], v[228:231], v[80:83]
    v_mfma_f32_16x16x32_bf16 v[116:119], a[248:251], v[244:247], v[116:119]
    s_waitcnt lgkmcnt(0)
    v_mfma_f32_16x16x32_bf16 v[48:51], a[252:255], v[212:215], v[48:51]
    v_mfma_f32_16x16x32_bf16 v[84:87], a[252:255], v[228:231], v[84:87]
    v_mfma_f32_16x16x32_bf16 v[120:123], a[252:255], v[244:247], v[120:123]
    v_add_u32 v7, 98304, v14
    s_cmp_eq_u32 s56, s54
    s_cbranch_scc1 L_keep
    s_lshl_b32 s72, s49, 2
    s_add_u32 s72, s72, s55
    s_lshl_b32 s72, s72, 2
    s_add_u32 s72, s72, s56
    s_lshl_b32 s72, s72, 2
    s_add_u32 s72, s72, s54
    s_lshl_b32 s72, s72, 14
    s_add_u32 s72, s72, 33554432
    v_lshlrev_b32 v8, 3, v0
    v_cvt_pk_bf16_f32 v152, v16, v17
    v_cvt_pk_bf16_f32 v153, v18, v19
    v_cvt_pk_bf16_f32 v154, v20, v21
    v_cvt_pk_bf16_f32 v155, v22, v23
    buffer_store_dwordx4 v[152:155], v14, s[32:35], s72 offen offset:0 sc1
    v_cvt_pk_bf16_f32 v156, v24, v25
    v_cvt_pk_bf16_f32 v157, v26, v27
    v_cvt_pk_bf16_f32 v158, v28, v29
    v_cvt_pk_bf16_f32 v159, v30, v31
    buffer_store_dwordx4 v[156:159], v14, s[32:35], s72 offen offset:1024 sc1
    v_cvt_pk_bf16_f32 v160, v32, v33
    v_cvt_pk_bf16_f32 v161, v34, v35
    v_cvt_pk_bf16_f32 v162, v36, v37
    v_cvt_pk_bf16_f32 v163, v38, v39
    buffer_store_dwordx4 v[160:163], v14, s[32:35], s72 offen offset:2048 sc1
    v_cvt_pk_bf16_f32 v164, v40, v41
    v_cvt_pk_bf16_f32 v165, v42, v43
    v_cvt_pk_bf16_f32 v166, v44, v45
    v_cvt_pk_bf16_f32 v167, v46, v47
    buffer_store_dwordx4 v[164:167], v14, s[32:35], s72 offen offset:3072 sc1
    s_add_u32 s72, s72, 4096
    v_cvt_pk_bf16_f32 v168, v52, v53
    v_cvt_pk_bf16_f32 v169, v54, v55
    v_cvt_pk_bf16_f32 v170, v56, v57
    v_cvt_pk_bf16_f32 v171, v58, v59
    buffer_store_dwordx4 v[168:171], v14, s[32:35], s72 offen offset:0 sc1
    v_cvt_pk_bf16_f32 v172, v60, v61
    v_cvt_pk_bf16_f32 v173, v62, v63
    v_cvt_pk_bf16_f32 v174, v64, v65
    v_cvt_pk_bf16_f32 v175, v66, v67
    buffer_store_dwordx4 v[172:175], v14, s[32:35], s72 offen offset:1024 sc1
    v_cvt_pk_bf16_f32 v176, v68, v69
    v_cvt_pk_bf16_f32 v177, v70, v71
    v_cvt_pk_bf16_f32 v178, v72, v73
    v_cvt_pk_bf16_f32 v179, v74, v75
    buffer_store_dwordx4 v[176:179], v14, s[32:35], s72 offen offset:2048 sc1
    v_cvt_pk_bf16_f32 v180, v76, v77
    v_cvt_pk_bf16_f32 v181, v78, v79
    v_cvt_pk_bf16_f32 v182, v80, v81
    v_cvt_pk_bf16_f32 v183, v82, v83
    buffer_store_dwordx4 v[180:183], v14, s[32:35], s72 offen offset:3072 sc1
    s_add_u32 s72, s72, 4096
    v_cvt_pk_bf16_f32 v184, v88, v89
    v_cvt_pk_bf16_f32 v185, v90, v91
    v_cvt_pk_bf16_f32 v186, v92, v93
    v_cvt_pk_bf16_f32 v187, v94, v95
    buffer_store_dwordx4 v[184:187], v14, s[32:35], s72 offen offset:0 sc1
    v_cvt_pk_bf16_f32 v188, v96, v97
    v_cvt_pk_bf16_f32 v189, v98, v99
    v_cvt_pk_bf16_f32 v190, v100, v101
    v_cvt_pk_bf16_f32 v191, v102, v103
    buffer_store_dwordx4 v[188:191], v14, s[32:35], s72 offen offset:1024 sc1
    v_cvt_pk_bf16_f32 v192, v104, v105
    v_cvt_pk_bf16_f32 v193, v106, v107
    v_cvt_pk_bf16_f32 v194, v108, v109
    v_cvt_pk_bf16_f32 v195, v110, v111
    buffer_store_dwordx4 v[192:195], v14, s[32:35], s72 offen offset:2048 sc1
    v_cvt_pk_bf16_f32 v196, v112, v113
    v_cvt_pk_bf16_f32 v197, v114, v115
    v_cvt_pk_bf16_f32 v198, v116, v117
    v_cvt_pk_bf16_f32 v199, v118, v119
    buffer_store_dwordx4 v[196:199], v14, s[32:35], s72 offen offset:3072 sc1
    s_add_u32 s72, s72, 4096
    v_cvt_pk_bf16_f32 v200, v48, v49
    v_cvt_pk_bf16_f32 v201, v50, v51
    buffer_store_dwordx2 v[200:201], v8, s[32:35], s72 offen offset:0 sc1
    v_cvt_pk_bf16_f32 v202, v84, v85
    v_cvt_pk_bf16_f32 v203, v86, v87
    buffer_store_dwordx2 v[202:203], v8, s[32:35], s72 offen offset:512 sc1
    v_cvt_pk_bf16_f32 v204, v120, v121
    v_cvt_pk_bf16_f32 v205, v122, v123
    buffer_store_dwordx2 v[204:205], v8, s[32:35], s72 offen offset:1024 sc1
    s_branch L_join
L_keep:
    s_nop 7
    ds_write_b128 v7, v[16:19] offset:0
    ds_write_b128 v7, v[20:23] offset:1024
    ds_write_b128 v7, v[24:27] offset:2048
    ds_write_b128 v7, v[28:31] offset:3072
    ds_write_b128 v7, v[32:35] offset:4096
    ds_write_b128 v7, v[36:39] offset:5120
    ds_write_b128 v7, v[40:43] offset:6144
    ds_write_b128 v7, v[44:47] offset:7168
    ds_write_b128 v7, v[48:51] offset:8192
    ds_write_b128 v7, v[52:55] offset:9216
    ds_write_b128 v7, v[56:59] offset:10240
    ds_write_b128 v7, v[60:63] offset:11264
    ds_write_b128 v7, v[64:67] offset:12288
    ds_write_b128 v7, v[68:71] offset:13312
    ds_write_b128 v7, v[72:75] offset:14336
    ds_write_b128 v7, v[76:79] offset:15360
    ds_write_b128 v7, v[80:83] offset:16384
    ds_write_b128 v7, v[84:87] offset:17408
    ds_write_b128 v7, v[88:91] offset:18432
    ds_write_b128 v7, v[92:95] offset:19456
    ds_write_b128 v7, v[96:99] offset:20480
    ds_write_b128 v7, v[100:103] offset:21504
    ds_write_b128 v7, v[104:107] offset:22528
    ds_write_b128 v7, v[108:111] offset:23552
    ds_write_b128 v7, v[112:115] offset:24576
    ds_write_b128 v7, v[116:119] offset:25600
    ds_write_b128 v7, v[120:123] offset:26624
L_join:
    s_waitcnt vmcnt(0) lgkmcnt(0)
    s_barrier
    s_lshl_b32 s72, s57, 7
    s_add_u32 s72, s72, 50331652
    buffer_store_dword v249, v248, s[32:35], s72 offen sc1
    s_lshl_b32 s73, s48, 11
    s_min_u32 s74, s48, 2
    s_mul_i32 s75, s74, 9216
    s_add_u32 s75, s75, 8192
    v_add_u32 v8, s73, v7
    v_add_u32 v7, s75, v7
    ds_read_b128 v[16:19], v8 offset:0
    ds_read_b128 v[20:23], v8 offset:1024
    ds_read_b128 v[24:27], v8 offset:9216
    ds_read_b128 v[28:31], v8 offset:10240
    ds_read_b128 v[32:35], v8 offset:18432
    ds_read_b128 v[36:39], v8 offset:19456
    ds_read_b128 v[40:43], v7
    s_and_b32 s72, s57, 0xf3
    s_lshl_b32 s72, s72, 7
    s_add_u32 s72, s72, 50331652
    s_mov_b32 s75, 0x200000
L_spin2:
    buffer_load_dword v136, v251, s[32:35], s72 offen sc1
    s_waitcnt vmcnt(0)
    v_cmp_eq_u32 vcc, 1, v136
    s_nop 1
    s_cmp_eq_u64 vcc, exec
    s_cbranch_scc1 L_go2
    s_sub_u32 s75, s75, 1
    s_cmp_lg_u32 s75, 0
    s_cbranch_scc1 L_spin2
L_go2:
    s_lshl_b32 s72, s49, 2
    s_add_u32 s72, s72, s55
    s_lshl_b32 s72, s72, 2
    s_add_u32 s72, s72, s54
    s_lshl_b32 s72, s72, 16
    s_add_u32 s72, s72, 33554432
    s_lshl_b32 s73, s48, 10
    s_lshl_b32 s74, s74, 9
    s_add_u32 s74, s74, 12288
    v_add_u32 v7, s73, v14
    v_add_u32 v8, 4096, v7
    v_add_u32 v9, 8192, v7
    v_lshlrev_b32 v6, 3, v0
    v_add_u32 v6, s74, v6
    s_add_u32 s73, s54, 1
    s_and_b32 s73, s73, 3
    s_lshl_b32 s73, s73, 14
    s_add_u32 s73, s73, s72
    buffer_load_dwordx4 v[64:67], v7, s[32:35], s73 offen sc1
    buffer_load_dwordx4 v[68:71], v8, s[32:35], s73 offen sc1
    buffer_load_dwordx4 v[72:75], v9, s[32:35], s73 offen sc1
    buffer_load_dwordx2 v[76:77], v6, s[32:35], s73 offen sc1
    s_add_u32 s73, s54, 2
    s_and_b32 s73, s73, 3
    s_lshl_b32 s73, s73, 14
    s_add_u32 s73, s73, s72
    buffer_load_dwordx4 v[80:83], v7, s[32:35], s73 offen sc1
    buffer_load_dwordx4 v[84:87], v8, s[32:35], s73 offen sc1
    buffer_load_dwordx4 v[88:91], v9, s[32:35], s73 offen sc1
    buffer_load_dwordx2 v[92:93], v6, s[32:35], s73 offen sc1
    s_add_u32 s73, s54, 3
    s_and_b32 s73, s73, 3
    s_lshl_b32 s73, s73, 14
    s_add_u32 s73, s73, s72
    buffer_load_dwordx4 v[96:99], v7, s[32:35], s73 offen sc1
    buffer_load_dwordx4 v[100:103], v8, s[32:35], s73 offen sc1
    buffer_load_dwordx4 v[104:107], v9, s[32:35], s73 offen sc1
    buffer_load_dwordx2 v[108:109], v6, s[32:35], s73 offen sc1
    v_and_b32 v1, 15, v0
    v_mul_u32_u24 v1, 1152, v1
    v_lshrrev_b32 v2, 4, v0
    v_lshl_add_u32 v3, v2, 3, v1
    v_lshl_add_u32 v1, v2, 4, v1
    s_lshl_b32 s72, s49, 2
    s_add_u32 s72, s72, s54
    s_mul_i32 s72, s72, 55296
    s_mul_i32 s73, s55, 288
    s_add_u32 s72, s72, s73
    s_mul_i32 s74, s48, 18432
    s_add_u32 s74, s74, s72
    s_add_u32 s74, s74, 256
    s_cmp_eq_u32 s48, 3
    s_cselect_b32 s74, 0x40000000, s74
    s_lshl_b32 s73, s48, 6
    s_add_u32 s72, s72, s73
    s_waitcnt vmcnt(11)
    v_lshlrev_b32 v136, 16, v64
    v_and_b32 v137, 0xffff0000, v64
    s_waitcnt lgkmcnt(6)
    v_pk_add_f32 v[16:17], v[16:17], v[136:137]
    v_lshlrev_b32 v138, 16, v65
    v_and_b32 v139, 0xffff0000, v65
    v_pk_add_f32 v[18:19], v[18:19], v[138:139]
    v_lshlrev_b32 v136, 16, v66
    v_and_b32 v137, 0xffff0000, v66
    s_waitcnt lgkmcnt(5)
    v_pk_add_f32 v[20:21], v[20:21], v[136:137]
    v_lshlrev_b32 v138, 16, v67
    v_and_b32 v139, 0xffff0000, v67
    v_pk_add_f32 v[22:23], v[22:23], v[138:139]
    s_waitcnt vmcnt(10)
    v_lshlrev_b32 v136, 16, v68
    v_and_b32 v137, 0xffff0000, v68
    s_waitcnt lgkmcnt(4)
    v_pk_add_f32 v[24:25], v[24:25], v[136:137]
    v_lshlrev_b32 v138, 16, v69
    v_and_b32 v139, 0xffff0000, v69
    v_pk_add_f32 v[26:27], v[26:27], v[138:139]
    v_lshlrev_b32 v136, 16, v70
    v_and_b32 v137, 0xffff0000, v70
    s_waitcnt lgkmcnt(3)
    v_pk_add_f32 v[28:29], v[28:29], v[136:137]
    v_lshlrev_b32 v138, 16, v71
    v_and_b32 v139, 0xffff0000, v71
    v_pk_add_f32 v[30:31], v[30:31], v[138:139]
    s_waitcnt vmcnt(9)
    v_lshlrev_b32 v136, 16, v72
    v_and_b32 v137, 0xffff0000, v72
    s_waitcnt lgkmcnt(2)
    v_pk_add_f32 v[32:33], v[32:33], v[136:137]
    v_lshlrev_b32 v138, 16, v73
    v_and_b32 v139, 0xffff0000, v73
    v_pk_add_f32 v[34:35], v[34:35], v[138:139]
    v_lshlrev_b32 v136, 16, v74
    v_and_b32 v137, 0xffff0000, v74
    s_waitcnt lgkmcnt(1)
    v_pk_add_f32 v[36:37], v[36:37], v[136:137]
    v_lshlrev_b32 v138, 16, v75
    v_and_b32 v139, 0xffff0000, v75
    v_pk_add_f32 v[38:39], v[38:39], v[138:139]
    s_waitcnt vmcnt(8)
    v_lshlrev_b32 v136, 16, v76
    v_and_b32 v137, 0xffff0000, v76
    s_waitcnt lgkmcnt(0)
    v_pk_add_f32 v[40:41], v[40:41], v[136:137]
    v_lshlrev_b32 v138, 16, v77
    v_and_b32 v139, 0xffff0000, v77
    v_pk_add_f32 v[42:43], v[42:43], v[138:139]
    s_waitcnt vmcnt(7)
    v_lshlrev_b32 v136, 16, v80
    v_and_b32 v137, 0xffff0000, v80
    v_pk_add_f32 v[16:17], v[16:17], v[136:137]
    v_lshlrev_b32 v138, 16, v81
    v_and_b32 v139, 0xffff0000, v81
    v_pk_add_f32 v[18:19], v[18:19], v[138:139]
    v_lshlrev_b32 v136, 16, v82
    v_and_b32 v137, 0xffff0000, v82
    v_pk_add_f32 v[20:21], v[20:21], v[136:137]
    v_lshlrev_b32 v138, 16, v83
    v_and_b32 v139, 0xffff0000, v83
    v_pk_add_f32 v[22:23], v[22:23], v[138:139]
    s_waitcnt vmcnt(6)
    v_lshlrev_b32 v136, 16, v84
    v_and_b32 v137, 0xffff0000, v84
    v_pk_add_f32 v[24:25], v[24:25], v[136:137]
    v_lshlrev_b32 v138, 16, v85
    v_and_b32 v139, 0xffff0000, v85
    v_pk_add_f32 v[26:27], v[26:27], v[138:139]
    v_lshlrev_b32 v136, 16, v86
    v_and_b32 v137, 0xffff0000, v86
    v_pk_add_f32 v[28:29], v[28:29], v[136:137]
    v_lshlrev_b32 v138, 16, v87
    v_and_b32 v139, 0xffff0000, v87
    v_pk_add_f32 v[30:31], v[30:31], v[138:139]
    s_waitcnt vmcnt(5)
    v_lshlrev_b32 v136, 16, v88
    v_and_b32 v137, 0xffff0000, v88
    v_pk_add_f32 v[32:33], v[32:33], v[136:137]
    v_lshlrev_b32 v138, 16, v89
    v_and_b32 v139, 0xffff0000, v89
    v_pk_add_f32 v[34:35], v[34:35], v[138:139]
    v_lshlrev_b32 v136, 16, v90
    v_and_b32 v137, 0xffff0000, v90
    v_pk_add_f32 v[36:37], v[36:37], v[136:137]
    v_lshlrev_b32 v138, 16, v91
    v_and_b32 v139, 0xffff0000, v91
    v_pk_add_f32 v[38:39], v[38:39], v[138:139]
    s_waitcnt vmcnt(4)
    v_lshlrev_b32 v136, 16, v92
    v_and_b32 v137, 0xffff0000, v92
    v_pk_add_f32 v[40:41], v[40:41], v[136:137]
    v_lshlrev_b32 v138, 16, v93
    v_and_b32 v139, 0xffff0000, v93
    v_pk_add_f32 v[42:43], v[42:43], v[138:139]
    s_waitcnt vmcnt(3)
    v_lshlrev_b32 v136, 16, v96
    v_and_b32 v137, 0xffff0000, v96
    v_pk_add_f32 v[16:17], v[16:17], v[136:137]
    v_lshlrev_b32 v138, 16, v97
    v_and_b32 v139, 0xffff0000, v97
    v_pk_add_f32 v[18:19], v[18:19], v[138:139]
    v_lshlrev_b32 v136, 16, v98
    v_and_b32 v137, 0xffff0000, v98
    v_pk_add_f32 v[20:21], v[20:21], v[136:137]
    v_lshlrev_b32 v138, 16, v99
    v_and_b32 v139, 0xffff0000, v99
    v_pk_add_f32 v[22:23], v[22:23], v[138:139]
    s_waitcnt vmcnt(2)
    v_lshlrev_b32 v136, 16, v100
    v_and_b32 v137, 0xffff0000, v100
    v_pk_add_f32 v[24:25], v[24:25], v[136:137]
    v_lshlrev_b32 v138, 16, v101
    v_and_b32 v139, 0xffff0000, v101
    v_pk_add_f32 v[26:27], v[26:27], v[138:139]
    v_lshlrev_b32 v136, 16, v102
    v_and_b32 v137, 0xffff0000, v102
    v_pk_add_f32 v[28:29], v[28:29], v[136:137]
    v_lshlrev_b32 v138, 16, v103
    v_and_b32 v139, 0xffff0000, v103
    v_pk_add_f32 v[30:31], v[30:31], v[138:139]
    s_waitcnt vmcnt(1)
    v_lshlrev_b32 v136, 16, v104
    v_and_b32 v137, 0xffff0000, v104
    v_pk_add_f32 v[32:33], v[32:33], v[136:137]
    v_lshlrev_b32 v138, 16, v105
    v_and_b32 v139, 0xffff0000, v105
    v_pk_add_f32 v[34:35], v[34:35], v[138:139]
    v_lshlrev_b32 v136, 16, v106
    v_and_b32 v137, 0xffff0000, v106
    v_pk_add_f32 v[36:37], v[36:37], v[136:137]
    v_lshlrev_b32 v138, 16, v107
    v_and_b32 v139, 0xffff0000, v107
    v_pk_add_f32 v[38:39], v[38:39], v[138:139]
    s_waitcnt vmcnt(0)
    v_lshlrev_b32 v136, 16, v108
    v_and_b32 v137, 0xffff0000, v108
    v_pk_add_f32 v[40:41], v[40:41], v[136:137]
    v_lshlrev_b32 v138, 16, v109
    v_and_b32 v139, 0xffff0000, v109
    v_pk_add_f32 v[42:43], v[42:43], v[138:139]
    v_cvt_pk_bf16_f32 v152, v16, v17
    v_cvt_pk_bf16_f32 v153, v18, v19
    v_cvt_pk_bf16_f32 v154, v20, v21
    v_cvt_pk_bf16_f32 v155, v22, v23
    v_cvt_pk_bf16_f32 v156, v24, v25
    v_cvt_pk_bf16_f32 v157, v26, v27
    v_cvt_pk_bf16_f32 v158, v28, v29
    v_cvt_pk_bf16_f32 v159, v30, v31
    v_cvt_pk_bf16_f32 v160, v32, v33
    v_cvt_pk_bf16_f32 v161, v34, v35
    v_cvt_pk_bf16_f32 v162, v36, v37
    v_cvt_pk_bf16_f32 v163, v38, v39
    v_cvt_pk_bf16_f32 v164, v40, v41
    v_cvt_pk_bf16_f32 v165, v42, v43
    v_permlane32_swap_b32 v152, v154
    v_permlane32_swap_b32 v153, v155
    v_permlane32_swap_b32 v156, v158
    v_permlane32_swap_b32 v157, v159
    v_permlane32_swap_b32 v160, v162
    v_permlane32_swap_b32 v161, v163
    v_permlane16_swap_b32 v152, v154
    v_permlane16_swap_b32 v153, v155
    v_permlane16_swap_b32 v156, v158
    v_permlane16_swap_b32 v157, v159
    v_permlane16_swap_b32 v160, v162
    v_permlane16_swap_b32 v161, v163
    buffer_store_dwordx4 v[152:155], v1, s[40:43], s72 offen
    s_add_u32 s72, s72, 18432
    buffer_store_dwordx4 v[156:159], v1, s[40:43], s72 offen
    s_add_u32 s72, s72, 18432
    buffer_store_dwordx4 v[160:163], v1, s[40:43], s72 offen
    s_add_u32 s72, s72, 18432
    buffer_store_dwordx2 v[164:165], v3, s[40:43], s74 offen
L_end:
    s_endpgm
L_stub0_1:
    s_call_b64 s[70:71], L_rare0
    s_branch L_back0_1
L_stub2_1:
    s_call_b64 s[70:71], L_rare2
    s_branch L_back2_1
L_stub4_2:
    s_call_b64 s[70:71], L_rare4
    s_branch L_back4_2
L_stub0_2:
    s_call_b64 s[70:71], L_rare0
    s_branch L_back0_2
L_stub2_2:
    s_call_b64 s[70:71], L_rare2
    s_branch L_back2_2
L_stub4_3:
    s_call_b64 s[70:71], L_rare4
    s_branch L_back4_3
L_stub0_3:
    s_call_b64 s[70:71], L_rare0
    s_branch L_back0_3
L_stub2_3:
    s_call_b64 s[70:71], L_rare2
    s_branch L_back2_3
L_stub4_4:
    s_call_b64 s[70:71], L_rare4
    s_branch L_back4_4
L_stub0_4:
    s_call_b64 s[70:71], L_rare0
    s_branch L_back0_4
L_stub2_4:
    s_call_b64 s[70:71], L_rare2
    s_branch L_back2_4
L_stub4_5:
    s_call_b64 s[70:71], L_rare4
    s_branch L_back4_5
L_stub0_5:
    s_call_b64 s[70:71], L_rare0
    s_branch L_back0_5
L_stub2_5:
    s_call_b64 s[70:71], L_rare2
    s_branch L_back2_5
L_stub4_6:
    s_call_b64 s[70:71], L_rare4
    s_branch L_back4_6
L_stub0_6:
    s_call_b64 s[70:71], L_rare0
    s_branch L_back0_6
L_stub2_6:
    s_call_b64 s[70:71], L_rare2
    s_branch L_back2_6
L_stub4_7:
    s_call_b64 s[70:71], L_rare4
    s_branch L_back4_7
L_stub0_7:
    s_call_b64 s[70:71], L_rare0
    s_branch L_back0_7
L_stub2_7:
    s_call_b64 s[70:71], L_rare2
    s_branch L_back2_7
L_stub4_8:
    s_call_b64 s[70:71], L_rare4
    s_branch L_back4_8
L_stub0_8:
    s_call_b64 s[70:71], L_rare0
    s_branch L_back0_8
L_stub2_8:
    s_call_b64 s[70:71], L_rare2
    s_branch L_back2_8
L_stub4_9:
    s_call_b64 s[70:71], L_rare4
    s_branch L_back4_9
L_stub0_9:
    s_call_b64 s[70:71], L_rare0
    s_branch L_back0_9
L_stub2_9:
    s_call_b64 s[70:71], L_rare2
    s_branch L_back2_9
L_stub4_10:
    s_call_b64 s[70:71], L_rare4
    s_branch L_back4_10
L_stub0_10:
    s_call_b64 s[70:71], L_rare0
    s_branch L_back0_10
L_stub2_10:
    s_call_b64 s[70:71], L_rare2
    s_branch L_back2_10
L_stub4_11:
    s_call_b64 s[70:71], L_rare4
    s_branch L_back4_11
L_stub0_11:
    s_call_b64 s[70:71], L_rare0
    s_branch L_back0_11
L_stub2_11:
    s_call_b64 s[70:71], L_rare2
    s_branch L_back2_11
L_stub4_12:
    s_call_b64 s[70:71], L_rare4
    s_branch L_back4_12
L_stub0_12:
    s_call_b64 s[70:71], L_rare0
    s_branch L_back0_12
L_stub2_12:
    s_call_b64 s[70:71], L_rare2
    s_branch L_back2_12
L_stub4_13:
    s_call_b64 s[70:71], L_rare4
    s_branch L_back4_13
L_stub0_13:
    s_call_b64 s[70:71], L_rare0
    s_branch L_back0_13
L_stub2_13:
    s_call_b64 s[70:71], L_rare2
    s_branch L_back2_13
L_stub4_14:
    s_call_b64 s[70:71], L_rare4
    s_branch L_back4_14
L_stub0_14:
    s_call_b64 s[70:71], L_rare0
    s_branch L_back0_14
L_stub2_14:
    s_call_b64 s[70:71], L_rare2
    s_branch L_back2_14
L_stub4_15:
    s_call_b64 s[70:71], L_rare4
    s_branch L_back4_15
L_stub0_15:
    s_call_b64 s[70:71], L_rare0
    s_branch L_back0_15
L_stub2_15:
    s_call_b64 s[70:71], L_rare2
    s_branch L_back2_15
L_stub4_16:
    s_call_b64 s[70:71], L_rare4
    s_branch L_back4_16
L_stub0_16:
    s_call_b64 s[70:71], L_rare0
    s_branch L_back0_16
L_stub2_16:
    s_call_b64 s[70:71], L_rare2
    s_branch L_back2_16
L_stub4_17:
    s_call_b64 s[70:71], L_rare4
    s_branch L_back4_17
L_stub0_17:
    s_call_b64 s[70:71], L_rare0
    s_branch L_back0_17
L_stub2_17:
    s_call_b64 s[70:71], L_rare2
    s_branch L_back2_17
L_stub4_18:
    s_call_b64 s[70:71], L_rare4
    s_branch L_back4_18
L_stub0_18:
    s_call_b64 s[70:71], L_rare0
    s_branch L_back0_18
L_stub2_18:
    s_call_b64 s[70:71], L_rare2
    s_branch L_back2_18
L_stub4_19:
    s_call_b64 s[70:71], L_rare4
    s_branch L_back4_19
L_stub0_19:
    s_call_b64 s[70:71], L_rare0
    s_branch L_back0_19
L_stub2_19:
    s_call_b64 s[70:71], L_rare2
    s_branch L_back2_19
L_stub4_20:
    s_call_b64 s[70:71], L_rare4
    s_branch L_back4_20
L_stub0_20:
    s_call_b64 s[70:71], L_rare0
    s_branch L_back0_20
L_stub2_20:
    s_call_b64 s[70:71], L_rare2
    s_branch L_back2_20
L_stub4_21:
    s_call_b64 s[70:71], L_rare4
    s_branch L_back4_21
L_stub0_21:
    s_call_b64 s[70:71], L_rare0
    s_branch L_back0_21
L_stub2_21:
    s_call_b64 s[70:71], L_rare2
    s_branch L_back2_21
L_stub4_22:
    s_call_b64 s[70:71], L_rare4
    s_branch L_back4_22
L_stub0_22:
    s_call_b64 s[70:71], L_rare0
    s_branch L_back0_22
L_stub2_22:
    s_call_b64 s[70:71], L_rare2
    s_branch L_back2_22
L_stub4_23:
    s_call_b64 s[70:71], L_rare4
    s_branch L_back4_23
L_stub0_23:
    s_call_b64 s[70:71], L_rare0
    s_branch L_back0_23
L_stub2_23:
    s_call_b64 s[70:71], L_rare2
    s_branch L_back2_23
L_stub4_24:
    s_call_b64 s[70:71], L_rare4
    s_branch L_back4_24
L_stub0_24:
    s_call_b64 s[70:71], L_rare0
    s_branch L_back0_24
L_stub2_24:
    s_call_b64 s[70:71], L_rare2
    s_branch L_back2_24
L_stub4_25:
    s_call_b64 s[70:71], L_rare4
    s_branch L_back4_25
L_stub0_25:
    s_call_b64 s[70:71], L_rare0
    s_branch L_back0_25
L_stub2_25:
    s_call_b64 s[70:71], L_rare2
    s_branch L_back2_25
L_stub4_26:
    s_call_b64 s[70:71], L_rare4
    s_branch L_back4_26
L_stub0_26:
    s_call_b64 s[70:71], L_rare0
    s_branch L_back0_26
L_stub2_26:
    s_call_b64 s[70:71], L_rare2
    s_branch L_back2_26
L_stub4_27:
    s_call_b64 s[70:71], L_rare4
    s_branch L_back4_27
L_stub0_27:
    s_call_b64 s[70:71], L_rare0
    s_branch L_back0_27
L_stub2_27:
    s_call_b64 s[70:71], L_rare2
    s_branch L_back2_27
L_stub4_28:
    s_call_b64 s[70:71], L_rare4
    s_branch L_back4_28
L_stub0_28:
    s_call_b64 s[70:71], L_rare0
    s_branch L_back0_28
L_stub2_28:
    s_call_b64 s[70:71], L_rare2
    s_branch L_back2_28
L_stub4_29:
    s_call_b64 s[70:71], L_rare4
    s_branch L_back4_29
L_stub0_29:
    s_call_b64 s[70:71], L_rare0
    s_branch L_back0_29
L_stub2_29:
    s_call_b64 s[70:71], L_rare2
    s_branch L_back2_29
L_stub4_30:
    s_call_b64 s[70:71], L_rare4
    s_branch L_back4_30
L_stub0_30:
    s_call_b64 s[70:71], L_rare0
    s_branch L_back0_30
L_stub2_30:
    s_call_b64 s[70:71], L_rare2
    s_branch L_back2_30
L_stub4_31:
    s_call_b64 s[70:71], L_rare4
    s_branch L_back4_31
L_stub0_31:
    s_call_b64 s[70:71], L_rare0
    s_branch L_back0_31
L_stub2_31:
    s_call_b64 s[70:71], L_rare2
    s_branch L_back2_31
L_stub4_32:
    s_call_b64 s[70:71], L_rare4
    s_branch L_back4_32
L_rare0:
    v_max3_f32 v6, v40, v41, v42
    v_max3_f32 v6, v6, v43, v44
    v_max3_f32 v6, v6, v45, v46
    v_max_f32 v6, v6, v47
    v_mov_b32 v7, v6
    s_nop 1
    v_permlane32_swap_b32 v7, v6
    v_max_f32 v6, v6, v7
    v_mov_b32 v7, v6
    s_nop 1
    v_permlane16_swap_b32 v7, v6
    v_max_f32 v6, v6, v7
    v_max_f32 v6, 0, v6
    v_sub_f32 v40, v40, v6
    v_sub_f32 v41, v41, v6
    v_sub_f32 v42, v42, v6
    v_sub_f32 v43, v43, v6
    v_sub_f32 v44, v44, v6
    v_sub_f32 v45, v45, v6
    v_sub_f32 v46, v46, v6
    v_sub_f32 v47, v47, v6
    v_sub_f32 v16, v16, v6
    v_sub_f32 v17, v17, v6
    v_sub_f32 v18, v18, v6
    v_sub_f32 v19, v19, v6
    v_max_f32 v7, 0, v6
    v_sub_f32 v7, 0, v7
    v_exp_f32 v7, v7
    v_accvgpr_read_b32 v8, a192
    v_mul_f32 v8, v8, v7
    v_accvgpr_write_b32 a192, v8
    v_accvgpr_read_b32 v8, a193
    v_mul_f32 v8, v8, v7
    v_accvgpr_write_b32 a193, v8
    v_accvgpr_read_b32 v8, a194
    v_mul_f32 v8, v8, v7
    v_accvgpr_write_b32 a194, v8
    v_accvgpr_read_b32 v8, a195
    v_mul_f32 v8, v8, v7
    v_accvgpr_write_b32 a195, v8
    v_accvgpr_read_b32 v8, a0
    v_mul_f32 v8, v8, v7
    v_accvgpr_write_b32 a0, v8
    v_accvgpr_read_b32 v8, a1
    v_mul_f32 v8, v8, v7
    v_accvgpr_write_b32 a1, v8
    v_accvgpr_read_b32 v8, a2
    v_mul_f32 v8, v8, v7
    v_accvgpr_write_b32 a2, v8
    v_accvgpr_read_b32 v8, a3
    v_mul_f32 v8, v8, v7
    v_accvgpr_write_b32 a3, v8
    v_accvgpr_read_b32 v8, a4
    v_mul_f32 v8, v8, v7
    v_accvgpr_write_b32 a4, v8
    v_accvgpr_read_b32 v8, a5
    v_mul_f32 v8, v8, v7
    v_accvgpr_write_b32 a5, v8
    v_accvgpr_read_b32 v8, a6
    v_mul_f32 v8, v8, v7
    v_accvgpr_write_b32 a6, v8
    v_accvgpr_read_b32 v8, a7
    v_mul_f32 v8, v8, v7
    v_accvgpr_write_b32 a7, v8
    v_accvgpr_read_b32 v8, a8
    v_mul_f32 v8, v8, v7
    v_accvgpr_write_b32 a8, v8
    v_accvgpr_read_b32 v8, a9
    v_mul_f32 v8, v8, v7
    v_accvgpr_write_b32 a9, v8
    v_accvgpr_read_b32 v8, a10
    v_mul_f32 v8, v8, v7
    v_accvgpr_write_b32 a10, v8
    v_accvgpr_read_b32 v8, a11
    v_mul_f32 v8, v8, v7
    v_accvgpr_write_b32 a11, v8
    v_accvgpr_read_b32 v8, a12
    v_mul_f32 v8, v8, v7
    v_accvgpr_write_b32 a12, v8
    v_accvgpr_read_b32 v8, a13
    v_mul_f32 v8, v8, v7
    v_accvgpr_write_b32 a13, v8
    v_accvgpr_read_b32 v8, a14
    v_mul_f32 v8, v8, v7
    v_accvgpr_write_b32 a14, v8
    v_accvgpr_read_b32 v8, a15
    v_mul_f32 v8, v8, v7
    v_accvgpr_write_b32 a15, v8
    v_accvgpr_read_b32 v8, a16
    v_mul_f32 v8, v8, v7
    v_accvgpr_write_b32 a16, v8
    v_accvgpr_read_b32 v8, a17
    v_mul_f32 v8, v8, v7
    v_accvgpr_write_b32 a17, v8
    v_accvgpr_read_b32 v8, a18
    v_mul_f32 v8, v8, v7
    v_accvgpr_write_b32 a18, v8
    v_accvgpr_read_b32 v8, a19
    v_mul_f32 v8, v8, v7
    v_accvgpr_write_b32 a19, v8
    v_accvgpr_read_b32 v8, a20
    v_mul_f32 v8, v8, v7
    v_accvgpr_write_b32 a20, v8
    v_accvgpr_read_b32 v8, a21
    v_mul_f32 v8, v8, v7
    v_accvgpr_write_b32 a21, v8
    v_accvgpr_read_b32 v8, a22
    v_mul_f32 v8, v8, v7
    v_accvgpr_write_b32 a22, v8
    v_accvgpr_read_b32 v8, a23
    v_mul_f32 v8, v8, v7
    v_accvgpr_write_b32 a23, v8
    v_accvgpr_read_b32 v8, a24
    v_mul_f32 v8, v8, v7
    v_accvgpr_write_b32 a24, v8
    v_accvgpr_read_b32 v8, a25
    v_mul_f32 v8, v8, v7
    v_accvgpr_write_b32 a25, v8
    v_accvgpr_read_b32 v8, a26
    v_mul_f32 v8, v8, v7
    v_accvgpr_write_b32 a26, v8
    v_accvgpr_read_b32 v8, a27
    v_mul_f32 v8, v8, v7
    v_accvgpr_write_b32 a27, v8
    v_accvgpr_read_b32 v8, a28
    v_mul_f32 v8, v8, v7
    v_accvgpr_write_b32 a28, v8
    v_accvgpr_read_b32 v8, a29
    v_mul_f32 v8, v8, v7
    v_accvgpr_write_b32 a29, v8
    v_accvgpr_read_b32 v8, a30
    v_mul_f32 v8, v8, v7
    v_accvgpr_write_b32 a30, v8
    v_accvgpr_read_b32 v8, a31
    v_mul_f32 v8, v8, v7
    v_accvgpr_write_b32 a31, v8
    v_max3_f32 v6, v48, v49, v50
    v_max3_f32 v6, v6, v51, v52
    v_max3_f32 v6, v6, v53, v54
    v_max_f32 v6, v6, v55
    v_mov_b32 v7, v6
    s_nop 1
    v_permlane32_swap_b32 v7, v6
    v_max_f32 v6, v6, v7
    v_mov_b32 v7, v6
    s_nop 1
    v_permlane16_swap_b32 v7, v6
    v_max_f32 v6, v6, v7
    v_max_f32 v6, 0, v6
    v_sub_f32 v48, v48, v6
    v_sub_f32 v49, v49, v6
    v_sub_f32 v50, v50, v6
    v_sub_f32 v51, v51, v6
    v_sub_f32 v52, v52, v6
    v_sub_f32 v53, v53, v6
    v_sub_f32 v54, v54, v6
    v_sub_f32 v55, v55, v6
    v_sub_f32 v20, v20, v6
    v_sub_f32 v21, v21, v6
    v_sub_f32 v22, v22, v6
    v_sub_f32 v23, v23, v6
    v_max_f32 v7, 0, v6
    v_sub_f32 v7, 0, v7
    v_exp_f32 v7, v7
    v_accvgpr_read_b32 v8, a196
    v_mul_f32 v8, v8, v7
    v_accvgpr_write_b32 a196, v8
    v_accvgpr_read_b32 v8, a197
    v_mul_f32 v8, v8, v7
    v_accvgpr_write_b32 a197, v8
    v_accvgpr_read_b32 v8, a198
    v_mul_f32 v8, v8, v7
    v_accvgpr_write_b32 a198, v8
    v_accvgpr_read_b32 v8, a199
    v_mul_f32 v8, v8, v7
    v_accvgpr_write_b32 a199, v8
    v_accvgpr_read_b32 v8, a32
    v_mul_f32 v8, v8, v7
    v_accvgpr_write_b32 a32, v8
    v_accvgpr_read_b32 v8, a33
    v_mul_f32 v8, v8, v7
    v_accvgpr_write_b32 a33, v8
    v_accvgpr_read_b32 v8, a34
    v_mul_f32 v8, v8, v7
    v_accvgpr_write_b32 a34, v8
    v_accvgpr_read_b32 v8, a35
    v_mul_f32 v8, v8, v7
    v_accvgpr_write_b32 a35, v8
    v_accvgpr_read_b32 v8, a36
    v_mul_f32 v8, v8, v7
    v_accvgpr_write_b32 a36, v8
    v_accvgpr_read_b32 v8, a37
    v_mul_f32 v8, v8, v7
    v_accvgpr_write_b32 a37, v8
    v_accvgpr_read_b32 v8, a38
    v_mul_f32 v8, v8, v7
    v_accvgpr_write_b32 a38, v8
    v_accvgpr_read_b32 v8, a39
    v_mul_f32 v8, v8, v7
    v_accvgpr_write_b32 a39, v8
    v_accvgpr_read_b32 v8, a40
    v_mul_f32 v8, v8, v7
    v_accvgpr_write_b32 a40, v8
    v_accvgpr_read_b32 v8, a41
    v_mul_f32 v8, v8, v7
    v_accvgpr_write_b32 a41, v8
    v_accvgpr_read_b32 v8, a42
    v_mul_f32 v8, v8, v7
    v_accvgpr_write_b32 a42, v8
    v_accvgpr_read_b32 v8, a43
    v_mul_f32 v8, v8, v7
    v_accvgpr_write_b32 a43, v8
    v_accvgpr_read_b32 v8, a44
    v_mul_f32 v8, v8, v7
    v_accvgpr_write_b32 a44, v8
    v_accvgpr_read_b32 v8, a45
    v_mul_f32 v8, v8, v7
    v_accvgpr_write_b32 a45, v8
    v_accvgpr_read_b32 v8, a46
    v_mul_f32 v8, v8, v7
    v_accvgpr_write_b32 a46, v8
    v_accvgpr_read_b32 v8, a47
    v_mul_f32 v8, v8, v7
    v_accvgpr_write_b32 a47, v8
    v_accvgpr_read_b32 v8, a48
    v_mul_f32 v8, v8, v7
    v_accvgpr_write_b32 a48, v8
    v_accvgpr_read_b32 v8, a49
    v_mul_f32 v8, v8, v7
    v_accvgpr_write_b32 a49, v8
    v_accvgpr_read_b32 v8, a50
    v_mul_f32 v8, v8, v7
    v_accvgpr_write_b32 a50, v8
    v_accvgpr_read_b32 v8, a51
    v_mul_f32 v8, v8, v7
    v_accvgpr_write_b32 a51, v8
    v_accvgpr_read_b32 v8, a52
    v_mul_f32 v8, v8, v7
    v_accvgpr_write_b32 a52, v8
    v_accvgpr_read_b32 v8, a53
    v_mul_f32 v8, v8, v7
    v_accvgpr_write_b32 a53, v8
    v_accvgpr_read_b32 v8, a54
    v_mul_f32 v8, v8, v7
    v_accvgpr_write_b32 a54, v8
    v_accvgpr_read_b32 v8, a55
    v_mul_f32 v8, v8, v7
    v_accvgpr_write_b32 a55, v8
    v_accvgpr_read_b32 v8, a56
    v_mul_f32 v8, v8, v7
    v_accvgpr_write_b32 a56, v8
    v_accvgpr_read_b32 v8, a57
    v_mul_f32 v8, v8, v7
    v_accvgpr_write_b32 a57, v8
    v_accvgpr_read_b32 v8, a58
    v_mul_f32 v8, v8, v7
    v_accvgpr_write_b32 a58, v8
    v_accvgpr_read_b32 v8, a59
    v_mul_f32 v8, v8, v7
    v_accvgpr_write_b32 a59, v8
    v_accvgpr_read_b32 v8, a60
    v_mul_f32 v8, v8, v7
    v_accvgpr_write_b32 a60, v8
    v_accvgpr_read_b32 v8, a61
    v_mul_f32 v8, v8, v7
    v_accvgpr_write_b32 a61, v8
    v_accvgpr_read_b32 v8, a62
    v_mul_f32 v8, v8, v7
    v_accvgpr_write_b32 a62, v8
    v_accvgpr_read_b32 v8, a63
    v_mul_f32 v8, v8, v7
    v_accvgpr_write_b32 a63, v8
    s_setpc_b64 s[70:71]
L_rare2:
    v_max3_f32 v6, v56, v57, v58
    v_max3_f32 v6, v6, v59, v60
    v_max3_f32 v6, v6, v61, v62
    v_max_f32 v6, v6, v63
    v_mov_b32 v7, v6
    s_nop 1
    v_permlane32_swap_b32 v7, v6
    v_max_f32 v6, v6, v7
    v_mov_b32 v7, v6
    s_nop 1
    v_permlane16_swap_b32 v7, v6
    v_max_f32 v6, v6, v7
    v_max_f32 v6, 0, v6
    v_sub_f32 v56, v56, v6
    v_sub_f32 v57, v57, v6
    v_sub_f32 v58, v58, v6
    v_sub_f32 v59, v59, v6
    v_sub_f32 v60, v60, v6
    v_sub_f32 v61, v61, v6
    v_sub_f32 v62, v62, v6
    v_sub_f32 v63, v63, v6
    v_sub_f32 v24, v24, v6
    v_sub_f32 v25, v25, v6
    v_sub_f32 v26, v26, v6
    v_sub_f32 v27, v27, v6
    v_max_f32 v7, 0, v6
    v_sub_f32 v7, 0, v7
    v_exp_f32 v7, v7
    v_accvgpr_read_b32 v8, a200
    v_mul_f32 v8, v8, v7
    v_accvgpr_write_b32 a200, v8
    v_accvgpr_read_b32 v8, a201
    v_mul_f32 v8, v8, v7
    v_accvgpr_write_b32 a201, v8
    v_accvgpr_read_b32 v8, a202
    v_mul_f32 v8, v8, v7
    v_accvgpr_write_b32 a202, v8
    v_accvgpr_read_b32 v8, a203
    v_mul_f32 v8, v8, v7
    v_accvgpr_write_b32 a203, v8
    v_accvgpr_read_b32 v8, a64
    v_mul_f32 v8, v8, v7
    v_accvgpr_write_b32 a64, v8
    v_accvgpr_read_b32 v8, a65
    v_mul_f32 v8, v8, v7
    v_accvgpr_write_b32 a65, v8
    v_accvgpr_read_b32 v8, a66
    v_mul_f32 v8, v8, v7
    v_accvgpr_write_b32 a66, v8
    v_accvgpr_read_b32 v8, a67
    v_mul_f32 v8, v8, v7
    v_accvgpr_write_b32 a67, v8
    v_accvgpr_read_b32 v8, a68
    v_mul_f32 v8, v8, v7
    v_accvgpr_write_b32 a68, v8
    v_accvgpr_read_b32 v8, a69
    v_mul_f32 v8, v8, v7
    v_accvgpr_write_b32 a69, v8
    v_accvgpr_read_b32 v8, a70
    v_mul_f32 v8, v8, v7
    v_accvgpr_write_b32 a70, v8
    v_accvgpr_read_b32 v8, a71
    v_mul_f32 v8, v8, v7
    v_accvgpr_write_b32 a71, v8
    v_accvgpr_read_b32 v8, a72
    v_mul_f32 v8, v8, v7
    v_accvgpr_write_b32 a72, v8
    v_accvgpr_read_b32 v8, a73
    v_mul_f32 v8, v8, v7
    v_accvgpr_write_b32 a73, v8
    v_accvgpr_read_b32 v8, a74
    v_mul_f32 v8, v8, v7
    v_accvgpr_write_b32 a74, v8
    v_accvgpr_read_b32 v8, a75
    v_mul_f32 v8, v8, v7
    v_accvgpr_write_b32 a75, v8
    v_accvgpr_read_b32 v8, a76
    v_mul_f32 v8, v8, v7
    v_accvgpr_write_b32 a76, v8
    v_accvgpr_read_b32 v8, a77
    v_mul_f32 v8, v8, v7
    v_accvgpr_write_b32 a77, v8
    v_accvgpr_read_b32 v8, a78
    v_mul_f32 v8, v8, v7
    v_accvgpr_write_b32 a78, v8
    v_accvgpr_read_b32 v8, a79
    v_mul_f32 v8, v8, v7
    v_accvgpr_write_b32 a79, v8
    v_accvgpr_read_b32 v8, a80
    v_mul_f32 v8, v8, v7
    v_accvgpr_write_b32 a80, v8
    v_accvgpr_read_b32 v8, a81
    v_mul_f32 v8, v8, v7
    v_accvgpr_write_b32 a81, v8
    v_accvgpr_read_b32 v8, a82
    v_mul_f32 v8, v8, v7
    v_accvgpr_write_b32 a82, v8
    v_accvgpr_read_b32 v8, a83
    v_mul_f32 v8, v8, v7
    v_accvgpr_write_b32 a83, v8
    v_accvgpr_read_b32 v8, a84
    v_mul_f32 v8, v8, v7
    v_accvgpr_write_b32 a84, v8
    v_accvgpr_read_b32 v8, a85
    v_mul_f32 v8, v8, v7
    v_accvgpr_write_b32 a85, v8
    v_accvgpr_read_b32 v8, a86
    v_mul_f32 v8, v8, v7
    v_accvgpr_write_b32 a86, v8
    v_accvgpr_read_b32 v8, a87
    v_mul_f32 v8, v8, v7
    v_accvgpr_write_b32 a87, v8
    v_accvgpr_read_b32 v8, a88
    v_mul_f32 v8, v8, v7
    v_accvgpr_write_b32 a88, v8
    v_accvgpr_read_b32 v8, a89
    v_mul_f32 v8, v8, v7
    v_accvgpr_write_b32 a89, v8
    v_accvgpr_read_b32 v8, a90
    v_mul_f32 v8, v8, v7
    v_accvgpr_write_b32 a90, v8
    v_accvgpr_read_b32 v8, a91
    v_mul_f32 v8, v8, v7
    v_accvgpr_write_b32 a91, v8
    v_accvgpr_read_b32 v8, a92
    v_mul_f32 v8, v8, v7
    v_accvgpr_write_b32 a92, v8
    v_accvgpr_read_b32 v8, a93
    v_mul_f32 v8, v8, v7
    v_accvgpr_write_b32 a93, v8
    v_accvgpr_read_b32 v8, a94
    v_mul_f32 v8, v8, v7
    v_accvgpr_write_b32 a94, v8
    v_accvgpr_read_b32 v8, a95
    v_mul_f32 v8, v8, v7
    v_accvgpr_write_b32 a95, v8
    v_max3_f32 v6, v64, v65, v66
    v_max3_f32 v6, v6, v67, v68
    v_max3_f32 v6, v6, v69, v70
    v_max_f32 v6, v6, v71
    v_mov_b32 v7, v6
    s_nop 1
    v_permlane32_swap_b32 v7, v6
    v_max_f32 v6, v6, v7
    v_mov_b32 v7, v6
    s_nop 1
    v_permlane16_swap_b32 v7, v6
    v_max_f32 v6, v6, v7
    v_max_f32 v6, 0, v6
    v_sub_f32 v64, v64, v6
    v_sub_f32 v65, v65, v6
    v_sub_f32 v66, v66, v6
    v_sub_f32 v67, v67, v6
    v_sub_f32 v68, v68, v6
    v_sub_f32 v69, v69, v6
    v_sub_f32 v70, v70, v6
    v_sub_f32 v71, v71, v6
    v_sub_f32 v28, v28, v6
    v_sub_f32 v29, v29, v6
    v_sub_f32 v30, v30, v6
    v_sub_f32 v31, v31, v6
    v_max_f32 v7, 0, v6
    v_sub_f32 v7, 0, v7
    v_exp_f32 v7, v7
    v_accvgpr_read_b32 v8, a204
    v_mul_f32 v8, v8, v7
    v_accvgpr_write_b32 a204, v8
    v_accvgpr_read_b32 v8, a205
    v_mul_f32 v8, v8, v7
    v_accvgpr_write_b32 a205, v8
    v_accvgpr_read_b32 v8, a206
    v_mul_f32 v8, v8, v7
    v_accvgpr_write_b32 a206, v8
    v_accvgpr_read_b32 v8, a207
    v_mul_f32 v8, v8, v7
    v_accvgpr_write_b32 a207, v8
    v_accvgpr_read_b32 v8, a96
    v_mul_f32 v8, v8, v7
    v_accvgpr_write_b32 a96, v8
    v_accvgpr_read_b32 v8, a97
    v_mul_f32 v8, v8, v7
    v_accvgpr_write_b32 a97, v8
    v_accvgpr_read_b32 v8, a98
    v_mul_f32 v8, v8, v7
    v_accvgpr_write_b32 a98, v8
    v_accvgpr_read_b32 v8, a99
    v_mul_f32 v8, v8, v7
    v_accvgpr_write_b32 a99, v8
    v_accvgpr_read_b32 v8, a100
    v_mul_f32 v8, v8, v7
    v_accvgpr_write_b32 a100, v8
    v_accvgpr_read_b32 v8, a101
    v_mul_f32 v8, v8, v7
    v_accvgpr_write_b32 a101, v8
    v_accvgpr_read_b32 v8, a102
    v_mul_f32 v8, v8, v7
    v_accvgpr_write_b32 a102, v8
    v_accvgpr_read_b32 v8, a103
    v_mul_f32 v8, v8, v7
    v_accvgpr_write_b32 a103, v8
    v_accvgpr_read_b32 v8, a104
    v_mul_f32 v8, v8, v7
    v_accvgpr_write_b32 a104, v8
    v_accvgpr_read_b32 v8, a105
    v_mul_f32 v8, v8, v7
    v_accvgpr_write_b32 a105, v8
    v_accvgpr_read_b32 v8, a106
    v_mul_f32 v8, v8, v7
    v_accvgpr_write_b32 a106, v8
    v_accvgpr_read_b32 v8, a107
    v_mul_f32 v8, v8, v7
    v_accvgpr_write_b32 a107, v8
    v_accvgpr_read_b32 v8, a108
    v_mul_f32 v8, v8, v7
    v_accvgpr_write_b32 a108, v8
    v_accvgpr_read_b32 v8, a109
    v_mul_f32 v8, v8, v7
    v_accvgpr_write_b32 a109, v8
    v_accvgpr_read_b32 v8, a110
    v_mul_f32 v8, v8, v7
    v_accvgpr_write_b32 a110, v8
    v_accvgpr_read_b32 v8, a111
    v_mul_f32 v8, v8, v7
    v_accvgpr_write_b32 a111, v8
    v_accvgpr_read_b32 v8, a112
    v_mul_f32 v8, v8, v7
    v_accvgpr_write_b32 a112, v8
    v_accvgpr_read_b32 v8, a113
    v_mul_f32 v8, v8, v7
    v_accvgpr_write_b32 a113, v8
    v_accvgpr_read_b32 v8, a114
    v_mul_f32 v8, v8, v7
    v_accvgpr_write_b32 a114, v8
    v_accvgpr_read_b32 v8, a115
    v_mul_f32 v8, v8, v7
    v_accvgpr_write_b32 a115, v8
    v_accvgpr_read_b32 v8, a116
    v_mul_f32 v8, v8, v7
    v_accvgpr_write_b32 a116, v8
    v_accvgpr_read_b32 v8, a117
    v_mul_f32 v8, v8, v7
    v_accvgpr_write_b32 a117, v8
    v_accvgpr_read_b32 v8, a118
    v_mul_f32 v8, v8, v7
    v_accvgpr_write_b32 a118, v8
    v_accvgpr_read_b32 v8, a119
    v_mul_f32 v8, v8, v7
    v_accvgpr_write_b32 a119, v8
    v_accvgpr_read_b32 v8, a120
    v_mul_f32 v8, v8, v7
    v_accvgpr_write_b32 a120, v8
    v_accvgpr_read_b32 v8, a121
    v_mul_f32 v8, v8, v7
    v_accvgpr_write_b32 a121, v8
    v_accvgpr_read_b32 v8, a122
    v_mul_f32 v8, v8, v7
    v_accvgpr_write_b32 a122, v8
    v_accvgpr_read_b32 v8, a123
    v_mul_f32 v8, v8, v7
    v_accvgpr_write_b32 a123, v8
    v_accvgpr_read_b32 v8, a124
    v_mul_f32 v8, v8, v7
    v_accvgpr_write_b32 a124, v8
    v_accvgpr_read_b32 v8, a125
    v_mul_f32 v8, v8, v7
    v_accvgpr_write_b32 a125, v8
    v_accvgpr_read_b32 v8, a126
    v_mul_f32 v8, v8, v7
    v_accvgpr_write_b32 a126, v8
    v_accvgpr_read_b32 v8, a127
    v_mul_f32 v8, v8, v7
    v_accvgpr_write_b32 a127, v8
    s_setpc_b64 s[70:71]
L_rare4:
    v_max3_f32 v6, v72, v73, v74
    v_max3_f32 v6, v6, v75, v76
    v_max3_f32 v6, v6, v77, v78
    v_max_f32 v6, v6, v79
    v_mov_b32 v7, v6
    s_nop 1
    v_permlane32_swap_b32 v7, v6
    v_max_f32 v6, v6, v7
    v_mov_b32 v7, v6
    s_nop 1
    v_permlane16_swap_b32 v7, v6
    v_max_f32 v6, v6, v7
    v_max_f32 v6, 0, v6
    v_sub_f32 v72, v72, v6
    v_sub_f32 v73, v73, v6
    v_sub_f32 v74, v74, v6
    v_sub_f32 v75, v75, v6
    v_sub_f32 v76, v76, v6
    v_sub_f32 v77, v77, v6
    v_sub_f32 v78, v78, v6
    v_sub_f32 v79, v79, v6
    v_sub_f32 v32, v32, v6
    v_sub_f32 v33, v33, v6
    v_sub_f32 v34, v34, v6
    v_sub_f32 v35, v35, v6
    v_max_f32 v7, 0, v6
    v_sub_f32 v7, 0, v7
    v_exp_f32 v7, v7
    v_accvgpr_read_b32 v8, a208
    v_mul_f32 v8, v8, v7
    v_accvgpr_write_b32 a208, v8
    v_accvgpr_read_b32 v8, a209
    v_mul_f32 v8, v8, v7
    v_accvgpr_write_b32 a209, v8
    v_accvgpr_read_b32 v8, a210
    v_mul_f32 v8, v8, v7
    v_accvgpr_write_b32 a210, v8
    v_accvgpr_read_b32 v8, a211
    v_mul_f32 v8, v8, v7
    v_accvgpr_write_b32 a211, v8
    v_accvgpr_read_b32 v8, a128
    v_mul_f32 v8, v8, v7
    v_accvgpr_write_b32 a128, v8
    v_accvgpr_read_b32 v8, a129
    v_mul_f32 v8, v8, v7
    v_accvgpr_write_b32 a129, v8
    v_accvgpr_read_b32 v8, a130
    v_mul_f32 v8, v8, v7
    v_accvgpr_write_b32 a130, v8
    v_accvgpr_read_b32 v8, a131
    v_mul_f32 v8, v8, v7
    v_accvgpr_write_b32 a131, v8
    v_accvgpr_read_b32 v8, a132
    v_mul_f32 v8, v8, v7
    v_accvgpr_write_b32 a132, v8
    v_accvgpr_read_b32 v8, a133
    v_mul_f32 v8, v8, v7
    v_accvgpr_write_b32 a133, v8
    v_accvgpr_read_b32 v8, a134
    v_mul_f32 v8, v8, v7
    v_accvgpr_write_b32 a134, v8
    v_accvgpr_read_b32 v8, a135
    v_mul_f32 v8, v8, v7
    v_accvgpr_write_b32 a135, v8
    v_accvgpr_read_b32 v8, a136
    v_mul_f32 v8, v8, v7
    v_accvgpr_write_b32 a136, v8
    v_accvgpr_read_b32 v8, a137
    v_mul_f32 v8, v8, v7
    v_accvgpr_write_b32 a137, v8
    v_accvgpr_read_b32 v8, a138
    v_mul_f32 v8, v8, v7
    v_accvgpr_write_b32 a138, v8
    v_accvgpr_read_b32 v8, a139
    v_mul_f32 v8, v8, v7
    v_accvgpr_write_b32 a139, v8
    v_accvgpr_read_b32 v8, a140
    v_mul_f32 v8, v8, v7
    v_accvgpr_write_b32 a140, v8
    v_accvgpr_read_b32 v8, a141
    v_mul_f32 v8, v8, v7
    v_accvgpr_write_b32 a141, v8
    v_accvgpr_read_b32 v8, a142
    v_mul_f32 v8, v8, v7
    v_accvgpr_write_b32 a142, v8
    v_accvgpr_read_b32 v8, a143
    v_mul_f32 v8, v8, v7
    v_accvgpr_write_b32 a143, v8
    v_accvgpr_read_b32 v8, a144
    v_mul_f32 v8, v8, v7
    v_accvgpr_write_b32 a144, v8
    v_accvgpr_read_b32 v8, a145
    v_mul_f32 v8, v8, v7
    v_accvgpr_write_b32 a145, v8
    v_accvgpr_read_b32 v8, a146
    v_mul_f32 v8, v8, v7
    v_accvgpr_write_b32 a146, v8
    v_accvgpr_read_b32 v8, a147
    v_mul_f32 v8, v8, v7
    v_accvgpr_write_b32 a147, v8
    v_accvgpr_read_b32 v8, a148
    v_mul_f32 v8, v8, v7
    v_accvgpr_write_b32 a148, v8
    v_accvgpr_read_b32 v8, a149
    v_mul_f32 v8, v8, v7
    v_accvgpr_write_b32 a149, v8
    v_accvgpr_read_b32 v8, a150
    v_mul_f32 v8, v8, v7
    v_accvgpr_write_b32 a150, v8
    v_accvgpr_read_b32 v8, a151
    v_mul_f32 v8, v8, v7
    v_accvgpr_write_b32 a151, v8
    v_accvgpr_read_b32 v8, a152
    v_mul_f32 v8, v8, v7
    v_accvgpr_write_b32 a152, v8
    v_accvgpr_read_b32 v8, a153
    v_mul_f32 v8, v8, v7
    v_accvgpr_write_b32 a153, v8
    v_accvgpr_read_b32 v8, a154
    v_mul_f32 v8, v8, v7
    v_accvgpr_write_b32 a154, v8
    v_accvgpr_read_b32 v8, a155
    v_mul_f32 v8, v8, v7
    v_accvgpr_write_b32 a155, v8
    v_accvgpr_read_b32 v8, a156
    v_mul_f32 v8, v8, v7
    v_accvgpr_write_b32 a156, v8
    v_accvgpr_read_b32 v8, a157
    v_mul_f32 v8, v8, v7
    v_accvgpr_write_b32 a157, v8
    v_accvgpr_read_b32 v8, a158
    v_mul_f32 v8, v8, v7
    v_accvgpr_write_b32 a158, v8
    v_accvgpr_read_b32 v8, a159
    v_mul_f32 v8, v8, v7
    v_accvgpr_write_b32 a159, v8
    v_max3_f32 v6, v80, v81, v82
    v_max3_f32 v6, v6, v83, v84
    v_max3_f32 v6, v6, v85, v86
    v_max_f32 v6, v6, v87
    v_mov_b32 v7, v6
    s_nop 1
    v_permlane32_swap_b32 v7, v6
    v_max_f32 v6, v6, v7
    v_mov_b32 v7, v6
    s_nop 1
    v_permlane16_swap_b32 v7, v6
    v_max_f32 v6, v6, v7
    v_max_f32 v6, 0, v6
    v_sub_f32 v80, v80, v6
    v_sub_f32 v81, v81, v6
    v_sub_f32 v82, v82, v6
    v_sub_f32 v83, v83, v6
    v_sub_f32 v84, v84, v6
    v_sub_f32 v85, v85, v6
    v_sub_f32 v86, v86, v6
    v_sub_f32 v87, v87, v6
    v_sub_f32 v36, v36, v6
    v_sub_f32 v37, v37, v6
    v_sub_f32 v38, v38, v6
    v_sub_f32 v39, v39, v6
    v_max_f32 v7, 0, v6
    v_sub_f32 v7, 0, v7
    v_exp_f32 v7, v7
    v_accvgpr_read_b32 v8, a212
    v_mul_f32 v8, v8, v7
    v_accvgpr_write_b32 a212, v8
    v_accvgpr_read_b32 v8, a213
    v_mul_f32 v8, v8, v7
    v_accvgpr_write_b32 a213, v8
    v_accvgpr_read_b32 v8, a214
    v_mul_f32 v8, v8, v7
    v_accvgpr_write_b32 a214, v8
    v_accvgpr_read_b32 v8, a215
    v_mul_f32 v8, v8, v7
    v_accvgpr_write_b32 a215, v8
    v_accvgpr_read_b32 v8, a160
    v_mul_f32 v8, v8, v7
    v_accvgpr_write_b32 a160, v8
    v_accvgpr_read_b32 v8, a161
    v_mul_f32 v8, v8, v7
    v_accvgpr_write_b32 a161, v8
    v_accvgpr_read_b32 v8, a162
    v_mul_f32 v8, v8, v7
    v_accvgpr_write_b32 a162, v8
    v_accvgpr_read_b32 v8, a163
    v_mul_f32 v8, v8, v7
    v_accvgpr_write_b32 a163, v8
    v_accvgpr_read_b32 v8, a164
    v_mul_f32 v8, v8, v7
    v_accvgpr_write_b32 a164, v8
    v_accvgpr_read_b32 v8, a165
    v_mul_f32 v8, v8, v7
    v_accvgpr_write_b32 a165, v8
    v_accvgpr_read_b32 v8, a166
    v_mul_f32 v8, v8, v7
    v_accvgpr_write_b32 a166, v8
    v_accvgpr_read_b32 v8, a167
    v_mul_f32 v8, v8, v7
    v_accvgpr_write_b32 a167, v8
    v_accvgpr_read_b32 v8, a168
    v_mul_f32 v8, v8, v7
    v_accvgpr_write_b32 a168, v8
    v_accvgpr_read_b32 v8, a169
    v_mul_f32 v8, v8, v7
    v_accvgpr_write_b32 a169, v8
    v_accvgpr_read_b32 v8, a170
    v_mul_f32 v8, v8, v7
    v_accvgpr_write_b32 a170, v8
    v_accvgpr_read_b32 v8, a171
    v_mul_f32 v8, v8, v7
    v_accvgpr_write_b32 a171, v8
    v_accvgpr_read_b32 v8, a172
    v_mul_f32 v8, v8, v7
    v_accvgpr_write_b32 a172, v8
    v_accvgpr_read_b32 v8, a173
    v_mul_f32 v8, v8, v7
    v_accvgpr_write_b32 a173, v8
    v_accvgpr_read_b32 v8, a174
    v_mul_f32 v8, v8, v7
    v_accvgpr_write_b32 a174, v8
    v_accvgpr_read_b32 v8, a175
    v_mul_f32 v8, v8, v7
    v_accvgpr_write_b32 a175, v8
    v_accvgpr_read_b32 v8, a176
    v_mul_f32 v8, v8, v7
    v_accvgpr_write_b32 a176, v8
    v_accvgpr_read_b32 v8, a177
    v_mul_f32 v8, v8, v7
    v_accvgpr_write_b32 a177, v8
    v_accvgpr_read_b32 v8, a178
    v_mul_f32 v8, v8, v7
    v_accvgpr_write_b32 a178, v8
    v_accvgpr_read_b32 v8, a179
    v_mul_f32 v8, v8, v7
    v_accvgpr_write_b32 a179, v8
    v_accvgpr_read_b32 v8, a180
    v_mul_f32 v8, v8, v7
    v_accvgpr_write_b32 a180, v8
    v_accvgpr_read_b32 v8, a181
    v_mul_f32 v8, v8, v7
    v_accvgpr_write_b32 a181, v8
    v_accvgpr_read_b32 v8, a182
    v_mul_f32 v8, v8, v7
    v_accvgpr_write_b32 a182, v8
    v_accvgpr_read_b32 v8, a183
    v_mul_f32 v8, v8, v7
    v_accvgpr_write_b32 a183, v8
    v_accvgpr_read_b32 v8, a184
    v_mul_f32 v8, v8, v7
    v_accvgpr_write_b32 a184, v8
    v_accvgpr_read_b32 v8, a185
    v_mul_f32 v8, v8, v7
    v_accvgpr_write_b32 a185, v8
    v_accvgpr_read_b32 v8, a186
    v_mul_f32 v8, v8, v7
    v_accvgpr_write_b32 a186, v8
    v_accvgpr_read_b32 v8, a187
    v_mul_f32 v8, v8, v7
    v_accvgpr_write_b32 a187, v8
    v_accvgpr_read_b32 v8, a188
    v_mul_f32 v8, v8, v7
    v_accvgpr_write_b32 a188, v8
    v_accvgpr_read_b32 v8, a189
    v_mul_f32 v8, v8, v7
    v_accvgpr_write_b32 a189, v8
    v_accvgpr_read_b32 v8, a190
    v_mul_f32 v8, v8, v7
    v_accvgpr_write_b32 a190, v8
    v_accvgpr_read_b32 v8, a191
    v_mul_f32 v8, v8, v7
    v_accvgpr_write_b32 a191, v8
    s_setpc_b64 s[70:71]
L_last:
    s_endpgm
.section .rodata,"a"
.p2align 6
.amdhsa_kernel standalone__mha_block_cached__near_ridge_kernel
  .amdhsa_next_free_vgpr 512
  .amdhsa_next_free_sgpr 102
  .amdhsa_accum_offset 256
  .amdhsa_group_segment_fixed_size 0
  .amdhsa_kernarg_size 64
  .amdhsa_user_sgpr_count 2
  .amdhsa_user_sgpr_kernarg_segment_ptr 1
  .amdhsa_system_sgpr_workgroup_id_x 1
.end_amdhsa_kernel
```
